```python
import torch

def _softmax(x, axis=-1):
    return torch.softmax(x, dim=axis)

def _gelu(x):
    return torch.nn.functional.gelu(x, approximate='tanh')

def _silu(x):
    return torch.nn.functional.silu(x)

def _sigmoid(x):
    return torch.sigmoid(x)

def _layernorm(x, axis=-1, eps=1e-05):
    m = x.mean(dim=axis, keepdim=True)
    v = x.var(dim=axis, keepdim=True, unbiased=False)
    return (x - m) / torch.sqrt(v + eps)

def _scatter_add(tgt, idx, src, axis=0):
    return tgt.clone().index_add_(axis, idx, src)

def _segment_sum(src, seg, n):
    out = torch.zeros((n,) + src.shape[1:], dtype=src.dtype)
    return out.index_add_(0, seg, src)

def _pad(x, pw):
    flat = tuple((v for pair in reversed(pw) for v in pair))
    return torch.nn.functional.pad(x, flat)
kernel_name = 'adaLN_cond__memory_aug_recurrent_mem_tr__swiglu_ffn__prompt'

def setup_inputs():

    _w = lambda a: (lambda t: t.to(torch.bfloat16) if t.is_floating_point() else t)(torch.as_tensor(a))

    def _A_setup():
        B, S, Dm = (1, 2048, 576)
        H, Dh = (32, 128)
        M, seg = (8, 32)
        seg = min(seg, S)
        S = S // seg * seg
        return {'x': _w((lambda *s: torch.randn(*s, dtype=torch.bfloat16) * 0.05)(B, S, Dm)), 'mem0': _w((lambda *s: torch.randn(*s, dtype=torch.bfloat16) * 0.4)(B, M, Dm)), 'Wq': _w((lambda *s: torch.randn(*s, dtype=torch.bfloat16) * 3.2)(Dm, H, Dh) * Dm ** (-0.5)), 'Wk': _w((lambda *s: torch.randn(*s, dtype=torch.bfloat16) * 3.2)(Dm, H, Dh) * Dm ** (-0.5)), 'Wv': _w((lambda *s: torch.randn(*s, dtype=torch.bfloat16) * 0.4)(Dm, H, Dh) * Dm ** (-0.5)), 'Wo': _w((lambda *s: torch.randn(*s, dtype=torch.bfloat16) * 0.4)(H, Dh, Dm) * (H * Dh) ** (-0.5)), 'seg_len': seg}
    _A_in = _A_setup()

    def _B_setup():
        B, S, D, F = (1, 2048, 576, 4608)
        return {'x': _w((lambda *s: torch.randn(*s, dtype=torch.bfloat16) * 0.05)(B, S, D)), 'w_gate': _w((lambda *s: torch.randn(*s, dtype=torch.bfloat16) * 0.05)(D, F)), 'w_up': _w((lambda *s: torch.randn(*s, dtype=torch.bfloat16) * 0.05)(D, F)), 'w_down': _w((lambda *s: torch.randn(*s, dtype=torch.bfloat16) * 0.05)(F, D))}
    _B_in = _B_setup()
    return {'A_x': _A_in['x'], 'A_mem0': _A_in['mem0'], 'A_Wq': _A_in['Wq'], 'A_Wk': _A_in['Wk'], 'A_Wv': _A_in['Wv'], 'A_Wo': _A_in['Wo'], 'A_seg_len': _A_in['seg_len'], 'B_x': _B_in['x'], 'B_w_gate': _B_in['w_gate'], 'B_w_up': _B_in['w_up'], 'B_w_down': _B_in['w_down'], 'c': _w((lambda *s: torch.randn(*s, dtype=torch.bfloat16) * 0.1)(1, 576) * 8.0), 'w_mod': _w((lambda *s: torch.randn(*s, dtype=torch.bfloat16) * 0.1)(576, 6 * 576) * 576 ** (-0.5) * 8.0)}

def reference(A_x, A_mem0, A_Wq, A_Wk, A_Wv, A_Wo, A_seg_len, B_x, B_w_gate, B_w_up, B_w_down, c, w_mod):

    def _A_ref(x, mem0, Wq, Wk, Wv, Wo, seg_len):
        B, S, Dm = x.shape
        H, Dh = (Wq.shape[1], Wq.shape[2])
        M = mem0.shape[1]
        scale = Dh ** (-0.5)
        n_seg = S // seg_len
        L = M + seg_len
        idx = torch.arange(L)
        mask = (idx[:, None] < M) | (idx[:, None] >= idx[None, :])
        mem = mem0
        outs = []
        for s in range(n_seg):
            xs = x[:, s * seg_len:(s + 1) * seg_len, :].clone()
            h = torch.concatenate([mem, xs], axis=1)
            q = torch.einsum('btd,dhe->bhte', h, Wq)
            k = torch.einsum('btd,dhe->bhte', h, Wk)
            v = torch.einsum('btd,dhe->bhte', h, Wv)
            scores = torch.einsum('bhqe,bhke->bhqk', q, k) * scale
            scores = torch.where(mask[None, None], scores, -1000000000.0)
            p = _softmax(scores, axis=-1)
            o = torch.einsum('bhqk,bhke->bhqe', p, v)
            o = torch.einsum('bhte,hed->btd', o, Wo)
            mem = o[:, :M, :].clone()
            outs.append(o[:, M:, :])
        return torch.concatenate(outs, axis=1)

    def _B_ref(x, w_gate, w_up, w_down):
        g = _silu(x @ w_gate)
        u = x @ w_up
        return g * u @ w_down
    x = A_x
    mod = (_silu(c) @ w_mod).reshape(c.shape[0], 6, 1, -1)
    sa, ca, ga, sb, cb, gb = (mod[:, 0].clone(), mod[:, 1].clone(), mod[:, 2].clone(), mod[:, 3].clone(), mod[:, 4].clone(), mod[:, 5].clone())
    h = _layernorm(x, axis=-1) * (1 + ca) + sa
    x = x + ga * _A_ref(h, A_mem0, A_Wq, A_Wk, A_Wv, A_Wo, A_seg_len)
    h = _layernorm(x, axis=-1) * (1 + cb) + sb
    x = x + gb * _B_ref(h, B_w_gate, B_w_up, B_w_down)
    return x
```

```asm
; @launch grid=(256,1,1) block=(256,1,1) lds=163840
.amdgcn_target "amdgcn-amd-amdhsa--gfx950"
.text
.globl adaLN_cond__memory_aug_recurrent_mem_tr__swiglu_ffn__prompt_kernel
.p2align 8
.type adaLN_cond__memory_aug_recurrent_mem_tr__swiglu_ffn__prompt_kernel,@function
adaLN_cond__memory_aug_recurrent_mem_tr__swiglu_ffn__prompt_kernel:
    s_cmp_ge_u32 s2, 256
    s_cbranch_scc1 L_exit
    s_load_dwordx4 s[4:7], s[0:1], 112
    s_getpc_b64 s[14:15]
L_code0:
    s_lshr_b32 s12, s2, 3
    s_lshl_b32 s12, s12, 12
    v_lshl_add_u32 v1, v0, 4, s12
    v_min_u32 v1, L_code_end-L_code0-4, v1
    v_and_b32 v2, 3, v0
    v_cmp_eq_u32 vcc, 0, v2
    s_mov_b64 exec, vcc
    global_load_dword v63, v1, s[14:15]
    s_mov_b64 exec, -1
    s_getreg_b32 s3, hwreg(HW_REG_XCC_ID, 0, 4)
    v_lshrrev_b32 v1, 6, v0
    s_nop 0
    v_readfirstlane_b32 s10, v1
    s_and_b32 s8, s2, 7
    s_lshl_b32 s8, s8, 2
    s_lshr_b32 s8, 0x47615320, s8
    s_and_b32 s8, s8, 7
    s_lshr_b32 s9, s2, 3
    v_and_b32 v1, 63, v0
    s_waitcnt lgkmcnt(0)
    s_mov_b64 s[12:13], s[4:5]
    s_mov_b64 s[4:5], s[6:7]
    s_mov_b64 s[6:7], s[12:13]
    s_cmp_lg_u32 s10, 3
    s_cbranch_scc1 L_pre_1
    s_lshl_b32 s12, s2, 8
    s_add_u32 s12, s12, 65536
    v_lshl_add_u32 v2, v1, 2, s12
    v_mov_b32 v3, 0
    global_store_dword v2, v3, s[4:5] sc1
    s_bfe_u32 s12, s2, 65536
    s_xor_b32 s12, s12, 1
    v_mov_b32 v4, s12
    v_mov_b32 v5, s12
    v_mov_b32 v6, s12
    v_mov_b32 v7, s12
    s_lshl_b32 s12, s2, 10
    s_add_u32 s12, s12, 60817408
    v_lshl_add_u32 v2, v1, 4, s12
    global_store_dwordx4 v2, v[4:7], s[4:5] sc1
    v_mov_b32 v8, -1
    v_mov_b32 v9, -1
    v_mov_b32 v10, -1
    v_mov_b32 v11, -1
    s_cmp_ge_u32 s2, 32
    s_cbranch_scc1 L_pre1_2
    s_bfe_u32 s12, s2, 0x10001
    s_xor_b32 s12, s12, 1
    v_mov_b32 v12, s12
    v_mov_b32 v13, s12
    v_mov_b32 v14, s12
    v_mov_b32 v15, s12
    v_add_u32 v3, 0x40000, v2
    global_store_dwordx4 v3, v[12:15], s[4:5] sc1
L_pre1_2:
    v_add_u32 v3, 1048576, v2
    global_store_dwordx4 v3, v[8:11], s[4:5] sc1
    s_mul_i32 s12, s3, s3
    s_lshl_b32 s12, s12, 10
    s_add_u32 s12, s12, s3
    s_lshl_b32 s12, s12, 8
    s_add_u32 s12, s12, 1
    v_mov_b32 v3, s12
    s_and_b32 s12, s8, 3
    s_lshr_b32 s13, s8, 2
    s_lshl_b32 s13, s13, 5
    s_add_u32 s12, s12, s13
    s_lshl_b32 s12, s12, 2
    v_mov_b32 v2, s12
    s_waitcnt vmcnt(0)
    s_mov_b64 exec, 1
    global_atomic_add v2, v3, s[6:7] sc1
    s_mov_b64 exec, -1
L_pre_1:
L_roles:
    s_cmp_eq_u32 s8, 0
    s_cbranch_scc1 L_role_r
    s_cmp_eq_u32 s8, 1
    s_cbranch_scc1 L_role_kv
    s_cmp_lt_u32 s8, 5
    s_cbranch_scc1 L_role_a
    s_mul_i32 s14, s9, 3
    s_add_u32 s14, s14, s8
    s_sub_u32 s14, s14, 5
    s_load_dwordx2 s[16:17], s[0:1], 0
    s_lshl_b32 s15, s14, 2
    s_add_u32 s15, s15, s10
    s_mul_hi_u32 s20, s15, 0x55555556
    s_mul_i32 s21, s20, 3
    s_sub_u32 s21, s15, s21
    v_mov_b32 v2, 0x0
    v_bfe_u32 v1, v0, 0, 4
    v_mul_u32_u24 v1, 0x480, v1
    v_add_u32 v2, v2, v1
    v_bfe_u32 v1, v0, 4, 2
    v_lshl_add_u32 v2, v1, 4, v2
    v_mov_b32 v3, 0x0
    v_bfe_u32 v1, v0, 4, 2
    v_lshl_add_u32 v3, v1, 4, v3
    v_mov_b32 v4, 0x0
    v_bfe_u32 v1, v0, 0, 6
    v_lshl_add_u32 v4, v1, 4, v4
    s_mul_i32 s12, s20, 18432
    s_waitcnt lgkmcnt(0)
    s_add_u32 s16, s16, s12
    s_addc_u32 s17, s17, 0
    s_mul_i32 s13, s21, 6144
    s_add_u32 s12, s12, s13
    s_add_u32 s12, s12, 1050624
    s_add_u32 s18, s4, s12
    s_addc_u32 s19, s5, 0
    s_mul_i32 s22, s21, 384
    v_add_u32 v3, s22, v3
    s_add_u32 s12, s16, s22
    s_addc_u32 s13, s17, 0
    global_load_dwordx4 v[160:163], v2, s[12:13] offset:0
    global_load_dwordx4 v[164:167], v2, s[12:13] offset:64
    global_load_dwordx4 v[168:171], v2, s[12:13] offset:128
    global_load_dwordx4 v[172:175], v2, s[12:13] offset:192
    global_load_dwordx4 v[176:179], v2, s[12:13] offset:256
    global_load_dwordx4 v[180:183], v2, s[12:13] offset:320
    s_add_u32 s22, s22, 384
    s_cmp_eq_u32 s22, 1152
    s_cselect_b32 s22, 0, s22
    s_add_u32 s12, s16, s22
    s_addc_u32 s13, s17, 0
    global_load_dwordx4 v[184:187], v2, s[12:13] offset:0
    global_load_dwordx4 v[188:191], v2, s[12:13] offset:64
    global_load_dwordx4 v[192:195], v2, s[12:13] offset:128
    global_load_dwordx4 v[196:199], v2, s[12:13] offset:192
    global_load_dwordx4 v[200:203], v2, s[12:13] offset:256
    global_load_dwordx4 v[204:207], v2, s[12:13] offset:320
    s_add_u32 s22, s22, 384
    s_cmp_eq_u32 s22, 1152
    s_cselect_b32 s22, 0, s22
    s_add_u32 s12, s16, s22
    s_addc_u32 s13, s17, 0
    global_load_dwordx4 v[208:211], v2, s[12:13] offset:0
    global_load_dwordx4 v[212:215], v2, s[12:13] offset:64
    global_load_dwordx4 v[216:219], v2, s[12:13] offset:128
    global_load_dwordx4 v[220:223], v2, s[12:13] offset:192
    global_load_dwordx4 v[224:227], v2, s[12:13] offset:256
    global_load_dwordx4 v[228:231], v2, s[12:13] offset:320
    v_mov_b64 v[6:7], 0
    s_waitcnt vmcnt(17)
    v_lshlrev_b32 v16, 16, v160
    v_and_b32 v17, 0xffff0000, v160
    v_pk_add_f32 v[6:7], v[6:7], v[16:17]
    v_lshlrev_b32 v18, 16, v161
    v_and_b32 v19, 0xffff0000, v161
    v_pk_add_f32 v[6:7], v[6:7], v[18:19]
    v_lshlrev_b32 v20, 16, v162
    v_and_b32 v21, 0xffff0000, v162
    v_pk_add_f32 v[6:7], v[6:7], v[20:21]
    v_lshlrev_b32 v22, 16, v163
    v_and_b32 v23, 0xffff0000, v163
    v_pk_add_f32 v[6:7], v[6:7], v[22:23]
    s_waitcnt vmcnt(16)
    v_lshlrev_b32 v24, 16, v164
    v_and_b32 v25, 0xffff0000, v164
    v_pk_add_f32 v[6:7], v[6:7], v[24:25]
    v_lshlrev_b32 v26, 16, v165
    v_and_b32 v27, 0xffff0000, v165
    v_pk_add_f32 v[6:7], v[6:7], v[26:27]
    v_lshlrev_b32 v28, 16, v166
    v_and_b32 v29, 0xffff0000, v166
    v_pk_add_f32 v[6:7], v[6:7], v[28:29]
    v_lshlrev_b32 v30, 16, v167
    v_and_b32 v31, 0xffff0000, v167
    v_pk_add_f32 v[6:7], v[6:7], v[30:31]
    s_waitcnt vmcnt(15)
    v_lshlrev_b32 v32, 16, v168
    v_and_b32 v33, 0xffff0000, v168
    v_pk_add_f32 v[6:7], v[6:7], v[32:33]
    v_lshlrev_b32 v34, 16, v169
    v_and_b32 v35, 0xffff0000, v169
    v_pk_add_f32 v[6:7], v[6:7], v[34:35]
    v_lshlrev_b32 v36, 16, v170
    v_and_b32 v37, 0xffff0000, v170
    v_pk_add_f32 v[6:7], v[6:7], v[36:37]
    v_lshlrev_b32 v38, 16, v171
    v_and_b32 v39, 0xffff0000, v171
    v_pk_add_f32 v[6:7], v[6:7], v[38:39]
    s_waitcnt vmcnt(14)
    v_lshlrev_b32 v40, 16, v172
    v_and_b32 v41, 0xffff0000, v172
    v_pk_add_f32 v[6:7], v[6:7], v[40:41]
    v_lshlrev_b32 v42, 16, v173
    v_and_b32 v43, 0xffff0000, v173
    v_pk_add_f32 v[6:7], v[6:7], v[42:43]
    v_lshlrev_b32 v44, 16, v174
    v_and_b32 v45, 0xffff0000, v174
    v_pk_add_f32 v[6:7], v[6:7], v[44:45]
    v_lshlrev_b32 v46, 16, v175
    v_and_b32 v47, 0xffff0000, v175
    v_pk_add_f32 v[6:7], v[6:7], v[46:47]
    s_waitcnt vmcnt(13)
    v_lshlrev_b32 v48, 16, v176
    v_and_b32 v49, 0xffff0000, v176
    v_pk_add_f32 v[6:7], v[6:7], v[48:49]
    v_lshlrev_b32 v50, 16, v177
    v_and_b32 v51, 0xffff0000, v177
    v_pk_add_f32 v[6:7], v[6:7], v[50:51]
    v_lshlrev_b32 v52, 16, v178
    v_and_b32 v53, 0xffff0000, v178
    v_pk_add_f32 v[6:7], v[6:7], v[52:53]
    v_lshlrev_b32 v54, 16, v179
    v_and_b32 v55, 0xffff0000, v179
    v_pk_add_f32 v[6:7], v[6:7], v[54:55]
    s_waitcnt vmcnt(12)
    v_lshlrev_b32 v56, 16, v180
    v_and_b32 v57, 0xffff0000, v180
    v_pk_add_f32 v[6:7], v[6:7], v[56:57]
    v_lshlrev_b32 v58, 16, v181
    v_and_b32 v59, 0xffff0000, v181
    v_pk_add_f32 v[6:7], v[6:7], v[58:59]
    v_lshlrev_b32 v60, 16, v182
    v_and_b32 v61, 0xffff0000, v182
    v_pk_add_f32 v[6:7], v[6:7], v[60:61]
    v_lshlrev_b32 v62, 16, v183
    v_and_b32 v63, 0xffff0000, v183
    v_pk_add_f32 v[6:7], v[6:7], v[62:63]
    s_waitcnt vmcnt(11)
    v_lshlrev_b32 v64, 16, v184
    v_and_b32 v65, 0xffff0000, v184
    v_pk_add_f32 v[6:7], v[6:7], v[64:65]
    v_lshlrev_b32 v66, 16, v185
    v_and_b32 v67, 0xffff0000, v185
    v_pk_add_f32 v[6:7], v[6:7], v[66:67]
    v_lshlrev_b32 v68, 16, v186
    v_and_b32 v69, 0xffff0000, v186
    v_pk_add_f32 v[6:7], v[6:7], v[68:69]
    v_lshlrev_b32 v70, 16, v187
    v_and_b32 v71, 0xffff0000, v187
    v_pk_add_f32 v[6:7], v[6:7], v[70:71]
    s_waitcnt vmcnt(10)
    v_lshlrev_b32 v72, 16, v188
    v_and_b32 v73, 0xffff0000, v188
    v_pk_add_f32 v[6:7], v[6:7], v[72:73]
    v_lshlrev_b32 v74, 16, v189
    v_and_b32 v75, 0xffff0000, v189
    v_pk_add_f32 v[6:7], v[6:7], v[74:75]
    v_lshlrev_b32 v76, 16, v190
    v_and_b32 v77, 0xffff0000, v190
    v_pk_add_f32 v[6:7], v[6:7], v[76:77]
    v_lshlrev_b32 v78, 16, v191
    v_and_b32 v79, 0xffff0000, v191
    v_pk_add_f32 v[6:7], v[6:7], v[78:79]
    s_waitcnt vmcnt(9)
    v_lshlrev_b32 v80, 16, v192
    v_and_b32 v81, 0xffff0000, v192
    v_pk_add_f32 v[6:7], v[6:7], v[80:81]
    v_lshlrev_b32 v82, 16, v193
    v_and_b32 v83, 0xffff0000, v193
    v_pk_add_f32 v[6:7], v[6:7], v[82:83]
    v_lshlrev_b32 v84, 16, v194
    v_and_b32 v85, 0xffff0000, v194
    v_pk_add_f32 v[6:7], v[6:7], v[84:85]
    v_lshlrev_b32 v86, 16, v195
    v_and_b32 v87, 0xffff0000, v195
    v_pk_add_f32 v[6:7], v[6:7], v[86:87]
    s_waitcnt vmcnt(8)
    v_lshlrev_b32 v88, 16, v196
    v_and_b32 v89, 0xffff0000, v196
    v_pk_add_f32 v[6:7], v[6:7], v[88:89]
    v_lshlrev_b32 v90, 16, v197
    v_and_b32 v91, 0xffff0000, v197
    v_pk_add_f32 v[6:7], v[6:7], v[90:91]
    v_lshlrev_b32 v92, 16, v198
    v_and_b32 v93, 0xffff0000, v198
    v_pk_add_f32 v[6:7], v[6:7], v[92:93]
    v_lshlrev_b32 v94, 16, v199
    v_and_b32 v95, 0xffff0000, v199
    v_pk_add_f32 v[6:7], v[6:7], v[94:95]
    s_waitcnt vmcnt(7)
    v_lshlrev_b32 v96, 16, v200
    v_and_b32 v97, 0xffff0000, v200
    v_pk_add_f32 v[6:7], v[6:7], v[96:97]
    v_lshlrev_b32 v98, 16, v201
    v_and_b32 v99, 0xffff0000, v201
    v_pk_add_f32 v[6:7], v[6:7], v[98:99]
    v_lshlrev_b32 v100, 16, v202
    v_and_b32 v101, 0xffff0000, v202
    v_pk_add_f32 v[6:7], v[6:7], v[100:101]
    v_lshlrev_b32 v102, 16, v203
    v_and_b32 v103, 0xffff0000, v203
    v_pk_add_f32 v[6:7], v[6:7], v[102:103]
    s_waitcnt vmcnt(6)
    v_lshlrev_b32 v104, 16, v204
    v_and_b32 v105, 0xffff0000, v204
    v_pk_add_f32 v[6:7], v[6:7], v[104:105]
    v_lshlrev_b32 v106, 16, v205
    v_and_b32 v107, 0xffff0000, v205
    v_pk_add_f32 v[6:7], v[6:7], v[106:107]
    v_lshlrev_b32 v108, 16, v206
    v_and_b32 v109, 0xffff0000, v206
    v_pk_add_f32 v[6:7], v[6:7], v[108:109]
    v_lshlrev_b32 v110, 16, v207
    v_and_b32 v111, 0xffff0000, v207
    v_pk_add_f32 v[6:7], v[6:7], v[110:111]
    s_waitcnt vmcnt(5)
    v_lshlrev_b32 v112, 16, v208
    v_and_b32 v113, 0xffff0000, v208
    v_pk_add_f32 v[6:7], v[6:7], v[112:113]
    v_lshlrev_b32 v114, 16, v209
    v_and_b32 v115, 0xffff0000, v209
    v_pk_add_f32 v[6:7], v[6:7], v[114:115]
    v_lshlrev_b32 v116, 16, v210
    v_and_b32 v117, 0xffff0000, v210
    v_pk_add_f32 v[6:7], v[6:7], v[116:117]
    v_lshlrev_b32 v118, 16, v211
    v_and_b32 v119, 0xffff0000, v211
    v_pk_add_f32 v[6:7], v[6:7], v[118:119]
    s_waitcnt vmcnt(4)
    v_lshlrev_b32 v120, 16, v212
    v_and_b32 v121, 0xffff0000, v212
    v_pk_add_f32 v[6:7], v[6:7], v[120:121]
    v_lshlrev_b32 v122, 16, v213
    v_and_b32 v123, 0xffff0000, v213
    v_pk_add_f32 v[6:7], v[6:7], v[122:123]
    v_lshlrev_b32 v124, 16, v214
    v_and_b32 v125, 0xffff0000, v214
    v_pk_add_f32 v[6:7], v[6:7], v[124:125]
    v_lshlrev_b32 v126, 16, v215
    v_and_b32 v127, 0xffff0000, v215
    v_pk_add_f32 v[6:7], v[6:7], v[126:127]
    s_waitcnt vmcnt(3)
    v_lshlrev_b32 v128, 16, v216
    v_and_b32 v129, 0xffff0000, v216
    v_pk_add_f32 v[6:7], v[6:7], v[128:129]
    v_lshlrev_b32 v130, 16, v217
    v_and_b32 v131, 0xffff0000, v217
    v_pk_add_f32 v[6:7], v[6:7], v[130:131]
    v_lshlrev_b32 v132, 16, v218
    v_and_b32 v133, 0xffff0000, v218
    v_pk_add_f32 v[6:7], v[6:7], v[132:133]
    v_lshlrev_b32 v134, 16, v219
    v_and_b32 v135, 0xffff0000, v219
    v_pk_add_f32 v[6:7], v[6:7], v[134:135]
    s_waitcnt vmcnt(2)
    v_lshlrev_b32 v136, 16, v220
    v_and_b32 v137, 0xffff0000, v220
    v_pk_add_f32 v[6:7], v[6:7], v[136:137]
    v_lshlrev_b32 v138, 16, v221
    v_and_b32 v139, 0xffff0000, v221
    v_pk_add_f32 v[6:7], v[6:7], v[138:139]
    v_lshlrev_b32 v140, 16, v222
    v_and_b32 v141, 0xffff0000, v222
    v_pk_add_f32 v[6:7], v[6:7], v[140:141]
    v_lshlrev_b32 v142, 16, v223
    v_and_b32 v143, 0xffff0000, v223
    v_pk_add_f32 v[6:7], v[6:7], v[142:143]
    s_waitcnt vmcnt(1)
    v_lshlrev_b32 v144, 16, v224
    v_and_b32 v145, 0xffff0000, v224
    v_pk_add_f32 v[6:7], v[6:7], v[144:145]
    v_lshlrev_b32 v146, 16, v225
    v_and_b32 v147, 0xffff0000, v225
    v_pk_add_f32 v[6:7], v[6:7], v[146:147]
    v_lshlrev_b32 v148, 16, v226
    v_and_b32 v149, 0xffff0000, v226
    v_pk_add_f32 v[6:7], v[6:7], v[148:149]
    v_lshlrev_b32 v150, 16, v227
    v_and_b32 v151, 0xffff0000, v227
    v_pk_add_f32 v[6:7], v[6:7], v[150:151]
    s_waitcnt vmcnt(0)
    v_lshlrev_b32 v152, 16, v228
    v_and_b32 v153, 0xffff0000, v228
    v_pk_add_f32 v[6:7], v[6:7], v[152:153]
    v_lshlrev_b32 v154, 16, v229
    v_and_b32 v155, 0xffff0000, v229
    v_pk_add_f32 v[6:7], v[6:7], v[154:155]
    v_lshlrev_b32 v156, 16, v230
    v_and_b32 v157, 0xffff0000, v230
    v_pk_add_f32 v[6:7], v[6:7], v[156:157]
    v_lshlrev_b32 v158, 16, v231
    v_and_b32 v159, 0xffff0000, v231
    v_pk_add_f32 v[6:7], v[6:7], v[158:159]
    v_add_f32 v6, v6, v7
    v_mov_b32 v7, v6
    s_nop 1
    v_permlane16_swap_b32 v6, v7
    v_add_f32 v6, v6, v7
    v_mov_b32 v7, v6
    s_nop 1
    v_permlane32_swap_b32 v6, v7
    v_add_f32 v6, v6, v7
    v_mul_f32 v6, 0x3ae38e39, v6
    v_mov_b64 v[8:9], 0
    v_pk_add_f32 v[10:11], v[16:17], v[6:7] op_sel_hi:[1,0] neg_lo:[0,1] neg_hi:[0,1]
    v_pk_fma_f32 v[8:9], v[10:11], v[10:11], v[8:9]
    v_pk_add_f32 v[10:11], v[18:19], v[6:7] op_sel_hi:[1,0] neg_lo:[0,1] neg_hi:[0,1]
    v_pk_fma_f32 v[8:9], v[10:11], v[10:11], v[8:9]
    v_pk_add_f32 v[10:11], v[20:21], v[6:7] op_sel_hi:[1,0] neg_lo:[0,1] neg_hi:[0,1]
    v_pk_fma_f32 v[8:9], v[10:11], v[10:11], v[8:9]
    v_pk_add_f32 v[10:11], v[22:23], v[6:7] op_sel_hi:[1,0] neg_lo:[0,1] neg_hi:[0,1]
    v_pk_fma_f32 v[8:9], v[10:11], v[10:11], v[8:9]
    v_pk_add_f32 v[10:11], v[24:25], v[6:7] op_sel_hi:[1,0] neg_lo:[0,1] neg_hi:[0,1]
    v_pk_fma_f32 v[8:9], v[10:11], v[10:11], v[8:9]
    v_pk_add_f32 v[10:11], v[26:27], v[6:7] op_sel_hi:[1,0] neg_lo:[0,1] neg_hi:[0,1]
    v_pk_fma_f32 v[8:9], v[10:11], v[10:11], v[8:9]
    v_pk_add_f32 v[10:11], v[28:29], v[6:7] op_sel_hi:[1,0] neg_lo:[0,1] neg_hi:[0,1]
    v_pk_fma_f32 v[8:9], v[10:11], v[10:11], v[8:9]
    v_pk_add_f32 v[10:11], v[30:31], v[6:7] op_sel_hi:[1,0] neg_lo:[0,1] neg_hi:[0,1]
    v_pk_fma_f32 v[8:9], v[10:11], v[10:11], v[8:9]
    v_pk_add_f32 v[10:11], v[32:33], v[6:7] op_sel_hi:[1,0] neg_lo:[0,1] neg_hi:[0,1]
    v_pk_fma_f32 v[8:9], v[10:11], v[10:11], v[8:9]
    v_pk_add_f32 v[10:11], v[34:35], v[6:7] op_sel_hi:[1,0] neg_lo:[0,1] neg_hi:[0,1]
    v_pk_fma_f32 v[8:9], v[10:11], v[10:11], v[8:9]
    v_pk_add_f32 v[10:11], v[36:37], v[6:7] op_sel_hi:[1,0] neg_lo:[0,1] neg_hi:[0,1]
    v_pk_fma_f32 v[8:9], v[10:11], v[10:11], v[8:9]
    v_pk_add_f32 v[10:11], v[38:39], v[6:7] op_sel_hi:[1,0] neg_lo:[0,1] neg_hi:[0,1]
    v_pk_fma_f32 v[8:9], v[10:11], v[10:11], v[8:9]
    v_pk_add_f32 v[10:11], v[40:41], v[6:7] op_sel_hi:[1,0] neg_lo:[0,1] neg_hi:[0,1]
    v_pk_fma_f32 v[8:9], v[10:11], v[10:11], v[8:9]
    v_pk_add_f32 v[10:11], v[42:43], v[6:7] op_sel_hi:[1,0] neg_lo:[0,1] neg_hi:[0,1]
    v_pk_fma_f32 v[8:9], v[10:11], v[10:11], v[8:9]
    v_pk_add_f32 v[10:11], v[44:45], v[6:7] op_sel_hi:[1,0] neg_lo:[0,1] neg_hi:[0,1]
    v_pk_fma_f32 v[8:9], v[10:11], v[10:11], v[8:9]
    v_pk_add_f32 v[10:11], v[46:47], v[6:7] op_sel_hi:[1,0] neg_lo:[0,1] neg_hi:[0,1]
    v_pk_fma_f32 v[8:9], v[10:11], v[10:11], v[8:9]
    v_pk_add_f32 v[10:11], v[48:49], v[6:7] op_sel_hi:[1,0] neg_lo:[0,1] neg_hi:[0,1]
    v_pk_fma_f32 v[8:9], v[10:11], v[10:11], v[8:9]
    v_pk_add_f32 v[10:11], v[50:51], v[6:7] op_sel_hi:[1,0] neg_lo:[0,1] neg_hi:[0,1]
    v_pk_fma_f32 v[8:9], v[10:11], v[10:11], v[8:9]
    v_pk_add_f32 v[10:11], v[52:53], v[6:7] op_sel_hi:[1,0] neg_lo:[0,1] neg_hi:[0,1]
    v_pk_fma_f32 v[8:9], v[10:11], v[10:11], v[8:9]
    v_pk_add_f32 v[10:11], v[54:55], v[6:7] op_sel_hi:[1,0] neg_lo:[0,1] neg_hi:[0,1]
    v_pk_fma_f32 v[8:9], v[10:11], v[10:11], v[8:9]
    v_pk_add_f32 v[10:11], v[56:57], v[6:7] op_sel_hi:[1,0] neg_lo:[0,1] neg_hi:[0,1]
    v_pk_fma_f32 v[8:9], v[10:11], v[10:11], v[8:9]
    v_pk_add_f32 v[10:11], v[58:59], v[6:7] op_sel_hi:[1,0] neg_lo:[0,1] neg_hi:[0,1]
    v_pk_fma_f32 v[8:9], v[10:11], v[10:11], v[8:9]
    v_pk_add_f32 v[10:11], v[60:61], v[6:7] op_sel_hi:[1,0] neg_lo:[0,1] neg_hi:[0,1]
    v_pk_fma_f32 v[8:9], v[10:11], v[10:11], v[8:9]
    v_pk_add_f32 v[10:11], v[62:63], v[6:7] op_sel_hi:[1,0] neg_lo:[0,1] neg_hi:[0,1]
    v_pk_fma_f32 v[8:9], v[10:11], v[10:11], v[8:9]
    v_pk_add_f32 v[10:11], v[64:65], v[6:7] op_sel_hi:[1,0] neg_lo:[0,1] neg_hi:[0,1]
    v_pk_fma_f32 v[8:9], v[10:11], v[10:11], v[8:9]
    v_pk_add_f32 v[10:11], v[66:67], v[6:7] op_sel_hi:[1,0] neg_lo:[0,1] neg_hi:[0,1]
    v_pk_fma_f32 v[8:9], v[10:11], v[10:11], v[8:9]
    v_pk_add_f32 v[10:11], v[68:69], v[6:7] op_sel_hi:[1,0] neg_lo:[0,1] neg_hi:[0,1]
    v_pk_fma_f32 v[8:9], v[10:11], v[10:11], v[8:9]
    v_pk_add_f32 v[10:11], v[70:71], v[6:7] op_sel_hi:[1,0] neg_lo:[0,1] neg_hi:[0,1]
    v_pk_fma_f32 v[8:9], v[10:11], v[10:11], v[8:9]
    v_pk_add_f32 v[10:11], v[72:73], v[6:7] op_sel_hi:[1,0] neg_lo:[0,1] neg_hi:[0,1]
    v_pk_fma_f32 v[8:9], v[10:11], v[10:11], v[8:9]
    v_pk_add_f32 v[10:11], v[74:75], v[6:7] op_sel_hi:[1,0] neg_lo:[0,1] neg_hi:[0,1]
    v_pk_fma_f32 v[8:9], v[10:11], v[10:11], v[8:9]
    v_pk_add_f32 v[10:11], v[76:77], v[6:7] op_sel_hi:[1,0] neg_lo:[0,1] neg_hi:[0,1]
    v_pk_fma_f32 v[8:9], v[10:11], v[10:11], v[8:9]
    v_pk_add_f32 v[10:11], v[78:79], v[6:7] op_sel_hi:[1,0] neg_lo:[0,1] neg_hi:[0,1]
    v_pk_fma_f32 v[8:9], v[10:11], v[10:11], v[8:9]
    v_pk_add_f32 v[10:11], v[80:81], v[6:7] op_sel_hi:[1,0] neg_lo:[0,1] neg_hi:[0,1]
    v_pk_fma_f32 v[8:9], v[10:11], v[10:11], v[8:9]
    v_pk_add_f32 v[10:11], v[82:83], v[6:7] op_sel_hi:[1,0] neg_lo:[0,1] neg_hi:[0,1]
    v_pk_fma_f32 v[8:9], v[10:11], v[10:11], v[8:9]
    v_pk_add_f32 v[10:11], v[84:85], v[6:7] op_sel_hi:[1,0] neg_lo:[0,1] neg_hi:[0,1]
    v_pk_fma_f32 v[8:9], v[10:11], v[10:11], v[8:9]
    v_pk_add_f32 v[10:11], v[86:87], v[6:7] op_sel_hi:[1,0] neg_lo:[0,1] neg_hi:[0,1]
    v_pk_fma_f32 v[8:9], v[10:11], v[10:11], v[8:9]
    v_pk_add_f32 v[10:11], v[88:89], v[6:7] op_sel_hi:[1,0] neg_lo:[0,1] neg_hi:[0,1]
    v_pk_fma_f32 v[8:9], v[10:11], v[10:11], v[8:9]
    v_pk_add_f32 v[10:11], v[90:91], v[6:7] op_sel_hi:[1,0] neg_lo:[0,1] neg_hi:[0,1]
    v_pk_fma_f32 v[8:9], v[10:11], v[10:11], v[8:9]
    v_pk_add_f32 v[10:11], v[92:93], v[6:7] op_sel_hi:[1,0] neg_lo:[0,1] neg_hi:[0,1]
    v_pk_fma_f32 v[8:9], v[10:11], v[10:11], v[8:9]
    v_pk_add_f32 v[10:11], v[94:95], v[6:7] op_sel_hi:[1,0] neg_lo:[0,1] neg_hi:[0,1]
    v_pk_fma_f32 v[8:9], v[10:11], v[10:11], v[8:9]
    v_pk_add_f32 v[10:11], v[96:97], v[6:7] op_sel_hi:[1,0] neg_lo:[0,1] neg_hi:[0,1]
    v_pk_fma_f32 v[8:9], v[10:11], v[10:11], v[8:9]
    v_pk_add_f32 v[10:11], v[98:99], v[6:7] op_sel_hi:[1,0] neg_lo:[0,1] neg_hi:[0,1]
    v_pk_fma_f32 v[8:9], v[10:11], v[10:11], v[8:9]
    v_pk_add_f32 v[10:11], v[100:101], v[6:7] op_sel_hi:[1,0] neg_lo:[0,1] neg_hi:[0,1]
    v_pk_fma_f32 v[8:9], v[10:11], v[10:11], v[8:9]
    v_pk_add_f32 v[10:11], v[102:103], v[6:7] op_sel_hi:[1,0] neg_lo:[0,1] neg_hi:[0,1]
    v_pk_fma_f32 v[8:9], v[10:11], v[10:11], v[8:9]
    v_pk_add_f32 v[10:11], v[104:105], v[6:7] op_sel_hi:[1,0] neg_lo:[0,1] neg_hi:[0,1]
    v_pk_fma_f32 v[8:9], v[10:11], v[10:11], v[8:9]
    v_pk_add_f32 v[10:11], v[106:107], v[6:7] op_sel_hi:[1,0] neg_lo:[0,1] neg_hi:[0,1]
    v_pk_fma_f32 v[8:9], v[10:11], v[10:11], v[8:9]
    v_pk_add_f32 v[10:11], v[108:109], v[6:7] op_sel_hi:[1,0] neg_lo:[0,1] neg_hi:[0,1]
    v_pk_fma_f32 v[8:9], v[10:11], v[10:11], v[8:9]
    v_pk_add_f32 v[10:11], v[110:111], v[6:7] op_sel_hi:[1,0] neg_lo:[0,1] neg_hi:[0,1]
    v_pk_fma_f32 v[8:9], v[10:11], v[10:11], v[8:9]
    v_pk_add_f32 v[10:11], v[112:113], v[6:7] op_sel_hi:[1,0] neg_lo:[0,1] neg_hi:[0,1]
    v_pk_fma_f32 v[8:9], v[10:11], v[10:11], v[8:9]
    v_pk_add_f32 v[10:11], v[114:115], v[6:7] op_sel_hi:[1,0] neg_lo:[0,1] neg_hi:[0,1]
    v_pk_fma_f32 v[8:9], v[10:11], v[10:11], v[8:9]
    v_pk_add_f32 v[10:11], v[116:117], v[6:7] op_sel_hi:[1,0] neg_lo:[0,1] neg_hi:[0,1]
    v_pk_fma_f32 v[8:9], v[10:11], v[10:11], v[8:9]
    v_pk_add_f32 v[10:11], v[118:119], v[6:7] op_sel_hi:[1,0] neg_lo:[0,1] neg_hi:[0,1]
    v_pk_fma_f32 v[8:9], v[10:11], v[10:11], v[8:9]
    v_pk_add_f32 v[10:11], v[120:121], v[6:7] op_sel_hi:[1,0] neg_lo:[0,1] neg_hi:[0,1]
    v_pk_fma_f32 v[8:9], v[10:11], v[10:11], v[8:9]
    v_pk_add_f32 v[10:11], v[122:123], v[6:7] op_sel_hi:[1,0] neg_lo:[0,1] neg_hi:[0,1]
    v_pk_fma_f32 v[8:9], v[10:11], v[10:11], v[8:9]
    v_pk_add_f32 v[10:11], v[124:125], v[6:7] op_sel_hi:[1,0] neg_lo:[0,1] neg_hi:[0,1]
    v_pk_fma_f32 v[8:9], v[10:11], v[10:11], v[8:9]
    v_pk_add_f32 v[10:11], v[126:127], v[6:7] op_sel_hi:[1,0] neg_lo:[0,1] neg_hi:[0,1]
    v_pk_fma_f32 v[8:9], v[10:11], v[10:11], v[8:9]
    v_pk_add_f32 v[10:11], v[128:129], v[6:7] op_sel_hi:[1,0] neg_lo:[0,1] neg_hi:[0,1]
    v_pk_fma_f32 v[8:9], v[10:11], v[10:11], v[8:9]
    v_pk_add_f32 v[10:11], v[130:131], v[6:7] op_sel_hi:[1,0] neg_lo:[0,1] neg_hi:[0,1]
    v_pk_fma_f32 v[8:9], v[10:11], v[10:11], v[8:9]
    v_pk_add_f32 v[10:11], v[132:133], v[6:7] op_sel_hi:[1,0] neg_lo:[0,1] neg_hi:[0,1]
    v_pk_fma_f32 v[8:9], v[10:11], v[10:11], v[8:9]
    v_pk_add_f32 v[10:11], v[134:135], v[6:7] op_sel_hi:[1,0] neg_lo:[0,1] neg_hi:[0,1]
    v_pk_fma_f32 v[8:9], v[10:11], v[10:11], v[8:9]
    v_pk_add_f32 v[10:11], v[136:137], v[6:7] op_sel_hi:[1,0] neg_lo:[0,1] neg_hi:[0,1]
    v_pk_fma_f32 v[8:9], v[10:11], v[10:11], v[8:9]
    v_pk_add_f32 v[10:11], v[138:139], v[6:7] op_sel_hi:[1,0] neg_lo:[0,1] neg_hi:[0,1]
    v_pk_fma_f32 v[8:9], v[10:11], v[10:11], v[8:9]
    v_pk_add_f32 v[10:11], v[140:141], v[6:7] op_sel_hi:[1,0] neg_lo:[0,1] neg_hi:[0,1]
    v_pk_fma_f32 v[8:9], v[10:11], v[10:11], v[8:9]
    v_pk_add_f32 v[10:11], v[142:143], v[6:7] op_sel_hi:[1,0] neg_lo:[0,1] neg_hi:[0,1]
    v_pk_fma_f32 v[8:9], v[10:11], v[10:11], v[8:9]
    v_pk_add_f32 v[10:11], v[144:145], v[6:7] op_sel_hi:[1,0] neg_lo:[0,1] neg_hi:[0,1]
    v_pk_fma_f32 v[8:9], v[10:11], v[10:11], v[8:9]
    v_pk_add_f32 v[10:11], v[146:147], v[6:7] op_sel_hi:[1,0] neg_lo:[0,1] neg_hi:[0,1]
    v_pk_fma_f32 v[8:9], v[10:11], v[10:11], v[8:9]
    v_pk_add_f32 v[10:11], v[148:149], v[6:7] op_sel_hi:[1,0] neg_lo:[0,1] neg_hi:[0,1]
    v_pk_fma_f32 v[8:9], v[10:11], v[10:11], v[8:9]
    v_pk_add_f32 v[10:11], v[150:151], v[6:7] op_sel_hi:[1,0] neg_lo:[0,1] neg_hi:[0,1]
    v_pk_fma_f32 v[8:9], v[10:11], v[10:11], v[8:9]
    v_pk_add_f32 v[10:11], v[152:153], v[6:7] op_sel_hi:[1,0] neg_lo:[0,1] neg_hi:[0,1]
    v_pk_fma_f32 v[8:9], v[10:11], v[10:11], v[8:9]
    v_pk_add_f32 v[10:11], v[154:155], v[6:7] op_sel_hi:[1,0] neg_lo:[0,1] neg_hi:[0,1]
    v_pk_fma_f32 v[8:9], v[10:11], v[10:11], v[8:9]
    v_pk_add_f32 v[10:11], v[156:157], v[6:7] op_sel_hi:[1,0] neg_lo:[0,1] neg_hi:[0,1]
    v_pk_fma_f32 v[8:9], v[10:11], v[10:11], v[8:9]
    v_pk_add_f32 v[10:11], v[158:159], v[6:7] op_sel_hi:[1,0] neg_lo:[0,1] neg_hi:[0,1]
    v_pk_fma_f32 v[8:9], v[10:11], v[10:11], v[8:9]
    v_add_f32 v8, v8, v9
    v_mov_b32 v9, v8
    s_nop 1
    v_permlane16_swap_b32 v8, v9
    v_add_f32 v8, v8, v9
    v_mov_b32 v9, v8
    s_nop 1
    v_permlane32_swap_b32 v8, v9
    v_add_f32 v8, v8, v9
    v_mul_f32 v8, 0x3ae38e39, v8
    v_cvt_pk_bf16_f32 v8, v8, v8
    v_lshlrev_b32 v8, 16, v8
    v_cvt_pk_bf16_f32 v6, v6, v6
    v_lshlrev_b32 v6, 16, v6
    v_add_f32 v8, 0x3727c5ac, v8
    v_cvt_pk_bf16_f32 v8, v8, v8
    v_lshlrev_b32 v8, 16, v8
    v_sqrt_f32 v8, v8
    s_nop 0
    v_cvt_pk_bf16_f32 v8, v8, v8
    v_lshlrev_b32 v8, 16, v8
    v_rcp_f32 v8, v8
    v_pk_add_f32 v[16:17], v[16:17], v[6:7] op_sel_hi:[1,0] neg_lo:[0,1] neg_hi:[0,1]
    v_cvt_pk_bf16_f32 v17, v16, v17
    v_lshlrev_b32 v16, 16, v17
    v_and_b32 v17, 0xffff0000, v17
    v_pk_mul_f32 v[16:17], v[16:17], v[8:9] op_sel_hi:[1,0]
    v_cvt_pk_bf16_f32 v17, v16, v17
    v_lshlrev_b32 v16, 16, v17
    v_and_b32 v17, 0xffff0000, v17
    v_pk_add_f32 v[18:19], v[18:19], v[6:7] op_sel_hi:[1,0] neg_lo:[0,1] neg_hi:[0,1]
    v_cvt_pk_bf16_f32 v19, v18, v19
    v_lshlrev_b32 v18, 16, v19
    v_and_b32 v19, 0xffff0000, v19
    v_pk_mul_f32 v[18:19], v[18:19], v[8:9] op_sel_hi:[1,0]
    v_cvt_pk_bf16_f32 v19, v18, v19
    v_lshlrev_b32 v18, 16, v19
    v_and_b32 v19, 0xffff0000, v19
    v_pk_add_f32 v[20:21], v[20:21], v[6:7] op_sel_hi:[1,0] neg_lo:[0,1] neg_hi:[0,1]
    v_cvt_pk_bf16_f32 v21, v20, v21
    v_lshlrev_b32 v20, 16, v21
    v_and_b32 v21, 0xffff0000, v21
    v_pk_mul_f32 v[20:21], v[20:21], v[8:9] op_sel_hi:[1,0]
    v_cvt_pk_bf16_f32 v21, v20, v21
    v_lshlrev_b32 v20, 16, v21
    v_and_b32 v21, 0xffff0000, v21
    v_pk_add_f32 v[22:23], v[22:23], v[6:7] op_sel_hi:[1,0] neg_lo:[0,1] neg_hi:[0,1]
    v_cvt_pk_bf16_f32 v23, v22, v23
    v_lshlrev_b32 v22, 16, v23
    v_and_b32 v23, 0xffff0000, v23
    v_pk_mul_f32 v[22:23], v[22:23], v[8:9] op_sel_hi:[1,0]
    v_cvt_pk_bf16_f32 v23, v22, v23
    v_lshlrev_b32 v22, 16, v23
    v_and_b32 v23, 0xffff0000, v23
    v_pk_add_f32 v[24:25], v[24:25], v[6:7] op_sel_hi:[1,0] neg_lo:[0,1] neg_hi:[0,1]
    v_cvt_pk_bf16_f32 v25, v24, v25
    v_lshlrev_b32 v24, 16, v25
    v_and_b32 v25, 0xffff0000, v25
    v_pk_mul_f32 v[24:25], v[24:25], v[8:9] op_sel_hi:[1,0]
    v_cvt_pk_bf16_f32 v25, v24, v25
    v_lshlrev_b32 v24, 16, v25
    v_and_b32 v25, 0xffff0000, v25
    v_pk_add_f32 v[26:27], v[26:27], v[6:7] op_sel_hi:[1,0] neg_lo:[0,1] neg_hi:[0,1]
    v_cvt_pk_bf16_f32 v27, v26, v27
    v_lshlrev_b32 v26, 16, v27
    v_and_b32 v27, 0xffff0000, v27
    v_pk_mul_f32 v[26:27], v[26:27], v[8:9] op_sel_hi:[1,0]
    v_cvt_pk_bf16_f32 v27, v26, v27
    v_lshlrev_b32 v26, 16, v27
    v_and_b32 v27, 0xffff0000, v27
    v_pk_add_f32 v[28:29], v[28:29], v[6:7] op_sel_hi:[1,0] neg_lo:[0,1] neg_hi:[0,1]
    v_cvt_pk_bf16_f32 v29, v28, v29
    v_lshlrev_b32 v28, 16, v29
    v_and_b32 v29, 0xffff0000, v29
    v_pk_mul_f32 v[28:29], v[28:29], v[8:9] op_sel_hi:[1,0]
    v_cvt_pk_bf16_f32 v29, v28, v29
    v_lshlrev_b32 v28, 16, v29
    v_and_b32 v29, 0xffff0000, v29
    v_pk_add_f32 v[30:31], v[30:31], v[6:7] op_sel_hi:[1,0] neg_lo:[0,1] neg_hi:[0,1]
    v_cvt_pk_bf16_f32 v31, v30, v31
    v_lshlrev_b32 v30, 16, v31
    v_and_b32 v31, 0xffff0000, v31
    v_pk_mul_f32 v[30:31], v[30:31], v[8:9] op_sel_hi:[1,0]
    v_cvt_pk_bf16_f32 v31, v30, v31
    v_lshlrev_b32 v30, 16, v31
    v_and_b32 v31, 0xffff0000, v31
    v_pk_add_f32 v[32:33], v[32:33], v[6:7] op_sel_hi:[1,0] neg_lo:[0,1] neg_hi:[0,1]
    v_cvt_pk_bf16_f32 v33, v32, v33
    v_lshlrev_b32 v32, 16, v33
    v_and_b32 v33, 0xffff0000, v33
    v_pk_mul_f32 v[32:33], v[32:33], v[8:9] op_sel_hi:[1,0]
    v_cvt_pk_bf16_f32 v33, v32, v33
    v_lshlrev_b32 v32, 16, v33
    v_and_b32 v33, 0xffff0000, v33
    v_pk_add_f32 v[34:35], v[34:35], v[6:7] op_sel_hi:[1,0] neg_lo:[0,1] neg_hi:[0,1]
    v_cvt_pk_bf16_f32 v35, v34, v35
    v_lshlrev_b32 v34, 16, v35
    v_and_b32 v35, 0xffff0000, v35
    v_pk_mul_f32 v[34:35], v[34:35], v[8:9] op_sel_hi:[1,0]
    v_cvt_pk_bf16_f32 v35, v34, v35
    v_lshlrev_b32 v34, 16, v35
    v_and_b32 v35, 0xffff0000, v35
    v_pk_add_f32 v[36:37], v[36:37], v[6:7] op_sel_hi:[1,0] neg_lo:[0,1] neg_hi:[0,1]
    v_cvt_pk_bf16_f32 v37, v36, v37
    v_lshlrev_b32 v36, 16, v37
    v_and_b32 v37, 0xffff0000, v37
    v_pk_mul_f32 v[36:37], v[36:37], v[8:9] op_sel_hi:[1,0]
    v_cvt_pk_bf16_f32 v37, v36, v37
    v_lshlrev_b32 v36, 16, v37
    v_and_b32 v37, 0xffff0000, v37
    v_pk_add_f32 v[38:39], v[38:39], v[6:7] op_sel_hi:[1,0] neg_lo:[0,1] neg_hi:[0,1]
    v_cvt_pk_bf16_f32 v39, v38, v39
    v_lshlrev_b32 v38, 16, v39
    v_and_b32 v39, 0xffff0000, v39
    v_pk_mul_f32 v[38:39], v[38:39], v[8:9] op_sel_hi:[1,0]
    v_cvt_pk_bf16_f32 v39, v38, v39
    v_lshlrev_b32 v38, 16, v39
    v_and_b32 v39, 0xffff0000, v39
    v_pk_add_f32 v[40:41], v[40:41], v[6:7] op_sel_hi:[1,0] neg_lo:[0,1] neg_hi:[0,1]
    v_cvt_pk_bf16_f32 v41, v40, v41
    v_lshlrev_b32 v40, 16, v41
    v_and_b32 v41, 0xffff0000, v41
    v_pk_mul_f32 v[40:41], v[40:41], v[8:9] op_sel_hi:[1,0]
    v_cvt_pk_bf16_f32 v41, v40, v41
    v_lshlrev_b32 v40, 16, v41
    v_and_b32 v41, 0xffff0000, v41
    v_pk_add_f32 v[42:43], v[42:43], v[6:7] op_sel_hi:[1,0] neg_lo:[0,1] neg_hi:[0,1]
    v_cvt_pk_bf16_f32 v43, v42, v43
    v_lshlrev_b32 v42, 16, v43
    v_and_b32 v43, 0xffff0000, v43
    v_pk_mul_f32 v[42:43], v[42:43], v[8:9] op_sel_hi:[1,0]
    v_cvt_pk_bf16_f32 v43, v42, v43
    v_lshlrev_b32 v42, 16, v43
    v_and_b32 v43, 0xffff0000, v43
    v_pk_add_f32 v[44:45], v[44:45], v[6:7] op_sel_hi:[1,0] neg_lo:[0,1] neg_hi:[0,1]
    v_cvt_pk_bf16_f32 v45, v44, v45
    v_lshlrev_b32 v44, 16, v45
    v_and_b32 v45, 0xffff0000, v45
    v_pk_mul_f32 v[44:45], v[44:45], v[8:9] op_sel_hi:[1,0]
    v_cvt_pk_bf16_f32 v45, v44, v45
    v_lshlrev_b32 v44, 16, v45
    v_and_b32 v45, 0xffff0000, v45
    v_pk_add_f32 v[46:47], v[46:47], v[6:7] op_sel_hi:[1,0] neg_lo:[0,1] neg_hi:[0,1]
    v_cvt_pk_bf16_f32 v47, v46, v47
    v_lshlrev_b32 v46, 16, v47
    v_and_b32 v47, 0xffff0000, v47
    v_pk_mul_f32 v[46:47], v[46:47], v[8:9] op_sel_hi:[1,0]
    v_cvt_pk_bf16_f32 v47, v46, v47
    v_lshlrev_b32 v46, 16, v47
    v_and_b32 v47, 0xffff0000, v47
    v_pk_add_f32 v[48:49], v[48:49], v[6:7] op_sel_hi:[1,0] neg_lo:[0,1] neg_hi:[0,1]
    v_cvt_pk_bf16_f32 v49, v48, v49
    v_lshlrev_b32 v48, 16, v49
    v_and_b32 v49, 0xffff0000, v49
    v_pk_mul_f32 v[48:49], v[48:49], v[8:9] op_sel_hi:[1,0]
    v_cvt_pk_bf16_f32 v49, v48, v49
    v_lshlrev_b32 v48, 16, v49
    v_and_b32 v49, 0xffff0000, v49
    v_pk_add_f32 v[50:51], v[50:51], v[6:7] op_sel_hi:[1,0] neg_lo:[0,1] neg_hi:[0,1]
    v_cvt_pk_bf16_f32 v51, v50, v51
    v_lshlrev_b32 v50, 16, v51
    v_and_b32 v51, 0xffff0000, v51
    v_pk_mul_f32 v[50:51], v[50:51], v[8:9] op_sel_hi:[1,0]
    v_cvt_pk_bf16_f32 v51, v50, v51
    v_lshlrev_b32 v50, 16, v51
    v_and_b32 v51, 0xffff0000, v51
    v_pk_add_f32 v[52:53], v[52:53], v[6:7] op_sel_hi:[1,0] neg_lo:[0,1] neg_hi:[0,1]
    v_cvt_pk_bf16_f32 v53, v52, v53
    v_lshlrev_b32 v52, 16, v53
    v_and_b32 v53, 0xffff0000, v53
    v_pk_mul_f32 v[52:53], v[52:53], v[8:9] op_sel_hi:[1,0]
    v_cvt_pk_bf16_f32 v53, v52, v53
    v_lshlrev_b32 v52, 16, v53
    v_and_b32 v53, 0xffff0000, v53
    v_pk_add_f32 v[54:55], v[54:55], v[6:7] op_sel_hi:[1,0] neg_lo:[0,1] neg_hi:[0,1]
    v_cvt_pk_bf16_f32 v55, v54, v55
    v_lshlrev_b32 v54, 16, v55
    v_and_b32 v55, 0xffff0000, v55
    v_pk_mul_f32 v[54:55], v[54:55], v[8:9] op_sel_hi:[1,0]
    v_cvt_pk_bf16_f32 v55, v54, v55
    v_lshlrev_b32 v54, 16, v55
    v_and_b32 v55, 0xffff0000, v55
    v_pk_add_f32 v[56:57], v[56:57], v[6:7] op_sel_hi:[1,0] neg_lo:[0,1] neg_hi:[0,1]
    v_cvt_pk_bf16_f32 v57, v56, v57
    v_lshlrev_b32 v56, 16, v57
    v_and_b32 v57, 0xffff0000, v57
    v_pk_mul_f32 v[56:57], v[56:57], v[8:9] op_sel_hi:[1,0]
    v_cvt_pk_bf16_f32 v57, v56, v57
    v_lshlrev_b32 v56, 16, v57
    v_and_b32 v57, 0xffff0000, v57
    v_pk_add_f32 v[58:59], v[58:59], v[6:7] op_sel_hi:[1,0] neg_lo:[0,1] neg_hi:[0,1]
    v_cvt_pk_bf16_f32 v59, v58, v59
    v_lshlrev_b32 v58, 16, v59
    v_and_b32 v59, 0xffff0000, v59
    v_pk_mul_f32 v[58:59], v[58:59], v[8:9] op_sel_hi:[1,0]
    v_cvt_pk_bf16_f32 v59, v58, v59
    v_lshlrev_b32 v58, 16, v59
    v_and_b32 v59, 0xffff0000, v59
    v_pk_add_f32 v[60:61], v[60:61], v[6:7] op_sel_hi:[1,0] neg_lo:[0,1] neg_hi:[0,1]
    v_cvt_pk_bf16_f32 v61, v60, v61
    v_lshlrev_b32 v60, 16, v61
    v_and_b32 v61, 0xffff0000, v61
    v_pk_mul_f32 v[60:61], v[60:61], v[8:9] op_sel_hi:[1,0]
    v_cvt_pk_bf16_f32 v61, v60, v61
    v_lshlrev_b32 v60, 16, v61
    v_and_b32 v61, 0xffff0000, v61
    v_pk_add_f32 v[62:63], v[62:63], v[6:7] op_sel_hi:[1,0] neg_lo:[0,1] neg_hi:[0,1]
    v_cvt_pk_bf16_f32 v63, v62, v63
    v_lshlrev_b32 v62, 16, v63
    v_and_b32 v63, 0xffff0000, v63
    v_pk_mul_f32 v[62:63], v[62:63], v[8:9] op_sel_hi:[1,0]
    v_cvt_pk_bf16_f32 v63, v62, v63
    v_lshlrev_b32 v62, 16, v63
    v_and_b32 v63, 0xffff0000, v63
    v_mov_b32 v10, 0x0
    v_bfe_u32 v11, v0, 0, 2
    v_lshl_add_u32 v10, v11, 2, v10
    v_bfe_u32 v11, v0, 2, 1
    v_lshl_add_u32 v10, v11, 7, v10
    s_mov_b32 s12, 0
L_mc_4:
    global_load_dword v11, v10, s[6:7] sc1
    s_add_u32 s12, s12, 1
    s_cmp_gt_u32 s12, 100000
    s_cbranch_scc1 L_exit
    s_waitcnt vmcnt(0)
    v_and_b32 v12, 0xff, v11
    v_cmp_ne_u32 vcc, 32, v12
    s_cbranch_vccz L_mc_done_3
    v_cmp_lt_u32 vcc, 32, v12
    s_cbranch_vccnz L_exit
    s_sleep 24
    s_branch L_mc_4
L_mc_done_3:
    v_readlane_b32 s12, v11, s8
    s_mul_i32 s13, s3, s3
    s_lshl_b32 s13, s13, 10
    s_add_u32 s13, s13, s3
    s_lshl_b32 s13, s13, 8
    s_add_u32 s13, s13, 1
    s_lshl_b32 s13, s13, 5
    s_cmp_eq_u32 s12, s13
    s_cselect_b32 s11, 1, 0
    s_cmp_lg_u32 s10, 0
    s_cbranch_scc1 L_cwd_6
    v_mov_b32 v10, 160
    s_mov_b32 s12, 0
L_cw_5:
    global_load_dword v11, v10, s[6:7] sc1
    s_add_u32 s12, s12, 1
    s_cmp_gt_u32 s12, 100000
    s_cbranch_scc1 L_exit
    s_waitcnt vmcnt(0)
    v_cmp_gt_u32 vcc, 18, v11
    s_cbranch_vccz L_cwd_6
    s_sleep 4
    s_branch L_cw_5
L_cwd_6:
    s_barrier
    global_load_dwordx4 v[160:163], v3, s[4:5] offset:1152 sc1
    global_load_dwordx4 v[164:167], v3, s[4:5] offset:0 sc1
    global_load_dwordx4 v[168:171], v3, s[4:5] offset:1216 sc1
    global_load_dwordx4 v[172:175], v3, s[4:5] offset:64 sc1
    global_load_dwordx4 v[176:179], v3, s[4:5] offset:1280 sc1
    global_load_dwordx4 v[180:183], v3, s[4:5] offset:128 sc1
    global_load_dwordx4 v[184:187], v3, s[4:5] offset:1344 sc1
    global_load_dwordx4 v[188:191], v3, s[4:5] offset:192 sc1
    global_load_dwordx4 v[192:195], v3, s[4:5] offset:1408 sc1
    global_load_dwordx4 v[196:199], v3, s[4:5] offset:256 sc1
    global_load_dwordx4 v[200:203], v3, s[4:5] offset:1472 sc1
    global_load_dwordx4 v[204:207], v3, s[4:5] offset:320 sc1
    s_waitcnt vmcnt(10)
    v_lshlrev_b32 v10, 16, v160
    v_and_b32 v11, 0xffff0000, v160
    v_lshlrev_b32 v12, 16, v164
    v_and_b32 v13, 0xffff0000, v164
    v_pk_mul_f32 v[16:17], v[16:17], v[10:11]
    v_cvt_pk_bf16_f32 v17, v16, v17
    v_lshlrev_b32 v16, 16, v17
    v_and_b32 v17, 0xffff0000, v17
    v_pk_add_f32 v[16:17], v[16:17], v[12:13]
    v_cvt_pk_bf16_f32 v16, v16, v17
    v_lshlrev_b32 v10, 16, v161
    v_and_b32 v11, 0xffff0000, v161
    v_lshlrev_b32 v12, 16, v165
    v_and_b32 v13, 0xffff0000, v165
    v_pk_mul_f32 v[18:19], v[18:19], v[10:11]
    v_cvt_pk_bf16_f32 v19, v18, v19
    v_lshlrev_b32 v18, 16, v19
    v_and_b32 v19, 0xffff0000, v19
    v_pk_add_f32 v[18:19], v[18:19], v[12:13]
    v_cvt_pk_bf16_f32 v17, v18, v19
    v_lshlrev_b32 v10, 16, v162
    v_and_b32 v11, 0xffff0000, v162
    v_lshlrev_b32 v12, 16, v166
    v_and_b32 v13, 0xffff0000, v166
    v_pk_mul_f32 v[20:21], v[20:21], v[10:11]
    v_cvt_pk_bf16_f32 v21, v20, v21
    v_lshlrev_b32 v20, 16, v21
    v_and_b32 v21, 0xffff0000, v21
    v_pk_add_f32 v[20:21], v[20:21], v[12:13]
    v_cvt_pk_bf16_f32 v18, v20, v21
    v_lshlrev_b32 v10, 16, v163
    v_and_b32 v11, 0xffff0000, v163
    v_lshlrev_b32 v12, 16, v167
    v_and_b32 v13, 0xffff0000, v167
    v_pk_mul_f32 v[22:23], v[22:23], v[10:11]
    v_cvt_pk_bf16_f32 v23, v22, v23
    v_lshlrev_b32 v22, 16, v23
    v_and_b32 v23, 0xffff0000, v23
    v_pk_add_f32 v[22:23], v[22:23], v[12:13]
    v_cvt_pk_bf16_f32 v19, v22, v23
    global_store_dwordx4 v4, v[16:19], s[18:19] offset:-2048 sc1
    s_waitcnt vmcnt(9)
    v_lshlrev_b32 v10, 16, v168
    v_and_b32 v11, 0xffff0000, v168
    v_lshlrev_b32 v12, 16, v172
    v_and_b32 v13, 0xffff0000, v172
    v_pk_mul_f32 v[24:25], v[24:25], v[10:11]
    v_cvt_pk_bf16_f32 v25, v24, v25
    v_lshlrev_b32 v24, 16, v25
    v_and_b32 v25, 0xffff0000, v25
    v_pk_add_f32 v[24:25], v[24:25], v[12:13]
    v_cvt_pk_bf16_f32 v24, v24, v25
    v_lshlrev_b32 v10, 16, v169
    v_and_b32 v11, 0xffff0000, v169
    v_lshlrev_b32 v12, 16, v173
    v_and_b32 v13, 0xffff0000, v173
    v_pk_mul_f32 v[26:27], v[26:27], v[10:11]
    v_cvt_pk_bf16_f32 v27, v26, v27
    v_lshlrev_b32 v26, 16, v27
    v_and_b32 v27, 0xffff0000, v27
    v_pk_add_f32 v[26:27], v[26:27], v[12:13]
    v_cvt_pk_bf16_f32 v25, v26, v27
    v_lshlrev_b32 v10, 16, v170
    v_and_b32 v11, 0xffff0000, v170
    v_lshlrev_b32 v12, 16, v174
    v_and_b32 v13, 0xffff0000, v174
    v_pk_mul_f32 v[28:29], v[28:29], v[10:11]
    v_cvt_pk_bf16_f32 v29, v28, v29
    v_lshlrev_b32 v28, 16, v29
    v_and_b32 v29, 0xffff0000, v29
    v_pk_add_f32 v[28:29], v[28:29], v[12:13]
    v_cvt_pk_bf16_f32 v26, v28, v29
    v_lshlrev_b32 v10, 16, v171
    v_and_b32 v11, 0xffff0000, v171
    v_lshlrev_b32 v12, 16, v175
    v_and_b32 v13, 0xffff0000, v175
    v_pk_mul_f32 v[30:31], v[30:31], v[10:11]
    v_cvt_pk_bf16_f32 v31, v30, v31
    v_lshlrev_b32 v30, 16, v31
    v_and_b32 v31, 0xffff0000, v31
    v_pk_add_f32 v[30:31], v[30:31], v[12:13]
    v_cvt_pk_bf16_f32 v27, v30, v31
    global_store_dwordx4 v4, v[24:27], s[18:19] offset:-1024 sc1
    s_waitcnt vmcnt(8)
    v_lshlrev_b32 v10, 16, v176
    v_and_b32 v11, 0xffff0000, v176
    v_lshlrev_b32 v12, 16, v180
    v_and_b32 v13, 0xffff0000, v180
    v_pk_mul_f32 v[32:33], v[32:33], v[10:11]
    v_cvt_pk_bf16_f32 v33, v32, v33
    v_lshlrev_b32 v32, 16, v33
    v_and_b32 v33, 0xffff0000, v33
    v_pk_add_f32 v[32:33], v[32:33], v[12:13]
    v_cvt_pk_bf16_f32 v32, v32, v33
    v_lshlrev_b32 v10, 16, v177
    v_and_b32 v11, 0xffff0000, v177
    v_lshlrev_b32 v12, 16, v181
    v_and_b32 v13, 0xffff0000, v181
    v_pk_mul_f32 v[34:35], v[34:35], v[10:11]
    v_cvt_pk_bf16_f32 v35, v34, v35
    v_lshlrev_b32 v34, 16, v35
    v_and_b32 v35, 0xffff0000, v35
    v_pk_add_f32 v[34:35], v[34:35], v[12:13]
    v_cvt_pk_bf16_f32 v33, v34, v35
    v_lshlrev_b32 v10, 16, v178
    v_and_b32 v11, 0xffff0000, v178
    v_lshlrev_b32 v12, 16, v182
    v_and_b32 v13, 0xffff0000, v182
    v_pk_mul_f32 v[36:37], v[36:37], v[10:11]
    v_cvt_pk_bf16_f32 v37, v36, v37
    v_lshlrev_b32 v36, 16, v37
    v_and_b32 v37, 0xffff0000, v37
    v_pk_add_f32 v[36:37], v[36:37], v[12:13]
    v_cvt_pk_bf16_f32 v34, v36, v37
    v_lshlrev_b32 v10, 16, v179
    v_and_b32 v11, 0xffff0000, v179
    v_lshlrev_b32 v12, 16, v183
    v_and_b32 v13, 0xffff0000, v183
    v_pk_mul_f32 v[38:39], v[38:39], v[10:11]
    v_cvt_pk_bf16_f32 v39, v38, v39
    v_lshlrev_b32 v38, 16, v39
    v_and_b32 v39, 0xffff0000, v39
    v_pk_add_f32 v[38:39], v[38:39], v[12:13]
    v_cvt_pk_bf16_f32 v35, v38, v39
    global_store_dwordx4 v4, v[32:35], s[18:19] offset:0 sc1
    s_waitcnt vmcnt(7)
    v_lshlrev_b32 v10, 16, v184
    v_and_b32 v11, 0xffff0000, v184
    v_lshlrev_b32 v12, 16, v188
    v_and_b32 v13, 0xffff0000, v188
    v_pk_mul_f32 v[40:41], v[40:41], v[10:11]
    v_cvt_pk_bf16_f32 v41, v40, v41
    v_lshlrev_b32 v40, 16, v41
    v_and_b32 v41, 0xffff0000, v41
    v_pk_add_f32 v[40:41], v[40:41], v[12:13]
    v_cvt_pk_bf16_f32 v40, v40, v41
    v_lshlrev_b32 v10, 16, v185
    v_and_b32 v11, 0xffff0000, v185
    v_lshlrev_b32 v12, 16, v189
    v_and_b32 v13, 0xffff0000, v189
    v_pk_mul_f32 v[42:43], v[42:43], v[10:11]
    v_cvt_pk_bf16_f32 v43, v42, v43
    v_lshlrev_b32 v42, 16, v43
    v_and_b32 v43, 0xffff0000, v43
    v_pk_add_f32 v[42:43], v[42:43], v[12:13]
    v_cvt_pk_bf16_f32 v41, v42, v43
    v_lshlrev_b32 v10, 16, v186
    v_and_b32 v11, 0xffff0000, v186
    v_lshlrev_b32 v12, 16, v190
    v_and_b32 v13, 0xffff0000, v190
    v_pk_mul_f32 v[44:45], v[44:45], v[10:11]
    v_cvt_pk_bf16_f32 v45, v44, v45
    v_lshlrev_b32 v44, 16, v45
    v_and_b32 v45, 0xffff0000, v45
    v_pk_add_f32 v[44:45], v[44:45], v[12:13]
    v_cvt_pk_bf16_f32 v42, v44, v45
    v_lshlrev_b32 v10, 16, v187
    v_and_b32 v11, 0xffff0000, v187
    v_lshlrev_b32 v12, 16, v191
    v_and_b32 v13, 0xffff0000, v191
    v_pk_mul_f32 v[46:47], v[46:47], v[10:11]
    v_cvt_pk_bf16_f32 v47, v46, v47
    v_lshlrev_b32 v46, 16, v47
    v_and_b32 v47, 0xffff0000, v47
    v_pk_add_f32 v[46:47], v[46:47], v[12:13]
    v_cvt_pk_bf16_f32 v43, v46, v47
    global_store_dwordx4 v4, v[40:43], s[18:19] offset:1024 sc1
    s_waitcnt vmcnt(6)
    v_lshlrev_b32 v10, 16, v192
    v_and_b32 v11, 0xffff0000, v192
    v_lshlrev_b32 v12, 16, v196
    v_and_b32 v13, 0xffff0000, v196
    v_pk_mul_f32 v[48:49], v[48:49], v[10:11]
    v_cvt_pk_bf16_f32 v49, v48, v49
    v_lshlrev_b32 v48, 16, v49
    v_and_b32 v49, 0xffff0000, v49
    v_pk_add_f32 v[48:49], v[48:49], v[12:13]
    v_cvt_pk_bf16_f32 v48, v48, v49
    v_lshlrev_b32 v10, 16, v193
    v_and_b32 v11, 0xffff0000, v193
    v_lshlrev_b32 v12, 16, v197
    v_and_b32 v13, 0xffff0000, v197
    v_pk_mul_f32 v[50:51], v[50:51], v[10:11]
    v_cvt_pk_bf16_f32 v51, v50, v51
    v_lshlrev_b32 v50, 16, v51
    v_and_b32 v51, 0xffff0000, v51
    v_pk_add_f32 v[50:51], v[50:51], v[12:13]
    v_cvt_pk_bf16_f32 v49, v50, v51
    v_lshlrev_b32 v10, 16, v194
    v_and_b32 v11, 0xffff0000, v194
    v_lshlrev_b32 v12, 16, v198
    v_and_b32 v13, 0xffff0000, v198
    v_pk_mul_f32 v[52:53], v[52:53], v[10:11]
    v_cvt_pk_bf16_f32 v53, v52, v53
    v_lshlrev_b32 v52, 16, v53
    v_and_b32 v53, 0xffff0000, v53
    v_pk_add_f32 v[52:53], v[52:53], v[12:13]
    v_cvt_pk_bf16_f32 v50, v52, v53
    v_lshlrev_b32 v10, 16, v195
    v_and_b32 v11, 0xffff0000, v195
    v_lshlrev_b32 v12, 16, v199
    v_and_b32 v13, 0xffff0000, v199
    v_pk_mul_f32 v[54:55], v[54:55], v[10:11]
    v_cvt_pk_bf16_f32 v55, v54, v55
    v_lshlrev_b32 v54, 16, v55
    v_and_b32 v55, 0xffff0000, v55
    v_pk_add_f32 v[54:55], v[54:55], v[12:13]
    v_cvt_pk_bf16_f32 v51, v54, v55
    global_store_dwordx4 v4, v[48:51], s[18:19] offset:2048 sc1
    s_waitcnt vmcnt(5)
    v_lshlrev_b32 v10, 16, v200
    v_and_b32 v11, 0xffff0000, v200
    v_lshlrev_b32 v12, 16, v204
    v_and_b32 v13, 0xffff0000, v204
    v_pk_mul_f32 v[56:57], v[56:57], v[10:11]
    v_cvt_pk_bf16_f32 v57, v56, v57
    v_lshlrev_b32 v56, 16, v57
    v_and_b32 v57, 0xffff0000, v57
    v_pk_add_f32 v[56:57], v[56:57], v[12:13]
    v_cvt_pk_bf16_f32 v56, v56, v57
    v_lshlrev_b32 v10, 16, v201
    v_and_b32 v11, 0xffff0000, v201
    v_lshlrev_b32 v12, 16, v205
    v_and_b32 v13, 0xffff0000, v205
    v_pk_mul_f32 v[58:59], v[58:59], v[10:11]
    v_cvt_pk_bf16_f32 v59, v58, v59
    v_lshlrev_b32 v58, 16, v59
    v_and_b32 v59, 0xffff0000, v59
    v_pk_add_f32 v[58:59], v[58:59], v[12:13]
    v_cvt_pk_bf16_f32 v57, v58, v59
    v_lshlrev_b32 v10, 16, v202
    v_and_b32 v11, 0xffff0000, v202
    v_lshlrev_b32 v12, 16, v206
    v_and_b32 v13, 0xffff0000, v206
    v_pk_mul_f32 v[60:61], v[60:61], v[10:11]
    v_cvt_pk_bf16_f32 v61, v60, v61
    v_lshlrev_b32 v60, 16, v61
    v_and_b32 v61, 0xffff0000, v61
    v_pk_add_f32 v[60:61], v[60:61], v[12:13]
    v_cvt_pk_bf16_f32 v58, v60, v61
    v_lshlrev_b32 v10, 16, v203
    v_and_b32 v11, 0xffff0000, v203
    v_lshlrev_b32 v12, 16, v207
    v_and_b32 v13, 0xffff0000, v207
    v_pk_mul_f32 v[62:63], v[62:63], v[10:11]
    v_cvt_pk_bf16_f32 v63, v62, v63
    v_lshlrev_b32 v62, 16, v63
    v_and_b32 v63, 0xffff0000, v63
    v_pk_add_f32 v[62:63], v[62:63], v[12:13]
    v_cvt_pk_bf16_f32 v59, v62, v63
    global_store_dwordx4 v4, v[56:59], s[18:19] offset:3072 sc1
    s_lshl_b32 s12, s14, 2
    s_add_u32 s12, s12, 118784
    v_mov_b32 v10, s12
    v_mov_b32 v11, 1
    s_waitcnt vmcnt(0)
    s_barrier
    s_cmp_lg_u32 s10, 0
    s_cbranch_scc1 L_lnf_7
    s_mov_b64 exec, 1
    global_store_dword v10, v11, s[4:5] sc1
    s_mov_b64 exec, -1
L_lnf_7:
    v_mov_b32 v12, 0x0
    v_bfe_u32 v13, v0, 0, 2
    v_lshl_add_u32 v12, v13, 2, v12
    v_bfe_u32 v13, v0, 2, 1
    v_lshl_add_u32 v12, v13, 7, v12
    s_mov_b32 s12, 0
L_mc_9:
    global_load_dword v13, v12, s[6:7] sc1
    s_add_u32 s12, s12, 1
    s_cmp_gt_u32 s12, 100000
    s_cbranch_scc1 L_exit
    s_waitcnt vmcnt(0)
    v_and_b32 v14, 0xff, v13
    v_cmp_ne_u32 vcc, 32, v14
    s_cbranch_vccz L_mc_done_8
    v_cmp_lt_u32 vcc, 32, v14
    s_cbranch_vccnz L_exit
    s_sleep 24
    s_branch L_mc_9
L_mc_done_8:
    v_readlane_b32 s12, v13, s8
    s_mul_i32 s13, s3, s3
    s_lshl_b32 s13, s13, 10
    s_add_u32 s13, s13, s3
    s_lshl_b32 s13, s13, 8
    s_add_u32 s13, s13, 1
    s_lshl_b32 s13, s13, 5
    s_cmp_eq_u32 s12, s13
    s_cselect_b32 s11, 1, 0
    s_cmp_lg_u32 s10, 0
    s_cbranch_scc1 L_fdw_10
    s_lshl_b32 s12, s9, 7
    s_add_u32 s12, s12, 69632
    v_mov_b32 v12, s12
    s_mov_b32 s14, 4
    s_mov_b32 s12, 0
L_fw_11:
    global_load_dword v13, v12, s[4:5] sc1
    s_add_u32 s12, s12, 1
    s_cmp_gt_u32 s12, 100000
    s_cbranch_scc1 L_exit
    s_waitcnt vmcnt(0)
    v_cmp_gt_u32 vcc, s14, v13
    s_cbranch_vccz L_fwd_12
    s_sleep 32
    s_branch L_fw_11
L_fwd_12:
L_fdw_10:
    s_barrier
    s_load_dwordx4 s[16:19], s[0:1], 64
    s_load_dwordx2 s[20:21], s[0:1], 80
    s_load_dwordx2 s[34:35], s[0:1], 104
    v_mov_b32 v12, 0x0
    v_bfe_u32 v1, v0, 4, 2
    v_mul_u32_u24 v1, 0x2400, v1
    v_add_u32 v12, v12, v1
    v_bfe_u32 v1, v0, 6, 2
    v_mul_u32_u24 v1, 0x24000, v1
    v_add_u32 v12, v12, v1
    v_mov_b32 v2, 0x0
    v_bfe_u32 v1, v0, 0, 4
    v_lshlrev_b32 v1, 4, v1
    v_xor_b32 v2, v2, v1
    v_bfe_u32 v1, v0, 4, 2
    v_lshlrev_b32 v1, 5, v1
    v_xor_b32 v2, v2, v1
    v_add_u32 v12, v12, v2
    v_mov_b32 v13, 0x9000
    v_bfe_u32 v1, v0, 4, 2
    v_mul_u32_u24 v1, 0x2400, v1
    v_add_u32 v13, v13, v1
    v_bfe_u32 v1, v0, 6, 2
    v_mul_u32_u24 v1, 0x24000, v1
    v_add_u32 v13, v13, v1
    v_mov_b32 v2, 0x0
    v_bfe_u32 v1, v0, 0, 4
    v_lshlrev_b32 v1, 4, v1
    v_xor_b32 v2, v2, v1
    v_bfe_u32 v1, v0, 4, 2
    v_lshlrev_b32 v1, 5, v1
    v_xor_b32 v2, v2, v1
    v_add_u32 v13, v13, v2
    v_mov_b32 v14, 0x12000
    v_bfe_u32 v1, v0, 4, 2
    v_mul_u32_u24 v1, 0x2400, v1
    v_add_u32 v14, v14, v1
    v_bfe_u32 v1, v0, 6, 2
    v_mul_u32_u24 v1, 0x24000, v1
    v_add_u32 v14, v14, v1
    v_mov_b32 v2, 0x80
    v_bfe_u32 v1, v0, 0, 4
    v_lshlrev_b32 v1, 4, v1
    v_xor_b32 v2, v2, v1
    v_bfe_u32 v1, v0, 4, 2
    v_lshlrev_b32 v1, 5, v1
    v_xor_b32 v2, v2, v1
    v_add_u32 v14, v14, v2
    v_mov_b32 v15, 0x1b000
    v_bfe_u32 v1, v0, 4, 2
    v_mul_u32_u24 v1, 0x2400, v1
    v_add_u32 v15, v15, v1
    v_bfe_u32 v1, v0, 6, 2
    v_mul_u32_u24 v1, 0x24000, v1
    v_add_u32 v15, v15, v1
    v_mov_b32 v2, 0x80
    v_bfe_u32 v1, v0, 0, 4
    v_lshlrev_b32 v1, 4, v1
    v_xor_b32 v2, v2, v1
    v_bfe_u32 v1, v0, 4, 2
    v_lshlrev_b32 v1, 5, v1
    v_xor_b32 v2, v2, v1
    v_add_u32 v15, v15, v2
    v_mov_b32 v16, 0x0
    v_bfe_u32 v1, v0, 0, 2
    v_lshlrev_b32 v1, 3, v1
    v_xor_b32 v16, v16, v1
    v_bfe_i32 v1, v0, 2, 1
    v_and_b32 v1, 0x120, v1
    v_xor_b32 v16, v16, v1
    v_bfe_i32 v1, v0, 3, 1
    v_and_b32 v1, 0x240, v1
    v_xor_b32 v16, v16, v1
    v_bfe_i32 v1, v0, 4, 1
    v_and_b32 v1, 0x880, v1
    v_xor_b32 v16, v16, v1
    v_bfe_u32 v1, v0, 5, 1
    v_lshlrev_b32 v1, 12, v1
    v_xor_b32 v16, v16, v1
    v_bfe_u32 v1, v0, 6, 2
    v_lshlrev_b32 v1, 6, v1
    v_xor_b32 v16, v16, v1
    v_mov_b32 v17, 0x20
    v_bfe_u32 v1, v0, 0, 2
    v_lshlrev_b32 v1, 3, v1
    v_xor_b32 v17, v17, v1
    v_bfe_i32 v1, v0, 2, 1
    v_and_b32 v1, 0x120, v1
    v_xor_b32 v17, v17, v1
    v_bfe_i32 v1, v0, 3, 1
    v_and_b32 v1, 0x240, v1
    v_xor_b32 v17, v17, v1
    v_bfe_i32 v1, v0, 4, 1
    v_and_b32 v1, 0x880, v1
    v_xor_b32 v17, v17, v1
    v_bfe_u32 v1, v0, 5, 1
    v_lshlrev_b32 v1, 12, v1
    v_xor_b32 v17, v17, v1
    v_bfe_u32 v1, v0, 6, 2
    v_lshlrev_b32 v1, 6, v1
    v_xor_b32 v17, v17, v1
    v_mov_b32 v20, 0x0
    v_bfe_u32 v1, v0, 3, 3
    v_mul_u32_u24 v1, 0x480, v1
    v_add_u32 v20, v20, v1
    v_bfe_u32 v1, v0, 6, 2
    v_mul_u32_u24 v1, 0x9000, v1
    v_add_u32 v20, v20, v1
    v_mov_b32 v2, 0x0
    v_bfe_u32 v1, v0, 0, 3
    v_lshlrev_b32 v1, 4, v1
    v_xor_b32 v2, v2, v1
    v_bfe_u32 v1, v0, 4, 2
    v_lshlrev_b32 v1, 5, v1
    v_xor_b32 v2, v2, v1
    v_add_u32 v20, v20, v2
    v_mov_b32 v21, 0x2400
    v_bfe_u32 v1, v0, 3, 3
    v_mul_u32_u24 v1, 0x480, v1
    v_add_u32 v21, v21, v1
    v_bfe_u32 v1, v0, 6, 2
    v_mul_u32_u24 v1, 0x9000, v1
    v_add_u32 v21, v21, v1
    v_mov_b32 v2, 0x0
    v_bfe_u32 v1, v0, 0, 3
    v_lshlrev_b32 v1, 4, v1
    v_xor_b32 v2, v2, v1
    v_bfe_u32 v1, v0, 4, 2
    v_lshlrev_b32 v1, 5, v1
    v_xor_b32 v2, v2, v1
    v_add_u32 v21, v21, v2
    v_mov_b32 v22, 0x4800
    v_bfe_u32 v1, v0, 3, 3
    v_mul_u32_u24 v1, 0x480, v1
    v_add_u32 v22, v22, v1
    v_bfe_u32 v1, v0, 6, 2
    v_mul_u32_u24 v1, 0x9000, v1
    v_add_u32 v22, v22, v1
    v_mov_b32 v2, 0x0
    v_bfe_u32 v1, v0, 0, 3
    v_lshlrev_b32 v1, 4, v1
    v_xor_b32 v2, v2, v1
    v_bfe_u32 v1, v0, 4, 2
    v_lshlrev_b32 v1, 5, v1
    v_xor_b32 v2, v2, v1
    v_add_u32 v22, v22, v2
    v_mov_b32 v23, 0x6c00
    v_bfe_u32 v1, v0, 3, 3
    v_mul_u32_u24 v1, 0x480, v1
    v_add_u32 v23, v23, v1
    v_bfe_u32 v1, v0, 6, 2
    v_mul_u32_u24 v1, 0x9000, v1
    v_add_u32 v23, v23, v1
    v_mov_b32 v2, 0x0
    v_bfe_u32 v1, v0, 0, 3
    v_lshlrev_b32 v1, 4, v1
    v_xor_b32 v2, v2, v1
    v_bfe_u32 v1, v0, 4, 2
    v_lshlrev_b32 v1, 5, v1
    v_xor_b32 v2, v2, v1
    v_add_u32 v23, v23, v2
    v_mov_b32 v18, 0x0
    v_bfe_u32 v1, v0, 0, 2
    v_lshlrev_b32 v1, 3, v1
    v_xor_b32 v18, v18, v1
    v_bfe_u32 v1, v0, 2, 1
    v_lshlrev_b32 v1, 7, v1
    v_xor_b32 v18, v18, v1
    v_bfe_i32 v1, v0, 3, 1
    v_and_b32 v1, 0x120, v1
    v_xor_b32 v18, v18, v1
    v_bfe_i32 v1, v0, 4, 1
    v_and_b32 v1, 0x240, v1
    v_xor_b32 v18, v18, v1
    v_bfe_u32 v1, v0, 5, 1
    v_lshlrev_b32 v1, 10, v1
    v_xor_b32 v18, v18, v1
    v_bfe_u32 v1, v0, 6, 2
    v_lshlrev_b32 v1, 5, v1
    v_xor_b32 v18, v18, v1
    v_mov_b32 v24, 0x100
    v_bfe_u32 v1, v0, 0, 1
    v_lshl_add_u32 v24, v1, 4, v24
    v_bfe_u32 v1, v0, 1, 7
    v_mul_u32_u24 v1, 0x2400, v1
    v_add_u32 v24, v24, v1
    v_mov_b32 v25, 0x0
    v_bfe_u32 v1, v0, 0, 8
    v_lshl_add_u32 v25, v1, 4, v25
    s_mul_i32 s12, s9, 288
    s_waitcnt lgkmcnt(0)
    s_add_u32 s16, s16, s12
    s_addc_u32 s17, s17, 0
    s_add_u32 s18, s18, s12
    s_addc_u32 s19, s19, 0
    s_mul_i32 s12, s9, 165888
    s_add_u32 s20, s20, s12
    s_addc_u32 s21, s21, 0
    s_lshl_b32 s26, s10, 10
    s_add_u32 s12, s16, 0
    s_addc_u32 s13, s17, 0
    s_add_u32 m0, s26, 0
    s_nop 0
    global_load_lds_dwordx4 v24, s[12:13]
    s_add_u32 s12, s16, 1179648
    s_addc_u32 s13, s17, 0
    s_add_u32 m0, s26, 4096
    s_nop 0
    global_load_lds_dwordx4 v24, s[12:13]
    s_add_u32 s12, s16, 2359296
    s_addc_u32 s13, s17, 0
    s_add_u32 m0, s26, 8192
    s_nop 0
    global_load_lds_dwordx4 v24, s[12:13]
    s_add_u32 s12, s16, 3538944
    s_addc_u32 s13, s17, 0
    s_add_u32 m0, s26, 12288
    s_nop 0
    global_load_lds_dwordx4 v24, s[12:13]
    s_cmp_ge_u32 s10, 2
    s_cbranch_scc1 L_f8_13
    s_add_u32 s12, s16, 4718592
    s_addc_u32 s13, s17, 0
    s_add_u32 m0, s26, 16384
    s_nop 0
    global_load_lds_dwordx4 v24, s[12:13]
L_f8_13:
    s_add_u32 s12, s18, 0
    s_addc_u32 s13, s19, 0
    s_add_u32 m0, s26, 18432
    s_nop 0
    global_load_lds_dwordx4 v24, s[12:13]
    s_add_u32 s12, s18, 1179648
    s_addc_u32 s13, s19, 0
    s_add_u32 m0, s26, 22528
    s_nop 0
    global_load_lds_dwordx4 v24, s[12:13]
    s_add_u32 s12, s18, 2359296
    s_addc_u32 s13, s19, 0
    s_add_u32 m0, s26, 26624
    s_nop 0
    global_load_lds_dwordx4 v24, s[12:13]
    s_add_u32 s12, s18, 3538944
    s_addc_u32 s13, s19, 0
    s_add_u32 m0, s26, 30720
    s_nop 0
    global_load_lds_dwordx4 v24, s[12:13]
    s_cmp_ge_u32 s10, 2
    s_cbranch_scc1 L_f8_14
    s_add_u32 s12, s18, 4718592
    s_addc_u32 s13, s19, 0
    s_add_u32 m0, s26, 34816
    s_nop 0
    global_load_lds_dwordx4 v24, s[12:13]
L_f8_14:
    s_add_u32 s12, s20, 147456
    s_addc_u32 s13, s21, 0
    s_add_u32 m0, s26, 36864
    s_nop 0
    global_load_lds_dwordx4 v25, s[12:13]
    s_add_u32 s12, s20, 151552
    s_addc_u32 s13, s21, 0
    s_add_u32 m0, s26, 40960
    s_nop 0
    global_load_lds_dwordx4 v25, s[12:13]
    s_add_u32 s12, s20, 155648
    s_addc_u32 s13, s21, 0
    s_add_u32 m0, s26, 45056
    s_nop 0
    global_load_lds_dwordx4 v25, s[12:13]
    s_add_u32 s12, s20, 159744
    s_addc_u32 s13, s21, 0
    s_add_u32 m0, s26, 49152
    s_nop 0
    global_load_lds_dwordx4 v25, s[12:13]
    s_cmp_ge_u32 s10, 2
    s_cbranch_scc1 L_f16_15
    s_add_u32 s12, s20, 163840
    s_addc_u32 s13, s21, 0
    s_add_u32 m0, s26, 53248
    s_nop 0
    global_load_lds_dwordx4 v25, s[12:13]
L_f16_15:
    s_lshl_b32 s26, s10, 12
    s_add_u32 s26, s26, 57344
    s_add_u32 s12, s16, 0
    s_addc_u32 s13, s17, 0
    s_add_u32 m0, s26, 0
    s_nop 0
    global_load_lds_dwordx4 v12, s[12:13]
    s_add_u32 m0, s26, 1024
    s_nop 0
    global_load_lds_dwordx4 v13, s[12:13]
    s_add_u32 m0, s26, 2048
    s_nop 0
    global_load_lds_dwordx4 v14, s[12:13]
    s_add_u32 m0, s26, 3072
    s_nop 0
    global_load_lds_dwordx4 v15, s[12:13]
    s_add_u32 s12, s18, 0
    s_addc_u32 s13, s19, 0
    s_add_u32 m0, s26, 16384
    s_nop 0
    global_load_lds_dwordx4 v12, s[12:13]
    s_add_u32 m0, s26, 17408
    s_nop 0
    global_load_lds_dwordx4 v13, s[12:13]
    s_add_u32 m0, s26, 18432
    s_nop 0
    global_load_lds_dwordx4 v14, s[12:13]
    s_add_u32 m0, s26, 19456
    s_nop 0
    global_load_lds_dwordx4 v15, s[12:13]
    s_add_u32 s12, s16, 589824
    s_addc_u32 s13, s17, 0
    s_add_u32 m0, s26, 32768
    s_nop 0
    global_load_lds_dwordx4 v12, s[12:13]
    s_add_u32 m0, s26, 33792
    s_nop 0
    global_load_lds_dwordx4 v13, s[12:13]
    s_add_u32 m0, s26, 34816
    s_nop 0
    global_load_lds_dwordx4 v14, s[12:13]
    s_add_u32 m0, s26, 35840
    s_nop 0
    global_load_lds_dwordx4 v15, s[12:13]
    s_add_u32 s12, s18, 589824
    s_addc_u32 s13, s19, 0
    s_add_u32 m0, s26, 49152
    s_nop 0
    global_load_lds_dwordx4 v12, s[12:13]
    s_add_u32 m0, s26, 50176
    s_nop 0
    global_load_lds_dwordx4 v13, s[12:13]
    s_add_u32 m0, s26, 51200
    s_nop 0
    global_load_lds_dwordx4 v14, s[12:13]
    s_add_u32 m0, s26, 52224
    s_nop 0
    global_load_lds_dwordx4 v15, s[12:13]
    s_add_u32 s12, s16, 1179648
    s_addc_u32 s13, s17, 0
    s_add_u32 m0, s26, 65536
    s_nop 0
    global_load_lds_dwordx4 v12, s[12:13]
    s_add_u32 m0, s26, 66560
    s_nop 0
    global_load_lds_dwordx4 v13, s[12:13]
    s_add_u32 m0, s26, 67584
    s_nop 0
    global_load_lds_dwordx4 v14, s[12:13]
    s_add_u32 m0, s26, 68608
    s_nop 0
    global_load_lds_dwordx4 v15, s[12:13]
    s_waitcnt vmcnt(16)
    s_barrier
    s_add_u32 s12, s18, 1179648
    s_addc_u32 s13, s19, 0
    s_add_u32 m0, s26, 81920
    s_nop 0
    global_load_lds_dwordx4 v12, s[12:13]
    s_add_u32 m0, s26, 82944
    s_nop 0
    global_load_lds_dwordx4 v13, s[12:13]
    s_add_u32 m0, s26, 83968
    s_nop 0
    global_load_lds_dwordx4 v14, s[12:13]
    s_add_u32 m0, s26, 84992
    s_nop 0
    global_load_lds_dwordx4 v15, s[12:13]
    v_add_u32 v28, 57344, v16
    v_add_u32 v29, 57344, v17
    ds_read_b64_tr_b16 a[0:1], v28 offset:0
    ds_read_b64_tr_b16 a[2:3], v28 offset:1024
    ds_read_b64_tr_b16 a[4:5], v29 offset:0
    ds_read_b64_tr_b16 a[6:7], v29 offset:1024
    ds_read_b64_tr_b16 a[16:17], v28 offset:8192
    ds_read_b64_tr_b16 a[18:19], v28 offset:9216
    ds_read_b64_tr_b16 a[20:21], v29 offset:8192
    ds_read_b64_tr_b16 a[22:23], v29 offset:9216
    s_waitcnt lgkmcnt(0)
    s_waitcnt vmcnt(16)
    s_barrier
    s_add_u32 s12, s16, 1769472
    s_addc_u32 s13, s17, 0
    s_add_u32 m0, s26, 0
    s_nop 0
    global_load_lds_dwordx4 v12, s[12:13]
    s_add_u32 m0, s26, 1024
    s_nop 0
    global_load_lds_dwordx4 v13, s[12:13]
    s_add_u32 m0, s26, 2048
    s_nop 0
    global_load_lds_dwordx4 v14, s[12:13]
    s_add_u32 m0, s26, 3072
    s_nop 0
    global_load_lds_dwordx4 v15, s[12:13]
    v_add_u32 v28, 73728, v16
    v_add_u32 v29, 73728, v17
    ds_read_b64_tr_b16 a[8:9], v28 offset:0
    ds_read_b64_tr_b16 a[10:11], v28 offset:1024
    ds_read_b64_tr_b16 a[12:13], v29 offset:0
    ds_read_b64_tr_b16 a[14:15], v29 offset:1024
    ds_read_b64_tr_b16 a[24:25], v28 offset:8192
    ds_read_b64_tr_b16 a[26:27], v28 offset:9216
    ds_read_b64_tr_b16 a[28:29], v29 offset:8192
    ds_read_b64_tr_b16 a[30:31], v29 offset:9216
    s_waitcnt lgkmcnt(0)
    s_waitcnt vmcnt(16)
    s_barrier
    s_add_u32 s12, s18, 1769472
    s_addc_u32 s13, s19, 0
    s_add_u32 m0, s26, 16384
    s_nop 0
    global_load_lds_dwordx4 v12, s[12:13]
    s_add_u32 m0, s26, 17408
    s_nop 0
    global_load_lds_dwordx4 v13, s[12:13]
    s_add_u32 m0, s26, 18432
    s_nop 0
    global_load_lds_dwordx4 v14, s[12:13]
    s_add_u32 m0, s26, 19456
    s_nop 0
    global_load_lds_dwordx4 v15, s[12:13]
    v_add_u32 v28, 90112, v16
    v_add_u32 v29, 90112, v17
    ds_read_b64_tr_b16 a[32:33], v28 offset:0
    ds_read_b64_tr_b16 a[34:35], v28 offset:1024
    ds_read_b64_tr_b16 a[36:37], v29 offset:0
    ds_read_b64_tr_b16 a[38:39], v29 offset:1024
    ds_read_b64_tr_b16 a[48:49], v28 offset:8192
    ds_read_b64_tr_b16 a[50:51], v28 offset:9216
    ds_read_b64_tr_b16 a[52:53], v29 offset:8192
    ds_read_b64_tr_b16 a[54:55], v29 offset:9216
    s_waitcnt lgkmcnt(0)
    s_waitcnt vmcnt(16)
    s_barrier
    s_add_u32 s12, s16, 2359296
    s_addc_u32 s13, s17, 0
    s_add_u32 m0, s26, 32768
    s_nop 0
    global_load_lds_dwordx4 v12, s[12:13]
    s_add_u32 m0, s26, 33792
    s_nop 0
    global_load_lds_dwordx4 v13, s[12:13]
    s_add_u32 m0, s26, 34816
    s_nop 0
    global_load_lds_dwordx4 v14, s[12:13]
    s_add_u32 m0, s26, 35840
    s_nop 0
    global_load_lds_dwordx4 v15, s[12:13]
    v_add_u32 v28, 106496, v16
    v_add_u32 v29, 106496, v17
    ds_read_b64_tr_b16 a[40:41], v28 offset:0
    ds_read_b64_tr_b16 a[42:43], v28 offset:1024
    ds_read_b64_tr_b16 a[44:45], v29 offset:0
    ds_read_b64_tr_b16 a[46:47], v29 offset:1024
    ds_read_b64_tr_b16 a[56:57], v28 offset:8192
    ds_read_b64_tr_b16 a[58:59], v28 offset:9216
    ds_read_b64_tr_b16 a[60:61], v29 offset:8192
    ds_read_b64_tr_b16 a[62:63], v29 offset:9216
    s_waitcnt lgkmcnt(0)
    s_waitcnt vmcnt(16)
    s_barrier
    s_add_u32 s12, s18, 2359296
    s_addc_u32 s13, s19, 0
    s_add_u32 m0, s26, 49152
    s_nop 0
    global_load_lds_dwordx4 v12, s[12:13]
    s_add_u32 m0, s26, 50176
    s_nop 0
    global_load_lds_dwordx4 v13, s[12:13]
    s_add_u32 m0, s26, 51200
    s_nop 0
    global_load_lds_dwordx4 v14, s[12:13]
    s_add_u32 m0, s26, 52224
    s_nop 0
    global_load_lds_dwordx4 v15, s[12:13]
    v_add_u32 v28, 122880, v16
    v_add_u32 v29, 122880, v17
    ds_read_b64_tr_b16 a[64:65], v28 offset:0
    ds_read_b64_tr_b16 a[66:67], v28 offset:1024
    ds_read_b64_tr_b16 a[68:69], v29 offset:0
    ds_read_b64_tr_b16 a[70:71], v29 offset:1024
    ds_read_b64_tr_b16 a[80:81], v28 offset:8192
    ds_read_b64_tr_b16 a[82:83], v28 offset:9216
    ds_read_b64_tr_b16 a[84:85], v29 offset:8192
    ds_read_b64_tr_b16 a[86:87], v29 offset:9216
    s_waitcnt lgkmcnt(0)
    s_waitcnt vmcnt(16)
    s_barrier
    s_add_u32 s12, s16, 2949120
    s_addc_u32 s13, s17, 0
    s_add_u32 m0, s26, 65536
    s_nop 0
    global_load_lds_dwordx4 v12, s[12:13]
    s_add_u32 m0, s26, 66560
    s_nop 0
    global_load_lds_dwordx4 v13, s[12:13]
    s_add_u32 m0, s26, 67584
    s_nop 0
    global_load_lds_dwordx4 v14, s[12:13]
    s_add_u32 m0, s26, 68608
    s_nop 0
    global_load_lds_dwordx4 v15, s[12:13]
    v_add_u32 v28, 139264, v16
    v_add_u32 v29, 139264, v17
    ds_read_b64_tr_b16 a[72:73], v28 offset:0
    ds_read_b64_tr_b16 a[74:75], v28 offset:1024
    ds_read_b64_tr_b16 a[76:77], v29 offset:0
    ds_read_b64_tr_b16 a[78:79], v29 offset:1024
    ds_read_b64_tr_b16 a[88:89], v28 offset:8192
    ds_read_b64_tr_b16 a[90:91], v28 offset:9216
    ds_read_b64_tr_b16 a[92:93], v29 offset:8192
    ds_read_b64_tr_b16 a[94:95], v29 offset:9216
    s_waitcnt lgkmcnt(0)
    s_waitcnt vmcnt(16)
    s_barrier
    s_add_u32 s12, s18, 2949120
    s_addc_u32 s13, s19, 0
    s_add_u32 m0, s26, 81920
    s_nop 0
    global_load_lds_dwordx4 v12, s[12:13]
    s_add_u32 m0, s26, 82944
    s_nop 0
    global_load_lds_dwordx4 v13, s[12:13]
    s_add_u32 m0, s26, 83968
    s_nop 0
    global_load_lds_dwordx4 v14, s[12:13]
    s_add_u32 m0, s26, 84992
    s_nop 0
    global_load_lds_dwordx4 v15, s[12:13]
    v_add_u32 v28, 57344, v16
    v_add_u32 v29, 57344, v17
    ds_read_b64_tr_b16 a[96:97], v28 offset:0
    ds_read_b64_tr_b16 a[98:99], v28 offset:1024
    ds_read_b64_tr_b16 a[100:101], v29 offset:0
    ds_read_b64_tr_b16 a[102:103], v29 offset:1024
    ds_read_b64_tr_b16 a[112:113], v28 offset:8192
    ds_read_b64_tr_b16 a[114:115], v28 offset:9216
    ds_read_b64_tr_b16 a[116:117], v29 offset:8192
    ds_read_b64_tr_b16 a[118:119], v29 offset:9216
    s_waitcnt lgkmcnt(0)
    s_waitcnt vmcnt(16)
    s_barrier
    s_add_u32 s12, s16, 3538944
    s_addc_u32 s13, s17, 0
    s_add_u32 m0, s26, 0
    s_nop 0
    global_load_lds_dwordx4 v12, s[12:13]
    s_add_u32 m0, s26, 1024
    s_nop 0
    global_load_lds_dwordx4 v13, s[12:13]
    s_add_u32 m0, s26, 2048
    s_nop 0
    global_load_lds_dwordx4 v14, s[12:13]
    s_add_u32 m0, s26, 3072
    s_nop 0
    global_load_lds_dwordx4 v15, s[12:13]
    v_add_u32 v28, 73728, v16
    v_add_u32 v29, 73728, v17
    ds_read_b64_tr_b16 a[104:105], v28 offset:0
    ds_read_b64_tr_b16 a[106:107], v28 offset:1024
    ds_read_b64_tr_b16 a[108:109], v29 offset:0
    ds_read_b64_tr_b16 a[110:111], v29 offset:1024
    ds_read_b64_tr_b16 a[120:121], v28 offset:8192
    ds_read_b64_tr_b16 a[122:123], v28 offset:9216
    ds_read_b64_tr_b16 a[124:125], v29 offset:8192
    ds_read_b64_tr_b16 a[126:127], v29 offset:9216
    s_waitcnt lgkmcnt(0)
    s_waitcnt vmcnt(16)
    s_barrier
    s_add_u32 s12, s18, 3538944
    s_addc_u32 s13, s19, 0
    s_add_u32 m0, s26, 16384
    s_nop 0
    global_load_lds_dwordx4 v12, s[12:13]
    s_add_u32 m0, s26, 17408
    s_nop 0
    global_load_lds_dwordx4 v13, s[12:13]
    s_add_u32 m0, s26, 18432
    s_nop 0
    global_load_lds_dwordx4 v14, s[12:13]
    s_add_u32 m0, s26, 19456
    s_nop 0
    global_load_lds_dwordx4 v15, s[12:13]
    v_add_u32 v28, 90112, v16
    v_add_u32 v29, 90112, v17
    ds_read_b64_tr_b16 a[128:129], v28 offset:0
    ds_read_b64_tr_b16 a[130:131], v28 offset:1024
    ds_read_b64_tr_b16 a[132:133], v29 offset:0
    ds_read_b64_tr_b16 a[134:135], v29 offset:1024
    ds_read_b64_tr_b16 a[144:145], v28 offset:8192
    ds_read_b64_tr_b16 a[146:147], v28 offset:9216
    ds_read_b64_tr_b16 a[148:149], v29 offset:8192
    ds_read_b64_tr_b16 a[150:151], v29 offset:9216
    s_waitcnt lgkmcnt(0)
    s_waitcnt vmcnt(16)
    s_barrier
    s_add_u32 s12, s16, 4128768
    s_addc_u32 s13, s17, 0
    s_add_u32 m0, s26, 32768
    s_nop 0
    global_load_lds_dwordx4 v12, s[12:13]
    s_add_u32 m0, s26, 33792
    s_nop 0
    global_load_lds_dwordx4 v13, s[12:13]
    s_add_u32 m0, s26, 34816
    s_nop 0
    global_load_lds_dwordx4 v14, s[12:13]
    s_add_u32 m0, s26, 35840
    s_nop 0
    global_load_lds_dwordx4 v15, s[12:13]
    v_add_u32 v28, 106496, v16
    v_add_u32 v29, 106496, v17
    ds_read_b64_tr_b16 a[136:137], v28 offset:0
    ds_read_b64_tr_b16 a[138:139], v28 offset:1024
    ds_read_b64_tr_b16 a[140:141], v29 offset:0
    ds_read_b64_tr_b16 a[142:143], v29 offset:1024
    ds_read_b64_tr_b16 a[152:153], v28 offset:8192
    ds_read_b64_tr_b16 a[154:155], v28 offset:9216
    ds_read_b64_tr_b16 a[156:157], v29 offset:8192
    ds_read_b64_tr_b16 a[158:159], v29 offset:9216
    s_waitcnt lgkmcnt(0)
    s_waitcnt vmcnt(16)
    s_barrier
    s_add_u32 s12, s18, 4128768
    s_addc_u32 s13, s19, 0
    s_add_u32 m0, s26, 49152
    s_nop 0
    global_load_lds_dwordx4 v12, s[12:13]
    s_add_u32 m0, s26, 50176
    s_nop 0
    global_load_lds_dwordx4 v13, s[12:13]
    s_add_u32 m0, s26, 51200
    s_nop 0
    global_load_lds_dwordx4 v14, s[12:13]
    s_add_u32 m0, s26, 52224
    s_nop 0
    global_load_lds_dwordx4 v15, s[12:13]
    v_add_u32 v28, 122880, v16
    v_add_u32 v29, 122880, v17
    ds_read_b64_tr_b16 a[160:161], v28 offset:0
    ds_read_b64_tr_b16 a[162:163], v28 offset:1024
    ds_read_b64_tr_b16 a[164:165], v29 offset:0
    ds_read_b64_tr_b16 a[166:167], v29 offset:1024
    ds_read_b64_tr_b16 a[176:177], v28 offset:8192
    ds_read_b64_tr_b16 a[178:179], v28 offset:9216
    ds_read_b64_tr_b16 a[180:181], v29 offset:8192
    ds_read_b64_tr_b16 a[182:183], v29 offset:9216
    s_waitcnt lgkmcnt(0)
    s_waitcnt vmcnt(16)
    s_barrier
    s_add_u32 s12, s16, 4718592
    s_addc_u32 s13, s17, 0
    s_add_u32 m0, s26, 65536
    s_nop 0
    global_load_lds_dwordx4 v12, s[12:13]
    s_add_u32 m0, s26, 66560
    s_nop 0
    global_load_lds_dwordx4 v13, s[12:13]
    s_add_u32 m0, s26, 67584
    s_nop 0
    global_load_lds_dwordx4 v14, s[12:13]
    s_add_u32 m0, s26, 68608
    s_nop 0
    global_load_lds_dwordx4 v15, s[12:13]
    v_add_u32 v28, 139264, v16
    v_add_u32 v29, 139264, v17
    ds_read_b64_tr_b16 a[168:169], v28 offset:0
    ds_read_b64_tr_b16 a[170:171], v28 offset:1024
    ds_read_b64_tr_b16 a[172:173], v29 offset:0
    ds_read_b64_tr_b16 a[174:175], v29 offset:1024
    ds_read_b64_tr_b16 a[184:185], v28 offset:8192
    ds_read_b64_tr_b16 a[186:187], v28 offset:9216
    ds_read_b64_tr_b16 a[188:189], v29 offset:8192
    ds_read_b64_tr_b16 a[190:191], v29 offset:9216
    s_waitcnt lgkmcnt(0)
    s_waitcnt vmcnt(16)
    s_barrier
    s_add_u32 s12, s18, 4718592
    s_addc_u32 s13, s19, 0
    s_add_u32 m0, s26, 81920
    s_nop 0
    global_load_lds_dwordx4 v12, s[12:13]
    s_add_u32 m0, s26, 82944
    s_nop 0
    global_load_lds_dwordx4 v13, s[12:13]
    s_add_u32 m0, s26, 83968
    s_nop 0
    global_load_lds_dwordx4 v14, s[12:13]
    s_add_u32 m0, s26, 84992
    s_nop 0
    global_load_lds_dwordx4 v15, s[12:13]
    v_add_u32 v28, 57344, v16
    v_add_u32 v29, 57344, v17
    ds_read_b64_tr_b16 a[192:193], v28 offset:0
    ds_read_b64_tr_b16 a[194:195], v28 offset:1024
    ds_read_b64_tr_b16 a[196:197], v29 offset:0
    ds_read_b64_tr_b16 a[198:199], v29 offset:1024
    ds_read_b64_tr_b16 a[208:209], v28 offset:8192
    ds_read_b64_tr_b16 a[210:211], v28 offset:9216
    ds_read_b64_tr_b16 a[212:213], v29 offset:8192
    ds_read_b64_tr_b16 a[214:215], v29 offset:9216
    s_waitcnt lgkmcnt(0)
    s_waitcnt vmcnt(16)
    s_barrier
    s_add_u32 s12, s20, 0
    s_addc_u32 s13, s21, 0
    s_add_u32 m0, s26, 0
    s_nop 0
    global_load_lds_dwordx4 v20, s[12:13]
    s_add_u32 m0, s26, 1024
    s_nop 0
    global_load_lds_dwordx4 v21, s[12:13]
    s_add_u32 m0, s26, 2048
    s_nop 0
    global_load_lds_dwordx4 v22, s[12:13]
    s_add_u32 m0, s26, 3072
    s_nop 0
    global_load_lds_dwordx4 v23, s[12:13]
    v_add_u32 v28, 73728, v16
    v_add_u32 v29, 73728, v17
    ds_read_b64_tr_b16 a[200:201], v28 offset:0
    ds_read_b64_tr_b16 a[202:203], v28 offset:1024
    ds_read_b64_tr_b16 a[204:205], v29 offset:0
    ds_read_b64_tr_b16 a[206:207], v29 offset:1024
    ds_read_b64_tr_b16 a[216:217], v28 offset:8192
    ds_read_b64_tr_b16 a[218:219], v28 offset:9216
    ds_read_b64_tr_b16 a[220:221], v29 offset:8192
    ds_read_b64_tr_b16 a[222:223], v29 offset:9216
    s_waitcnt lgkmcnt(0)
    s_waitcnt vmcnt(16)
    s_barrier
    s_add_u32 s12, s20, 128
    s_addc_u32 s13, s21, 0
    s_add_u32 m0, s26, 16384
    s_nop 0
    global_load_lds_dwordx4 v20, s[12:13]
    s_add_u32 m0, s26, 17408
    s_nop 0
    global_load_lds_dwordx4 v21, s[12:13]
    s_add_u32 m0, s26, 18432
    s_nop 0
    global_load_lds_dwordx4 v22, s[12:13]
    s_add_u32 m0, s26, 19456
    s_nop 0
    global_load_lds_dwordx4 v23, s[12:13]
    v_add_u32 v28, 90112, v16
    v_add_u32 v29, 90112, v17
    ds_read_b64_tr_b16 a[224:225], v28 offset:0
    ds_read_b64_tr_b16 a[226:227], v28 offset:1024
    ds_read_b64_tr_b16 a[228:229], v29 offset:0
    ds_read_b64_tr_b16 a[230:231], v29 offset:1024
    ds_read_b64_tr_b16 a[240:241], v28 offset:8192
    ds_read_b64_tr_b16 a[242:243], v28 offset:9216
    ds_read_b64_tr_b16 a[244:245], v29 offset:8192
    ds_read_b64_tr_b16 a[246:247], v29 offset:9216
    s_waitcnt lgkmcnt(0)
    s_waitcnt vmcnt(16)
    s_barrier
    s_add_u32 s12, s20, 256
    s_addc_u32 s13, s21, 0
    s_add_u32 m0, s26, 32768
    s_nop 0
    global_load_lds_dwordx4 v20, s[12:13]
    s_add_u32 m0, s26, 33792
    s_nop 0
    global_load_lds_dwordx4 v21, s[12:13]
    s_add_u32 m0, s26, 34816
    s_nop 0
    global_load_lds_dwordx4 v22, s[12:13]
    s_add_u32 m0, s26, 35840
    s_nop 0
    global_load_lds_dwordx4 v23, s[12:13]
    v_add_u32 v28, 106496, v16
    v_add_u32 v29, 106496, v17
    ds_read_b64_tr_b16 a[232:233], v28 offset:0
    ds_read_b64_tr_b16 a[234:235], v28 offset:1024
    ds_read_b64_tr_b16 a[236:237], v29 offset:0
    ds_read_b64_tr_b16 a[238:239], v29 offset:1024
    ds_read_b64_tr_b16 a[248:249], v28 offset:8192
    ds_read_b64_tr_b16 a[250:251], v28 offset:9216
    ds_read_b64_tr_b16 a[252:253], v29 offset:8192
    ds_read_b64_tr_b16 a[254:255], v29 offset:9216
    s_waitcnt lgkmcnt(0)
    s_waitcnt vmcnt(16)
    s_barrier
    s_add_u32 s12, s20, 384
    s_addc_u32 s13, s21, 0
    s_add_u32 m0, s26, 49152
    s_nop 0
    global_load_lds_dwordx4 v20, s[12:13]
    s_add_u32 m0, s26, 50176
    s_nop 0
    global_load_lds_dwordx4 v21, s[12:13]
    s_add_u32 m0, s26, 51200
    s_nop 0
    global_load_lds_dwordx4 v22, s[12:13]
    s_add_u32 m0, s26, 52224
    s_nop 0
    global_load_lds_dwordx4 v23, s[12:13]
    v_add_u32 v28, 122880, v16
    v_add_u32 v29, 122880, v17
    ds_read_b64_tr_b16 v[80:81], v28 offset:0
    ds_read_b64_tr_b16 v[82:83], v28 offset:1024
    ds_read_b64_tr_b16 v[84:85], v29 offset:0
    ds_read_b64_tr_b16 v[86:87], v29 offset:1024
    ds_read_b64_tr_b16 v[96:97], v28 offset:8192
    ds_read_b64_tr_b16 v[98:99], v28 offset:9216
    ds_read_b64_tr_b16 v[100:101], v29 offset:8192
    ds_read_b64_tr_b16 v[102:103], v29 offset:9216
    s_waitcnt lgkmcnt(0)
    s_waitcnt vmcnt(16)
    s_barrier
    s_add_u32 s12, s20, 512
    s_addc_u32 s13, s21, 0
    s_add_u32 m0, s26, 65536
    s_nop 0
    global_load_lds_dwordx4 v20, s[12:13]
    s_add_u32 m0, s26, 66560
    s_nop 0
    global_load_lds_dwordx4 v21, s[12:13]
    s_add_u32 m0, s26, 67584
    s_nop 0
    global_load_lds_dwordx4 v22, s[12:13]
    s_add_u32 m0, s26, 68608
    s_nop 0
    global_load_lds_dwordx4 v23, s[12:13]
    v_add_u32 v28, 139264, v16
    v_add_u32 v29, 139264, v17
    ds_read_b64_tr_b16 v[88:89], v28 offset:0
    ds_read_b64_tr_b16 v[90:91], v28 offset:1024
    ds_read_b64_tr_b16 v[92:93], v29 offset:0
    ds_read_b64_tr_b16 v[94:95], v29 offset:1024
    ds_read_b64_tr_b16 v[104:105], v28 offset:8192
    ds_read_b64_tr_b16 v[106:107], v28 offset:9216
    ds_read_b64_tr_b16 v[108:109], v29 offset:8192
    ds_read_b64_tr_b16 v[110:111], v29 offset:9216
    s_waitcnt lgkmcnt(0)
    s_waitcnt vmcnt(16)
    s_barrier
    s_add_u32 s12, s20, 640
    s_addc_u32 s13, s21, 0
    s_add_u32 m0, s26, 81920
    s_nop 0
    global_load_lds_dwordx4 v20, s[12:13]
    s_add_u32 m0, s26, 82944
    s_nop 0
    global_load_lds_dwordx4 v21, s[12:13]
    s_add_u32 m0, s26, 83968
    s_nop 0
    global_load_lds_dwordx4 v22, s[12:13]
    s_add_u32 m0, s26, 84992
    s_nop 0
    global_load_lds_dwordx4 v23, s[12:13]
    v_add_u32 v28, 57344, v18
    ds_read_b64_tr_b16 v[112:113], v28 offset:0
    ds_read_b64_tr_b16 v[114:115], v28 offset:2048
    ds_read_b64_tr_b16 v[116:117], v28 offset:4096
    ds_read_b64_tr_b16 v[118:119], v28 offset:6144
    ds_read_b64_tr_b16 v[120:121], v28 offset:8192
    ds_read_b64_tr_b16 v[122:123], v28 offset:10240
    ds_read_b64_tr_b16 v[124:125], v28 offset:12288
    ds_read_b64_tr_b16 v[126:127], v28 offset:14336
    s_waitcnt lgkmcnt(0)
    s_waitcnt vmcnt(16)
    s_barrier
    s_add_u32 s12, s20, 768
    s_addc_u32 s13, s21, 0
    s_add_u32 m0, s26, 0
    s_nop 0
    global_load_lds_dwordx4 v20, s[12:13]
    s_add_u32 m0, s26, 1024
    s_nop 0
    global_load_lds_dwordx4 v21, s[12:13]
    s_add_u32 m0, s26, 2048
    s_nop 0
    global_load_lds_dwordx4 v22, s[12:13]
    s_add_u32 m0, s26, 3072
    s_nop 0
    global_load_lds_dwordx4 v23, s[12:13]
    v_add_u32 v28, 73728, v18
    ds_read_b64_tr_b16 v[128:129], v28 offset:0
    ds_read_b64_tr_b16 v[130:131], v28 offset:2048
    ds_read_b64_tr_b16 v[132:133], v28 offset:4096
    ds_read_b64_tr_b16 v[134:135], v28 offset:6144
    ds_read_b64_tr_b16 v[136:137], v28 offset:8192
    ds_read_b64_tr_b16 v[138:139], v28 offset:10240
    ds_read_b64_tr_b16 v[140:141], v28 offset:12288
    ds_read_b64_tr_b16 v[142:143], v28 offset:14336
    s_waitcnt lgkmcnt(0)
    s_waitcnt vmcnt(16)
    s_barrier
    s_add_u32 s12, s20, 896
    s_addc_u32 s13, s21, 0
    s_add_u32 m0, s26, 16384
    s_nop 0
    global_load_lds_dwordx4 v20, s[12:13]
    s_add_u32 m0, s26, 17408
    s_nop 0
    global_load_lds_dwordx4 v21, s[12:13]
    s_add_u32 m0, s26, 18432
    s_nop 0
    global_load_lds_dwordx4 v22, s[12:13]
    s_add_u32 m0, s26, 19456
    s_nop 0
    global_load_lds_dwordx4 v23, s[12:13]
    v_add_u32 v28, 90112, v18
    ds_read_b64_tr_b16 v[144:145], v28 offset:0
    ds_read_b64_tr_b16 v[146:147], v28 offset:2048
    ds_read_b64_tr_b16 v[148:149], v28 offset:4096
    ds_read_b64_tr_b16 v[150:151], v28 offset:6144
    ds_read_b64_tr_b16 v[152:153], v28 offset:8192
    ds_read_b64_tr_b16 v[154:155], v28 offset:10240
    ds_read_b64_tr_b16 v[156:157], v28 offset:12288
    ds_read_b64_tr_b16 v[158:159], v28 offset:14336
    s_waitcnt lgkmcnt(0)
    s_waitcnt vmcnt(16)
    s_barrier
    s_add_u32 s12, s20, 1024
    s_addc_u32 s13, s21, 0
    s_add_u32 m0, s26, 32768
    s_nop 0
    global_load_lds_dwordx4 v20, s[12:13]
    s_add_u32 m0, s26, 33792
    s_nop 0
    global_load_lds_dwordx4 v21, s[12:13]
    s_add_u32 m0, s26, 34816
    s_nop 0
    global_load_lds_dwordx4 v22, s[12:13]
    s_add_u32 m0, s26, 35840
    s_nop 0
    global_load_lds_dwordx4 v23, s[12:13]
    v_add_u32 v28, 106496, v18
    ds_read_b64_tr_b16 v[160:161], v28 offset:0
    ds_read_b64_tr_b16 v[162:163], v28 offset:2048
    ds_read_b64_tr_b16 v[164:165], v28 offset:4096
    ds_read_b64_tr_b16 v[166:167], v28 offset:6144
    ds_read_b64_tr_b16 v[168:169], v28 offset:8192
    ds_read_b64_tr_b16 v[170:171], v28 offset:10240
    ds_read_b64_tr_b16 v[172:173], v28 offset:12288
    ds_read_b64_tr_b16 v[174:175], v28 offset:14336
    s_waitcnt lgkmcnt(0)
    s_waitcnt vmcnt(16)
    s_barrier
    v_add_u32 v28, 122880, v18
    ds_read_b64_tr_b16 v[176:177], v28 offset:0
    ds_read_b64_tr_b16 v[178:179], v28 offset:2048
    ds_read_b64_tr_b16 v[180:181], v28 offset:4096
    ds_read_b64_tr_b16 v[182:183], v28 offset:6144
    ds_read_b64_tr_b16 v[184:185], v28 offset:8192
    ds_read_b64_tr_b16 v[186:187], v28 offset:10240
    ds_read_b64_tr_b16 v[188:189], v28 offset:12288
    ds_read_b64_tr_b16 v[190:191], v28 offset:14336
    s_waitcnt lgkmcnt(0)
    s_waitcnt vmcnt(12)
    s_barrier
    v_add_u32 v28, 139264, v18
    ds_read_b64_tr_b16 v[192:193], v28 offset:0
    ds_read_b64_tr_b16 v[194:195], v28 offset:2048
    ds_read_b64_tr_b16 v[196:197], v28 offset:4096
    ds_read_b64_tr_b16 v[198:199], v28 offset:6144
    ds_read_b64_tr_b16 v[200:201], v28 offset:8192
    ds_read_b64_tr_b16 v[202:203], v28 offset:10240
    ds_read_b64_tr_b16 v[204:205], v28 offset:12288
    ds_read_b64_tr_b16 v[206:207], v28 offset:14336
    s_waitcnt lgkmcnt(0)
    s_waitcnt vmcnt(8)
    s_barrier
    v_add_u32 v28, 57344, v18
    ds_read_b64_tr_b16 v[208:209], v28 offset:0
    ds_read_b64_tr_b16 v[210:211], v28 offset:2048
    ds_read_b64_tr_b16 v[212:213], v28 offset:4096
    ds_read_b64_tr_b16 v[214:215], v28 offset:6144
    ds_read_b64_tr_b16 v[216:217], v28 offset:8192
    ds_read_b64_tr_b16 v[218:219], v28 offset:10240
    ds_read_b64_tr_b16 v[220:221], v28 offset:12288
    ds_read_b64_tr_b16 v[222:223], v28 offset:14336
    s_waitcnt lgkmcnt(0)
    s_waitcnt vmcnt(4)
    s_barrier
    v_add_u32 v28, 73728, v18
    ds_read_b64_tr_b16 v[224:225], v28 offset:0
    ds_read_b64_tr_b16 v[226:227], v28 offset:2048
    ds_read_b64_tr_b16 v[228:229], v28 offset:4096
    ds_read_b64_tr_b16 v[230:231], v28 offset:6144
    ds_read_b64_tr_b16 v[232:233], v28 offset:8192
    ds_read_b64_tr_b16 v[234:235], v28 offset:10240
    ds_read_b64_tr_b16 v[236:237], v28 offset:12288
    ds_read_b64_tr_b16 v[238:239], v28 offset:14336
    s_waitcnt lgkmcnt(0)
    s_waitcnt vmcnt(0)
    s_barrier
    v_add_u32 v28, 90112, v18
    ds_read_b64_tr_b16 v[240:241], v28 offset:0
    ds_read_b64_tr_b16 v[242:243], v28 offset:2048
    ds_read_b64_tr_b16 v[244:245], v28 offset:4096
    ds_read_b64_tr_b16 v[246:247], v28 offset:6144
    ds_read_b64_tr_b16 v[248:249], v28 offset:8192
    ds_read_b64_tr_b16 v[250:251], v28 offset:10240
    ds_read_b64_tr_b16 v[252:253], v28 offset:12288
    ds_read_b64_tr_b16 v[254:255], v28 offset:14336
    s_waitcnt lgkmcnt(0)
    s_barrier
    v_mov_b32 v12, 0x0
    v_bfe_u32 v13, v0, 0, 2
    v_lshl_add_u32 v12, v13, 2, v12
    v_bfe_u32 v13, v0, 2, 1
    v_lshl_add_u32 v12, v13, 7, v12
    s_mov_b32 s12, 0
L_mc_17:
    global_load_dword v13, v12, s[6:7] sc1
    s_add_u32 s12, s12, 1
    s_cmp_gt_u32 s12, 100000
    s_cbranch_scc1 L_exit
    s_waitcnt vmcnt(0)
    v_and_b32 v14, 0xff, v13
    v_cmp_ne_u32 vcc, 32, v14
    s_cbranch_vccz L_mc_done_16
    v_cmp_lt_u32 vcc, 32, v14
    s_cbranch_vccnz L_exit
    s_sleep 24
    s_branch L_mc_17
L_mc_done_16:
    v_readlane_b32 s12, v13, s8
    s_mul_i32 s13, s3, s3
    s_lshl_b32 s13, s13, 10
    s_add_u32 s13, s13, s3
    s_lshl_b32 s13, s13, 8
    s_add_u32 s13, s13, 1
    s_lshl_b32 s13, s13, 5
    s_cmp_eq_u32 s12, s13
    s_cselect_b32 s11, 1, 0
    v_mov_b32 v1, 0x0
    v_bfe_u32 v12, v0, 0, 6
    v_lshl_add_u32 v1, v12, 4, v1
    v_mov_b32 v2, 0x0
    v_bfe_u32 v12, v0, 0, 4
    v_lshl_add_u32 v2, v12, 3, v2
    v_bfe_u32 v12, v0, 4, 2
    v_mul_u32_u24 v12, 0x24000, v12
    v_add_u32 v2, v2, v12
    v_bfe_u32 v12, v0, 6, 2
    v_lshl_add_u32 v2, v12, 8, v2
    v_mov_b32 v3, 0x400
    v_bfe_u32 v12, v0, 0, 4
    v_mul_u32_u24 v12, 0x9000, v12
    v_add_u32 v3, v3, v12
    v_bfe_u32 v12, v0, 4, 4
    v_lshl_add_u32 v3, v12, 3, v3
    v_mov_b32 v4, 0x0
    v_bfe_u32 v12, v0, 0, 4
    v_lshl_add_u32 v4, v12, 4, v4
    v_bfe_u32 v12, v0, 4, 2
    v_mul_u32_u24 v12, 0x480, v12
    v_add_u32 v4, v4, v12
    v_bfe_u32 v12, v0, 6, 2
    v_lshl_add_u32 v4, v12, 8, v4
    v_mov_b32 v6, 0x400
    v_bfe_u32 v12, v0, 0, 3
    v_lshl_add_u32 v6, v12, 4, v6
    v_bfe_u32 v12, v0, 3, 5
    v_mul_u32_u24 v12, 0x480, v12
    v_add_u32 v6, v6, v12
    v_mov_b32 v5, 0x1b000
    v_bfe_u32 v12, v0, 0, 3
    v_lshl_add_u32 v5, v12, 3, v5
    v_bfe_u32 v12, v0, 3, 1
    v_lshl_add_u32 v5, v12, 10, v5
    v_bfe_u32 v12, v0, 4, 1
    v_lshl_add_u32 v5, v12, 2, v5
    v_bfe_u32 v12, v0, 6, 2
    v_lshl_add_u32 v5, v12, 6, v5
    v_mov_b32 v7, 0x0
    v_bfe_u32 v12, v0, 0, 6
    v_lshl_add_u32 v7, v12, 2, v7
    s_mul_i32 s12, s8, 1179648
    s_add_u32 s12, s12, 67108864
    s_mul_i32 s13, s9, 1152
    s_add_u32 s13, s13, s12
    s_add_u32 s40, s4, s13
    s_addc_u32 s41, s5, 0
    s_mul_i32 s13, s9, 36864
    s_add_u32 s13, s13, s12
    s_add_u32 s42, s4, s13
    s_addc_u32 s43, s5, 0
    s_lshl_b32 s12, s8, 7
    s_add_u32 s12, s12, 114688
    s_add_u32 s44, s4, s12
    s_addc_u32 s45, s5, 0
    s_mov_b32 s47, 0
    v_lshlrev_b32 v0, 4, v0
    s_sub_u32 s24, s8, 5
    s_mul_i32 s12, s24, 36864
    s_add_u32 s13, s12, 4194304
    s_add_u32 s20, s4, s13
    s_addc_u32 s21, s5, 0
    s_mul_i32 s13, s9, 1152
    s_add_u32 s12, s12, s13
    s_add_u32 s34, s34, s12
    s_addc_u32 s35, s35, 0
    s_add_u32 s13, s12, 7340032
    s_add_u32 s36, s4, s13
    s_addc_u32 s37, s5, 0
    s_lshl_b32 s13, s24, 7
    s_add_u32 s13, s13, 106496
    s_add_u32 s52, s4, s13
    s_addc_u32 s53, s5, 0
    s_add_u32 s54, s4, 5760
    s_addc_u32 s55, s5, 0
    s_lshl_b32 s26, s10, 10
    s_add_u32 s26, s26, 57344
    s_mov_b32 s25, 1
    s_mov_b32 s60, 0xbfb8aa3b
    s_cmp_ge_u32 s10, 2
    s_cselect_b64 s[62:63], -1, 0
    s_mov_b32 s59, 0
    s_cmp_eq_u32 s11, 0
    s_cbranch_scc1 L_f_top_s
L_f_top_f:
    s_cmp_lg_u32 s59, 0
    s_cbranch_scc1 L_fpd_18
    v_and_b32 v8, 0x7c, v7
    s_mov_b32 s12, 0
L_fw_19:
    global_load_dword v9, v8, s[52:53] sc1
    s_add_u32 s12, s12, 1
    s_cmp_gt_u32 s12, 100000
    s_cbranch_scc1 L_exit
    s_waitcnt vmcnt(0)
    v_cmp_gt_u32 vcc, s25, v9
    s_cbranch_vccz L_fwd_20
    s_sleep 1
    s_branch L_fw_19
L_fwd_20:
    s_mov_b64 s[12:13], s[20:21]
    s_add_u32 m0, s26, 0
    s_nop 0
    global_load_lds_dwordx4 v0, s[12:13]
    s_add_u32 s12, s12, 4096
    s_addc_u32 s13, s13, 0
    s_add_u32 m0, s26, 4096
    s_nop 0
    global_load_lds_dwordx4 v0, s[12:13]
    s_add_u32 s12, s12, 4096
    s_addc_u32 s13, s13, 0
    s_add_u32 m0, s26, 8192
    s_nop 0
    global_load_lds_dwordx4 v0, s[12:13]
    s_add_u32 s12, s12, 4096
    s_addc_u32 s13, s13, 0
    s_add_u32 m0, s26, 12288
    s_nop 0
    global_load_lds_dwordx4 v0, s[12:13]
    s_add_u32 s12, s12, 4096
    s_addc_u32 s13, s13, 0
    s_add_u32 m0, s26, 16384
    s_nop 0
    global_load_lds_dwordx4 v0, s[12:13]
    s_add_u32 s12, s12, 4096
    s_addc_u32 s13, s13, 0
    s_add_u32 m0, s26, 20480
    s_nop 0
    global_load_lds_dwordx4 v0, s[12:13]
    s_add_u32 s12, s12, 4096
    s_addc_u32 s13, s13, 0
    s_add_u32 m0, s26, 24576
    s_nop 0
    global_load_lds_dwordx4 v0, s[12:13]
    s_add_u32 s12, s12, 4096
    s_addc_u32 s13, s13, 0
    s_add_u32 m0, s26, 28672
    s_nop 0
    global_load_lds_dwordx4 v0, s[12:13]
    s_add_u32 s12, s12, 4096
    s_addc_u32 s13, s13, 0
    s_add_u32 m0, s26, 32768
    s_nop 0
    global_load_lds_dwordx4 v0, s[12:13]
L_fpd_18:
    s_cmp_lg_u32 s10, 0
    s_cbranch_scc1 L_fx_21
    s_mov_b32 m0, 114688
    s_nop 0
    global_load_lds_dwordx4 v1, s[36:37]
    s_mov_b64 exec, 0xff
    global_load_lds_dwordx4 v1, s[36:37] offset:1024
    s_mov_b64 exec, -1
    s_mov_b32 m0, 116736
    s_nop 0
    global_load_lds_dwordx4 v1, s[54:55]
    s_mov_b64 exec, 0xff
    global_load_lds_dwordx4 v1, s[54:55] offset:1024
    s_mov_b64 exec, -1
L_fx_21:
    v_lshrrev_b32 v78, 4, v0
    v_mov_b32 v72, 0xe000
    v_bfe_u32 v8, v78, 0, 4
    v_mul_u32_u24 v8, 0x480, v8
    v_add_u32 v72, v72, v8
    v_bfe_u32 v8, v78, 6, 1
    v_mul_u32_u24 v8, 0x4800, v8
    v_add_u32 v72, v72, v8
    v_mov_b32 v9, 0x0
    v_bfe_u32 v8, v78, 1, 3
    v_lshlrev_b32 v8, 4, v8
    v_xor_b32 v9, v9, v8
    v_bfe_u32 v8, v78, 4, 2
    v_lshlrev_b32 v8, 4, v8
    v_xor_b32 v9, v9, v8
    v_add_u32 v72, v72, v9
    v_mov_b32 v73, 0xe000
    v_bfe_u32 v8, v78, 0, 4
    v_mul_u32_u24 v8, 0x480, v8
    v_add_u32 v73, v73, v8
    v_bfe_u32 v8, v78, 6, 1
    v_mul_u32_u24 v8, 0x4800, v8
    v_add_u32 v73, v73, v8
    v_mov_b32 v9, 0x40
    v_bfe_u32 v8, v78, 1, 3
    v_lshlrev_b32 v8, 4, v8
    v_xor_b32 v9, v9, v8
    v_bfe_u32 v8, v78, 4, 2
    v_lshlrev_b32 v8, 4, v8
    v_xor_b32 v9, v9, v8
    v_add_u32 v73, v73, v9
    v_mov_b32 v74, 0x12800
    v_bfe_u32 v8, v78, 0, 4
    v_mul_u32_u24 v8, 0x480, v8
    v_add_u32 v74, v74, v8
    v_bfe_i32 v8, v78, 6, 1
    v_and_b32 v8, 0xffffb800, v8
    v_add_u32 v74, v74, v8
    v_mov_b32 v9, 0x0
    v_bfe_u32 v8, v78, 1, 3
    v_lshlrev_b32 v8, 4, v8
    v_xor_b32 v9, v9, v8
    v_bfe_u32 v8, v78, 4, 2
    v_lshlrev_b32 v8, 4, v8
    v_xor_b32 v9, v9, v8
    v_add_u32 v74, v74, v9
    v_mov_b32 v75, 0x12800
    v_bfe_u32 v8, v78, 0, 4
    v_mul_u32_u24 v8, 0x480, v8
    v_add_u32 v75, v75, v8
    v_bfe_i32 v8, v78, 6, 1
    v_and_b32 v8, 0xffffb800, v8
    v_add_u32 v75, v75, v8
    v_mov_b32 v9, 0x40
    v_bfe_u32 v8, v78, 1, 3
    v_lshlrev_b32 v8, 4, v8
    v_xor_b32 v9, v9, v8
    v_bfe_u32 v8, v78, 4, 2
    v_lshlrev_b32 v8, 4, v8
    v_xor_b32 v9, v9, v8
    v_add_u32 v75, v75, v9
    v_mov_b32 v76, 0x0
    v_bfe_u32 v8, v78, 0, 4
    v_lshl_add_u32 v76, v8, 3, v76
    v_bfe_u32 v8, v78, 4, 2
    v_lshl_add_u32 v76, v8, 8, v76
    v_bfe_u32 v8, v78, 7, 1
    v_mul_u32_u24 v8, 0x4800, v8
    v_add_u32 v76, v76, v8
    v_mov_b32 v77, 0x18000
    v_bfe_u32 v8, v78, 0, 6
    v_lshl_add_u32 v77, v8, 4, v77
    v_bfe_u32 v8, v78, 6, 1
    v_mul_u32_u24 v8, 0x1400, v8
    v_add_u32 v77, v77, v8
    v_bfe_u32 v8, v78, 7, 1
    v_lshl_add_u32 v77, v8, 11, v77
    s_waitcnt vmcnt(0)
    s_barrier
    v_and_b32 v68, 0x7c, v7
    global_load_dword v79, v68, s[52:53] offset:384 sc1
    global_load_dword v69, v68, s[44:45] offset:1024 sc1
    ds_read_b128 v[48:51], v72 offset:0
    ds_read_b64_tr_b16 v[24:25], v76 offset:0
    ds_read_b64_tr_b16 v[26:27], v76 offset:128
    ds_read_b128 v[52:55], v73 offset:0
    ds_read_b64_tr_b16 v[28:29], v76 offset:1024
    ds_read_b64_tr_b16 v[30:31], v76 offset:1152
    ds_read_b128 v[56:59], v72 offset:128
    ds_read_b64_tr_b16 v[32:33], v76 offset:2048
    ds_read_b64_tr_b16 v[34:35], v76 offset:2176
    s_waitcnt lgkmcnt(8)
    v_mfma_f32_16x16x32_bf16 v[8:11], a[0:3], v[48:51], 0
    ds_read_b128 v[60:63], v73 offset:128
    v_mfma_f32_16x16x32_bf16 v[12:15], a[4:7], v[48:51], 0
    ds_read_b64_tr_b16 v[36:37], v76 offset:3072
    ds_read_b64_tr_b16 v[38:39], v76 offset:3200
    v_mfma_f32_16x16x32_bf16 v[16:19], a[8:11], v[48:51], 0
    v_mfma_f32_16x16x32_bf16 v[20:23], a[12:15], v[48:51], 0
    s_waitcnt lgkmcnt(9)
    v_mfma_f32_16x16x32_bf16 v[40:43], v[24:27], v[48:51], 0
    s_waitcnt lgkmcnt(8)
    v_mfma_f32_16x16x32_bf16 v[8:11], a[16:19], v[52:55], v[8:11]
    ds_read_b128 v[48:51], v72 offset:256
    v_mfma_f32_16x16x32_bf16 v[12:15], a[20:23], v[52:55], v[12:15]
    ds_read_b64_tr_b16 v[24:25], v76 offset:4096
    ds_read_b64_tr_b16 v[26:27], v76 offset:4224
    v_mfma_f32_16x16x32_bf16 v[16:19], a[24:27], v[52:55], v[16:19]
    v_mfma_f32_16x16x32_bf16 v[20:23], a[28:31], v[52:55], v[20:23]
    s_waitcnt lgkmcnt(9)
    v_mfma_f32_16x16x32_bf16 v[40:43], v[28:31], v[52:55], v[40:43]
    s_waitcnt lgkmcnt(8)
    v_mfma_f32_16x16x32_bf16 v[8:11], a[32:35], v[56:59], v[8:11]
    ds_read_b128 v[52:55], v73 offset:256
    v_mfma_f32_16x16x32_bf16 v[12:15], a[36:39], v[56:59], v[12:15]
    ds_read_b64_tr_b16 v[28:29], v76 offset:5120
    ds_read_b64_tr_b16 v[30:31], v76 offset:5248
    v_mfma_f32_16x16x32_bf16 v[16:19], a[40:43], v[56:59], v[16:19]
    v_mfma_f32_16x16x32_bf16 v[20:23], a[44:47], v[56:59], v[20:23]
    s_waitcnt lgkmcnt(9)
    v_mfma_f32_16x16x32_bf16 v[40:43], v[32:35], v[56:59], v[40:43]
    s_waitcnt lgkmcnt(8)
    v_mfma_f32_16x16x32_bf16 v[8:11], a[48:51], v[60:63], v[8:11]
    ds_read_b128 v[56:59], v72 offset:384
    v_mfma_f32_16x16x32_bf16 v[12:15], a[52:55], v[60:63], v[12:15]
    ds_read_b64_tr_b16 v[32:33], v76 offset:6144
    ds_read_b64_tr_b16 v[34:35], v76 offset:6272
    v_mfma_f32_16x16x32_bf16 v[16:19], a[56:59], v[60:63], v[16:19]
    v_mfma_f32_16x16x32_bf16 v[20:23], a[60:63], v[60:63], v[20:23]
    s_waitcnt lgkmcnt(9)
    v_mfma_f32_16x16x32_bf16 v[40:43], v[36:39], v[60:63], v[40:43]
    s_waitcnt lgkmcnt(8)
    v_mfma_f32_16x16x32_bf16 v[8:11], a[64:67], v[48:51], v[8:11]
    ds_read_b128 v[60:63], v73 offset:384
    v_mfma_f32_16x16x32_bf16 v[12:15], a[68:71], v[48:51], v[12:15]
    ds_read_b64_tr_b16 v[36:37], v76 offset:7168
    ds_read_b64_tr_b16 v[38:39], v76 offset:7296
    v_mfma_f32_16x16x32_bf16 v[16:19], a[72:75], v[48:51], v[16:19]
    v_mfma_f32_16x16x32_bf16 v[20:23], a[76:79], v[48:51], v[20:23]
    s_waitcnt lgkmcnt(9)
    v_mfma_f32_16x16x32_bf16 v[40:43], v[24:27], v[48:51], v[40:43]
    s_waitcnt lgkmcnt(8)
    v_mfma_f32_16x16x32_bf16 v[8:11], a[80:83], v[52:55], v[8:11]
    ds_read_b128 v[48:51], v72 offset:512
    v_mfma_f32_16x16x32_bf16 v[12:15], a[84:87], v[52:55], v[12:15]
    ds_read_b64_tr_b16 v[24:25], v76 offset:8192
    ds_read_b64_tr_b16 v[26:27], v76 offset:8320
    v_mfma_f32_16x16x32_bf16 v[16:19], a[88:91], v[52:55], v[16:19]
    v_mfma_f32_16x16x32_bf16 v[20:23], a[92:95], v[52:55], v[20:23]
    s_waitcnt lgkmcnt(9)
    v_mfma_f32_16x16x32_bf16 v[40:43], v[28:31], v[52:55], v[40:43]
    s_waitcnt lgkmcnt(8)
    v_mfma_f32_16x16x32_bf16 v[8:11], a[96:99], v[56:59], v[8:11]
    ds_read_b128 v[52:55], v73 offset:512
    v_mfma_f32_16x16x32_bf16 v[12:15], a[100:103], v[56:59], v[12:15]
    ds_read_b64_tr_b16 v[28:29], v76 offset:9216
    ds_read_b64_tr_b16 v[30:31], v76 offset:9344
    v_mfma_f32_16x16x32_bf16 v[16:19], a[104:107], v[56:59], v[16:19]
    v_mfma_f32_16x16x32_bf16 v[20:23], a[108:111], v[56:59], v[20:23]
    s_waitcnt lgkmcnt(9)
    v_mfma_f32_16x16x32_bf16 v[40:43], v[32:35], v[56:59], v[40:43]
    s_waitcnt lgkmcnt(8)
    v_mfma_f32_16x16x32_bf16 v[8:11], a[112:115], v[60:63], v[8:11]
    ds_read_b128 v[56:59], v72 offset:640
    v_mfma_f32_16x16x32_bf16 v[12:15], a[116:119], v[60:63], v[12:15]
    ds_read_b64_tr_b16 v[32:33], v76 offset:10240
    ds_read_b64_tr_b16 v[34:35], v76 offset:10368
    v_mfma_f32_16x16x32_bf16 v[16:19], a[120:123], v[60:63], v[16:19]
    v_mfma_f32_16x16x32_bf16 v[20:23], a[124:127], v[60:63], v[20:23]
    s_waitcnt lgkmcnt(9)
    v_mfma_f32_16x16x32_bf16 v[40:43], v[36:39], v[60:63], v[40:43]
    s_waitcnt lgkmcnt(8)
    v_mfma_f32_16x16x32_bf16 v[8:11], a[128:131], v[48:51], v[8:11]
    ds_read_b128 v[60:63], v73 offset:640
    v_mfma_f32_16x16x32_bf16 v[12:15], a[132:135], v[48:51], v[12:15]
    ds_read_b64_tr_b16 v[36:37], v76 offset:11264
    ds_read_b64_tr_b16 v[38:39], v76 offset:11392
    v_mfma_f32_16x16x32_bf16 v[16:19], a[136:139], v[48:51], v[16:19]
    v_mfma_f32_16x16x32_bf16 v[20:23], a[140:143], v[48:51], v[20:23]
    s_waitcnt lgkmcnt(9)
    v_mfma_f32_16x16x32_bf16 v[40:43], v[24:27], v[48:51], v[40:43]
    s_waitcnt lgkmcnt(8)
    v_mfma_f32_16x16x32_bf16 v[8:11], a[144:147], v[52:55], v[8:11]
    ds_read_b128 v[48:51], v72 offset:768
    v_mfma_f32_16x16x32_bf16 v[12:15], a[148:151], v[52:55], v[12:15]
    ds_read_b64_tr_b16 v[24:25], v76 offset:12288
    ds_read_b64_tr_b16 v[26:27], v76 offset:12416
    v_mfma_f32_16x16x32_bf16 v[16:19], a[152:155], v[52:55], v[16:19]
    v_mfma_f32_16x16x32_bf16 v[20:23], a[156:159], v[52:55], v[20:23]
    s_waitcnt lgkmcnt(9)
    v_mfma_f32_16x16x32_bf16 v[40:43], v[28:31], v[52:55], v[40:43]
    s_waitcnt lgkmcnt(8)
    v_mfma_f32_16x16x32_bf16 v[8:11], a[160:163], v[56:59], v[8:11]
    ds_read_b128 v[52:55], v73 offset:768
    v_mfma_f32_16x16x32_bf16 v[12:15], a[164:167], v[56:59], v[12:15]
    ds_read_b64_tr_b16 v[28:29], v76 offset:13312
    ds_read_b64_tr_b16 v[30:31], v76 offset:13440
    v_mfma_f32_16x16x32_bf16 v[16:19], a[168:171], v[56:59], v[16:19]
    v_mfma_f32_16x16x32_bf16 v[20:23], a[172:175], v[56:59], v[20:23]
    s_waitcnt lgkmcnt(9)
    v_mfma_f32_16x16x32_bf16 v[40:43], v[32:35], v[56:59], v[40:43]
    s_waitcnt lgkmcnt(8)
    v_mfma_f32_16x16x32_bf16 v[8:11], a[176:179], v[60:63], v[8:11]
    ds_read_b128 v[56:59], v72 offset:896
    v_mfma_f32_16x16x32_bf16 v[12:15], a[180:183], v[60:63], v[12:15]
    ds_read_b64_tr_b16 v[32:33], v76 offset:14336
    ds_read_b64_tr_b16 v[34:35], v76 offset:14464
    v_mfma_f32_16x16x32_bf16 v[16:19], a[184:187], v[60:63], v[16:19]
    v_mfma_f32_16x16x32_bf16 v[20:23], a[188:191], v[60:63], v[20:23]
    s_waitcnt lgkmcnt(9)
    v_mfma_f32_16x16x32_bf16 v[40:43], v[36:39], v[60:63], v[40:43]
    s_waitcnt lgkmcnt(8)
    v_mfma_f32_16x16x32_bf16 v[8:11], a[192:195], v[48:51], v[8:11]
    ds_read_b128 v[60:63], v73 offset:896
    v_mfma_f32_16x16x32_bf16 v[12:15], a[196:199], v[48:51], v[12:15]
    ds_read_b64_tr_b16 v[36:37], v76 offset:15360
    ds_read_b64_tr_b16 v[38:39], v76 offset:15488
    v_mfma_f32_16x16x32_bf16 v[16:19], a[200:203], v[48:51], v[16:19]
    v_mfma_f32_16x16x32_bf16 v[20:23], a[204:207], v[48:51], v[20:23]
    s_waitcnt lgkmcnt(9)
    v_mfma_f32_16x16x32_bf16 v[40:43], v[24:27], v[48:51], v[40:43]
    s_waitcnt lgkmcnt(8)
    v_mfma_f32_16x16x32_bf16 v[8:11], a[208:211], v[52:55], v[8:11]
    ds_read_b128 v[48:51], v72 offset:1024
    v_mfma_f32_16x16x32_bf16 v[12:15], a[212:215], v[52:55], v[12:15]
    ds_read_b64_tr_b16 v[24:25], v76 offset:16384
    ds_read_b64_tr_b16 v[26:27], v76 offset:16512
    v_mfma_f32_16x16x32_bf16 v[16:19], a[216:219], v[52:55], v[16:19]
    v_mfma_f32_16x16x32_bf16 v[20:23], a[220:223], v[52:55], v[20:23]
    s_waitcnt lgkmcnt(9)
    v_mfma_f32_16x16x32_bf16 v[40:43], v[28:31], v[52:55], v[40:43]
    s_waitcnt lgkmcnt(8)
    v_mfma_f32_16x16x32_bf16 v[8:11], a[224:227], v[56:59], v[8:11]
    ds_read_b128 v[52:55], v73 offset:1024
    v_mfma_f32_16x16x32_bf16 v[12:15], a[228:231], v[56:59], v[12:15]
    ds_read_b64_tr_b16 v[28:29], v76 offset:17408
    ds_read_b64_tr_b16 v[30:31], v76 offset:17536
    v_mfma_f32_16x16x32_bf16 v[16:19], a[232:235], v[56:59], v[16:19]
    v_mfma_f32_16x16x32_bf16 v[20:23], a[236:239], v[56:59], v[20:23]
    s_waitcnt lgkmcnt(9)
    v_mfma_f32_16x16x32_bf16 v[40:43], v[32:35], v[56:59], v[40:43]
    s_waitcnt lgkmcnt(8)
    v_mfma_f32_16x16x32_bf16 v[8:11], a[240:243], v[60:63], v[8:11]
    ds_read_b128 v[56:59], v74 offset:0
    v_mfma_f32_16x16x32_bf16 v[12:15], a[244:247], v[60:63], v[12:15]
    v_mfma_f32_16x16x32_bf16 v[16:19], a[248:251], v[60:63], v[16:19]
    v_mfma_f32_16x16x32_bf16 v[20:23], a[252:255], v[60:63], v[20:23]
    s_waitcnt lgkmcnt(7)
    v_mfma_f32_16x16x32_bf16 v[40:43], v[36:39], v[60:63], v[40:43]
    s_waitcnt lgkmcnt(6)
    v_mfma_f32_16x16x32_bf16 v[8:11], v[80:83], v[48:51], v[8:11]
    ds_read_b128 v[60:63], v75 offset:0
    v_mfma_f32_16x16x32_bf16 v[12:15], v[84:87], v[48:51], v[12:15]
    v_mfma_f32_16x16x32_bf16 v[16:19], v[88:91], v[48:51], v[16:19]
    v_mfma_f32_16x16x32_bf16 v[20:23], v[92:95], v[48:51], v[20:23]
    s_waitcnt lgkmcnt(5)
    v_mfma_f32_16x16x32_bf16 v[40:43], v[24:27], v[48:51], v[40:43]
    s_waitcnt lgkmcnt(4)
    v_mfma_f32_16x16x32_bf16 v[8:11], v[96:99], v[52:55], v[8:11]
    ds_read_b128 v[48:51], v74 offset:128
    v_mfma_f32_16x16x32_bf16 v[12:15], v[100:103], v[52:55], v[12:15]
    v_mfma_f32_16x16x32_bf16 v[16:19], v[104:107], v[52:55], v[16:19]
    v_mfma_f32_16x16x32_bf16 v[20:23], v[108:111], v[52:55], v[20:23]
    s_waitcnt lgkmcnt(3)
    v_mfma_f32_16x16x32_bf16 v[40:43], v[28:31], v[52:55], v[40:43]
    s_waitcnt lgkmcnt(2)
    v_mfma_f32_16x16x32_bf16 v[24:27], a[0:3], v[56:59], 0
    ds_read_b128 v[52:55], v75 offset:128
    v_mfma_f32_16x16x32_bf16 v[28:31], a[4:7], v[56:59], 0
    v_mfma_f32_16x16x32_bf16 v[32:35], a[8:11], v[56:59], 0
    v_mfma_f32_16x16x32_bf16 v[36:39], a[12:15], v[56:59], 0
    s_waitcnt lgkmcnt(2)
    v_mfma_f32_16x16x32_bf16 v[24:27], a[16:19], v[60:63], v[24:27]
    ds_read_b128 v[56:59], v74 offset:256
    v_mfma_f32_16x16x32_bf16 v[28:31], a[20:23], v[60:63], v[28:31]
    v_mfma_f32_16x16x32_bf16 v[32:35], a[24:27], v[60:63], v[32:35]
    v_mfma_f32_16x16x32_bf16 v[36:39], a[28:31], v[60:63], v[36:39]
    s_waitcnt lgkmcnt(2)
    v_mfma_f32_16x16x32_bf16 v[24:27], a[32:35], v[48:51], v[24:27]
    ds_read_b128 v[60:63], v75 offset:256
    v_cvt_pk_bf16_f32 v9, v8, v9
    v_lshlrev_b32 v8, 16, v9
    v_mfma_f32_16x16x32_bf16 v[28:31], a[36:39], v[48:51], v[28:31]
    v_and_b32 v9, 0xffff0000, v9
    v_cvt_pk_bf16_f32 v17, v16, v17
    v_mfma_f32_16x16x32_bf16 v[32:35], a[40:43], v[48:51], v[32:35]
    v_lshlrev_b32 v16, 16, v17
    v_and_b32 v17, 0xffff0000, v17
    v_mfma_f32_16x16x32_bf16 v[36:39], a[44:47], v[48:51], v[36:39]
    v_mul_f32 v70, s60, v8
    v_mul_f32 v71, s60, v9
    s_waitcnt lgkmcnt(2)
    v_mfma_f32_16x16x32_bf16 v[24:27], a[48:51], v[52:55], v[24:27]
    ds_read_b128 v[48:51], v74 offset:384
    v_exp_f32 v70, v70
    v_exp_f32 v71, v71
    v_mfma_f32_16x16x32_bf16 v[28:31], a[52:55], v[52:55], v[28:31]
    v_add_f32 v70, 1.0, v70
    v_add_f32 v71, 1.0, v71
    v_mfma_f32_16x16x32_bf16 v[32:35], a[56:59], v[52:55], v[32:35]
    v_rcp_f32 v70, v70
    v_rcp_f32 v71, v71
    v_mfma_f32_16x16x32_bf16 v[36:39], a[60:63], v[52:55], v[36:39]
    v_mul_f32 v8, v8, v70
    v_mul_f32 v9, v9, v71
    s_waitcnt lgkmcnt(2)
    v_mfma_f32_16x16x32_bf16 v[24:27], a[64:67], v[56:59], v[24:27]
    ds_read_b128 v[52:55], v75 offset:384
    v_cvt_pk_bf16_f32 v9, v8, v9
    v_lshlrev_b32 v8, 16, v9
    v_mfma_f32_16x16x32_bf16 v[28:31], a[68:71], v[56:59], v[28:31]
    v_and_b32 v9, 0xffff0000, v9
    v_mul_f32 v8, v8, v16
    v_mfma_f32_16x16x32_bf16 v[32:35], a[72:75], v[56:59], v[32:35]
    v_mul_f32 v9, v9, v17
    v_cvt_pk_bf16_f32 v64, v8, v9
    v_mfma_f32_16x16x32_bf16 v[36:39], a[76:79], v[56:59], v[36:39]
    v_cvt_pk_bf16_f32 v11, v10, v11
    v_lshlrev_b32 v10, 16, v11
    s_waitcnt lgkmcnt(2)
    v_mfma_f32_16x16x32_bf16 v[24:27], a[80:83], v[60:63], v[24:27]
    ds_read_b128 v[56:59], v74 offset:512
    v_and_b32 v11, 0xffff0000, v11
    v_cvt_pk_bf16_f32 v19, v18, v19
    v_mfma_f32_16x16x32_bf16 v[28:31], a[84:87], v[60:63], v[28:31]
    v_lshlrev_b32 v18, 16, v19
    v_and_b32 v19, 0xffff0000, v19
    v_mfma_f32_16x16x32_bf16 v[32:35], a[88:91], v[60:63], v[32:35]
    v_mul_f32 v70, s60, v10
    v_mul_f32 v71, s60, v11
    v_mfma_f32_16x16x32_bf16 v[36:39], a[92:95], v[60:63], v[36:39]
    v_exp_f32 v70, v70
    v_exp_f32 v71, v71
    s_waitcnt lgkmcnt(2)
    v_mfma_f32_16x16x32_bf16 v[24:27], a[96:99], v[48:51], v[24:27]
    ds_read_b128 v[60:63], v75 offset:512
    v_add_f32 v70, 1.0, v70
    v_add_f32 v71, 1.0, v71
    v_mfma_f32_16x16x32_bf16 v[28:31], a[100:103], v[48:51], v[28:31]
    v_rcp_f32 v70, v70
    v_rcp_f32 v71, v71
    v_mfma_f32_16x16x32_bf16 v[32:35], a[104:107], v[48:51], v[32:35]
    v_mul_f32 v10, v10, v70
    v_mul_f32 v11, v11, v71
    v_mfma_f32_16x16x32_bf16 v[36:39], a[108:111], v[48:51], v[36:39]
    v_cvt_pk_bf16_f32 v11, v10, v11
    v_lshlrev_b32 v10, 16, v11
    s_waitcnt lgkmcnt(2)
    v_mfma_f32_16x16x32_bf16 v[24:27], a[112:115], v[52:55], v[24:27]
    ds_read_b128 v[48:51], v74 offset:640
    v_and_b32 v11, 0xffff0000, v11
    v_mul_f32 v10, v10, v18
    v_mfma_f32_16x16x32_bf16 v[28:31], a[116:119], v[52:55], v[28:31]
    v_mul_f32 v11, v11, v19
    v_cvt_pk_bf16_f32 v65, v10, v11
    v_mfma_f32_16x16x32_bf16 v[32:35], a[120:123], v[52:55], v[32:35]
    v_cvt_pk_bf16_f32 v13, v12, v13
    v_lshlrev_b32 v12, 16, v13
    v_mfma_f32_16x16x32_bf16 v[36:39], a[124:127], v[52:55], v[36:39]
    v_and_b32 v13, 0xffff0000, v13
    v_cvt_pk_bf16_f32 v21, v20, v21
    s_waitcnt lgkmcnt(2)
    v_mfma_f32_16x16x32_bf16 v[24:27], a[128:131], v[56:59], v[24:27]
    ds_read_b128 v[52:55], v75 offset:640
    v_lshlrev_b32 v20, 16, v21
    v_and_b32 v21, 0xffff0000, v21
    v_mfma_f32_16x16x32_bf16 v[28:31], a[132:135], v[56:59], v[28:31]
    v_mul_f32 v70, s60, v12
    v_mul_f32 v71, s60, v13
    v_mfma_f32_16x16x32_bf16 v[32:35], a[136:139], v[56:59], v[32:35]
    v_exp_f32 v70, v70
    v_exp_f32 v71, v71
    v_mfma_f32_16x16x32_bf16 v[36:39], a[140:143], v[56:59], v[36:39]
    v_add_f32 v70, 1.0, v70
    v_add_f32 v71, 1.0, v71
    s_waitcnt lgkmcnt(2)
    v_mfma_f32_16x16x32_bf16 v[24:27], a[144:147], v[60:63], v[24:27]
    ds_read_b128 v[56:59], v74 offset:768
    v_rcp_f32 v70, v70
    v_rcp_f32 v71, v71
    v_mfma_f32_16x16x32_bf16 v[28:31], a[148:151], v[60:63], v[28:31]
    v_mul_f32 v12, v12, v70
    v_mul_f32 v13, v13, v71
    v_mfma_f32_16x16x32_bf16 v[32:35], a[152:155], v[60:63], v[32:35]
    v_cvt_pk_bf16_f32 v13, v12, v13
    v_lshlrev_b32 v12, 16, v13
    v_mfma_f32_16x16x32_bf16 v[36:39], a[156:159], v[60:63], v[36:39]
    v_and_b32 v13, 0xffff0000, v13
    v_mul_f32 v12, v12, v20
    s_waitcnt lgkmcnt(2)
    v_mfma_f32_16x16x32_bf16 v[24:27], a[160:163], v[48:51], v[24:27]
    ds_read_b128 v[60:63], v75 offset:768
    v_mul_f32 v13, v13, v21
    v_cvt_pk_bf16_f32 v66, v12, v13
    v_mfma_f32_16x16x32_bf16 v[28:31], a[164:167], v[48:51], v[28:31]
    v_cvt_pk_bf16_f32 v15, v14, v15
    v_lshlrev_b32 v14, 16, v15
    v_mfma_f32_16x16x32_bf16 v[32:35], a[168:171], v[48:51], v[32:35]
    v_and_b32 v15, 0xffff0000, v15
    v_cvt_pk_bf16_f32 v23, v22, v23
    v_mfma_f32_16x16x32_bf16 v[36:39], a[172:175], v[48:51], v[36:39]
    v_lshlrev_b32 v22, 16, v23
    v_and_b32 v23, 0xffff0000, v23
    s_waitcnt lgkmcnt(2)
    v_mfma_f32_16x16x32_bf16 v[24:27], a[176:179], v[52:55], v[24:27]
    ds_read_b128 v[48:51], v74 offset:896
    v_mul_f32 v70, s60, v14
    v_mul_f32 v71, s60, v15
    v_mfma_f32_16x16x32_bf16 v[28:31], a[180:183], v[52:55], v[28:31]
    v_exp_f32 v70, v70
    v_exp_f32 v71, v71
    v_mfma_f32_16x16x32_bf16 v[32:35], a[184:187], v[52:55], v[32:35]
    v_add_f32 v70, 1.0, v70
    v_add_f32 v71, 1.0, v71
    v_mfma_f32_16x16x32_bf16 v[36:39], a[188:191], v[52:55], v[36:39]
    v_rcp_f32 v70, v70
    v_rcp_f32 v71, v71
    s_waitcnt lgkmcnt(2)
    v_mfma_f32_16x16x32_bf16 v[24:27], a[192:195], v[56:59], v[24:27]
    ds_read_b128 v[52:55], v75 offset:896
    v_mul_f32 v14, v14, v70
    v_mul_f32 v15, v15, v71
    v_mfma_f32_16x16x32_bf16 v[28:31], a[196:199], v[56:59], v[28:31]
    v_cvt_pk_bf16_f32 v15, v14, v15
    v_lshlrev_b32 v14, 16, v15
    v_mfma_f32_16x16x32_bf16 v[32:35], a[200:203], v[56:59], v[32:35]
    v_and_b32 v15, 0xffff0000, v15
    v_mul_f32 v14, v14, v22
    v_mfma_f32_16x16x32_bf16 v[36:39], a[204:207], v[56:59], v[36:39]
    v_mul_f32 v15, v15, v23
    v_cvt_pk_bf16_f32 v67, v14, v15
    s_waitcnt lgkmcnt(2)
    v_mfma_f32_16x16x32_bf16 v[24:27], a[208:211], v[60:63], v[24:27]
    ds_read_b128 v[56:59], v74 offset:1024
    ds_write_b128 v77, v[64:67]
    v_cvt_pk_bf16_f32 v41, v40, v41
    v_mfma_f32_16x16x32_bf16 v[28:31], a[212:215], v[60:63], v[28:31]
    v_lshlrev_b32 v40, 16, v41
    v_and_b32 v41, 0xffff0000, v41
    v_mfma_f32_16x16x32_bf16 v[32:35], a[216:219], v[60:63], v[32:35]
    v_cvt_pk_bf16_f32 v43, v42, v43
    v_lshlrev_b32 v42, 16, v43
    v_mfma_f32_16x16x32_bf16 v[36:39], a[220:223], v[60:63], v[36:39]
    v_and_b32 v43, 0xffff0000, v43
    v_mul_f32 v44, s60, v40
    s_waitcnt lgkmcnt(3)
    v_mfma_f32_16x16x32_bf16 v[24:27], a[224:227], v[48:51], v[24:27]
    ds_read_b128 v[60:63], v75 offset:1024
    v_mul_f32 v45, s60, v41
    v_mul_f32 v46, s60, v42
    v_mfma_f32_16x16x32_bf16 v[28:31], a[228:231], v[48:51], v[28:31]
    v_mul_f32 v47, s60, v43
    v_exp_f32 v44, v44
    v_mfma_f32_16x16x32_bf16 v[32:35], a[232:235], v[48:51], v[32:35]
    v_exp_f32 v45, v45
    v_exp_f32 v46, v46
    v_mfma_f32_16x16x32_bf16 v[36:39], a[236:239], v[48:51], v[36:39]
    v_exp_f32 v47, v47
    v_add_f32 v44, 1.0, v44
    s_waitcnt lgkmcnt(3)
    v_mfma_f32_16x16x32_bf16 v[24:27], a[240:243], v[52:55], v[24:27]
    v_add_f32 v45, 1.0, v45
    v_add_f32 v46, 1.0, v46
    v_mfma_f32_16x16x32_bf16 v[28:31], a[244:247], v[52:55], v[28:31]
    v_add_f32 v47, 1.0, v47
    v_rcp_f32 v44, v44
    v_mfma_f32_16x16x32_bf16 v[32:35], a[248:251], v[52:55], v[32:35]
    v_rcp_f32 v45, v45
    v_rcp_f32 v46, v46
    v_mfma_f32_16x16x32_bf16 v[36:39], a[252:255], v[52:55], v[36:39]
    v_rcp_f32 v47, v47
    v_mul_f32 v44, v40, v44
    s_waitcnt lgkmcnt(2)
    v_mfma_f32_16x16x32_bf16 v[24:27], v[80:83], v[56:59], v[24:27]
    v_mul_f32 v45, v41, v45
    v_mul_f32 v46, v42, v46
    v_mfma_f32_16x16x32_bf16 v[28:31], v[84:87], v[56:59], v[28:31]
    v_mul_f32 v47, v43, v47
    v_cvt_pk_bf16_f32 v45, v44, v45
    v_mfma_f32_16x16x32_bf16 v[32:35], v[88:91], v[56:59], v[32:35]
    v_lshlrev_b32 v44, 16, v45
    v_and_b32 v45, 0xffff0000, v45
    v_mfma_f32_16x16x32_bf16 v[36:39], v[92:95], v[56:59], v[36:39]
    v_cvt_pk_bf16_f32 v47, v46, v47
    v_lshlrev_b32 v46, 16, v47
    s_waitcnt lgkmcnt(0)
    v_mfma_f32_16x16x32_bf16 v[24:27], v[96:99], v[60:63], v[24:27]
    v_and_b32 v47, 0xffff0000, v47
    v_cndmask_b32 v40, v44, v40, s[62:63]
    v_mfma_f32_16x16x32_bf16 v[28:31], v[100:103], v[60:63], v[28:31]
    v_cndmask_b32 v41, v45, v41, s[62:63]
    v_cndmask_b32 v42, v46, v42, s[62:63]
    v_mfma_f32_16x16x32_bf16 v[32:35], v[104:107], v[60:63], v[32:35]
    v_cndmask_b32 v43, v47, v43, s[62:63]
    v_add_u32 v70, 106496, v0
    v_mfma_f32_16x16x32_bf16 v[36:39], v[108:111], v[60:63], v[36:39]
    ds_write_b128 v70, v[40:43]
    v_cvt_pk_bf16_f32 v25, v24, v25
    v_cvt_pk_bf16_f32 v29, v28, v29
    v_lshlrev_b32 v24, 16, v25
    v_lshlrev_b32 v28, 16, v29
    v_and_b32 v25, 0xffff0000, v25
    v_and_b32 v29, 0xffff0000, v29
    v_cvt_pk_bf16_f32 v33, v32, v33
    v_cvt_pk_bf16_f32 v37, v36, v37
    v_lshlrev_b32 v32, 16, v33
    v_lshlrev_b32 v36, 16, v37
    v_and_b32 v33, 0xffff0000, v33
    v_and_b32 v37, 0xffff0000, v37
    v_pk_mul_f32 v[52:53], v[24:25], s[60:61] op_sel_hi:[1,0]
    v_pk_mul_f32 v[54:55], v[28:29], s[60:61] op_sel_hi:[1,0]
    v_exp_f32 v52, v52
    v_exp_f32 v54, v54
    v_exp_f32 v53, v53
    v_exp_f32 v55, v55
    v_pk_add_f32 v[52:53], v[52:53], 1.0 op_sel_hi:[1,0]
    v_pk_add_f32 v[54:55], v[54:55], 1.0 op_sel_hi:[1,0]
    v_rcp_f32 v52, v52
    v_rcp_f32 v54, v54
    v_rcp_f32 v53, v53
    v_rcp_f32 v55, v55
    v_pk_mul_f32 v[24:25], v[24:25], v[52:53]
    v_pk_mul_f32 v[28:29], v[28:29], v[54:55]
    v_cvt_pk_bf16_f32 v25, v24, v25
    v_cvt_pk_bf16_f32 v29, v28, v29
    v_lshlrev_b32 v24, 16, v25
    v_lshlrev_b32 v28, 16, v29
    v_and_b32 v25, 0xffff0000, v25
    v_and_b32 v29, 0xffff0000, v29
    v_pk_mul_f32 v[24:25], v[24:25], v[32:33]
    v_pk_mul_f32 v[28:29], v[28:29], v[36:37]
    v_cvt_pk_bf16_f32 v48, v24, v25
    v_cvt_pk_bf16_f32 v50, v28, v29
    v_cvt_pk_bf16_f32 v27, v26, v27
    v_cvt_pk_bf16_f32 v31, v30, v31
    v_lshlrev_b32 v26, 16, v27
    v_lshlrev_b32 v30, 16, v31
    v_and_b32 v27, 0xffff0000, v27
    v_and_b32 v31, 0xffff0000, v31
    v_cvt_pk_bf16_f32 v35, v34, v35
    v_cvt_pk_bf16_f32 v39, v38, v39
    v_lshlrev_b32 v34, 16, v35
    v_lshlrev_b32 v38, 16, v39
    v_and_b32 v35, 0xffff0000, v35
    v_and_b32 v39, 0xffff0000, v39
    v_pk_mul_f32 v[52:53], v[26:27], s[60:61] op_sel_hi:[1,0]
    v_pk_mul_f32 v[54:55], v[30:31], s[60:61] op_sel_hi:[1,0]
    v_exp_f32 v52, v52
    v_exp_f32 v54, v54
    v_exp_f32 v53, v53
    v_exp_f32 v55, v55
    v_pk_add_f32 v[52:53], v[52:53], 1.0 op_sel_hi:[1,0]
    v_pk_add_f32 v[54:55], v[54:55], 1.0 op_sel_hi:[1,0]
    v_rcp_f32 v52, v52
    v_rcp_f32 v54, v54
    v_rcp_f32 v53, v53
    v_rcp_f32 v55, v55
    v_pk_mul_f32 v[26:27], v[26:27], v[52:53]
    v_pk_mul_f32 v[30:31], v[30:31], v[54:55]
    v_cvt_pk_bf16_f32 v27, v26, v27
    v_cvt_pk_bf16_f32 v31, v30, v31
    v_lshlrev_b32 v26, 16, v27
    v_lshlrev_b32 v30, 16, v31
    v_and_b32 v27, 0xffff0000, v27
    v_and_b32 v31, 0xffff0000, v31
    v_pk_mul_f32 v[26:27], v[26:27], v[34:35]
    v_pk_mul_f32 v[30:31], v[30:31], v[38:39]
    v_cvt_pk_bf16_f32 v49, v26, v27
    v_cvt_pk_bf16_f32 v51, v30, v31
    v_xor_b32 v77, 4096, v77
    ds_write_b128 v77, v[48:51]
    v_mov_b32 v27, 0x9000
    v_bfe_u32 v8, v78, 0, 2
    v_lshl_add_u32 v27, v8, 3, v27
    v_bfe_u32 v8, v78, 2, 4
    v_mul_u32_u24 v8, 0x480, v8
    v_add_u32 v27, v27, v8
    v_bfe_u32 v8, v78, 6, 2
    v_lshl_add_u32 v27, v8, 5, v27
    s_waitcnt vmcnt(0)
    v_cmp_gt_u32 vcc, s47, v69
    s_cbranch_vccz L_fcw_22
    v_and_b32 v8, 0x7c, v7
    v_add_u32 v8, 1024, v8
    s_mov_b32 s12, 0
L_fw_23:
    global_load_dword v9, v8, s[44:45] sc1
    s_add_u32 s12, s12, 1
    s_cmp_gt_u32 s12, 100000
    s_cbranch_scc1 L_exit
    s_waitcnt vmcnt(0)
    v_cmp_gt_u32 vcc, s47, v9
    s_cbranch_vccz L_fwd_24
    s_branch L_fw_23
L_fwd_24:
L_fcw_22:
    v_cmp_eq_u32 vcc, 0, v79
    s_waitcnt lgkmcnt(0)
    s_barrier
    s_mov_b32 s59, 0
    s_cbranch_vccnz L_fnp_25
    s_cmp_ge_u32 s24, 61
    s_cbranch_scc1 L_fnp_25
    s_add_u32 s56, s20, 110592
    s_addc_u32 s57, s21, 0
    s_mov_b64 s[12:13], s[56:57]
    s_add_u32 m0, s26, 0
    s_nop 0
    global_load_lds_dwordx4 v0, s[12:13]
    s_add_u32 s12, s12, 4096
    s_addc_u32 s13, s13, 0
    s_add_u32 m0, s26, 4096
    s_nop 0
    global_load_lds_dwordx4 v0, s[12:13]
    s_add_u32 s12, s12, 4096
    s_addc_u32 s13, s13, 0
    s_add_u32 m0, s26, 8192
    s_nop 0
    global_load_lds_dwordx4 v0, s[12:13]
    s_add_u32 s12, s12, 4096
    s_addc_u32 s13, s13, 0
    s_add_u32 m0, s26, 12288
    s_nop 0
    global_load_lds_dwordx4 v0, s[12:13]
    s_add_u32 s12, s12, 4096
    s_addc_u32 s13, s13, 0
    s_add_u32 m0, s26, 16384
    s_nop 0
    global_load_lds_dwordx4 v0, s[12:13]
    s_add_u32 s12, s12, 4096
    s_addc_u32 s13, s13, 0
    s_add_u32 m0, s26, 20480
    s_nop 0
    global_load_lds_dwordx4 v0, s[12:13]
    s_add_u32 s12, s12, 4096
    s_addc_u32 s13, s13, 0
    s_add_u32 m0, s26, 24576
    s_nop 0
    global_load_lds_dwordx4 v0, s[12:13]
    s_add_u32 s12, s12, 4096
    s_addc_u32 s13, s13, 0
    s_add_u32 m0, s26, 28672
    s_nop 0
    global_load_lds_dwordx4 v0, s[12:13]
    s_add_u32 s12, s12, 4096
    s_addc_u32 s13, s13, 0
    s_add_u32 m0, s26, 32768
    s_nop 0
    global_load_lds_dwordx4 v0, s[12:13]
    s_mov_b32 s59, 1
L_fnp_25:
    v_add_u32 v1, 98304, v1
    s_add_u32 s47, s47, 1
    s_xor_b32 s46, s47, s9
    s_and_b32 s46, s46, 1
    v_mov_b32 v24, s46
    ds_read_b128 v[52:55], v1 offset:8192
    ds_read_b128 v[56:59], v1 offset:10240
    ds_read_b128 v[60:63], v1 offset:9216
    ds_read_b128 v[64:67], v1 offset:11264
    ds_read_b64_tr_b16 v[68:69], v27 offset:1024
    ds_read_b64_tr_b16 v[70:71], v27 offset:0
    ds_read_b64_tr_b16 v[76:77], v27 offset:128
    ds_read_b64_tr_b16 v[78:79], v27 offset:256
    ds_read_b128 v[8:11], v1 offset:0
    ds_read_b128 v[12:15], v1 offset:1024
    ds_read_b128 v[16:19], v1 offset:2048
    ds_read_b128 v[20:23], v1 offset:3072
    s_waitcnt lgkmcnt(10)
    v_pk_mul_f32 v[52:53], v[52:53], v[56:57]
    v_pk_mul_f32 v[54:55], v[54:55], v[58:59]
    v_cvt_pk_bf16_f32 v72, v52, v53
    v_cvt_pk_bf16_f32 v73, v54, v55
    s_waitcnt lgkmcnt(8)
    v_pk_mul_f32 v[60:61], v[60:61], v[64:65]
    v_pk_mul_f32 v[62:63], v[62:63], v[66:67]
    v_cvt_pk_bf16_f32 v74, v60, v61
    v_cvt_pk_bf16_f32 v75, v62, v63
    s_waitcnt lgkmcnt(3)
    v_mfma_f32_16x16x32_bf16 v[28:31], v[240:243], v[8:11], 0
    v_mfma_f32_16x16x32_bf16 v[32:35], v[8:11], v[112:115], 0
    v_mfma_f32_16x16x32_bf16 v[36:39], v[8:11], v[128:131], 0
    s_waitcnt lgkmcnt(2)
    v_mfma_f32_16x16x32_bf16 v[28:31], v[244:247], v[12:15], v[28:31]
    v_mfma_f32_16x16x32_bf16 v[32:35], v[12:15], v[116:119], v[32:35]
    v_mfma_f32_16x16x32_bf16 v[36:39], v[12:15], v[132:135], v[36:39]
    s_waitcnt lgkmcnt(1)
    v_mfma_f32_16x16x32_bf16 v[28:31], v[248:251], v[16:19], v[28:31]
    v_mfma_f32_16x16x32_bf16 v[32:35], v[16:19], v[120:123], v[32:35]
    v_mfma_f32_16x16x32_bf16 v[36:39], v[16:19], v[136:139], v[36:39]
    s_waitcnt lgkmcnt(0)
    v_mfma_f32_16x16x32_bf16 v[28:31], v[252:255], v[20:23], v[28:31]
    v_mfma_f32_16x16x32_bf16 v[32:35], v[20:23], v[124:127], v[32:35]
    v_mfma_f32_16x16x32_bf16 v[36:39], v[20:23], v[140:143], v[36:39]
    v_mfma_f32_16x16x32_bf16 v[40:43], v[8:11], v[144:147], 0
    v_mfma_f32_16x16x32_bf16 v[44:47], v[8:11], v[160:163], 0
    s_nop 1
    v_mfma_f32_16x16x16_bf16 v[28:31], v[68:69], v[72:73], v[28:31]
    ds_read_b64_tr_b16 v[68:69], v27 offset:384
    v_mfma_f32_16x16x16_bf16 v[32:35], v[72:73], v[70:71], v[32:35]
    ds_read_b64_tr_b16 v[70:71], v27 offset:512
    v_mfma_f32_16x16x16_bf16 v[36:39], v[72:73], v[76:77], v[36:39]
    ds_read_b64_tr_b16 v[76:77], v27 offset:640
    v_mfma_f32_16x16x32_bf16 v[40:43], v[12:15], v[148:151], v[40:43]
    v_mfma_f32_16x16x32_bf16 v[44:47], v[12:15], v[164:167], v[44:47]
    v_mfma_f32_16x16x32_bf16 v[40:43], v[16:19], v[152:155], v[40:43]
    v_mfma_f32_16x16x32_bf16 v[44:47], v[16:19], v[168:171], v[44:47]
    v_cvt_pk_bf16_f32 v28, v28, v29
    v_cvt_pk_bf16_f32 v29, v30, v31
    v_mfma_f32_16x16x32_bf16 v[40:43], v[20:23], v[156:159], v[40:43]
    v_bfi_b32 v28, 1, v24, v28
    s_add_u32 s12, s40, 0
    s_addc_u32 s13, s41, 0
    global_store_dwordx2 v3, v[28:29], s[12:13]
    v_mfma_f32_16x16x32_bf16 v[44:47], v[20:23], v[172:175], v[44:47]
    v_cvt_pk_bf16_f32 v52, v32, v36
    v_cvt_pk_bf16_f32 v56, v33, v37
    v_mfma_f32_16x16x32_bf16 v[48:51], v[8:11], v[176:179], 0
    v_cvt_pk_bf16_f32 v60, v34, v38
    v_cvt_pk_bf16_f32 v64, v35, v39
    v_mfma_f32_16x16x32_bf16 v[28:31], v[8:11], v[192:195], 0
    v_bfi_b32 v52, 1, v24, v52
    v_bfi_b32 v56, 1, v24, v56
    v_mfma_f32_16x16x16_bf16 v[40:43], v[72:73], v[78:79], v[40:43]
    v_bfi_b32 v60, 1, v24, v60
    v_bfi_b32 v64, 1, v24, v64
    ds_read_b64_tr_b16 v[78:79], v27 offset:768
    s_waitcnt lgkmcnt(3)
    v_mfma_f32_16x16x16_bf16 v[44:47], v[72:73], v[68:69], v[44:47]
    ds_read_b64_tr_b16 v[68:69], v27 offset:896
    v_mfma_f32_16x16x32_bf16 v[48:51], v[12:15], v[180:183], v[48:51]
    v_mfma_f32_16x16x32_bf16 v[28:31], v[12:15], v[196:199], v[28:31]
    v_mfma_f32_16x16x32_bf16 v[48:51], v[16:19], v[184:187], v[48:51]
    v_mfma_f32_16x16x32_bf16 v[28:31], v[16:19], v[200:203], v[28:31]
    s_nop 2
    v_cvt_pk_bf16_f32 v53, v40, v44
    v_cvt_pk_bf16_f32 v57, v41, v45
    v_mfma_f32_16x16x32_bf16 v[48:51], v[20:23], v[188:191], v[48:51]
    v_cvt_pk_bf16_f32 v61, v42, v46
    v_cvt_pk_bf16_f32 v65, v43, v47
    v_mfma_f32_16x16x32_bf16 v[28:31], v[20:23], v[204:207], v[28:31]
    s_add_u32 s12, s40, 0
    s_addc_u32 s13, s41, 0
    global_store_dwordx2 v2, v[52:53], s[12:13] offset:0
    v_mfma_f32_16x16x32_bf16 v[32:35], v[8:11], v[208:211], 0
    s_add_u32 s12, s40, 36864
    s_addc_u32 s13, s41, 0
    global_store_dwordx2 v2, v[56:57], s[12:13] offset:0
    v_mfma_f32_16x16x32_bf16 v[36:39], v[8:11], v[224:227], 0
    s_add_u32 s12, s40, 73728
    s_addc_u32 s13, s41, 0
    global_store_dwordx2 v2, v[60:61], s[12:13] offset:0
    s_waitcnt lgkmcnt(3)
    v_mfma_f32_16x16x16_bf16 v[48:51], v[72:73], v[70:71], v[48:51]
    s_add_u32 s12, s40, 110592
    s_addc_u32 s13, s41, 0
    global_store_dwordx2 v2, v[64:65], s[12:13] offset:0
    ds_read_b64_tr_b16 v[70:71], v27 offset:1024
    s_waitcnt lgkmcnt(3)
    v_mfma_f32_16x16x16_bf16 v[28:31], v[72:73], v[76:77], v[28:31]
    ds_read_b64_tr_b16 v[76:77], v27 offset:0
    v_mfma_f32_16x16x32_bf16 v[32:35], v[12:15], v[212:215], v[32:35]
    v_mfma_f32_16x16x32_bf16 v[36:39], v[12:15], v[228:231], v[36:39]
    v_mfma_f32_16x16x32_bf16 v[32:35], v[16:19], v[216:219], v[32:35]
    v_mfma_f32_16x16x32_bf16 v[36:39], v[16:19], v[232:235], v[36:39]
    s_nop 2
    v_cvt_pk_bf16_f32 v54, v48, v28
    v_cvt_pk_bf16_f32 v58, v49, v29
    v_mfma_f32_16x16x32_bf16 v[32:35], v[20:23], v[220:223], v[32:35]
    v_cvt_pk_bf16_f32 v62, v50, v30
    v_cvt_pk_bf16_f32 v66, v51, v31
    v_mfma_f32_16x16x32_bf16 v[36:39], v[20:23], v[236:239], v[36:39]
    v_bfi_b32 v54, 1, v24, v54
    v_bfi_b32 v58, 1, v24, v58
    ds_read_b128 v[8:11], v1 offset:4096
    ds_read_b128 v[12:15], v1 offset:5120
    ds_read_b128 v[16:19], v1 offset:6144
    ds_read_b128 v[20:23], v1 offset:7168
    s_waitcnt lgkmcnt(3)
    v_mfma_f32_16x16x32_bf16 v[40:43], v[240:243], v[8:11], 0
    v_bfi_b32 v62, 1, v24, v62
    v_bfi_b32 v66, 1, v24, v66
    v_mfma_f32_16x16x32_bf16 v[44:47], v[8:11], v[112:115], 0
    v_mfma_f32_16x16x32_bf16 v[48:51], v[8:11], v[128:131], 0
    v_mfma_f32_16x16x16_bf16 v[32:35], v[72:73], v[78:79], v[32:35]
    ds_read_b64_tr_b16 v[78:79], v27 offset:128
    v_mfma_f32_16x16x16_bf16 v[36:39], v[72:73], v[68:69], v[36:39]
    ds_read_b64_tr_b16 v[68:69], v27 offset:256
    s_waitcnt lgkmcnt(4)
    v_mfma_f32_16x16x32_bf16 v[40:43], v[244:247], v[12:15], v[40:43]
    v_mfma_f32_16x16x32_bf16 v[44:47], v[12:15], v[116:119], v[44:47]
    v_mfma_f32_16x16x32_bf16 v[48:51], v[12:15], v[132:135], v[48:51]
    s_waitcnt lgkmcnt(3)
    v_mfma_f32_16x16x32_bf16 v[40:43], v[248:251], v[16:19], v[40:43]
    s_nop 0
    v_cvt_pk_bf16_f32 v55, v32, v36
    v_cvt_pk_bf16_f32 v59, v33, v37
    v_mfma_f32_16x16x32_bf16 v[44:47], v[16:19], v[120:123], v[44:47]
    v_cvt_pk_bf16_f32 v63, v34, v38
    v_cvt_pk_bf16_f32 v67, v35, v39
    v_mfma_f32_16x16x32_bf16 v[48:51], v[16:19], v[136:139], v[48:51]
    s_add_u32 s12, s40, 0
    s_addc_u32 s13, s41, 0
    global_store_dwordx2 v2, v[54:55], s[12:13] offset:128
    s_waitcnt lgkmcnt(2)
    v_mfma_f32_16x16x32_bf16 v[40:43], v[252:255], v[20:23], v[40:43]
    s_add_u32 s12, s40, 36864
    s_addc_u32 s13, s41, 0
    global_store_dwordx2 v2, v[58:59], s[12:13] offset:128
    v_mfma_f32_16x16x32_bf16 v[44:47], v[20:23], v[124:127], v[44:47]
    s_add_u32 s12, s40, 73728
    s_addc_u32 s13, s41, 0
    global_store_dwordx2 v2, v[62:63], s[12:13] offset:128
    v_mfma_f32_16x16x32_bf16 v[48:51], v[20:23], v[140:143], v[48:51]
    s_add_u32 s12, s40, 110592
    s_addc_u32 s13, s41, 0
    global_store_dwordx2 v2, v[66:67], s[12:13] offset:128
    v_mfma_f32_16x16x32_bf16 v[28:31], v[8:11], v[144:147], 0
    v_mfma_f32_16x16x32_bf16 v[32:35], v[8:11], v[160:163], 0
    v_mfma_f32_16x16x16_bf16 v[40:43], v[70:71], v[74:75], v[40:43]
    ds_read_b64_tr_b16 v[70:71], v27 offset:384
    v_mfma_f32_16x16x16_bf16 v[44:47], v[74:75], v[76:77], v[44:47]
    ds_read_b64_tr_b16 v[76:77], v27 offset:512
    s_waitcnt lgkmcnt(3)
    v_mfma_f32_16x16x16_bf16 v[48:51], v[74:75], v[78:79], v[48:51]
    ds_read_b64_tr_b16 v[78:79], v27 offset:640
    v_mfma_f32_16x16x32_bf16 v[28:31], v[12:15], v[148:151], v[28:31]
    v_mfma_f32_16x16x32_bf16 v[32:35], v[12:15], v[164:167], v[32:35]
    v_mfma_f32_16x16x32_bf16 v[28:31], v[16:19], v[152:155], v[28:31]
    v_mfma_f32_16x16x32_bf16 v[32:35], v[16:19], v[168:171], v[32:35]
    v_cvt_pk_bf16_f32 v40, v40, v41
    v_cvt_pk_bf16_f32 v41, v42, v43
    v_mfma_f32_16x16x32_bf16 v[28:31], v[20:23], v[156:159], v[28:31]
    v_bfi_b32 v40, 1, v24, v40
    s_add_u32 s12, s40, 589824
    s_addc_u32 s13, s41, 0
    global_store_dwordx2 v3, v[40:41], s[12:13]
    v_mfma_f32_16x16x32_bf16 v[32:35], v[20:23], v[172:175], v[32:35]
    v_cvt_pk_bf16_f32 v52, v44, v48
    v_cvt_pk_bf16_f32 v56, v45, v49
    v_mfma_f32_16x16x32_bf16 v[36:39], v[8:11], v[176:179], 0
    v_cvt_pk_bf16_f32 v60, v46, v50
    v_cvt_pk_bf16_f32 v64, v47, v51
    v_mfma_f32_16x16x32_bf16 v[40:43], v[8:11], v[192:195], 0
    v_bfi_b32 v52, 1, v24, v52
    v_bfi_b32 v56, 1, v24, v56
    s_waitcnt lgkmcnt(3)
    v_mfma_f32_16x16x16_bf16 v[28:31], v[74:75], v[68:69], v[28:31]
    v_bfi_b32 v60, 1, v24, v60
    v_bfi_b32 v64, 1, v24, v64
    ds_read_b64_tr_b16 v[68:69], v27 offset:768
    s_waitcnt lgkmcnt(3)
    v_mfma_f32_16x16x16_bf16 v[32:35], v[74:75], v[70:71], v[32:35]
    ds_read_b64_tr_b16 v[70:71], v27 offset:896
    v_mfma_f32_16x16x32_bf16 v[36:39], v[12:15], v[180:183], v[36:39]
    v_mfma_f32_16x16x32_bf16 v[40:43], v[12:15], v[196:199], v[40:43]
    v_mfma_f32_16x16x32_bf16 v[36:39], v[16:19], v[184:187], v[36:39]
    v_mfma_f32_16x16x32_bf16 v[40:43], v[16:19], v[200:203], v[40:43]
    s_nop 2
    v_cvt_pk_bf16_f32 v53, v28, v32
    v_cvt_pk_bf16_f32 v57, v29, v33
    v_mfma_f32_16x16x32_bf16 v[36:39], v[20:23], v[188:191], v[36:39]
    v_cvt_pk_bf16_f32 v61, v30, v34
    v_cvt_pk_bf16_f32 v65, v31, v35
    v_mfma_f32_16x16x32_bf16 v[40:43], v[20:23], v[204:207], v[40:43]
    s_add_u32 s12, s40, 589824
    s_addc_u32 s13, s41, 0
    global_store_dwordx2 v2, v[52:53], s[12:13] offset:0
    v_mfma_f32_16x16x32_bf16 v[44:47], v[8:11], v[208:211], 0
    s_add_u32 s12, s40, 626688
    s_addc_u32 s13, s41, 0
    global_store_dwordx2 v2, v[56:57], s[12:13] offset:0
    v_mfma_f32_16x16x32_bf16 v[48:51], v[8:11], v[224:227], 0
    s_add_u32 s12, s40, 663552
    s_addc_u32 s13, s41, 0
    global_store_dwordx2 v2, v[60:61], s[12:13] offset:0
    s_waitcnt lgkmcnt(3)
    v_mfma_f32_16x16x16_bf16 v[36:39], v[74:75], v[76:77], v[36:39]
    s_add_u32 s12, s40, 700416
    s_addc_u32 s13, s41, 0
    global_store_dwordx2 v2, v[64:65], s[12:13] offset:0
    s_waitcnt lgkmcnt(2)
    v_mfma_f32_16x16x16_bf16 v[40:43], v[74:75], v[78:79], v[40:43]
    v_mfma_f32_16x16x32_bf16 v[44:47], v[12:15], v[212:215], v[44:47]
    v_mfma_f32_16x16x32_bf16 v[48:51], v[12:15], v[228:231], v[48:51]
    v_mfma_f32_16x16x32_bf16 v[44:47], v[16:19], v[216:219], v[44:47]
    v_mfma_f32_16x16x32_bf16 v[48:51], v[16:19], v[232:235], v[48:51]
    s_nop 3
    v_cvt_pk_bf16_f32 v54, v36, v40
    v_cvt_pk_bf16_f32 v58, v37, v41
    v_mfma_f32_16x16x32_bf16 v[44:47], v[20:23], v[220:223], v[44:47]
    v_cvt_pk_bf16_f32 v62, v38, v42
    v_cvt_pk_bf16_f32 v66, v39, v43
    v_mfma_f32_16x16x32_bf16 v[48:51], v[20:23], v[236:239], v[48:51]
    v_bfi_b32 v54, 1, v24, v54
    v_bfi_b32 v58, 1, v24, v58
    s_waitcnt lgkmcnt(1)
    v_mfma_f32_16x16x16_bf16 v[44:47], v[74:75], v[68:69], v[44:47]
    s_waitcnt lgkmcnt(0)
    s_nop 0
    v_mfma_f32_16x16x16_bf16 v[48:51], v[74:75], v[70:71], v[48:51]
    v_bfi_b32 v62, 1, v24, v62
    v_bfi_b32 v66, 1, v24, v66
    s_nop 5
    v_cvt_pk_bf16_f32 v55, v44, v48
    v_cvt_pk_bf16_f32 v59, v45, v49
    v_cvt_pk_bf16_f32 v63, v46, v50
    v_cvt_pk_bf16_f32 v67, v47, v51
    s_add_u32 s12, s40, 589824
    s_addc_u32 s13, s41, 0
    global_store_dwordx2 v2, v[54:55], s[12:13] offset:128
    s_add_u32 s12, s40, 626688
    s_addc_u32 s13, s41, 0
    global_store_dwordx2 v2, v[58:59], s[12:13] offset:128
    s_add_u32 s12, s40, 663552
    s_addc_u32 s13, s41, 0
    global_store_dwordx2 v2, v[62:63], s[12:13] offset:128
    s_add_u32 s12, s40, 700416
    s_addc_u32 s13, s41, 0
    global_store_dwordx2 v2, v[66:67], s[12:13] offset:128
    v_bfe_u32 v10, v7, 2, 1
    v_lshlrev_b32 v10, 4, v10
    v_mov_b32 v11, 0x3f80
    v_lshlrev_b32 v11, v10, v11
    v_bfe_u32 v10, v7, 3, 2
    v_cmp_eq_u32 vcc, 0, v10
    s_nop 1
    v_cndmask_b32 v12, 0, v11, vcc
    v_cmp_eq_u32 vcc, 1, v10
    s_nop 1
    v_cndmask_b32 v13, 0, v11, vcc
    v_cmp_eq_u32 vcc, 2, v10
    s_nop 1
    v_cndmask_b32 v14, 0, v11, vcc
    v_cmp_eq_u32 vcc, 3, v10
    s_nop 1
    v_cndmask_b32 v15, 0, v11, vcc
    v_mov_b32 v26, 0x1b800
    v_bfe_u32 v10, v0, 4, 3
    v_lshl_add_u32 v26, v10, 5, v26
    v_bfe_u32 v10, v0, 8, 1
    v_lshl_add_u32 v26, v10, 4, v26
    v_bfe_u32 v10, v0, 10, 2
    v_lshl_add_u32 v26, v10, 8, v26
    s_and_b32 s12, s47, 1
    s_sub_u32 s12, 0, s12
    v_bfe_i32 v10, v7, 6, 1
    v_bfe_i32 v11, v7, 5, 1
    v_xor_b32 v10, s12, v10
    v_xor_b32 v11, s12, v11
    s_waitcnt vmcnt(0)
    s_cmp_lg_u32 s47, 1
    s_cbranch_scc1 L_nf_26
    s_barrier
    s_cmp_lg_u32 s10, 0
    s_cbranch_scc1 L_pf_27
    s_lshl_b32 s12, s9, 2
    v_mov_b32 v8, s12
    v_mov_b32 v9, s47
    s_mov_b64 exec, 1
    global_store_dword v8, v9, s[44:45] offset:0
    s_mov_b64 exec, -1
L_pf_27:
    v_and_b32 v8, 0x7c, v7
    s_mov_b32 s12, 0
L_fw_28:
    global_load_dword v9, v8, s[44:45] sc1
    s_add_u32 s12, s12, 1
    s_cmp_gt_u32 s12, 100000
    s_cbranch_scc1 L_exit
    s_waitcnt vmcnt(0)
    v_cmp_gt_u32 vcc, s47, v9
    s_cbranch_vccz L_fwd_29
    s_sleep 8
    s_branch L_fw_28
L_fwd_29:
L_nf_26:
    s_mov_b32 s14, 0
L_xr_30:
    s_mov_b64 s[12:13], s[42:43]
    global_load_dwordx4 v[60:63], v6, s[12:13] sc1
    global_load_dwordx4 v[28:31], v4, s[12:13] sc1
    s_add_u32 s12, s12, 4608
    s_addc_u32 s13, s13, 0
    global_load_dwordx4 v[32:35], v4, s[12:13] sc1
    s_add_u32 s12, s12, 4608
    s_addc_u32 s13, s13, 0
    global_load_dwordx4 v[36:39], v4, s[12:13] sc1
    s_add_u32 s12, s12, 4608
    s_addc_u32 s13, s13, 0
    global_load_dwordx4 v[40:43], v4, s[12:13] sc1
    s_add_u32 s12, s12, 4608
    s_addc_u32 s13, s13, 0
    global_load_dwordx4 v[44:47], v4, s[12:13] sc1
    s_add_u32 s12, s12, 4608
    s_addc_u32 s13, s13, 0
    global_load_dwordx4 v[48:51], v4, s[12:13] sc1
    s_add_u32 s12, s12, 4608
    s_addc_u32 s13, s13, 0
    global_load_dwordx4 v[52:55], v4, s[12:13] sc1
    s_add_u32 s12, s12, 4608
    s_addc_u32 s13, s13, 0
    global_load_dwordx4 v[56:59], v4, s[12:13] sc1
    s_mov_b64 exec, -1
    s_add_u32 s14, s14, 1
    s_cmp_gt_u32 s14, 100000
    s_cbranch_scc1 L_exit
    s_waitcnt vmcnt(8)
    v_mfma_f32_16x16x32_bf16 v[20:23], v[12:15], v[60:63], 0
    v_bitop3_b32 v8, v60, v62, v11 bitop3:0x7e
    v_and_b32 v8, 1, v8
    s_waitcnt vmcnt(7)
    v_mfma_f32_16x16x32_bf16 v[16:19], v[12:15], v[28:31], 0
    v_bitop3_b32 v9, v28, v30, v10 bitop3:0x7e
    v_and_or_b32 v8, v9, 1, v8
    s_waitcnt vmcnt(6)
    v_mfma_f32_16x16x32_bf16 v[16:19], v[12:15], v[32:35], v[16:19]
    v_bitop3_b32 v9, v32, v34, v10 bitop3:0x7e
    v_and_or_b32 v8, v9, 1, v8
    s_waitcnt vmcnt(5)
    v_mfma_f32_16x16x32_bf16 v[16:19], v[12:15], v[36:39], v[16:19]
    v_bitop3_b32 v9, v36, v38, v10 bitop3:0x7e
    v_and_or_b32 v8, v9, 1, v8
    s_waitcnt vmcnt(4)
    v_mfma_f32_16x16x32_bf16 v[16:19], v[12:15], v[40:43], v[16:19]
    v_bitop3_b32 v9, v40, v42, v10 bitop3:0x7e
    v_and_or_b32 v8, v9, 1, v8
    s_waitcnt vmcnt(3)
    v_mfma_f32_16x16x32_bf16 v[16:19], v[12:15], v[44:47], v[16:19]
    v_bitop3_b32 v9, v44, v46, v10 bitop3:0x7e
    v_and_or_b32 v8, v9, 1, v8
    v_add_f32_dpp v20, v20, v20 row_ror:8 row_mask:0xf bank_mask:0xf
    v_add_f32_dpp v21, v21, v21 row_ror:8 row_mask:0xf bank_mask:0xf
    v_add_f32_dpp v22, v22, v22 row_ror:8 row_mask:0xf bank_mask:0xf
    v_add_f32_dpp v23, v23, v23 row_ror:8 row_mask:0xf bank_mask:0xf
    ds_write_b128 v26, v[20:23]
    s_waitcnt vmcnt(2)
    v_mfma_f32_16x16x32_bf16 v[16:19], v[12:15], v[48:51], v[16:19]
    v_bitop3_b32 v9, v48, v50, v10 bitop3:0x7e
    v_and_or_b32 v8, v9, 1, v8
    s_waitcnt vmcnt(1)
    v_mfma_f32_16x16x32_bf16 v[16:19], v[12:15], v[52:55], v[16:19]
    v_bitop3_b32 v9, v52, v54, v10 bitop3:0x7e
    v_and_or_b32 v8, v9, 1, v8
    s_waitcnt vmcnt(0)
    v_mfma_f32_16x16x32_bf16 v[16:19], v[12:15], v[56:59], v[16:19]
    v_bitop3_b32 v9, v56, v58, v10 bitop3:0x7e
    v_and_or_b32 v8, v9, 1, v8
    v_cmp_ne_u32 vcc, 0, v8
    s_mov_b64 exec, vcc
    s_cbranch_vccnz L_xr_30
    s_mov_b64 exec, -1
    s_nop 1
    ds_write_b32 v5, v16 offset:0
    ds_write_b32 v5, v17 offset:256
    ds_write_b32 v5, v18 offset:512
    ds_write_b32 v5, v19 offset:768
    s_waitcnt lgkmcnt(0)
    s_barrier
    s_cmp_lg_u32 s10, 1
    s_cbranch_scc1 L_pf_31
    s_lshl_b32 s12, s9, 2
    v_mov_b32 v8, s12
    v_mov_b32 v9, s47
    s_mov_b64 exec, 1
    global_store_dword v8, v9, s[44:45] offset:1024
    s_mov_b64 exec, -1
L_pf_31:
    v_subrev_u32 v1, 98304, v1
    s_cmp_lg_u32 s10, 0
    s_cbranch_scc1 L_f_next_f
    v_add_u32 v49, 114688, v7
    ds_read_b32 v56, v49 offset:0
    ds_read_b32 v50, v49 offset:2048
    ds_read_b32 v57, v49 offset:256
    ds_read_b32 v51, v49 offset:2304
    ds_read_b32 v58, v49 offset:512
    ds_read_b32 v52, v49 offset:2560
    ds_read_b32 v59, v49 offset:768
    ds_read_b32 v53, v49 offset:2816
    ds_read_b32 v60, v49 offset:1024
    ds_read_b32 v54, v49 offset:3072
    v_add_u32 v7, 55296, v7
    v_lshlrev_b32 v48, 1, v7
    ds_read_b64 v[16:17], v48 offset:2048
    ds_read_b64 v[18:19], v48 offset:2304
    ds_read_b64 v[20:21], v48 offset:2560
    ds_read_b64 v[22:23], v48 offset:2816
    ds_read_b64 v[8:9], v48 offset:0
    ds_read_b64 v[10:11], v48 offset:512
    ds_read_b64 v[12:13], v48 offset:1024
    ds_read_b64 v[14:15], v48 offset:1536
    s_waitcnt lgkmcnt(4)
    v_pk_add_f32 v[16:17], v[16:17], v[18:19]
    v_pk_add_f32 v[20:21], v[20:21], v[22:23]
    v_pk_add_f32 v[16:17], v[16:17], v[20:21]
    s_waitcnt lgkmcnt(0)
    v_cvt_pk_bf16_f32 v9, v8, v9
    v_lshlrev_b32 v8, 16, v9
    v_and_b32 v9, 0xffff0000, v9
    v_cvt_pk_bf16_f32 v11, v10, v11
    v_lshlrev_b32 v10, 16, v11
    v_and_b32 v11, 0xffff0000, v11
    v_cvt_pk_bf16_f32 v13, v12, v13
    v_lshlrev_b32 v12, 16, v13
    v_and_b32 v13, 0xffff0000, v13
    v_cvt_pk_bf16_f32 v15, v14, v15
    v_lshlrev_b32 v14, 16, v15
    v_and_b32 v15, 0xffff0000, v15
    v_cvt_pk_bf16_f32 v17, v16, v17
    v_lshlrev_b32 v16, 16, v17
    v_and_b32 v17, 0xffff0000, v17
    v_subrev_u32 v7, 55296, v7
    v_lshlrev_b32 v18, 16, v50
    v_and_b32 v19, 0xffff0000, v50
    v_pk_mul_f32 v[8:9], v[8:9], v[18:19]
    v_cvt_pk_bf16_f32 v9, v8, v9
    v_lshlrev_b32 v8, 16, v9
    v_and_b32 v9, 0xffff0000, v9
    v_lshlrev_b32 v18, 16, v56
    v_and_b32 v19, 0xffff0000, v56
    v_pk_add_f32 v[8:9], v[8:9], v[18:19]
    v_cvt_pk_bf16_f32 v24, v8, v9
    global_store_dword v7, v24, s[34:35] offset:0
    v_lshlrev_b32 v18, 16, v51
    v_and_b32 v19, 0xffff0000, v51
    v_pk_mul_f32 v[10:11], v[10:11], v[18:19]
    v_cvt_pk_bf16_f32 v11, v10, v11
    v_lshlrev_b32 v10, 16, v11
    v_and_b32 v11, 0xffff0000, v11
    v_lshlrev_b32 v18, 16, v57
    v_and_b32 v19, 0xffff0000, v57
    v_pk_add_f32 v[10:11], v[10:11], v[18:19]
    v_cvt_pk_bf16_f32 v25, v10, v11
    global_store_dword v7, v25, s[34:35] offset:256
    v_lshlrev_b32 v18, 16, v52
    v_and_b32 v19, 0xffff0000, v52
    v_pk_mul_f32 v[12:13], v[12:13], v[18:19]
    v_cvt_pk_bf16_f32 v13, v12, v13
    v_lshlrev_b32 v12, 16, v13
    v_and_b32 v13, 0xffff0000, v13
    v_lshlrev_b32 v18, 16, v58
    v_and_b32 v19, 0xffff0000, v58
    v_pk_add_f32 v[12:13], v[12:13], v[18:19]
    v_cvt_pk_bf16_f32 v26, v12, v13
    global_store_dword v7, v26, s[34:35] offset:512
    v_lshlrev_b32 v18, 16, v53
    v_and_b32 v19, 0xffff0000, v53
    v_pk_mul_f32 v[14:15], v[14:15], v[18:19]
    v_cvt_pk_bf16_f32 v15, v14, v15
    v_lshlrev_b32 v14, 16, v15
    v_and_b32 v15, 0xffff0000, v15
    v_lshlrev_b32 v18, 16, v59
    v_and_b32 v19, 0xffff0000, v59
    v_pk_add_f32 v[14:15], v[14:15], v[18:19]
    v_cvt_pk_bf16_f32 v27, v14, v15
    global_store_dword v7, v27, s[34:35] offset:768
    s_mov_b32 exec_hi, 0
    v_lshlrev_b32 v18, 16, v54
    v_and_b32 v19, 0xffff0000, v54
    v_pk_mul_f32 v[16:17], v[16:17], v[18:19]
    v_cvt_pk_bf16_f32 v17, v16, v17
    v_lshlrev_b32 v16, 16, v17
    v_and_b32 v17, 0xffff0000, v17
    v_lshlrev_b32 v18, 16, v60
    v_and_b32 v19, 0xffff0000, v60
    v_pk_add_f32 v[16:17], v[16:17], v[18:19]
    v_cvt_pk_bf16_f32 v28, v16, v17
    global_store_dword v7, v28, s[34:35] offset:1024
    s_mov_b64 exec, -1
L_f_next_f:
    s_add_u32 s20, s20, 110592
    s_addc_u32 s21, s21, 0
    s_add_u32 s34, s34, 110592
    s_addc_u32 s35, s35, 0
    s_add_u32 s36, s36, 110592
    s_addc_u32 s37, s37, 0
    s_add_u32 s52, s52, 384
    s_addc_u32 s53, s53, 0
    s_add_u32 s24, s24, 3
    s_cmp_lt_u32 s24, 64
    s_cbranch_scc1 L_f_top_f
    s_branch L_exit
L_f_top_s:
    s_cmp_lg_u32 s59, 0
    s_cbranch_scc1 L_fpd_32
    v_and_b32 v8, 0x7c, v7
    s_mov_b32 s12, 0
L_fw_33:
    global_load_dword v9, v8, s[52:53] sc1
    s_add_u32 s12, s12, 1
    s_cmp_gt_u32 s12, 100000
    s_cbranch_scc1 L_exit
    s_waitcnt vmcnt(0)
    v_cmp_gt_u32 vcc, s25, v9
    s_cbranch_vccz L_fwd_34
    s_sleep 1
    s_branch L_fw_33
L_fwd_34:
    s_mov_b64 s[12:13], s[20:21]
    s_add_u32 m0, s26, 0
    s_nop 0
    global_load_lds_dwordx4 v0, s[12:13]
    s_add_u32 s12, s12, 4096
    s_addc_u32 s13, s13, 0
    s_add_u32 m0, s26, 4096
    s_nop 0
    global_load_lds_dwordx4 v0, s[12:13]
    s_add_u32 s12, s12, 4096
    s_addc_u32 s13, s13, 0
    s_add_u32 m0, s26, 8192
    s_nop 0
    global_load_lds_dwordx4 v0, s[12:13]
    s_add_u32 s12, s12, 4096
    s_addc_u32 s13, s13, 0
    s_add_u32 m0, s26, 12288
    s_nop 0
    global_load_lds_dwordx4 v0, s[12:13]
    s_add_u32 s12, s12, 4096
    s_addc_u32 s13, s13, 0
    s_add_u32 m0, s26, 16384
    s_nop 0
    global_load_lds_dwordx4 v0, s[12:13]
    s_add_u32 s12, s12, 4096
    s_addc_u32 s13, s13, 0
    s_add_u32 m0, s26, 20480
    s_nop 0
    global_load_lds_dwordx4 v0, s[12:13]
    s_add_u32 s12, s12, 4096
    s_addc_u32 s13, s13, 0
    s_add_u32 m0, s26, 24576
    s_nop 0
    global_load_lds_dwordx4 v0, s[12:13]
    s_add_u32 s12, s12, 4096
    s_addc_u32 s13, s13, 0
    s_add_u32 m0, s26, 28672
    s_nop 0
    global_load_lds_dwordx4 v0, s[12:13]
    s_add_u32 s12, s12, 4096
    s_addc_u32 s13, s13, 0
    s_add_u32 m0, s26, 32768
    s_nop 0
    global_load_lds_dwordx4 v0, s[12:13]
L_fpd_32:
    s_cmp_lg_u32 s10, 0
    s_cbranch_scc1 L_fx_35
    s_mov_b32 m0, 114688
    s_nop 0
    global_load_lds_dwordx4 v1, s[36:37]
    s_mov_b64 exec, 0xff
    global_load_lds_dwordx4 v1, s[36:37] offset:1024
    s_mov_b64 exec, -1
    s_mov_b32 m0, 116736
    s_nop 0
    global_load_lds_dwordx4 v1, s[54:55]
    s_mov_b64 exec, 0xff
    global_load_lds_dwordx4 v1, s[54:55] offset:1024
    s_mov_b64 exec, -1
L_fx_35:
    v_lshrrev_b32 v78, 4, v0
    v_mov_b32 v72, 0xe000
    v_bfe_u32 v8, v78, 0, 4
    v_mul_u32_u24 v8, 0x480, v8
    v_add_u32 v72, v72, v8
    v_bfe_u32 v8, v78, 6, 1
    v_mul_u32_u24 v8, 0x4800, v8
    v_add_u32 v72, v72, v8
    v_mov_b32 v9, 0x0
    v_bfe_u32 v8, v78, 1, 3
    v_lshlrev_b32 v8, 4, v8
    v_xor_b32 v9, v9, v8
    v_bfe_u32 v8, v78, 4, 2
    v_lshlrev_b32 v8, 4, v8
    v_xor_b32 v9, v9, v8
    v_add_u32 v72, v72, v9
    v_mov_b32 v73, 0xe000
    v_bfe_u32 v8, v78, 0, 4
    v_mul_u32_u24 v8, 0x480, v8
    v_add_u32 v73, v73, v8
    v_bfe_u32 v8, v78, 6, 1
    v_mul_u32_u24 v8, 0x4800, v8
    v_add_u32 v73, v73, v8
    v_mov_b32 v9, 0x40
    v_bfe_u32 v8, v78, 1, 3
    v_lshlrev_b32 v8, 4, v8
    v_xor_b32 v9, v9, v8
    v_bfe_u32 v8, v78, 4, 2
    v_lshlrev_b32 v8, 4, v8
    v_xor_b32 v9, v9, v8
    v_add_u32 v73, v73, v9
    v_mov_b32 v74, 0x12800
    v_bfe_u32 v8, v78, 0, 4
    v_mul_u32_u24 v8, 0x480, v8
    v_add_u32 v74, v74, v8
    v_bfe_i32 v8, v78, 6, 1
    v_and_b32 v8, 0xffffb800, v8
    v_add_u32 v74, v74, v8
    v_mov_b32 v9, 0x0
    v_bfe_u32 v8, v78, 1, 3
    v_lshlrev_b32 v8, 4, v8
    v_xor_b32 v9, v9, v8
    v_bfe_u32 v8, v78, 4, 2
    v_lshlrev_b32 v8, 4, v8
    v_xor_b32 v9, v9, v8
    v_add_u32 v74, v74, v9
    v_mov_b32 v75, 0x12800
    v_bfe_u32 v8, v78, 0, 4
    v_mul_u32_u24 v8, 0x480, v8
    v_add_u32 v75, v75, v8
    v_bfe_i32 v8, v78, 6, 1
    v_and_b32 v8, 0xffffb800, v8
    v_add_u32 v75, v75, v8
    v_mov_b32 v9, 0x40
    v_bfe_u32 v8, v78, 1, 3
    v_lshlrev_b32 v8, 4, v8
    v_xor_b32 v9, v9, v8
    v_bfe_u32 v8, v78, 4, 2
    v_lshlrev_b32 v8, 4, v8
    v_xor_b32 v9, v9, v8
    v_add_u32 v75, v75, v9
    v_mov_b32 v76, 0x0
    v_bfe_u32 v8, v78, 0, 4
    v_lshl_add_u32 v76, v8, 3, v76
    v_bfe_u32 v8, v78, 4, 2
    v_lshl_add_u32 v76, v8, 8, v76
    v_bfe_u32 v8, v78, 7, 1
    v_mul_u32_u24 v8, 0x4800, v8
    v_add_u32 v76, v76, v8
    v_mov_b32 v77, 0x18000
    v_bfe_u32 v8, v78, 0, 6
    v_lshl_add_u32 v77, v8, 4, v77
    v_bfe_u32 v8, v78, 6, 1
    v_mul_u32_u24 v8, 0x1400, v8
    v_add_u32 v77, v77, v8
    v_bfe_u32 v8, v78, 7, 1
    v_lshl_add_u32 v77, v8, 11, v77
    s_waitcnt vmcnt(0)
    s_barrier
    v_and_b32 v68, 0x7c, v7
    global_load_dword v79, v68, s[52:53] offset:384 sc1
    global_load_dword v69, v68, s[44:45] offset:1024 sc1
    ds_read_b128 v[48:51], v72 offset:0
    ds_read_b64_tr_b16 v[24:25], v76 offset:0
    ds_read_b64_tr_b16 v[26:27], v76 offset:128
    ds_read_b128 v[52:55], v73 offset:0
    ds_read_b64_tr_b16 v[28:29], v76 offset:1024
    ds_read_b64_tr_b16 v[30:31], v76 offset:1152
    ds_read_b128 v[56:59], v72 offset:128
    ds_read_b64_tr_b16 v[32:33], v76 offset:2048
    ds_read_b64_tr_b16 v[34:35], v76 offset:2176
    s_waitcnt lgkmcnt(8)
    v_mfma_f32_16x16x32_bf16 v[8:11], a[0:3], v[48:51], 0
    ds_read_b128 v[60:63], v73 offset:128
    v_mfma_f32_16x16x32_bf16 v[12:15], a[4:7], v[48:51], 0
    ds_read_b64_tr_b16 v[36:37], v76 offset:3072
    ds_read_b64_tr_b16 v[38:39], v76 offset:3200
    v_mfma_f32_16x16x32_bf16 v[16:19], a[8:11], v[48:51], 0
    v_mfma_f32_16x16x32_bf16 v[20:23], a[12:15], v[48:51], 0
    s_waitcnt lgkmcnt(9)
    v_mfma_f32_16x16x32_bf16 v[40:43], v[24:27], v[48:51], 0
    s_waitcnt lgkmcnt(8)
    v_mfma_f32_16x16x32_bf16 v[8:11], a[16:19], v[52:55], v[8:11]
    ds_read_b128 v[48:51], v72 offset:256
    v_mfma_f32_16x16x32_bf16 v[12:15], a[20:23], v[52:55], v[12:15]
    ds_read_b64_tr_b16 v[24:25], v76 offset:4096
    ds_read_b64_tr_b16 v[26:27], v76 offset:4224
    v_mfma_f32_16x16x32_bf16 v[16:19], a[24:27], v[52:55], v[16:19]
    v_mfma_f32_16x16x32_bf16 v[20:23], a[28:31], v[52:55], v[20:23]
    s_waitcnt lgkmcnt(9)
    v_mfma_f32_16x16x32_bf16 v[40:43], v[28:31], v[52:55], v[40:43]
    s_waitcnt lgkmcnt(8)
    v_mfma_f32_16x16x32_bf16 v[8:11], a[32:35], v[56:59], v[8:11]
    ds_read_b128 v[52:55], v73 offset:256
    v_mfma_f32_16x16x32_bf16 v[12:15], a[36:39], v[56:59], v[12:15]
    ds_read_b64_tr_b16 v[28:29], v76 offset:5120
    ds_read_b64_tr_b16 v[30:31], v76 offset:5248
    v_mfma_f32_16x16x32_bf16 v[16:19], a[40:43], v[56:59], v[16:19]
    v_mfma_f32_16x16x32_bf16 v[20:23], a[44:47], v[56:59], v[20:23]
    s_waitcnt lgkmcnt(9)
    v_mfma_f32_16x16x32_bf16 v[40:43], v[32:35], v[56:59], v[40:43]
    s_waitcnt lgkmcnt(8)
    v_mfma_f32_16x16x32_bf16 v[8:11], a[48:51], v[60:63], v[8:11]
    ds_read_b128 v[56:59], v72 offset:384
    v_mfma_f32_16x16x32_bf16 v[12:15], a[52:55], v[60:63], v[12:15]
    ds_read_b64_tr_b16 v[32:33], v76 offset:6144
    ds_read_b64_tr_b16 v[34:35], v76 offset:6272
    v_mfma_f32_16x16x32_bf16 v[16:19], a[56:59], v[60:63], v[16:19]
    v_mfma_f32_16x16x32_bf16 v[20:23], a[60:63], v[60:63], v[20:23]
    s_waitcnt lgkmcnt(9)
    v_mfma_f32_16x16x32_bf16 v[40:43], v[36:39], v[60:63], v[40:43]
    s_waitcnt lgkmcnt(8)
    v_mfma_f32_16x16x32_bf16 v[8:11], a[64:67], v[48:51], v[8:11]
    ds_read_b128 v[60:63], v73 offset:384
    v_mfma_f32_16x16x32_bf16 v[12:15], a[68:71], v[48:51], v[12:15]
    ds_read_b64_tr_b16 v[36:37], v76 offset:7168
    ds_read_b64_tr_b16 v[38:39], v76 offset:7296
    v_mfma_f32_16x16x32_bf16 v[16:19], a[72:75], v[48:51], v[16:19]
    v_mfma_f32_16x16x32_bf16 v[20:23], a[76:79], v[48:51], v[20:23]
    s_waitcnt lgkmcnt(9)
    v_mfma_f32_16x16x32_bf16 v[40:43], v[24:27], v[48:51], v[40:43]
    s_waitcnt lgkmcnt(8)
    v_mfma_f32_16x16x32_bf16 v[8:11], a[80:83], v[52:55], v[8:11]
    ds_read_b128 v[48:51], v72 offset:512
    v_mfma_f32_16x16x32_bf16 v[12:15], a[84:87], v[52:55], v[12:15]
    ds_read_b64_tr_b16 v[24:25], v76 offset:8192
    ds_read_b64_tr_b16 v[26:27], v76 offset:8320
    v_mfma_f32_16x16x32_bf16 v[16:19], a[88:91], v[52:55], v[16:19]
    v_mfma_f32_16x16x32_bf16 v[20:23], a[92:95], v[52:55], v[20:23]
    s_waitcnt lgkmcnt(9)
    v_mfma_f32_16x16x32_bf16 v[40:43], v[28:31], v[52:55], v[40:43]
    s_waitcnt lgkmcnt(8)
    v_mfma_f32_16x16x32_bf16 v[8:11], a[96:99], v[56:59], v[8:11]
    ds_read_b128 v[52:55], v73 offset:512
    v_mfma_f32_16x16x32_bf16 v[12:15], a[100:103], v[56:59], v[12:15]
    ds_read_b64_tr_b16 v[28:29], v76 offset:9216
    ds_read_b64_tr_b16 v[30:31], v76 offset:9344
    v_mfma_f32_16x16x32_bf16 v[16:19], a[104:107], v[56:59], v[16:19]
    v_mfma_f32_16x16x32_bf16 v[20:23], a[108:111], v[56:59], v[20:23]
    s_waitcnt lgkmcnt(9)
    v_mfma_f32_16x16x32_bf16 v[40:43], v[32:35], v[56:59], v[40:43]
    s_waitcnt lgkmcnt(8)
    v_mfma_f32_16x16x32_bf16 v[8:11], a[112:115], v[60:63], v[8:11]
    ds_read_b128 v[56:59], v72 offset:640
    v_mfma_f32_16x16x32_bf16 v[12:15], a[116:119], v[60:63], v[12:15]
    ds_read_b64_tr_b16 v[32:33], v76 offset:10240
    ds_read_b64_tr_b16 v[34:35], v76 offset:10368
    v_mfma_f32_16x16x32_bf16 v[16:19], a[120:123], v[60:63], v[16:19]
    v_mfma_f32_16x16x32_bf16 v[20:23], a[124:127], v[60:63], v[20:23]
    s_waitcnt lgkmcnt(9)
    v_mfma_f32_16x16x32_bf16 v[40:43], v[36:39], v[60:63], v[40:43]
    s_waitcnt lgkmcnt(8)
    v_mfma_f32_16x16x32_bf16 v[8:11], a[128:131], v[48:51], v[8:11]
    ds_read_b128 v[60:63], v73 offset:640
    v_mfma_f32_16x16x32_bf16 v[12:15], a[132:135], v[48:51], v[12:15]
    ds_read_b64_tr_b16 v[36:37], v76 offset:11264
    ds_read_b64_tr_b16 v[38:39], v76 offset:11392
    v_mfma_f32_16x16x32_bf16 v[16:19], a[136:139], v[48:51], v[16:19]
    v_mfma_f32_16x16x32_bf16 v[20:23], a[140:143], v[48:51], v[20:23]
    s_waitcnt lgkmcnt(9)
    v_mfma_f32_16x16x32_bf16 v[40:43], v[24:27], v[48:51], v[40:43]
    s_waitcnt lgkmcnt(8)
    v_mfma_f32_16x16x32_bf16 v[8:11], a[144:147], v[52:55], v[8:11]
    ds_read_b128 v[48:51], v72 offset:768
    v_mfma_f32_16x16x32_bf16 v[12:15], a[148:151], v[52:55], v[12:15]
    ds_read_b64_tr_b16 v[24:25], v76 offset:12288
    ds_read_b64_tr_b16 v[26:27], v76 offset:12416
    v_mfma_f32_16x16x32_bf16 v[16:19], a[152:155], v[52:55], v[16:19]
    v_mfma_f32_16x16x32_bf16 v[20:23], a[156:159], v[52:55], v[20:23]
    s_waitcnt lgkmcnt(9)
    v_mfma_f32_16x16x32_bf16 v[40:43], v[28:31], v[52:55], v[40:43]
    s_waitcnt lgkmcnt(8)
    v_mfma_f32_16x16x32_bf16 v[8:11], a[160:163], v[56:59], v[8:11]
    ds_read_b128 v[52:55], v73 offset:768
    v_mfma_f32_16x16x32_bf16 v[12:15], a[164:167], v[56:59], v[12:15]
    ds_read_b64_tr_b16 v[28:29], v76 offset:13312
    ds_read_b64_tr_b16 v[30:31], v76 offset:13440
    v_mfma_f32_16x16x32_bf16 v[16:19], a[168:171], v[56:59], v[16:19]
    v_mfma_f32_16x16x32_bf16 v[20:23], a[172:175], v[56:59], v[20:23]
    s_waitcnt lgkmcnt(9)
    v_mfma_f32_16x16x32_bf16 v[40:43], v[32:35], v[56:59], v[40:43]
    s_waitcnt lgkmcnt(8)
    v_mfma_f32_16x16x32_bf16 v[8:11], a[176:179], v[60:63], v[8:11]
    ds_read_b128 v[56:59], v72 offset:896
    v_mfma_f32_16x16x32_bf16 v[12:15], a[180:183], v[60:63], v[12:15]
    ds_read_b64_tr_b16 v[32:33], v76 offset:14336
    ds_read_b64_tr_b16 v[34:35], v76 offset:14464
    v_mfma_f32_16x16x32_bf16 v[16:19], a[184:187], v[60:63], v[16:19]
    v_mfma_f32_16x16x32_bf16 v[20:23], a[188:191], v[60:63], v[20:23]
    s_waitcnt lgkmcnt(9)
    v_mfma_f32_16x16x32_bf16 v[40:43], v[36:39], v[60:63], v[40:43]
    s_waitcnt lgkmcnt(8)
    v_mfma_f32_16x16x32_bf16 v[8:11], a[192:195], v[48:51], v[8:11]
    ds_read_b128 v[60:63], v73 offset:896
    v_mfma_f32_16x16x32_bf16 v[12:15], a[196:199], v[48:51], v[12:15]
    ds_read_b64_tr_b16 v[36:37], v76 offset:15360
    ds_read_b64_tr_b16 v[38:39], v76 offset:15488
    v_mfma_f32_16x16x32_bf16 v[16:19], a[200:203], v[48:51], v[16:19]
    v_mfma_f32_16x16x32_bf16 v[20:23], a[204:207], v[48:51], v[20:23]
    s_waitcnt lgkmcnt(9)
    v_mfma_f32_16x16x32_bf16 v[40:43], v[24:27], v[48:51], v[40:43]
    s_waitcnt lgkmcnt(8)
    v_mfma_f32_16x16x32_bf16 v[8:11], a[208:211], v[52:55], v[8:11]
    ds_read_b128 v[48:51], v72 offset:1024
    v_mfma_f32_16x16x32_bf16 v[12:15], a[212:215], v[52:55], v[12:15]
    ds_read_b64_tr_b16 v[24:25], v76 offset:16384
    ds_read_b64_tr_b16 v[26:27], v76 offset:16512
    v_mfma_f32_16x16x32_bf16 v[16:19], a[216:219], v[52:55], v[16:19]
    v_mfma_f32_16x16x32_bf16 v[20:23], a[220:223], v[52:55], v[20:23]
    s_waitcnt lgkmcnt(9)
    v_mfma_f32_16x16x32_bf16 v[40:43], v[28:31], v[52:55], v[40:43]
    s_waitcnt lgkmcnt(8)
    v_mfma_f32_16x16x32_bf16 v[8:11], a[224:227], v[56:59], v[8:11]
    ds_read_b128 v[52:55], v73 offset:1024
    v_mfma_f32_16x16x32_bf16 v[12:15], a[228:231], v[56:59], v[12:15]
    ds_read_b64_tr_b16 v[28:29], v76 offset:17408
    ds_read_b64_tr_b16 v[30:31], v76 offset:17536
    v_mfma_f32_16x16x32_bf16 v[16:19], a[232:235], v[56:59], v[16:19]
    v_mfma_f32_16x16x32_bf16 v[20:23], a[236:239], v[56:59], v[20:23]
    s_waitcnt lgkmcnt(9)
    v_mfma_f32_16x16x32_bf16 v[40:43], v[32:35], v[56:59], v[40:43]
    s_waitcnt lgkmcnt(8)
    v_mfma_f32_16x16x32_bf16 v[8:11], a[240:243], v[60:63], v[8:11]
    ds_read_b128 v[56:59], v74 offset:0
    v_mfma_f32_16x16x32_bf16 v[12:15], a[244:247], v[60:63], v[12:15]
    v_mfma_f32_16x16x32_bf16 v[16:19], a[248:251], v[60:63], v[16:19]
    v_mfma_f32_16x16x32_bf16 v[20:23], a[252:255], v[60:63], v[20:23]
    s_waitcnt lgkmcnt(7)
    v_mfma_f32_16x16x32_bf16 v[40:43], v[36:39], v[60:63], v[40:43]
    s_waitcnt lgkmcnt(6)
    v_mfma_f32_16x16x32_bf16 v[8:11], v[80:83], v[48:51], v[8:11]
    ds_read_b128 v[60:63], v75 offset:0
    v_mfma_f32_16x16x32_bf16 v[12:15], v[84:87], v[48:51], v[12:15]
    v_mfma_f32_16x16x32_bf16 v[16:19], v[88:91], v[48:51], v[16:19]
    v_mfma_f32_16x16x32_bf16 v[20:23], v[92:95], v[48:51], v[20:23]
    s_waitcnt lgkmcnt(5)
    v_mfma_f32_16x16x32_bf16 v[40:43], v[24:27], v[48:51], v[40:43]
    s_waitcnt lgkmcnt(4)
    v_mfma_f32_16x16x32_bf16 v[8:11], v[96:99], v[52:55], v[8:11]
    ds_read_b128 v[48:51], v74 offset:128
    v_mfma_f32_16x16x32_bf16 v[12:15], v[100:103], v[52:55], v[12:15]
    v_mfma_f32_16x16x32_bf16 v[16:19], v[104:107], v[52:55], v[16:19]
    v_mfma_f32_16x16x32_bf16 v[20:23], v[108:111], v[52:55], v[20:23]
    s_waitcnt lgkmcnt(3)
    v_mfma_f32_16x16x32_bf16 v[40:43], v[28:31], v[52:55], v[40:43]
    s_waitcnt lgkmcnt(2)
    v_mfma_f32_16x16x32_bf16 v[24:27], a[0:3], v[56:59], 0
    ds_read_b128 v[52:55], v75 offset:128
    v_mfma_f32_16x16x32_bf16 v[28:31], a[4:7], v[56:59], 0
    v_mfma_f32_16x16x32_bf16 v[32:35], a[8:11], v[56:59], 0
    v_mfma_f32_16x16x32_bf16 v[36:39], a[12:15], v[56:59], 0
    s_waitcnt lgkmcnt(2)
    v_mfma_f32_16x16x32_bf16 v[24:27], a[16:19], v[60:63], v[24:27]
    ds_read_b128 v[56:59], v74 offset:256
    v_mfma_f32_16x16x32_bf16 v[28:31], a[20:23], v[60:63], v[28:31]
    v_mfma_f32_16x16x32_bf16 v[32:35], a[24:27], v[60:63], v[32:35]
    v_mfma_f32_16x16x32_bf16 v[36:39], a[28:31], v[60:63], v[36:39]
    s_waitcnt lgkmcnt(2)
    v_mfma_f32_16x16x32_bf16 v[24:27], a[32:35], v[48:51], v[24:27]
    ds_read_b128 v[60:63], v75 offset:256
    v_cvt_pk_bf16_f32 v9, v8, v9
    v_lshlrev_b32 v8, 16, v9
    v_mfma_f32_16x16x32_bf16 v[28:31], a[36:39], v[48:51], v[28:31]
    v_and_b32 v9, 0xffff0000, v9
    v_cvt_pk_bf16_f32 v17, v16, v17
    v_mfma_f32_16x16x32_bf16 v[32:35], a[40:43], v[48:51], v[32:35]
    v_lshlrev_b32 v16, 16, v17
    v_and_b32 v17, 0xffff0000, v17
    v_mfma_f32_16x16x32_bf16 v[36:39], a[44:47], v[48:51], v[36:39]
    v_mul_f32 v70, s60, v8
    v_mul_f32 v71, s60, v9
    s_waitcnt lgkmcnt(2)
    v_mfma_f32_16x16x32_bf16 v[24:27], a[48:51], v[52:55], v[24:27]
    ds_read_b128 v[48:51], v74 offset:384
    v_exp_f32 v70, v70
    v_exp_f32 v71, v71
    v_mfma_f32_16x16x32_bf16 v[28:31], a[52:55], v[52:55], v[28:31]
    v_add_f32 v70, 1.0, v70
    v_add_f32 v71, 1.0, v71
    v_mfma_f32_16x16x32_bf16 v[32:35], a[56:59], v[52:55], v[32:35]
    v_rcp_f32 v70, v70
    v_rcp_f32 v71, v71
    v_mfma_f32_16x16x32_bf16 v[36:39], a[60:63], v[52:55], v[36:39]
    v_mul_f32 v8, v8, v70
    v_mul_f32 v9, v9, v71
    s_waitcnt lgkmcnt(2)
    v_mfma_f32_16x16x32_bf16 v[24:27], a[64:67], v[56:59], v[24:27]
    ds_read_b128 v[52:55], v75 offset:384
    v_cvt_pk_bf16_f32 v9, v8, v9
    v_lshlrev_b32 v8, 16, v9
    v_mfma_f32_16x16x32_bf16 v[28:31], a[68:71], v[56:59], v[28:31]
    v_and_b32 v9, 0xffff0000, v9
    v_mul_f32 v8, v8, v16
    v_mfma_f32_16x16x32_bf16 v[32:35], a[72:75], v[56:59], v[32:35]
    v_mul_f32 v9, v9, v17
    v_cvt_pk_bf16_f32 v64, v8, v9
    v_mfma_f32_16x16x32_bf16 v[36:39], a[76:79], v[56:59], v[36:39]
    v_cvt_pk_bf16_f32 v11, v10, v11
    v_lshlrev_b32 v10, 16, v11
    s_waitcnt lgkmcnt(2)
    v_mfma_f32_16x16x32_bf16 v[24:27], a[80:83], v[60:63], v[24:27]
    ds_read_b128 v[56:59], v74 offset:512
    v_and_b32 v11, 0xffff0000, v11
    v_cvt_pk_bf16_f32 v19, v18, v19
    v_mfma_f32_16x16x32_bf16 v[28:31], a[84:87], v[60:63], v[28:31]
    v_lshlrev_b32 v18, 16, v19
    v_and_b32 v19, 0xffff0000, v19
    v_mfma_f32_16x16x32_bf16 v[32:35], a[88:91], v[60:63], v[32:35]
    v_mul_f32 v70, s60, v10
    v_mul_f32 v71, s60, v11
    v_mfma_f32_16x16x32_bf16 v[36:39], a[92:95], v[60:63], v[36:39]
    v_exp_f32 v70, v70
    v_exp_f32 v71, v71
    s_waitcnt lgkmcnt(2)
    v_mfma_f32_16x16x32_bf16 v[24:27], a[96:99], v[48:51], v[24:27]
    ds_read_b128 v[60:63], v75 offset:512
    v_add_f32 v70, 1.0, v70
    v_add_f32 v71, 1.0, v71
    v_mfma_f32_16x16x32_bf16 v[28:31], a[100:103], v[48:51], v[28:31]
    v_rcp_f32 v70, v70
    v_rcp_f32 v71, v71
    v_mfma_f32_16x16x32_bf16 v[32:35], a[104:107], v[48:51], v[32:35]
    v_mul_f32 v10, v10, v70
    v_mul_f32 v11, v11, v71
    v_mfma_f32_16x16x32_bf16 v[36:39], a[108:111], v[48:51], v[36:39]
    v_cvt_pk_bf16_f32 v11, v10, v11
    v_lshlrev_b32 v10, 16, v11
    s_waitcnt lgkmcnt(2)
    v_mfma_f32_16x16x32_bf16 v[24:27], a[112:115], v[52:55], v[24:27]
    ds_read_b128 v[48:51], v74 offset:640
    v_and_b32 v11, 0xffff0000, v11
    v_mul_f32 v10, v10, v18
    v_mfma_f32_16x16x32_bf16 v[28:31], a[116:119], v[52:55], v[28:31]
    v_mul_f32 v11, v11, v19
    v_cvt_pk_bf16_f32 v65, v10, v11
    v_mfma_f32_16x16x32_bf16 v[32:35], a[120:123], v[52:55], v[32:35]
    v_cvt_pk_bf16_f32 v13, v12, v13
    v_lshlrev_b32 v12, 16, v13
    v_mfma_f32_16x16x32_bf16 v[36:39], a[124:127], v[52:55], v[36:39]
    v_and_b32 v13, 0xffff0000, v13
    v_cvt_pk_bf16_f32 v21, v20, v21
    s_waitcnt lgkmcnt(2)
    v_mfma_f32_16x16x32_bf16 v[24:27], a[128:131], v[56:59], v[24:27]
    ds_read_b128 v[52:55], v75 offset:640
    v_lshlrev_b32 v20, 16, v21
    v_and_b32 v21, 0xffff0000, v21
    v_mfma_f32_16x16x32_bf16 v[28:31], a[132:135], v[56:59], v[28:31]
    v_mul_f32 v70, s60, v12
    v_mul_f32 v71, s60, v13
    v_mfma_f32_16x16x32_bf16 v[32:35], a[136:139], v[56:59], v[32:35]
    v_exp_f32 v70, v70
    v_exp_f32 v71, v71
    v_mfma_f32_16x16x32_bf16 v[36:39], a[140:143], v[56:59], v[36:39]
    v_add_f32 v70, 1.0, v70
    v_add_f32 v71, 1.0, v71
    s_waitcnt lgkmcnt(2)
    v_mfma_f32_16x16x32_bf16 v[24:27], a[144:147], v[60:63], v[24:27]
    ds_read_b128 v[56:59], v74 offset:768
    v_rcp_f32 v70, v70
    v_rcp_f32 v71, v71
    v_mfma_f32_16x16x32_bf16 v[28:31], a[148:151], v[60:63], v[28:31]
    v_mul_f32 v12, v12, v70
    v_mul_f32 v13, v13, v71
    v_mfma_f32_16x16x32_bf16 v[32:35], a[152:155], v[60:63], v[32:35]
    v_cvt_pk_bf16_f32 v13, v12, v13
    v_lshlrev_b32 v12, 16, v13
    v_mfma_f32_16x16x32_bf16 v[36:39], a[156:159], v[60:63], v[36:39]
    v_and_b32 v13, 0xffff0000, v13
    v_mul_f32 v12, v12, v20
    s_waitcnt lgkmcnt(2)
    v_mfma_f32_16x16x32_bf16 v[24:27], a[160:163], v[48:51], v[24:27]
    ds_read_b128 v[60:63], v75 offset:768
    v_mul_f32 v13, v13, v21
    v_cvt_pk_bf16_f32 v66, v12, v13
    v_mfma_f32_16x16x32_bf16 v[28:31], a[164:167], v[48:51], v[28:31]
    v_cvt_pk_bf16_f32 v15, v14, v15
    v_lshlrev_b32 v14, 16, v15
    v_mfma_f32_16x16x32_bf16 v[32:35], a[168:171], v[48:51], v[32:35]
    v_and_b32 v15, 0xffff0000, v15
    v_cvt_pk_bf16_f32 v23, v22, v23
    v_mfma_f32_16x16x32_bf16 v[36:39], a[172:175], v[48:51], v[36:39]
    v_lshlrev_b32 v22, 16, v23
    v_and_b32 v23, 0xffff0000, v23
    s_waitcnt lgkmcnt(2)
    v_mfma_f32_16x16x32_bf16 v[24:27], a[176:179], v[52:55], v[24:27]
    ds_read_b128 v[48:51], v74 offset:896
    v_mul_f32 v70, s60, v14
    v_mul_f32 v71, s60, v15
    v_mfma_f32_16x16x32_bf16 v[28:31], a[180:183], v[52:55], v[28:31]
    v_exp_f32 v70, v70
    v_exp_f32 v71, v71
    v_mfma_f32_16x16x32_bf16 v[32:35], a[184:187], v[52:55], v[32:35]
    v_add_f32 v70, 1.0, v70
    v_add_f32 v71, 1.0, v71
    v_mfma_f32_16x16x32_bf16 v[36:39], a[188:191], v[52:55], v[36:39]
    v_rcp_f32 v70, v70
    v_rcp_f32 v71, v71
    s_waitcnt lgkmcnt(2)
    v_mfma_f32_16x16x32_bf16 v[24:27], a[192:195], v[56:59], v[24:27]
    ds_read_b128 v[52:55], v75 offset:896
    v_mul_f32 v14, v14, v70
    v_mul_f32 v15, v15, v71
    v_mfma_f32_16x16x32_bf16 v[28:31], a[196:199], v[56:59], v[28:31]
    v_cvt_pk_bf16_f32 v15, v14, v15
    v_lshlrev_b32 v14, 16, v15
    v_mfma_f32_16x16x32_bf16 v[32:35], a[200:203], v[56:59], v[32:35]
    v_and_b32 v15, 0xffff0000, v15
    v_mul_f32 v14, v14, v22
    v_mfma_f32_16x16x32_bf16 v[36:39], a[204:207], v[56:59], v[36:39]
    v_mul_f32 v15, v15, v23
    v_cvt_pk_bf16_f32 v67, v14, v15
    s_waitcnt lgkmcnt(2)
    v_mfma_f32_16x16x32_bf16 v[24:27], a[208:211], v[60:63], v[24:27]
    ds_read_b128 v[56:59], v74 offset:1024
    ds_write_b128 v77, v[64:67]
    v_cvt_pk_bf16_f32 v41, v40, v41
    v_mfma_f32_16x16x32_bf16 v[28:31], a[212:215], v[60:63], v[28:31]
    v_lshlrev_b32 v40, 16, v41
    v_and_b32 v41, 0xffff0000, v41
    v_mfma_f32_16x16x32_bf16 v[32:35], a[216:219], v[60:63], v[32:35]
    v_cvt_pk_bf16_f32 v43, v42, v43
    v_lshlrev_b32 v42, 16, v43
    v_mfma_f32_16x16x32_bf16 v[36:39], a[220:223], v[60:63], v[36:39]
    v_and_b32 v43, 0xffff0000, v43
    v_mul_f32 v44, s60, v40
    s_waitcnt lgkmcnt(3)
    v_mfma_f32_16x16x32_bf16 v[24:27], a[224:227], v[48:51], v[24:27]
    ds_read_b128 v[60:63], v75 offset:1024
    v_mul_f32 v45, s60, v41
    v_mul_f32 v46, s60, v42
    v_mfma_f32_16x16x32_bf16 v[28:31], a[228:231], v[48:51], v[28:31]
    v_mul_f32 v47, s60, v43
    v_exp_f32 v44, v44
    v_mfma_f32_16x16x32_bf16 v[32:35], a[232:235], v[48:51], v[32:35]
    v_exp_f32 v45, v45
    v_exp_f32 v46, v46
    v_mfma_f32_16x16x32_bf16 v[36:39], a[236:239], v[48:51], v[36:39]
    v_exp_f32 v47, v47
    v_add_f32 v44, 1.0, v44
    s_waitcnt lgkmcnt(3)
    v_mfma_f32_16x16x32_bf16 v[24:27], a[240:243], v[52:55], v[24:27]
    v_add_f32 v45, 1.0, v45
    v_add_f32 v46, 1.0, v46
    v_mfma_f32_16x16x32_bf16 v[28:31], a[244:247], v[52:55], v[28:31]
    v_add_f32 v47, 1.0, v47
    v_rcp_f32 v44, v44
    v_mfma_f32_16x16x32_bf16 v[32:35], a[248:251], v[52:55], v[32:35]
    v_rcp_f32 v45, v45
    v_rcp_f32 v46, v46
    v_mfma_f32_16x16x32_bf16 v[36:39], a[252:255], v[52:55], v[36:39]
    v_rcp_f32 v47, v47
    v_mul_f32 v44, v40, v44
    s_waitcnt lgkmcnt(2)
    v_mfma_f32_16x16x32_bf16 v[24:27], v[80:83], v[56:59], v[24:27]
    v_mul_f32 v45, v41, v45
    v_mul_f32 v46, v42, v46
    v_mfma_f32_16x16x32_bf16 v[28:31], v[84:87], v[56:59], v[28:31]
    v_mul_f32 v47, v43, v47
    v_cvt_pk_bf16_f32 v45, v44, v45
    v_mfma_f32_16x16x32_bf16 v[32:35], v[88:91], v[56:59], v[32:35]
    v_lshlrev_b32 v44, 16, v45
    v_and_b32 v45, 0xffff0000, v45
    v_mfma_f32_16x16x32_bf16 v[36:39], v[92:95], v[56:59], v[36:39]
    v_cvt_pk_bf16_f32 v47, v46, v47
    v_lshlrev_b32 v46, 16, v47
    s_waitcnt lgkmcnt(0)
    v_mfma_f32_16x16x32_bf16 v[24:27], v[96:99], v[60:63], v[24:27]
    v_and_b32 v47, 0xffff0000, v47
    v_cndmask_b32 v40, v44, v40, s[62:63]
    v_mfma_f32_16x16x32_bf16 v[28:31], v[100:103], v[60:63], v[28:31]
    v_cndmask_b32 v41, v45, v41, s[62:63]
    v_cndmask_b32 v42, v46, v42, s[62:63]
    v_mfma_f32_16x16x32_bf16 v[32:35], v[104:107], v[60:63], v[32:35]
    v_cndmask_b32 v43, v47, v43, s[62:63]
    v_add_u32 v70, 106496, v0
    v_mfma_f32_16x16x32_bf16 v[36:39], v[108:111], v[60:63], v[36:39]
    ds_write_b128 v70, v[40:43]
    v_cvt_pk_bf16_f32 v25, v24, v25
    v_cvt_pk_bf16_f32 v29, v28, v29
    v_lshlrev_b32 v24, 16, v25
    v_lshlrev_b32 v28, 16, v29
    v_and_b32 v25, 0xffff0000, v25
    v_and_b32 v29, 0xffff0000, v29
    v_cvt_pk_bf16_f32 v33, v32, v33
    v_cvt_pk_bf16_f32 v37, v36, v37
    v_lshlrev_b32 v32, 16, v33
    v_lshlrev_b32 v36, 16, v37
    v_and_b32 v33, 0xffff0000, v33
    v_and_b32 v37, 0xffff0000, v37
    v_pk_mul_f32 v[52:53], v[24:25], s[60:61] op_sel_hi:[1,0]
    v_pk_mul_f32 v[54:55], v[28:29], s[60:61] op_sel_hi:[1,0]
    v_exp_f32 v52, v52
    v_exp_f32 v54, v54
    v_exp_f32 v53, v53
    v_exp_f32 v55, v55
    v_pk_add_f32 v[52:53], v[52:53], 1.0 op_sel_hi:[1,0]
    v_pk_add_f32 v[54:55], v[54:55], 1.0 op_sel_hi:[1,0]
    v_rcp_f32 v52, v52
    v_rcp_f32 v54, v54
    v_rcp_f32 v53, v53
    v_rcp_f32 v55, v55
    v_pk_mul_f32 v[24:25], v[24:25], v[52:53]
    v_pk_mul_f32 v[28:29], v[28:29], v[54:55]
    v_cvt_pk_bf16_f32 v25, v24, v25
    v_cvt_pk_bf16_f32 v29, v28, v29
    v_lshlrev_b32 v24, 16, v25
    v_lshlrev_b32 v28, 16, v29
    v_and_b32 v25, 0xffff0000, v25
    v_and_b32 v29, 0xffff0000, v29
    v_pk_mul_f32 v[24:25], v[24:25], v[32:33]
    v_pk_mul_f32 v[28:29], v[28:29], v[36:37]
    v_cvt_pk_bf16_f32 v48, v24, v25
    v_cvt_pk_bf16_f32 v50, v28, v29
    v_cvt_pk_bf16_f32 v27, v26, v27
    v_cvt_pk_bf16_f32 v31, v30, v31
    v_lshlrev_b32 v26, 16, v27
    v_lshlrev_b32 v30, 16, v31
    v_and_b32 v27, 0xffff0000, v27
    v_and_b32 v31, 0xffff0000, v31
    v_cvt_pk_bf16_f32 v35, v34, v35
    v_cvt_pk_bf16_f32 v39, v38, v39
    v_lshlrev_b32 v34, 16, v35
    v_lshlrev_b32 v38, 16, v39
    v_and_b32 v35, 0xffff0000, v35
    v_and_b32 v39, 0xffff0000, v39
    v_pk_mul_f32 v[52:53], v[26:27], s[60:61] op_sel_hi:[1,0]
    v_pk_mul_f32 v[54:55], v[30:31], s[60:61] op_sel_hi:[1,0]
    v_exp_f32 v52, v52
    v_exp_f32 v54, v54
    v_exp_f32 v53, v53
    v_exp_f32 v55, v55
    v_pk_add_f32 v[52:53], v[52:53], 1.0 op_sel_hi:[1,0]
    v_pk_add_f32 v[54:55], v[54:55], 1.0 op_sel_hi:[1,0]
    v_rcp_f32 v52, v52
    v_rcp_f32 v54, v54
    v_rcp_f32 v53, v53
    v_rcp_f32 v55, v55
    v_pk_mul_f32 v[26:27], v[26:27], v[52:53]
    v_pk_mul_f32 v[30:31], v[30:31], v[54:55]
    v_cvt_pk_bf16_f32 v27, v26, v27
    v_cvt_pk_bf16_f32 v31, v30, v31
    v_lshlrev_b32 v26, 16, v27
    v_lshlrev_b32 v30, 16, v31
    v_and_b32 v27, 0xffff0000, v27
    v_and_b32 v31, 0xffff0000, v31
    v_pk_mul_f32 v[26:27], v[26:27], v[34:35]
    v_pk_mul_f32 v[30:31], v[30:31], v[38:39]
    v_cvt_pk_bf16_f32 v49, v26, v27
    v_cvt_pk_bf16_f32 v51, v30, v31
    v_xor_b32 v77, 4096, v77
    ds_write_b128 v77, v[48:51]
    v_mov_b32 v27, 0x9000
    v_bfe_u32 v8, v78, 0, 2
    v_lshl_add_u32 v27, v8, 3, v27
    v_bfe_u32 v8, v78, 2, 4
    v_mul_u32_u24 v8, 0x480, v8
    v_add_u32 v27, v27, v8
    v_bfe_u32 v8, v78, 6, 2
    v_lshl_add_u32 v27, v8, 5, v27
    s_waitcnt vmcnt(0)
    v_cmp_gt_u32 vcc, s47, v69
    s_cbranch_vccz L_fcw_36
    v_and_b32 v8, 0x7c, v7
    v_add_u32 v8, 1024, v8
    s_mov_b32 s12, 0
L_fw_37:
    global_load_dword v9, v8, s[44:45] sc1
    s_add_u32 s12, s12, 1
    s_cmp_gt_u32 s12, 100000
    s_cbranch_scc1 L_exit
    s_waitcnt vmcnt(0)
    v_cmp_gt_u32 vcc, s47, v9
    s_cbranch_vccz L_fwd_38
    s_branch L_fw_37
L_fwd_38:
L_fcw_36:
    v_cmp_eq_u32 vcc, 0, v79
    s_waitcnt lgkmcnt(0)
    s_barrier
    s_mov_b32 s59, 0
    s_cbranch_vccnz L_fnp_39
    s_cmp_ge_u32 s24, 61
    s_cbranch_scc1 L_fnp_39
    s_add_u32 s56, s20, 110592
    s_addc_u32 s57, s21, 0
    s_mov_b64 s[12:13], s[56:57]
    s_add_u32 m0, s26, 0
    s_nop 0
    global_load_lds_dwordx4 v0, s[12:13]
    s_add_u32 s12, s12, 4096
    s_addc_u32 s13, s13, 0
    s_add_u32 m0, s26, 4096
    s_nop 0
    global_load_lds_dwordx4 v0, s[12:13]
    s_add_u32 s12, s12, 4096
    s_addc_u32 s13, s13, 0
    s_add_u32 m0, s26, 8192
    s_nop 0
    global_load_lds_dwordx4 v0, s[12:13]
    s_add_u32 s12, s12, 4096
    s_addc_u32 s13, s13, 0
    s_add_u32 m0, s26, 12288
    s_nop 0
    global_load_lds_dwordx4 v0, s[12:13]
    s_add_u32 s12, s12, 4096
    s_addc_u32 s13, s13, 0
    s_add_u32 m0, s26, 16384
    s_nop 0
    global_load_lds_dwordx4 v0, s[12:13]
    s_add_u32 s12, s12, 4096
    s_addc_u32 s13, s13, 0
    s_add_u32 m0, s26, 20480
    s_nop 0
    global_load_lds_dwordx4 v0, s[12:13]
    s_add_u32 s12, s12, 4096
    s_addc_u32 s13, s13, 0
    s_add_u32 m0, s26, 24576
    s_nop 0
    global_load_lds_dwordx4 v0, s[12:13]
    s_add_u32 s12, s12, 4096
    s_addc_u32 s13, s13, 0
    s_add_u32 m0, s26, 28672
    s_nop 0
    global_load_lds_dwordx4 v0, s[12:13]
    s_add_u32 s12, s12, 4096
    s_addc_u32 s13, s13, 0
    s_add_u32 m0, s26, 32768
    s_nop 0
    global_load_lds_dwordx4 v0, s[12:13]
    s_mov_b32 s59, 1
L_fnp_39:
    v_add_u32 v1, 98304, v1
    s_add_u32 s47, s47, 1
    s_xor_b32 s46, s47, s9
    s_and_b32 s46, s46, 1
    v_mov_b32 v24, s46
    ds_read_b128 v[52:55], v1 offset:8192
    ds_read_b128 v[56:59], v1 offset:10240
    ds_read_b128 v[60:63], v1 offset:9216
    ds_read_b128 v[64:67], v1 offset:11264
    ds_read_b64_tr_b16 v[68:69], v27 offset:1024
    ds_read_b64_tr_b16 v[70:71], v27 offset:0
    ds_read_b64_tr_b16 v[76:77], v27 offset:128
    ds_read_b64_tr_b16 v[78:79], v27 offset:256
    ds_read_b128 v[8:11], v1 offset:0
    ds_read_b128 v[12:15], v1 offset:1024
    ds_read_b128 v[16:19], v1 offset:2048
    ds_read_b128 v[20:23], v1 offset:3072
    s_waitcnt lgkmcnt(10)
    v_pk_mul_f32 v[52:53], v[52:53], v[56:57]
    v_pk_mul_f32 v[54:55], v[54:55], v[58:59]
    v_cvt_pk_bf16_f32 v72, v52, v53
    v_cvt_pk_bf16_f32 v73, v54, v55
    s_waitcnt lgkmcnt(8)
    v_pk_mul_f32 v[60:61], v[60:61], v[64:65]
    v_pk_mul_f32 v[62:63], v[62:63], v[66:67]
    v_cvt_pk_bf16_f32 v74, v60, v61
    v_cvt_pk_bf16_f32 v75, v62, v63
    s_waitcnt lgkmcnt(3)
    v_mfma_f32_16x16x32_bf16 v[28:31], v[240:243], v[8:11], 0
    v_mfma_f32_16x16x32_bf16 v[32:35], v[8:11], v[112:115], 0
    v_mfma_f32_16x16x32_bf16 v[36:39], v[8:11], v[128:131], 0
    s_waitcnt lgkmcnt(2)
    v_mfma_f32_16x16x32_bf16 v[28:31], v[244:247], v[12:15], v[28:31]
    v_mfma_f32_16x16x32_bf16 v[32:35], v[12:15], v[116:119], v[32:35]
    v_mfma_f32_16x16x32_bf16 v[36:39], v[12:15], v[132:135], v[36:39]
    s_waitcnt lgkmcnt(1)
    v_mfma_f32_16x16x32_bf16 v[28:31], v[248:251], v[16:19], v[28:31]
    v_mfma_f32_16x16x32_bf16 v[32:35], v[16:19], v[120:123], v[32:35]
    v_mfma_f32_16x16x32_bf16 v[36:39], v[16:19], v[136:139], v[36:39]
    s_waitcnt lgkmcnt(0)
    v_mfma_f32_16x16x32_bf16 v[28:31], v[252:255], v[20:23], v[28:31]
    v_mfma_f32_16x16x32_bf16 v[32:35], v[20:23], v[124:127], v[32:35]
    v_mfma_f32_16x16x32_bf16 v[36:39], v[20:23], v[140:143], v[36:39]
    v_mfma_f32_16x16x32_bf16 v[40:43], v[8:11], v[144:147], 0
    v_mfma_f32_16x16x32_bf16 v[44:47], v[8:11], v[160:163], 0
    s_nop 1
    v_mfma_f32_16x16x16_bf16 v[28:31], v[68:69], v[72:73], v[28:31]
    ds_read_b64_tr_b16 v[68:69], v27 offset:384
    v_mfma_f32_16x16x16_bf16 v[32:35], v[72:73], v[70:71], v[32:35]
    ds_read_b64_tr_b16 v[70:71], v27 offset:512
    v_mfma_f32_16x16x16_bf16 v[36:39], v[72:73], v[76:77], v[36:39]
    ds_read_b64_tr_b16 v[76:77], v27 offset:640
    v_mfma_f32_16x16x32_bf16 v[40:43], v[12:15], v[148:151], v[40:43]
    v_mfma_f32_16x16x32_bf16 v[44:47], v[12:15], v[164:167], v[44:47]
    v_mfma_f32_16x16x32_bf16 v[40:43], v[16:19], v[152:155], v[40:43]
    v_mfma_f32_16x16x32_bf16 v[44:47], v[16:19], v[168:171], v[44:47]
    v_cvt_pk_bf16_f32 v28, v28, v29
    v_cvt_pk_bf16_f32 v29, v30, v31
    v_mfma_f32_16x16x32_bf16 v[40:43], v[20:23], v[156:159], v[40:43]
    v_bfi_b32 v28, 1, v24, v28
    s_add_u32 s12, s40, 0
    s_addc_u32 s13, s41, 0
    global_store_dwordx2 v3, v[28:29], s[12:13] sc1
    v_mfma_f32_16x16x32_bf16 v[44:47], v[20:23], v[172:175], v[44:47]
    v_cvt_pk_bf16_f32 v52, v32, v36
    v_cvt_pk_bf16_f32 v56, v33, v37
    v_mfma_f32_16x16x32_bf16 v[48:51], v[8:11], v[176:179], 0
    v_cvt_pk_bf16_f32 v60, v34, v38
    v_cvt_pk_bf16_f32 v64, v35, v39
    v_mfma_f32_16x16x32_bf16 v[28:31], v[8:11], v[192:195], 0
    v_bfi_b32 v52, 1, v24, v52
    v_bfi_b32 v56, 1, v24, v56
    v_mfma_f32_16x16x16_bf16 v[40:43], v[72:73], v[78:79], v[40:43]
    v_bfi_b32 v60, 1, v24, v60
    v_bfi_b32 v64, 1, v24, v64
    ds_read_b64_tr_b16 v[78:79], v27 offset:768
    s_waitcnt lgkmcnt(3)
    v_mfma_f32_16x16x16_bf16 v[44:47], v[72:73], v[68:69], v[44:47]
    ds_read_b64_tr_b16 v[68:69], v27 offset:896
    v_mfma_f32_16x16x32_bf16 v[48:51], v[12:15], v[180:183], v[48:51]
    v_mfma_f32_16x16x32_bf16 v[28:31], v[12:15], v[196:199], v[28:31]
    v_mfma_f32_16x16x32_bf16 v[48:51], v[16:19], v[184:187], v[48:51]
    v_mfma_f32_16x16x32_bf16 v[28:31], v[16:19], v[200:203], v[28:31]
    s_nop 2
    v_cvt_pk_bf16_f32 v53, v40, v44
    v_cvt_pk_bf16_f32 v57, v41, v45
    v_mfma_f32_16x16x32_bf16 v[48:51], v[20:23], v[188:191], v[48:51]
    v_cvt_pk_bf16_f32 v61, v42, v46
    v_cvt_pk_bf16_f32 v65, v43, v47
    v_mfma_f32_16x16x32_bf16 v[28:31], v[20:23], v[204:207], v[28:31]
    s_add_u32 s12, s40, 0
    s_addc_u32 s13, s41, 0
    global_store_dwordx2 v2, v[52:53], s[12:13] offset:0 sc1
    v_mfma_f32_16x16x32_bf16 v[32:35], v[8:11], v[208:211], 0
    s_add_u32 s12, s40, 36864
    s_addc_u32 s13, s41, 0
    global_store_dwordx2 v2, v[56:57], s[12:13] offset:0 sc1
    v_mfma_f32_16x16x32_bf16 v[36:39], v[8:11], v[224:227], 0
    s_add_u32 s12, s40, 73728
    s_addc_u32 s13, s41, 0
    global_store_dwordx2 v2, v[60:61], s[12:13] offset:0 sc1
    s_waitcnt lgkmcnt(3)
    v_mfma_f32_16x16x16_bf16 v[48:51], v[72:73], v[70:71], v[48:51]
    s_add_u32 s12, s40, 110592
    s_addc_u32 s13, s41, 0
    global_store_dwordx2 v2, v[64:65], s[12:13] offset:0 sc1
    ds_read_b64_tr_b16 v[70:71], v27 offset:1024
    s_waitcnt lgkmcnt(3)
    v_mfma_f32_16x16x16_bf16 v[28:31], v[72:73], v[76:77], v[28:31]
    ds_read_b64_tr_b16 v[76:77], v27 offset:0
    v_mfma_f32_16x16x32_bf16 v[32:35], v[12:15], v[212:215], v[32:35]
    v_mfma_f32_16x16x32_bf16 v[36:39], v[12:15], v[228:231], v[36:39]
    v_mfma_f32_16x16x32_bf16 v[32:35], v[16:19], v[216:219], v[32:35]
    v_mfma_f32_16x16x32_bf16 v[36:39], v[16:19], v[232:235], v[36:39]
    s_nop 2
    v_cvt_pk_bf16_f32 v54, v48, v28
    v_cvt_pk_bf16_f32 v58, v49, v29
    v_mfma_f32_16x16x32_bf16 v[32:35], v[20:23], v[220:223], v[32:35]
    v_cvt_pk_bf16_f32 v62, v50, v30
    v_cvt_pk_bf16_f32 v66, v51, v31
    v_mfma_f32_16x16x32_bf16 v[36:39], v[20:23], v[236:239], v[36:39]
    v_bfi_b32 v54, 1, v24, v54
    v_bfi_b32 v58, 1, v24, v58
    ds_read_b128 v[8:11], v1 offset:4096
    ds_read_b128 v[12:15], v1 offset:5120
    ds_read_b128 v[16:19], v1 offset:6144
    ds_read_b128 v[20:23], v1 offset:7168
    s_waitcnt lgkmcnt(3)
    v_mfma_f32_16x16x32_bf16 v[40:43], v[240:243], v[8:11], 0
    v_bfi_b32 v62, 1, v24, v62
    v_bfi_b32 v66, 1, v24, v66
    v_mfma_f32_16x16x32_bf16 v[44:47], v[8:11], v[112:115], 0
    v_mfma_f32_16x16x32_bf16 v[48:51], v[8:11], v[128:131], 0
    v_mfma_f32_16x16x16_bf16 v[32:35], v[72:73], v[78:79], v[32:35]
    ds_read_b64_tr_b16 v[78:79], v27 offset:128
    v_mfma_f32_16x16x16_bf16 v[36:39], v[72:73], v[68:69], v[36:39]
    ds_read_b64_tr_b16 v[68:69], v27 offset:256
    s_waitcnt lgkmcnt(4)
    v_mfma_f32_16x16x32_bf16 v[40:43], v[244:247], v[12:15], v[40:43]
    v_mfma_f32_16x16x32_bf16 v[44:47], v[12:15], v[116:119], v[44:47]
    v_mfma_f32_16x16x32_bf16 v[48:51], v[12:15], v[132:135], v[48:51]
    s_waitcnt lgkmcnt(3)
    v_mfma_f32_16x16x32_bf16 v[40:43], v[248:251], v[16:19], v[40:43]
    s_nop 0
    v_cvt_pk_bf16_f32 v55, v32, v36
    v_cvt_pk_bf16_f32 v59, v33, v37
    v_mfma_f32_16x16x32_bf16 v[44:47], v[16:19], v[120:123], v[44:47]
    v_cvt_pk_bf16_f32 v63, v34, v38
    v_cvt_pk_bf16_f32 v67, v35, v39
    v_mfma_f32_16x16x32_bf16 v[48:51], v[16:19], v[136:139], v[48:51]
    s_add_u32 s12, s40, 0
    s_addc_u32 s13, s41, 0
    global_store_dwordx2 v2, v[54:55], s[12:13] offset:128 sc1
    s_waitcnt lgkmcnt(2)
    v_mfma_f32_16x16x32_bf16 v[40:43], v[252:255], v[20:23], v[40:43]
    s_add_u32 s12, s40, 36864
    s_addc_u32 s13, s41, 0
    global_store_dwordx2 v2, v[58:59], s[12:13] offset:128 sc1
    v_mfma_f32_16x16x32_bf16 v[44:47], v[20:23], v[124:127], v[44:47]
    s_add_u32 s12, s40, 73728
    s_addc_u32 s13, s41, 0
    global_store_dwordx2 v2, v[62:63], s[12:13] offset:128 sc1
    v_mfma_f32_16x16x32_bf16 v[48:51], v[20:23], v[140:143], v[48:51]
    s_add_u32 s12, s40, 110592
    s_addc_u32 s13, s41, 0
    global_store_dwordx2 v2, v[66:67], s[12:13] offset:128 sc1
    v_mfma_f32_16x16x32_bf16 v[28:31], v[8:11], v[144:147], 0
    v_mfma_f32_16x16x32_bf16 v[32:35], v[8:11], v[160:163], 0
    v_mfma_f32_16x16x16_bf16 v[40:43], v[70:71], v[74:75], v[40:43]
    ds_read_b64_tr_b16 v[70:71], v27 offset:384
    v_mfma_f32_16x16x16_bf16 v[44:47], v[74:75], v[76:77], v[44:47]
    ds_read_b64_tr_b16 v[76:77], v27 offset:512
    s_waitcnt lgkmcnt(3)
    v_mfma_f32_16x16x16_bf16 v[48:51], v[74:75], v[78:79], v[48:51]
    ds_read_b64_tr_b16 v[78:79], v27 offset:640
    v_mfma_f32_16x16x32_bf16 v[28:31], v[12:15], v[148:151], v[28:31]
    v_mfma_f32_16x16x32_bf16 v[32:35], v[12:15], v[164:167], v[32:35]
    v_mfma_f32_16x16x32_bf16 v[28:31], v[16:19], v[152:155], v[28:31]
    v_mfma_f32_16x16x32_bf16 v[32:35], v[16:19], v[168:171], v[32:35]
    v_cvt_pk_bf16_f32 v40, v40, v41
    v_cvt_pk_bf16_f32 v41, v42, v43
    v_mfma_f32_16x16x32_bf16 v[28:31], v[20:23], v[156:159], v[28:31]
    v_bfi_b32 v40, 1, v24, v40
    s_add_u32 s12, s40, 589824
    s_addc_u32 s13, s41, 0
    global_store_dwordx2 v3, v[40:41], s[12:13] sc1
    v_mfma_f32_16x16x32_bf16 v[32:35], v[20:23], v[172:175], v[32:35]
    v_cvt_pk_bf16_f32 v52, v44, v48
    v_cvt_pk_bf16_f32 v56, v45, v49
    v_mfma_f32_16x16x32_bf16 v[36:39], v[8:11], v[176:179], 0
    v_cvt_pk_bf16_f32 v60, v46, v50
    v_cvt_pk_bf16_f32 v64, v47, v51
    v_mfma_f32_16x16x32_bf16 v[40:43], v[8:11], v[192:195], 0
    v_bfi_b32 v52, 1, v24, v52
    v_bfi_b32 v56, 1, v24, v56
    s_waitcnt lgkmcnt(3)
    v_mfma_f32_16x16x16_bf16 v[28:31], v[74:75], v[68:69], v[28:31]
    v_bfi_b32 v60, 1, v24, v60
    v_bfi_b32 v64, 1, v24, v64
    ds_read_b64_tr_b16 v[68:69], v27 offset:768
    s_waitcnt lgkmcnt(3)
    v_mfma_f32_16x16x16_bf16 v[32:35], v[74:75], v[70:71], v[32:35]
    ds_read_b64_tr_b16 v[70:71], v27 offset:896
    v_mfma_f32_16x16x32_bf16 v[36:39], v[12:15], v[180:183], v[36:39]
    v_mfma_f32_16x16x32_bf16 v[40:43], v[12:15], v[196:199], v[40:43]
    v_mfma_f32_16x16x32_bf16 v[36:39], v[16:19], v[184:187], v[36:39]
    v_mfma_f32_16x16x32_bf16 v[40:43], v[16:19], v[200:203], v[40:43]
    s_nop 2
    v_cvt_pk_bf16_f32 v53, v28, v32
    v_cvt_pk_bf16_f32 v57, v29, v33
    v_mfma_f32_16x16x32_bf16 v[36:39], v[20:23], v[188:191], v[36:39]
    v_cvt_pk_bf16_f32 v61, v30, v34
    v_cvt_pk_bf16_f32 v65, v31, v35
    v_mfma_f32_16x16x32_bf16 v[40:43], v[20:23], v[204:207], v[40:43]
    s_add_u32 s12, s40, 589824
    s_addc_u32 s13, s41, 0
    global_store_dwordx2 v2, v[52:53], s[12:13] offset:0 sc1
    v_mfma_f32_16x16x32_bf16 v[44:47], v[8:11], v[208:211], 0
    s_add_u32 s12, s40, 626688
    s_addc_u32 s13, s41, 0
    global_store_dwordx2 v2, v[56:57], s[12:13] offset:0 sc1
    v_mfma_f32_16x16x32_bf16 v[48:51], v[8:11], v[224:227], 0
    s_add_u32 s12, s40, 663552
    s_addc_u32 s13, s41, 0
    global_store_dwordx2 v2, v[60:61], s[12:13] offset:0 sc1
    s_waitcnt lgkmcnt(3)
    v_mfma_f32_16x16x16_bf16 v[36:39], v[74:75], v[76:77], v[36:39]
    s_add_u32 s12, s40, 700416
    s_addc_u32 s13, s41, 0
    global_store_dwordx2 v2, v[64:65], s[12:13] offset:0 sc1
    s_waitcnt lgkmcnt(2)
    v_mfma_f32_16x16x16_bf16 v[40:43], v[74:75], v[78:79], v[40:43]
    v_mfma_f32_16x16x32_bf16 v[44:47], v[12:15], v[212:215], v[44:47]
    v_mfma_f32_16x16x32_bf16 v[48:51], v[12:15], v[228:231], v[48:51]
    v_mfma_f32_16x16x32_bf16 v[44:47], v[16:19], v[216:219], v[44:47]
    v_mfma_f32_16x16x32_bf16 v[48:51], v[16:19], v[232:235], v[48:51]
    s_nop 3
    v_cvt_pk_bf16_f32 v54, v36, v40
    v_cvt_pk_bf16_f32 v58, v37, v41
    v_mfma_f32_16x16x32_bf16 v[44:47], v[20:23], v[220:223], v[44:47]
    v_cvt_pk_bf16_f32 v62, v38, v42
    v_cvt_pk_bf16_f32 v66, v39, v43
    v_mfma_f32_16x16x32_bf16 v[48:51], v[20:23], v[236:239], v[48:51]
    v_bfi_b32 v54, 1, v24, v54
    v_bfi_b32 v58, 1, v24, v58
    s_waitcnt lgkmcnt(1)
    v_mfma_f32_16x16x16_bf16 v[44:47], v[74:75], v[68:69], v[44:47]
    s_waitcnt lgkmcnt(0)
    s_nop 0
    v_mfma_f32_16x16x16_bf16 v[48:51], v[74:75], v[70:71], v[48:51]
    v_bfi_b32 v62, 1, v24, v62
    v_bfi_b32 v66, 1, v24, v66
    s_nop 5
    v_cvt_pk_bf16_f32 v55, v44, v48
    v_cvt_pk_bf16_f32 v59, v45, v49
    v_cvt_pk_bf16_f32 v63, v46, v50
    v_cvt_pk_bf16_f32 v67, v47, v51
    s_add_u32 s12, s40, 589824
    s_addc_u32 s13, s41, 0
    global_store_dwordx2 v2, v[54:55], s[12:13] offset:128 sc1
    s_add_u32 s12, s40, 626688
    s_addc_u32 s13, s41, 0
    global_store_dwordx2 v2, v[58:59], s[12:13] offset:128 sc1
    s_add_u32 s12, s40, 663552
    s_addc_u32 s13, s41, 0
    global_store_dwordx2 v2, v[62:63], s[12:13] offset:128 sc1
    s_add_u32 s12, s40, 700416
    s_addc_u32 s13, s41, 0
    global_store_dwordx2 v2, v[66:67], s[12:13] offset:128 sc1
    v_bfe_u32 v10, v7, 2, 1
    v_lshlrev_b32 v10, 4, v10
    v_mov_b32 v11, 0x3f80
    v_lshlrev_b32 v11, v10, v11
    v_bfe_u32 v10, v7, 3, 2
    v_cmp_eq_u32 vcc, 0, v10
    s_nop 1
    v_cndmask_b32 v12, 0, v11, vcc
    v_cmp_eq_u32 vcc, 1, v10
    s_nop 1
    v_cndmask_b32 v13, 0, v11, vcc
    v_cmp_eq_u32 vcc, 2, v10
    s_nop 1
    v_cndmask_b32 v14, 0, v11, vcc
    v_cmp_eq_u32 vcc, 3, v10
    s_nop 1
    v_cndmask_b32 v15, 0, v11, vcc
    v_mov_b32 v26, 0x1b800
    v_bfe_u32 v10, v0, 4, 3
    v_lshl_add_u32 v26, v10, 5, v26
    v_bfe_u32 v10, v0, 8, 1
    v_lshl_add_u32 v26, v10, 4, v26
    v_bfe_u32 v10, v0, 10, 2
    v_lshl_add_u32 v26, v10, 8, v26
    s_and_b32 s12, s47, 1
    s_sub_u32 s12, 0, s12
    v_bfe_i32 v10, v7, 6, 1
    v_bfe_i32 v11, v7, 5, 1
    v_xor_b32 v10, s12, v10
    v_xor_b32 v11, s12, v11
    s_waitcnt vmcnt(0)
    s_cmp_lg_u32 s47, 1
    s_cbranch_scc1 L_nf_40
    s_barrier
    s_cmp_lg_u32 s10, 0
    s_cbranch_scc1 L_pf_41
    s_lshl_b32 s12, s9, 2
    v_mov_b32 v8, s12
    v_mov_b32 v9, s47
    s_mov_b64 exec, 1
    global_store_dword v8, v9, s[44:45] offset:0 sc1
    s_mov_b64 exec, -1
L_pf_41:
    v_and_b32 v8, 0x7c, v7
    s_mov_b32 s12, 0
L_fw_42:
    global_load_dword v9, v8, s[44:45] sc1
    s_add_u32 s12, s12, 1
    s_cmp_gt_u32 s12, 100000
    s_cbranch_scc1 L_exit
    s_waitcnt vmcnt(0)
    v_cmp_gt_u32 vcc, s47, v9
    s_cbranch_vccz L_fwd_43
    s_sleep 8
    s_branch L_fw_42
L_fwd_43:
L_nf_40:
    s_mov_b32 s14, 0
L_xr_44:
    s_mov_b64 s[12:13], s[42:43]
    global_load_dwordx4 v[60:63], v6, s[12:13] sc1
    global_load_dwordx4 v[28:31], v4, s[12:13] sc1
    s_add_u32 s12, s12, 4608
    s_addc_u32 s13, s13, 0
    global_load_dwordx4 v[32:35], v4, s[12:13] sc1
    s_add_u32 s12, s12, 4608
    s_addc_u32 s13, s13, 0
    global_load_dwordx4 v[36:39], v4, s[12:13] sc1
    s_add_u32 s12, s12, 4608
    s_addc_u32 s13, s13, 0
    global_load_dwordx4 v[40:43], v4, s[12:13] sc1
    s_add_u32 s12, s12, 4608
    s_addc_u32 s13, s13, 0
    global_load_dwordx4 v[44:47], v4, s[12:13] sc1
    s_add_u32 s12, s12, 4608
    s_addc_u32 s13, s13, 0
    global_load_dwordx4 v[48:51], v4, s[12:13] sc1
    s_add_u32 s12, s12, 4608
    s_addc_u32 s13, s13, 0
    global_load_dwordx4 v[52:55], v4, s[12:13] sc1
    s_add_u32 s12, s12, 4608
    s_addc_u32 s13, s13, 0
    global_load_dwordx4 v[56:59], v4, s[12:13] sc1
    s_mov_b64 exec, -1
    s_add_u32 s14, s14, 1
    s_cmp_gt_u32 s14, 100000
    s_cbranch_scc1 L_exit
    s_waitcnt vmcnt(8)
    v_mfma_f32_16x16x32_bf16 v[20:23], v[12:15], v[60:63], 0
    v_bitop3_b32 v8, v60, v62, v11 bitop3:0x7e
    v_and_b32 v8, 1, v8
    s_waitcnt vmcnt(7)
    v_mfma_f32_16x16x32_bf16 v[16:19], v[12:15], v[28:31], 0
    v_bitop3_b32 v9, v28, v30, v10 bitop3:0x7e
    v_and_or_b32 v8, v9, 1, v8
    s_waitcnt vmcnt(6)
    v_mfma_f32_16x16x32_bf16 v[16:19], v[12:15], v[32:35], v[16:19]
    v_bitop3_b32 v9, v32, v34, v10 bitop3:0x7e
    v_and_or_b32 v8, v9, 1, v8
    s_waitcnt vmcnt(5)
    v_mfma_f32_16x16x32_bf16 v[16:19], v[12:15], v[36:39], v[16:19]
    v_bitop3_b32 v9, v36, v38, v10 bitop3:0x7e
    v_and_or_b32 v8, v9, 1, v8
    s_waitcnt vmcnt(4)
    v_mfma_f32_16x16x32_bf16 v[16:19], v[12:15], v[40:43], v[16:19]
    v_bitop3_b32 v9, v40, v42, v10 bitop3:0x7e
    v_and_or_b32 v8, v9, 1, v8
    s_waitcnt vmcnt(3)
    v_mfma_f32_16x16x32_bf16 v[16:19], v[12:15], v[44:47], v[16:19]
    v_bitop3_b32 v9, v44, v46, v10 bitop3:0x7e
    v_and_or_b32 v8, v9, 1, v8
    v_add_f32_dpp v20, v20, v20 row_ror:8 row_mask:0xf bank_mask:0xf
    v_add_f32_dpp v21, v21, v21 row_ror:8 row_mask:0xf bank_mask:0xf
    v_add_f32_dpp v22, v22, v22 row_ror:8 row_mask:0xf bank_mask:0xf
    v_add_f32_dpp v23, v23, v23 row_ror:8 row_mask:0xf bank_mask:0xf
    ds_write_b128 v26, v[20:23]
    s_waitcnt vmcnt(2)
    v_mfma_f32_16x16x32_bf16 v[16:19], v[12:15], v[48:51], v[16:19]
    v_bitop3_b32 v9, v48, v50, v10 bitop3:0x7e
    v_and_or_b32 v8, v9, 1, v8
    s_waitcnt vmcnt(1)
    v_mfma_f32_16x16x32_bf16 v[16:19], v[12:15], v[52:55], v[16:19]
    v_bitop3_b32 v9, v52, v54, v10 bitop3:0x7e
    v_and_or_b32 v8, v9, 1, v8
    s_waitcnt vmcnt(0)
    v_mfma_f32_16x16x32_bf16 v[16:19], v[12:15], v[56:59], v[16:19]
    v_bitop3_b32 v9, v56, v58, v10 bitop3:0x7e
    v_and_or_b32 v8, v9, 1, v8
    v_cmp_ne_u32 vcc, 0, v8
    s_mov_b64 exec, vcc
    s_cbranch_vccnz L_xr_44
    s_mov_b64 exec, -1
    s_nop 1
    ds_write_b32 v5, v16 offset:0
    ds_write_b32 v5, v17 offset:256
    ds_write_b32 v5, v18 offset:512
    ds_write_b32 v5, v19 offset:768
    s_waitcnt lgkmcnt(0)
    s_barrier
    s_cmp_lg_u32 s10, 1
    s_cbranch_scc1 L_pf_45
    s_lshl_b32 s12, s9, 2
    v_mov_b32 v8, s12
    v_mov_b32 v9, s47
    s_mov_b64 exec, 1
    global_store_dword v8, v9, s[44:45] offset:1024 sc1
    s_mov_b64 exec, -1
L_pf_45:
    v_subrev_u32 v1, 98304, v1
    s_cmp_lg_u32 s10, 0
    s_cbranch_scc1 L_f_next_s
    v_add_u32 v49, 114688, v7
    ds_read_b32 v56, v49 offset:0
    ds_read_b32 v50, v49 offset:2048
    ds_read_b32 v57, v49 offset:256
    ds_read_b32 v51, v49 offset:2304
    ds_read_b32 v58, v49 offset:512
    ds_read_b32 v52, v49 offset:2560
    ds_read_b32 v59, v49 offset:768
    ds_read_b32 v53, v49 offset:2816
    ds_read_b32 v60, v49 offset:1024
    ds_read_b32 v54, v49 offset:3072
    v_add_u32 v7, 55296, v7
    v_lshlrev_b32 v48, 1, v7
    ds_read_b64 v[16:17], v48 offset:2048
    ds_read_b64 v[18:19], v48 offset:2304
    ds_read_b64 v[20:21], v48 offset:2560
    ds_read_b64 v[22:23], v48 offset:2816
    ds_read_b64 v[8:9], v48 offset:0
    ds_read_b64 v[10:11], v48 offset:512
    ds_read_b64 v[12:13], v48 offset:1024
    ds_read_b64 v[14:15], v48 offset:1536
    s_waitcnt lgkmcnt(4)
    v_pk_add_f32 v[16:17], v[16:17], v[18:19]
    v_pk_add_f32 v[20:21], v[20:21], v[22:23]
    v_pk_add_f32 v[16:17], v[16:17], v[20:21]
    s_waitcnt lgkmcnt(0)
    v_cvt_pk_bf16_f32 v9, v8, v9
    v_lshlrev_b32 v8, 16, v9
    v_and_b32 v9, 0xffff0000, v9
    v_cvt_pk_bf16_f32 v11, v10, v11
    v_lshlrev_b32 v10, 16, v11
    v_and_b32 v11, 0xffff0000, v11
    v_cvt_pk_bf16_f32 v13, v12, v13
    v_lshlrev_b32 v12, 16, v13
    v_and_b32 v13, 0xffff0000, v13
    v_cvt_pk_bf16_f32 v15, v14, v15
    v_lshlrev_b32 v14, 16, v15
    v_and_b32 v15, 0xffff0000, v15
    v_cvt_pk_bf16_f32 v17, v16, v17
    v_lshlrev_b32 v16, 16, v17
    v_and_b32 v17, 0xffff0000, v17
    v_subrev_u32 v7, 55296, v7
    v_lshlrev_b32 v18, 16, v50
    v_and_b32 v19, 0xffff0000, v50
    v_pk_mul_f32 v[8:9], v[8:9], v[18:19]
    v_cvt_pk_bf16_f32 v9, v8, v9
    v_lshlrev_b32 v8, 16, v9
    v_and_b32 v9, 0xffff0000, v9
    v_lshlrev_b32 v18, 16, v56
    v_and_b32 v19, 0xffff0000, v56
    v_pk_add_f32 v[8:9], v[8:9], v[18:19]
    v_cvt_pk_bf16_f32 v24, v8, v9
    global_store_dword v7, v24, s[34:35] offset:0
    v_lshlrev_b32 v18, 16, v51
    v_and_b32 v19, 0xffff0000, v51
    v_pk_mul_f32 v[10:11], v[10:11], v[18:19]
    v_cvt_pk_bf16_f32 v11, v10, v11
    v_lshlrev_b32 v10, 16, v11
    v_and_b32 v11, 0xffff0000, v11
    v_lshlrev_b32 v18, 16, v57
    v_and_b32 v19, 0xffff0000, v57
    v_pk_add_f32 v[10:11], v[10:11], v[18:19]
    v_cvt_pk_bf16_f32 v25, v10, v11
    global_store_dword v7, v25, s[34:35] offset:256
    v_lshlrev_b32 v18, 16, v52
    v_and_b32 v19, 0xffff0000, v52
    v_pk_mul_f32 v[12:13], v[12:13], v[18:19]
    v_cvt_pk_bf16_f32 v13, v12, v13
    v_lshlrev_b32 v12, 16, v13
    v_and_b32 v13, 0xffff0000, v13
    v_lshlrev_b32 v18, 16, v58
    v_and_b32 v19, 0xffff0000, v58
    v_pk_add_f32 v[12:13], v[12:13], v[18:19]
    v_cvt_pk_bf16_f32 v26, v12, v13
    global_store_dword v7, v26, s[34:35] offset:512
    v_lshlrev_b32 v18, 16, v53
    v_and_b32 v19, 0xffff0000, v53
    v_pk_mul_f32 v[14:15], v[14:15], v[18:19]
    v_cvt_pk_bf16_f32 v15, v14, v15
    v_lshlrev_b32 v14, 16, v15
    v_and_b32 v15, 0xffff0000, v15
    v_lshlrev_b32 v18, 16, v59
    v_and_b32 v19, 0xffff0000, v59
    v_pk_add_f32 v[14:15], v[14:15], v[18:19]
    v_cvt_pk_bf16_f32 v27, v14, v15
    global_store_dword v7, v27, s[34:35] offset:768
    s_mov_b32 exec_hi, 0
    v_lshlrev_b32 v18, 16, v54
    v_and_b32 v19, 0xffff0000, v54
    v_pk_mul_f32 v[16:17], v[16:17], v[18:19]
    v_cvt_pk_bf16_f32 v17, v16, v17
    v_lshlrev_b32 v16, 16, v17
    v_and_b32 v17, 0xffff0000, v17
    v_lshlrev_b32 v18, 16, v60
    v_and_b32 v19, 0xffff0000, v60
    v_pk_add_f32 v[16:17], v[16:17], v[18:19]
    v_cvt_pk_bf16_f32 v28, v16, v17
    global_store_dword v7, v28, s[34:35] offset:1024
    s_mov_b64 exec, -1
L_f_next_s:
    s_add_u32 s20, s20, 110592
    s_addc_u32 s21, s21, 0
    s_add_u32 s34, s34, 110592
    s_addc_u32 s35, s35, 0
    s_add_u32 s36, s36, 110592
    s_addc_u32 s37, s37, 0
    s_add_u32 s52, s52, 384
    s_addc_u32 s53, s53, 0
    s_add_u32 s24, s24, 3
    s_cmp_lt_u32 s24, 64
    s_cbranch_scc1 L_f_top_s
    s_branch L_exit
L_exit:
    s_endpgm
L_role_r:
    s_load_dwordx4 s[16:19], s[0:1], 16
    s_load_dwordx4 s[20:23], s[0:1], 32
    s_load_dwordx2 s[24:25], s[0:1], 8
    v_mov_b32 v12, 0x0
    v_bfe_u32 v1, v0, 0, 4
    v_lshlrev_b32 v1, 4, v1
    v_xor_b32 v12, v12, v1
    v_bfe_i32 v1, v0, 4, 1
    v_and_b32 v1, 0x8020, v1
    v_xor_b32 v12, v12, v1
    v_bfe_u32 v1, v0, 5, 1
    v_lshlrev_b32 v1, 16, v1
    v_xor_b32 v12, v12, v1
    v_bfe_u32 v1, v0, 6, 1
    v_lshlrev_b32 v1, 13, v1
    v_xor_b32 v12, v12, v1
    v_bfe_i32 v1, v0, 7, 1
    v_and_b32 v1, 0x4080, v1
    v_xor_b32 v12, v12, v1
    v_mov_b32 v16, 0x400000
    v_bfe_u32 v1, v0, 0, 4
    v_lshlrev_b32 v1, 4, v1
    v_xor_b32 v16, v16, v1
    v_bfe_i32 v1, v0, 4, 1
    v_and_b32 v1, 0x10020, v1
    v_xor_b32 v16, v16, v1
    v_bfe_u32 v1, v0, 5, 1
    v_lshlrev_b32 v1, 17, v1
    v_xor_b32 v16, v16, v1
    v_bfe_u32 v1, v0, 6, 1
    v_lshlrev_b32 v1, 14, v1
    v_xor_b32 v16, v16, v1
    v_bfe_i32 v1, v0, 7, 1
    v_and_b32 v1, 0x8080, v1
    v_xor_b32 v16, v16, v1
    v_mov_b32 v20, 0x0
    v_bfe_u32 v1, v0, 3, 3
    v_mul_u32_u24 v1, 0x480, v1
    v_add_u32 v20, v20, v1
    v_bfe_u32 v1, v0, 6, 2
    v_mul_u32_u24 v1, 0x9000, v1
    v_add_u32 v20, v20, v1
    v_mov_b32 v2, 0x0
    v_bfe_u32 v1, v0, 0, 3
    v_lshlrev_b32 v1, 4, v1
    v_xor_b32 v2, v2, v1
    v_bfe_u32 v1, v0, 5, 1
    v_lshlrev_b32 v1, 5, v1
    v_xor_b32 v2, v2, v1
    v_add_u32 v20, v20, v2
    v_mov_b32 v13, 0x20000
    v_bfe_u32 v1, v0, 0, 4
    v_lshlrev_b32 v1, 4, v1
    v_xor_b32 v13, v13, v1
    v_bfe_i32 v1, v0, 4, 1
    v_and_b32 v1, 0x8020, v1
    v_xor_b32 v13, v13, v1
    v_bfe_u32 v1, v0, 5, 1
    v_lshlrev_b32 v1, 16, v1
    v_xor_b32 v13, v13, v1
    v_bfe_u32 v1, v0, 6, 1
    v_lshlrev_b32 v1, 13, v1
    v_xor_b32 v13, v13, v1
    v_bfe_i32 v1, v0, 7, 1
    v_and_b32 v1, 0x4080, v1
    v_xor_b32 v13, v13, v1
    v_mov_b32 v17, 0x440000
    v_bfe_u32 v1, v0, 0, 4
    v_lshlrev_b32 v1, 4, v1
    v_xor_b32 v17, v17, v1
    v_bfe_i32 v1, v0, 4, 1
    v_and_b32 v1, 0x10020, v1
    v_xor_b32 v17, v17, v1
    v_bfe_u32 v1, v0, 5, 1
    v_lshlrev_b32 v1, 17, v1
    v_xor_b32 v17, v17, v1
    v_bfe_u32 v1, v0, 6, 1
    v_lshlrev_b32 v1, 14, v1
    v_xor_b32 v17, v17, v1
    v_bfe_i32 v1, v0, 7, 1
    v_and_b32 v1, 0x8080, v1
    v_xor_b32 v17, v17, v1
    v_mov_b32 v21, 0x2400
    v_bfe_u32 v1, v0, 3, 3
    v_mul_u32_u24 v1, 0x480, v1
    v_add_u32 v21, v21, v1
    v_bfe_u32 v1, v0, 6, 2
    v_mul_u32_u24 v1, 0x9000, v1
    v_add_u32 v21, v21, v1
    v_mov_b32 v2, 0x0
    v_bfe_u32 v1, v0, 0, 3
    v_lshlrev_b32 v1, 4, v1
    v_xor_b32 v2, v2, v1
    v_bfe_u32 v1, v0, 5, 1
    v_lshlrev_b32 v1, 5, v1
    v_xor_b32 v2, v2, v1
    v_add_u32 v21, v21, v2
    v_mov_b32 v14, 0x80040
    v_bfe_u32 v1, v0, 0, 4
    v_lshlrev_b32 v1, 4, v1
    v_xor_b32 v14, v14, v1
    v_bfe_i32 v1, v0, 4, 1
    v_and_b32 v1, 0x8020, v1
    v_xor_b32 v14, v14, v1
    v_bfe_u32 v1, v0, 5, 1
    v_lshlrev_b32 v1, 16, v1
    v_xor_b32 v14, v14, v1
    v_bfe_u32 v1, v0, 6, 1
    v_lshlrev_b32 v1, 13, v1
    v_xor_b32 v14, v14, v1
    v_bfe_i32 v1, v0, 7, 1
    v_and_b32 v1, 0x4080, v1
    v_xor_b32 v14, v14, v1
    v_mov_b32 v18, 0x402040
    v_bfe_u32 v1, v0, 0, 4
    v_lshlrev_b32 v1, 4, v1
    v_xor_b32 v18, v18, v1
    v_bfe_i32 v1, v0, 4, 1
    v_and_b32 v1, 0x10020, v1
    v_xor_b32 v18, v18, v1
    v_bfe_u32 v1, v0, 5, 1
    v_lshlrev_b32 v1, 17, v1
    v_xor_b32 v18, v18, v1
    v_bfe_u32 v1, v0, 6, 1
    v_lshlrev_b32 v1, 14, v1
    v_xor_b32 v18, v18, v1
    v_bfe_i32 v1, v0, 7, 1
    v_and_b32 v1, 0x8080, v1
    v_xor_b32 v18, v18, v1
    v_mov_b32 v22, 0x4800
    v_bfe_u32 v1, v0, 3, 3
    v_mul_u32_u24 v1, 0x480, v1
    v_add_u32 v22, v22, v1
    v_bfe_u32 v1, v0, 6, 2
    v_mul_u32_u24 v1, 0x9000, v1
    v_add_u32 v22, v22, v1
    v_mov_b32 v2, 0x40
    v_bfe_u32 v1, v0, 0, 3
    v_lshlrev_b32 v1, 4, v1
    v_xor_b32 v2, v2, v1
    v_bfe_u32 v1, v0, 5, 1
    v_lshlrev_b32 v1, 5, v1
    v_xor_b32 v2, v2, v1
    v_add_u32 v22, v22, v2
    v_mov_b32 v15, 0xa0040
    v_bfe_u32 v1, v0, 0, 4
    v_lshlrev_b32 v1, 4, v1
    v_xor_b32 v15, v15, v1
    v_bfe_i32 v1, v0, 4, 1
    v_and_b32 v1, 0x8020, v1
    v_xor_b32 v15, v15, v1
    v_bfe_u32 v1, v0, 5, 1
    v_lshlrev_b32 v1, 16, v1
    v_xor_b32 v15, v15, v1
    v_bfe_u32 v1, v0, 6, 1
    v_lshlrev_b32 v1, 13, v1
    v_xor_b32 v15, v15, v1
    v_bfe_i32 v1, v0, 7, 1
    v_and_b32 v1, 0x4080, v1
    v_xor_b32 v15, v15, v1
    v_mov_b32 v19, 0x442040
    v_bfe_u32 v1, v0, 0, 4
    v_lshlrev_b32 v1, 4, v1
    v_xor_b32 v19, v19, v1
    v_bfe_i32 v1, v0, 4, 1
    v_and_b32 v1, 0x10020, v1
    v_xor_b32 v19, v19, v1
    v_bfe_u32 v1, v0, 5, 1
    v_lshlrev_b32 v1, 17, v1
    v_xor_b32 v19, v19, v1
    v_bfe_u32 v1, v0, 6, 1
    v_lshlrev_b32 v1, 14, v1
    v_xor_b32 v19, v19, v1
    v_bfe_i32 v1, v0, 7, 1
    v_and_b32 v1, 0x8080, v1
    v_xor_b32 v19, v19, v1
    v_mov_b32 v23, 0x6c00
    v_bfe_u32 v1, v0, 3, 3
    v_mul_u32_u24 v1, 0x480, v1
    v_add_u32 v23, v23, v1
    v_bfe_u32 v1, v0, 6, 2
    v_mul_u32_u24 v1, 0x9000, v1
    v_add_u32 v23, v23, v1
    v_mov_b32 v2, 0x40
    v_bfe_u32 v1, v0, 0, 3
    v_lshlrev_b32 v1, 4, v1
    v_xor_b32 v2, v2, v1
    v_bfe_u32 v1, v0, 5, 1
    v_lshlrev_b32 v1, 5, v1
    v_xor_b32 v2, v2, v1
    v_add_u32 v23, v23, v2
    v_mov_b32 v24, 0x8000
    v_bfe_u32 v1, v0, 0, 2
    v_lshlrev_b32 v1, 3, v1
    v_xor_b32 v24, v24, v1
    v_bfe_i32 v1, v0, 2, 1
    v_and_b32 v1, 0x840, v1
    v_xor_b32 v24, v24, v1
    v_bfe_i32 v1, v0, 3, 1
    v_and_b32 v1, 0x120, v1
    v_xor_b32 v24, v24, v1
    v_bfe_i32 v1, v0, 4, 1
    v_and_b32 v1, 0x2080, v1
    v_xor_b32 v24, v24, v1
    v_bfe_u32 v1, v0, 5, 1
    v_lshlrev_b32 v1, 9, v1
    v_xor_b32 v24, v24, v1
    v_bfe_u32 v1, v0, 6, 2
    v_lshlrev_b32 v1, 6, v1
    v_xor_b32 v24, v24, v1
    v_mov_b32 v25, 0x8020
    v_bfe_u32 v1, v0, 0, 2
    v_lshlrev_b32 v1, 3, v1
    v_xor_b32 v25, v25, v1
    v_bfe_i32 v1, v0, 2, 1
    v_and_b32 v1, 0x840, v1
    v_xor_b32 v25, v25, v1
    v_bfe_i32 v1, v0, 3, 1
    v_and_b32 v1, 0x120, v1
    v_xor_b32 v25, v25, v1
    v_bfe_i32 v1, v0, 4, 1
    v_and_b32 v1, 0x2080, v1
    v_xor_b32 v25, v25, v1
    v_bfe_u32 v1, v0, 5, 1
    v_lshlrev_b32 v1, 9, v1
    v_xor_b32 v25, v25, v1
    v_bfe_u32 v1, v0, 6, 2
    v_lshlrev_b32 v1, 6, v1
    v_xor_b32 v25, v25, v1
    v_mov_b32 v26, 0x8000
    v_bfe_u32 v1, v0, 0, 2
    v_lshlrev_b32 v1, 3, v1
    v_xor_b32 v26, v26, v1
    v_bfe_u32 v1, v0, 2, 1
    v_lshlrev_b32 v1, 7, v1
    v_xor_b32 v26, v26, v1
    v_bfe_i32 v1, v0, 3, 1
    v_and_b32 v1, 0x220, v1
    v_xor_b32 v26, v26, v1
    v_bfe_i32 v1, v0, 4, 1
    v_and_b32 v1, 0x840, v1
    v_xor_b32 v26, v26, v1
    v_bfe_u32 v1, v0, 5, 1
    v_lshlrev_b32 v1, 10, v1
    v_xor_b32 v26, v26, v1
    v_bfe_u32 v1, v0, 6, 2
    v_lshlrev_b32 v1, 5, v1
    v_xor_b32 v26, v26, v1
    v_mov_b32 v27, 0x8000
    v_bfe_u32 v1, v0, 0, 8
    v_lshl_add_u32 v27, v1, 4, v27
    s_waitcnt lgkmcnt(0)
    s_lshl_b32 s12, s9, 8
    s_add_u32 s16, s16, s12
    s_addc_u32 s17, s17, 0
    s_add_u32 s18, s18, s12
    s_addc_u32 s19, s19, 0
    s_add_u32 s20, s20, s12
    s_addc_u32 s21, s21, 0
    s_mul_i32 s12, s9, 147456
    s_add_u32 s22, s22, s12
    s_addc_u32 s23, s23, 0
    s_lshl_b32 s26, s10, 12
    s_add_u32 s26, s26, 32768
    s_add_u32 s12, s16, 0
    s_addc_u32 s13, s17, 0
    s_add_u32 m0, s26, 0
    s_nop 0
    global_load_lds_dwordx4 v12, s[12:13] nt
    s_add_u32 m0, s26, 1024
    s_nop 0
    global_load_lds_dwordx4 v13, s[12:13] nt
    s_add_u32 m0, s26, 2048
    s_nop 0
    global_load_lds_dwordx4 v14, s[12:13] nt
    s_add_u32 m0, s26, 3072
    s_nop 0
    global_load_lds_dwordx4 v15, s[12:13] nt
    s_add_u32 s12, s16, 262144
    s_addc_u32 s13, s17, 0
    s_add_u32 m0, s26, 16384
    s_nop 0
    global_load_lds_dwordx4 v12, s[12:13] nt
    s_add_u32 m0, s26, 17408
    s_nop 0
    global_load_lds_dwordx4 v13, s[12:13] nt
    s_add_u32 m0, s26, 18432
    s_nop 0
    global_load_lds_dwordx4 v14, s[12:13] nt
    s_add_u32 m0, s26, 19456
    s_nop 0
    global_load_lds_dwordx4 v15, s[12:13] nt
    s_add_u32 s12, s16, 1048576
    s_addc_u32 s13, s17, 0
    s_add_u32 m0, s26, 32768
    s_nop 0
    global_load_lds_dwordx4 v12, s[12:13] nt
    s_add_u32 m0, s26, 33792
    s_nop 0
    global_load_lds_dwordx4 v13, s[12:13] nt
    s_add_u32 m0, s26, 34816
    s_nop 0
    global_load_lds_dwordx4 v14, s[12:13] nt
    s_add_u32 m0, s26, 35840
    s_nop 0
    global_load_lds_dwordx4 v15, s[12:13] nt
    s_add_u32 s12, s16, 1310720
    s_addc_u32 s13, s17, 0
    s_add_u32 m0, s26, 49152
    s_nop 0
    global_load_lds_dwordx4 v12, s[12:13] nt
    s_add_u32 m0, s26, 50176
    s_nop 0
    global_load_lds_dwordx4 v13, s[12:13] nt
    s_add_u32 m0, s26, 51200
    s_nop 0
    global_load_lds_dwordx4 v14, s[12:13] nt
    s_add_u32 m0, s26, 52224
    s_nop 0
    global_load_lds_dwordx4 v15, s[12:13] nt
    s_add_u32 s12, s16, 2097152
    s_addc_u32 s13, s17, 0
    s_add_u32 m0, s26, 65536
    s_nop 0
    global_load_lds_dwordx4 v12, s[12:13] nt
    s_add_u32 m0, s26, 66560
    s_nop 0
    global_load_lds_dwordx4 v13, s[12:13] nt
    s_add_u32 m0, s26, 67584
    s_nop 0
    global_load_lds_dwordx4 v14, s[12:13] nt
    s_add_u32 m0, s26, 68608
    s_nop 0
    global_load_lds_dwordx4 v15, s[12:13] nt
    s_add_u32 s12, s16, 2359296
    s_addc_u32 s13, s17, 0
    s_add_u32 m0, s26, 81920
    s_nop 0
    global_load_lds_dwordx4 v12, s[12:13] nt
    s_add_u32 m0, s26, 82944
    s_nop 0
    global_load_lds_dwordx4 v13, s[12:13] nt
    s_add_u32 m0, s26, 83968
    s_nop 0
    global_load_lds_dwordx4 v14, s[12:13] nt
    s_add_u32 m0, s26, 84992
    s_nop 0
    global_load_lds_dwordx4 v15, s[12:13] nt
    s_add_u32 s12, s16, 3145728
    s_addc_u32 s13, s17, 0
    s_add_u32 m0, s26, 98304
    s_nop 0
    global_load_lds_dwordx4 v12, s[12:13] nt
    s_add_u32 m0, s26, 99328
    s_nop 0
    global_load_lds_dwordx4 v13, s[12:13] nt
    s_add_u32 m0, s26, 100352
    s_nop 0
    global_load_lds_dwordx4 v14, s[12:13] nt
    s_add_u32 m0, s26, 101376
    s_nop 0
    global_load_lds_dwordx4 v15, s[12:13] nt
    s_waitcnt vmcnt(24)
    s_barrier
    s_add_u32 s12, s16, 3407872
    s_addc_u32 s13, s17, 0
    s_add_u32 m0, s26, 114688
    s_nop 0
    global_load_lds_dwordx4 v12, s[12:13] nt
    s_add_u32 m0, s26, 115712
    s_nop 0
    global_load_lds_dwordx4 v13, s[12:13] nt
    s_add_u32 m0, s26, 116736
    s_nop 0
    global_load_lds_dwordx4 v14, s[12:13] nt
    s_add_u32 m0, s26, 117760
    s_nop 0
    global_load_lds_dwordx4 v15, s[12:13] nt
    v_mov_b32 v4, 0x0
    v_bfe_u32 v1, v0, 0, 8
    v_lshl_add_u32 v4, v1, 1, v4
    v_mov_b32 v8, 0x0
    v_bfe_u32 v1, v0, 0, 3
    v_lshl_add_u32 v8, v1, 2, v8
    v_bfe_u32 v1, v0, 3, 3
    v_lshl_add_u32 v8, v1, 8, v8
    v_bfe_u32 v1, v0, 6, 1
    v_lshl_add_u32 v8, v1, 1, v8
    v_bfe_u32 v1, v0, 7, 1
    v_lshl_add_u32 v8, v1, 11, v8
    v_add_u32 v2, 0, v4
    global_load_ushort v32, v2, s[24:25]
    v_add_u32 v2, 1152, v4
    global_load_ushort v33, v2, s[24:25]
    v_add_u32 v2, 2304, v4
    global_load_ushort v34, v2, s[24:25]
    v_add_u32 v2, 3456, v4
    global_load_ushort v35, v2, s[24:25]
    v_add_u32 v2, 4608, v4
    global_load_ushort v36, v2, s[24:25]
    v_add_u32 v2, 5760, v4
    global_load_ushort v37, v2, s[24:25]
    v_add_u32 v2, 6912, v4
    global_load_ushort v38, v2, s[24:25]
    v_add_u32 v2, 8064, v4
    global_load_ushort v39, v2, s[24:25]
    v_mov_b32 v5, 0x200
    v_bfe_u32 v1, v0, 0, 8
    v_lshl_add_u32 v5, v1, 1, v5
    v_mov_b32 v9, 0x1000
    v_bfe_u32 v1, v0, 0, 3
    v_lshl_add_u32 v9, v1, 2, v9
    v_bfe_u32 v1, v0, 3, 3
    v_lshl_add_u32 v9, v1, 8, v9
    v_bfe_u32 v1, v0, 6, 1
    v_lshl_add_u32 v9, v1, 1, v9
    v_bfe_u32 v1, v0, 7, 1
    v_lshl_add_u32 v9, v1, 11, v9
    v_add_u32 v2, 0, v5
    global_load_ushort v40, v2, s[24:25]
    v_add_u32 v2, 1152, v5
    global_load_ushort v41, v2, s[24:25]
    v_add_u32 v2, 2304, v5
    global_load_ushort v42, v2, s[24:25]
    v_add_u32 v2, 3456, v5
    global_load_ushort v43, v2, s[24:25]
    v_add_u32 v2, 4608, v5
    global_load_ushort v44, v2, s[24:25]
    v_add_u32 v2, 5760, v5
    global_load_ushort v45, v2, s[24:25]
    v_add_u32 v2, 6912, v5
    global_load_ushort v46, v2, s[24:25]
    v_add_u32 v2, 8064, v5
    global_load_ushort v47, v2, s[24:25]
    v_mov_b32 v6, 0x400
    v_bfe_u32 v1, v0, 0, 6
    v_lshl_add_u32 v6, v1, 1, v6
    v_mov_b32 v10, 0x2000
    v_bfe_u32 v1, v0, 0, 4
    v_lshl_add_u32 v10, v1, 1, v10
    v_bfe_u32 v1, v0, 4, 2
    v_lshl_add_u32 v10, v1, 8, v10
    v_add_u32 v2, 0, v6
    global_load_ushort v48, v2, s[24:25]
    v_add_u32 v2, 1152, v6
    global_load_ushort v49, v2, s[24:25]
    v_add_u32 v2, 2304, v6
    global_load_ushort v50, v2, s[24:25]
    v_add_u32 v2, 3456, v6
    global_load_ushort v51, v2, s[24:25]
    v_add_u32 v2, 4608, v6
    global_load_ushort v52, v2, s[24:25]
    v_add_u32 v2, 5760, v6
    global_load_ushort v53, v2, s[24:25]
    v_add_u32 v2, 6912, v6
    global_load_ushort v54, v2, s[24:25]
    v_add_u32 v2, 8064, v6
    global_load_ushort v55, v2, s[24:25]
    v_add_u32 v28, 0, v24
    v_add_u32 v29, 0, v25
    ds_read_b64_tr_b16 a[0:1], v28 offset:0
    ds_read_b64_tr_b16 a[2:3], v28 offset:4096
    ds_read_b64_tr_b16 a[4:5], v28 offset:1024
    ds_read_b64_tr_b16 a[6:7], v28 offset:5120
    ds_read_b64_tr_b16 a[8:9], v29 offset:0
    ds_read_b64_tr_b16 a[10:11], v29 offset:4096
    ds_read_b64_tr_b16 a[12:13], v29 offset:1024
    ds_read_b64_tr_b16 a[14:15], v29 offset:5120
    s_waitcnt lgkmcnt(0)
    s_waitcnt vmcnt(48)
    s_barrier
    s_add_u32 s12, s16, 0
    s_addc_u32 s13, s17, 0
    s_add_u32 m0, s26, 0
    s_nop 0
    global_load_lds_dwordx4 v16, s[12:13] nt
    s_add_u32 m0, s26, 1024
    s_nop 0
    global_load_lds_dwordx4 v17, s[12:13] nt
    s_add_u32 m0, s26, 2048
    s_nop 0
    global_load_lds_dwordx4 v18, s[12:13] nt
    s_add_u32 m0, s26, 3072
    s_nop 0
    global_load_lds_dwordx4 v19, s[12:13] nt
    v_add_u32 v28, 16384, v24
    v_add_u32 v29, 16384, v25
    ds_read_b64_tr_b16 a[16:17], v28 offset:0
    ds_read_b64_tr_b16 a[18:19], v28 offset:4096
    ds_read_b64_tr_b16 a[20:21], v28 offset:1024
    ds_read_b64_tr_b16 a[22:23], v28 offset:5120
    ds_read_b64_tr_b16 a[24:25], v29 offset:0
    ds_read_b64_tr_b16 a[26:27], v29 offset:4096
    ds_read_b64_tr_b16 a[28:29], v29 offset:1024
    ds_read_b64_tr_b16 a[30:31], v29 offset:5120
    s_waitcnt lgkmcnt(0)
    s_waitcnt vmcnt(48)
    s_barrier
    s_add_u32 s12, s20, 0
    s_addc_u32 s13, s21, 0
    s_add_u32 m0, s26, 16384
    s_nop 0
    global_load_lds_dwordx4 v12, s[12:13] nt
    s_add_u32 m0, s26, 17408
    s_nop 0
    global_load_lds_dwordx4 v13, s[12:13] nt
    s_add_u32 m0, s26, 18432
    s_nop 0
    global_load_lds_dwordx4 v14, s[12:13] nt
    s_add_u32 m0, s26, 19456
    s_nop 0
    global_load_lds_dwordx4 v15, s[12:13] nt
    v_add_u32 v28, 32768, v24
    v_add_u32 v29, 32768, v25
    ds_read_b64_tr_b16 a[32:33], v28 offset:0
    ds_read_b64_tr_b16 a[34:35], v28 offset:4096
    ds_read_b64_tr_b16 a[36:37], v28 offset:1024
    ds_read_b64_tr_b16 a[38:39], v28 offset:5120
    ds_read_b64_tr_b16 a[40:41], v29 offset:0
    ds_read_b64_tr_b16 a[42:43], v29 offset:4096
    ds_read_b64_tr_b16 a[44:45], v29 offset:1024
    ds_read_b64_tr_b16 a[46:47], v29 offset:5120
    s_waitcnt lgkmcnt(0)
    s_waitcnt vmcnt(48)
    s_barrier
    s_add_u32 s12, s20, 262144
    s_addc_u32 s13, s21, 0
    s_add_u32 m0, s26, 32768
    s_nop 0
    global_load_lds_dwordx4 v12, s[12:13] nt
    s_add_u32 m0, s26, 33792
    s_nop 0
    global_load_lds_dwordx4 v13, s[12:13] nt
    s_add_u32 m0, s26, 34816
    s_nop 0
    global_load_lds_dwordx4 v14, s[12:13] nt
    s_add_u32 m0, s26, 35840
    s_nop 0
    global_load_lds_dwordx4 v15, s[12:13] nt
    v_add_u32 v28, 49152, v24
    v_add_u32 v29, 49152, v25
    ds_read_b64_tr_b16 a[48:49], v28 offset:0
    ds_read_b64_tr_b16 a[50:51], v28 offset:4096
    ds_read_b64_tr_b16 a[52:53], v28 offset:1024
    ds_read_b64_tr_b16 a[54:55], v28 offset:5120
    ds_read_b64_tr_b16 a[56:57], v29 offset:0
    ds_read_b64_tr_b16 a[58:59], v29 offset:4096
    ds_read_b64_tr_b16 a[60:61], v29 offset:1024
    ds_read_b64_tr_b16 a[62:63], v29 offset:5120
    s_waitcnt lgkmcnt(0)
    s_waitcnt vmcnt(48)
    s_barrier
    s_add_u32 s12, s20, 1048576
    s_addc_u32 s13, s21, 0
    s_add_u32 m0, s26, 49152
    s_nop 0
    global_load_lds_dwordx4 v12, s[12:13] nt
    s_add_u32 m0, s26, 50176
    s_nop 0
    global_load_lds_dwordx4 v13, s[12:13] nt
    s_add_u32 m0, s26, 51200
    s_nop 0
    global_load_lds_dwordx4 v14, s[12:13] nt
    s_add_u32 m0, s26, 52224
    s_nop 0
    global_load_lds_dwordx4 v15, s[12:13] nt
    v_add_u32 v28, 65536, v24
    v_add_u32 v29, 65536, v25
    ds_read_b64_tr_b16 a[64:65], v28 offset:0
    ds_read_b64_tr_b16 a[66:67], v28 offset:4096
    ds_read_b64_tr_b16 a[68:69], v28 offset:1024
    ds_read_b64_tr_b16 a[70:71], v28 offset:5120
    ds_read_b64_tr_b16 a[72:73], v29 offset:0
    ds_read_b64_tr_b16 a[74:75], v29 offset:4096
    ds_read_b64_tr_b16 a[76:77], v29 offset:1024
    ds_read_b64_tr_b16 a[78:79], v29 offset:5120
    s_waitcnt lgkmcnt(0)
    s_waitcnt vmcnt(48)
    s_barrier
    s_add_u32 s12, s20, 1310720
    s_addc_u32 s13, s21, 0
    s_add_u32 m0, s26, 65536
    s_nop 0
    global_load_lds_dwordx4 v12, s[12:13] nt
    s_add_u32 m0, s26, 66560
    s_nop 0
    global_load_lds_dwordx4 v13, s[12:13] nt
    s_add_u32 m0, s26, 67584
    s_nop 0
    global_load_lds_dwordx4 v14, s[12:13] nt
    s_add_u32 m0, s26, 68608
    s_nop 0
    global_load_lds_dwordx4 v15, s[12:13] nt
    v_add_u32 v28, 81920, v24
    v_add_u32 v29, 81920, v25
    ds_read_b64_tr_b16 a[80:81], v28 offset:0
    ds_read_b64_tr_b16 a[82:83], v28 offset:4096
    ds_read_b64_tr_b16 a[84:85], v28 offset:1024
    ds_read_b64_tr_b16 a[86:87], v28 offset:5120
    ds_read_b64_tr_b16 a[88:89], v29 offset:0
    ds_read_b64_tr_b16 a[90:91], v29 offset:4096
    ds_read_b64_tr_b16 a[92:93], v29 offset:1024
    ds_read_b64_tr_b16 a[94:95], v29 offset:5120
    s_waitcnt lgkmcnt(0)
    s_waitcnt vmcnt(48)
    s_barrier
    s_add_u32 s12, s20, 2097152
    s_addc_u32 s13, s21, 0
    s_add_u32 m0, s26, 81920
    s_nop 0
    global_load_lds_dwordx4 v12, s[12:13] nt
    s_add_u32 m0, s26, 82944
    s_nop 0
    global_load_lds_dwordx4 v13, s[12:13] nt
    s_add_u32 m0, s26, 83968
    s_nop 0
    global_load_lds_dwordx4 v14, s[12:13] nt
    s_add_u32 m0, s26, 84992
    s_nop 0
    global_load_lds_dwordx4 v15, s[12:13] nt
    v_add_u32 v28, 98304, v24
    v_add_u32 v29, 98304, v25
    ds_read_b64_tr_b16 a[96:97], v28 offset:0
    ds_read_b64_tr_b16 a[98:99], v28 offset:4096
    ds_read_b64_tr_b16 a[100:101], v28 offset:1024
    ds_read_b64_tr_b16 a[102:103], v28 offset:5120
    ds_read_b64_tr_b16 a[104:105], v29 offset:0
    ds_read_b64_tr_b16 a[106:107], v29 offset:4096
    ds_read_b64_tr_b16 a[108:109], v29 offset:1024
    ds_read_b64_tr_b16 a[110:111], v29 offset:5120
    s_waitcnt lgkmcnt(0)
    s_waitcnt vmcnt(48)
    s_barrier
    s_add_u32 s12, s20, 2359296
    s_addc_u32 s13, s21, 0
    s_add_u32 m0, s26, 98304
    s_nop 0
    global_load_lds_dwordx4 v12, s[12:13] nt
    s_add_u32 m0, s26, 99328
    s_nop 0
    global_load_lds_dwordx4 v13, s[12:13] nt
    s_add_u32 m0, s26, 100352
    s_nop 0
    global_load_lds_dwordx4 v14, s[12:13] nt
    s_add_u32 m0, s26, 101376
    s_nop 0
    global_load_lds_dwordx4 v15, s[12:13] nt
    v_add_u32 v28, 114688, v24
    v_add_u32 v29, 114688, v25
    ds_read_b64_tr_b16 a[112:113], v28 offset:0
    ds_read_b64_tr_b16 a[114:115], v28 offset:4096
    ds_read_b64_tr_b16 a[116:117], v28 offset:1024
    ds_read_b64_tr_b16 a[118:119], v28 offset:5120
    ds_read_b64_tr_b16 a[120:121], v29 offset:0
    ds_read_b64_tr_b16 a[122:123], v29 offset:4096
    ds_read_b64_tr_b16 a[124:125], v29 offset:1024
    ds_read_b64_tr_b16 a[126:127], v29 offset:5120
    s_waitcnt lgkmcnt(0)
    s_waitcnt vmcnt(24)
    s_barrier
    s_add_u32 s12, s20, 3145728
    s_addc_u32 s13, s21, 0
    s_add_u32 m0, s26, 114688
    s_nop 0
    global_load_lds_dwordx4 v12, s[12:13] nt
    s_add_u32 m0, s26, 115712
    s_nop 0
    global_load_lds_dwordx4 v13, s[12:13] nt
    s_add_u32 m0, s26, 116736
    s_nop 0
    global_load_lds_dwordx4 v14, s[12:13] nt
    s_add_u32 m0, s26, 117760
    s_nop 0
    global_load_lds_dwordx4 v15, s[12:13] nt
    v_add_u32 v28, 0, v24
    v_add_u32 v29, 0, v25
    ds_read_b64_tr_b16 a[128:129], v28 offset:0
    ds_read_b64_tr_b16 a[130:131], v28 offset:4096
    ds_read_b64_tr_b16 a[132:133], v28 offset:1024
    ds_read_b64_tr_b16 a[134:135], v28 offset:5120
    ds_read_b64_tr_b16 a[136:137], v29 offset:0
    ds_read_b64_tr_b16 a[138:139], v29 offset:4096
    ds_read_b64_tr_b16 a[140:141], v29 offset:1024
    ds_read_b64_tr_b16 a[142:143], v29 offset:5120
    s_waitcnt lgkmcnt(0)
    s_waitcnt vmcnt(24)
    s_barrier
    s_add_u32 s12, s20, 3407872
    s_addc_u32 s13, s21, 0
    s_add_u32 m0, s26, 0
    s_nop 0
    global_load_lds_dwordx4 v12, s[12:13] nt
    s_add_u32 m0, s26, 1024
    s_nop 0
    global_load_lds_dwordx4 v13, s[12:13] nt
    s_add_u32 m0, s26, 2048
    s_nop 0
    global_load_lds_dwordx4 v14, s[12:13] nt
    s_add_u32 m0, s26, 3072
    s_nop 0
    global_load_lds_dwordx4 v15, s[12:13] nt
    ds_write_b16 v8, v32 offset:0
    ds_write_b16 v8, v33 offset:32
    ds_write_b16 v8, v34 offset:64
    ds_write_b16 v8, v35 offset:96
    ds_write_b16 v8, v36 offset:128
    ds_write_b16 v8, v37 offset:160
    ds_write_b16 v8, v38 offset:192
    ds_write_b16 v8, v39 offset:224
    ds_write_b16 v9, v40 offset:0
    ds_write_b16 v9, v41 offset:32
    ds_write_b16 v9, v42 offset:64
    ds_write_b16 v9, v43 offset:96
    ds_write_b16 v9, v44 offset:128
    ds_write_b16 v9, v45 offset:160
    ds_write_b16 v9, v46 offset:192
    ds_write_b16 v9, v47 offset:224
    ds_write_b16 v10, v48 offset:0
    ds_write_b16 v10, v49 offset:32
    ds_write_b16 v10, v50 offset:64
    ds_write_b16 v10, v51 offset:96
    ds_write_b16 v10, v52 offset:128
    ds_write_b16 v10, v53 offset:160
    ds_write_b16 v10, v54 offset:192
    ds_write_b16 v10, v55 offset:224
    v_add_u32 v28, 16384, v24
    v_add_u32 v29, 16384, v25
    ds_read_b64_tr_b16 a[144:145], v28 offset:0
    ds_read_b64_tr_b16 a[146:147], v28 offset:4096
    ds_read_b64_tr_b16 a[148:149], v28 offset:1024
    ds_read_b64_tr_b16 a[150:151], v28 offset:5120
    ds_read_b64_tr_b16 a[152:153], v29 offset:0
    ds_read_b64_tr_b16 a[154:155], v29 offset:4096
    ds_read_b64_tr_b16 a[156:157], v29 offset:1024
    ds_read_b64_tr_b16 a[158:159], v29 offset:5120
    s_waitcnt lgkmcnt(0)
    s_waitcnt vmcnt(24)
    s_barrier
    s_add_u32 s12, s20, 0
    s_addc_u32 s13, s21, 0
    s_add_u32 m0, s26, 16384
    s_nop 0
    global_load_lds_dwordx4 v16, s[12:13] nt
    s_add_u32 m0, s26, 17408
    s_nop 0
    global_load_lds_dwordx4 v17, s[12:13] nt
    s_add_u32 m0, s26, 18432
    s_nop 0
    global_load_lds_dwordx4 v18, s[12:13] nt
    s_add_u32 m0, s26, 19456
    s_nop 0
    global_load_lds_dwordx4 v19, s[12:13] nt
    v_add_u32 v28, 32768, v24
    v_add_u32 v29, 32768, v25
    ds_read_b64_tr_b16 a[160:161], v28 offset:0
    ds_read_b64_tr_b16 a[162:163], v28 offset:4096
    ds_read_b64_tr_b16 a[164:165], v28 offset:1024
    ds_read_b64_tr_b16 a[166:167], v28 offset:5120
    ds_read_b64_tr_b16 a[168:169], v29 offset:0
    ds_read_b64_tr_b16 a[170:171], v29 offset:4096
    ds_read_b64_tr_b16 a[172:173], v29 offset:1024
    ds_read_b64_tr_b16 a[174:175], v29 offset:5120
    s_waitcnt lgkmcnt(0)
    s_waitcnt vmcnt(24)
    s_barrier
    s_add_u32 s12, s22, 0
    s_addc_u32 s13, s23, 0
    s_add_u32 m0, s26, 32768
    s_nop 0
    global_load_lds_dwordx4 v20, s[12:13] nt
    s_add_u32 m0, s26, 33792
    s_nop 0
    global_load_lds_dwordx4 v21, s[12:13] nt
    s_add_u32 m0, s26, 34816
    s_nop 0
    global_load_lds_dwordx4 v22, s[12:13] nt
    s_add_u32 m0, s26, 35840
    s_nop 0
    global_load_lds_dwordx4 v23, s[12:13] nt
    v_add_u32 v28, 49152, v24
    v_add_u32 v29, 49152, v25
    ds_read_b64_tr_b16 a[176:177], v28 offset:0
    ds_read_b64_tr_b16 a[178:179], v28 offset:4096
    ds_read_b64_tr_b16 a[180:181], v28 offset:1024
    ds_read_b64_tr_b16 a[182:183], v28 offset:5120
    ds_read_b64_tr_b16 a[184:185], v29 offset:0
    ds_read_b64_tr_b16 a[186:187], v29 offset:4096
    ds_read_b64_tr_b16 a[188:189], v29 offset:1024
    ds_read_b64_tr_b16 a[190:191], v29 offset:5120
    s_waitcnt lgkmcnt(0)
    s_waitcnt vmcnt(24)
    s_barrier
    s_add_u32 s12, s22, 128
    s_addc_u32 s13, s23, 0
    s_add_u32 m0, s26, 49152
    s_nop 0
    global_load_lds_dwordx4 v20, s[12:13] nt
    s_add_u32 m0, s26, 50176
    s_nop 0
    global_load_lds_dwordx4 v21, s[12:13] nt
    s_add_u32 m0, s26, 51200
    s_nop 0
    global_load_lds_dwordx4 v22, s[12:13] nt
    s_add_u32 m0, s26, 52224
    s_nop 0
    global_load_lds_dwordx4 v23, s[12:13] nt
    v_add_u32 v28, 65536, v24
    v_add_u32 v29, 65536, v25
    ds_read_b64_tr_b16 a[192:193], v28 offset:0
    ds_read_b64_tr_b16 a[194:195], v28 offset:4096
    ds_read_b64_tr_b16 a[196:197], v28 offset:1024
    ds_read_b64_tr_b16 a[198:199], v28 offset:5120
    ds_read_b64_tr_b16 a[200:201], v29 offset:0
    ds_read_b64_tr_b16 a[202:203], v29 offset:4096
    ds_read_b64_tr_b16 a[204:205], v29 offset:1024
    ds_read_b64_tr_b16 a[206:207], v29 offset:5120
    s_waitcnt lgkmcnt(0)
    s_waitcnt vmcnt(24)
    s_barrier
    s_add_u32 s12, s22, 256
    s_addc_u32 s13, s23, 0
    s_add_u32 m0, s26, 65536
    s_nop 0
    global_load_lds_dwordx4 v20, s[12:13] nt
    s_add_u32 m0, s26, 66560
    s_nop 0
    global_load_lds_dwordx4 v21, s[12:13] nt
    s_add_u32 m0, s26, 67584
    s_nop 0
    global_load_lds_dwordx4 v22, s[12:13] nt
    s_add_u32 m0, s26, 68608
    s_nop 0
    global_load_lds_dwordx4 v23, s[12:13] nt
    v_add_u32 v28, 81920, v24
    v_add_u32 v29, 81920, v25
    ds_read_b64_tr_b16 a[208:209], v28 offset:0
    ds_read_b64_tr_b16 a[210:211], v28 offset:4096
    ds_read_b64_tr_b16 a[212:213], v28 offset:1024
    ds_read_b64_tr_b16 a[214:215], v28 offset:5120
    ds_read_b64_tr_b16 a[216:217], v29 offset:0
    ds_read_b64_tr_b16 a[218:219], v29 offset:4096
    ds_read_b64_tr_b16 a[220:221], v29 offset:1024
    ds_read_b64_tr_b16 a[222:223], v29 offset:5120
    s_waitcnt lgkmcnt(0)
    s_waitcnt vmcnt(24)
    s_barrier
    s_add_u32 s12, s22, 384
    s_addc_u32 s13, s23, 0
    s_add_u32 m0, s26, 81920
    s_nop 0
    global_load_lds_dwordx4 v20, s[12:13] nt
    s_add_u32 m0, s26, 82944
    s_nop 0
    global_load_lds_dwordx4 v21, s[12:13] nt
    s_add_u32 m0, s26, 83968
    s_nop 0
    global_load_lds_dwordx4 v22, s[12:13] nt
    s_add_u32 m0, s26, 84992
    s_nop 0
    global_load_lds_dwordx4 v23, s[12:13] nt
    v_add_u32 v28, 98304, v24
    v_add_u32 v29, 98304, v25
    ds_read_b64_tr_b16 a[224:225], v28 offset:0
    ds_read_b64_tr_b16 a[226:227], v28 offset:4096
    ds_read_b64_tr_b16 a[228:229], v28 offset:1024
    ds_read_b64_tr_b16 a[230:231], v28 offset:5120
    ds_read_b64_tr_b16 a[232:233], v29 offset:0
    ds_read_b64_tr_b16 a[234:235], v29 offset:4096
    ds_read_b64_tr_b16 a[236:237], v29 offset:1024
    ds_read_b64_tr_b16 a[238:239], v29 offset:5120
    s_waitcnt lgkmcnt(0)
    s_waitcnt vmcnt(24)
    s_barrier
    s_add_u32 s12, s22, 512
    s_addc_u32 s13, s23, 0
    s_add_u32 m0, s26, 98304
    s_nop 0
    global_load_lds_dwordx4 v20, s[12:13] nt
    s_add_u32 m0, s26, 99328
    s_nop 0
    global_load_lds_dwordx4 v21, s[12:13] nt
    s_add_u32 m0, s26, 100352
    s_nop 0
    global_load_lds_dwordx4 v22, s[12:13] nt
    s_add_u32 m0, s26, 101376
    s_nop 0
    global_load_lds_dwordx4 v23, s[12:13] nt
    v_add_u32 v28, 114688, v24
    v_add_u32 v29, 114688, v25
    ds_read_b64_tr_b16 a[240:241], v28 offset:0
    ds_read_b64_tr_b16 a[242:243], v28 offset:4096
    ds_read_b64_tr_b16 a[244:245], v28 offset:1024
    ds_read_b64_tr_b16 a[246:247], v28 offset:5120
    ds_read_b64_tr_b16 a[248:249], v29 offset:0
    ds_read_b64_tr_b16 a[250:251], v29 offset:4096
    ds_read_b64_tr_b16 a[252:253], v29 offset:1024
    ds_read_b64_tr_b16 a[254:255], v29 offset:5120
    s_waitcnt lgkmcnt(0)
    s_waitcnt vmcnt(24)
    s_barrier
    s_add_u32 s12, s22, 640
    s_addc_u32 s13, s23, 0
    s_add_u32 m0, s26, 114688
    s_nop 0
    global_load_lds_dwordx4 v20, s[12:13] nt
    s_add_u32 m0, s26, 115712
    s_nop 0
    global_load_lds_dwordx4 v21, s[12:13] nt
    s_add_u32 m0, s26, 116736
    s_nop 0
    global_load_lds_dwordx4 v22, s[12:13] nt
    s_add_u32 m0, s26, 117760
    s_nop 0
    global_load_lds_dwordx4 v23, s[12:13] nt
    v_add_u32 v28, 0, v24
    v_add_u32 v29, 0, v25
    ds_read_b64_tr_b16 v[64:65], v28 offset:0
    ds_read_b64_tr_b16 v[66:67], v28 offset:4096
    ds_read_b64_tr_b16 v[68:69], v28 offset:1024
    ds_read_b64_tr_b16 v[70:71], v28 offset:5120
    ds_read_b64_tr_b16 v[72:73], v29 offset:0
    ds_read_b64_tr_b16 v[74:75], v29 offset:4096
    ds_read_b64_tr_b16 v[76:77], v29 offset:1024
    ds_read_b64_tr_b16 v[78:79], v29 offset:5120
    s_waitcnt lgkmcnt(0)
    s_waitcnt vmcnt(24)
    s_barrier
    s_add_u32 s12, s22, 768
    s_addc_u32 s13, s23, 0
    s_add_u32 m0, s26, 0
    s_nop 0
    global_load_lds_dwordx4 v20, s[12:13] nt
    s_add_u32 m0, s26, 1024
    s_nop 0
    global_load_lds_dwordx4 v21, s[12:13] nt
    s_add_u32 m0, s26, 2048
    s_nop 0
    global_load_lds_dwordx4 v22, s[12:13] nt
    s_add_u32 m0, s26, 3072
    s_nop 0
    global_load_lds_dwordx4 v23, s[12:13] nt
    v_add_u32 v28, 16384, v24
    v_add_u32 v29, 16384, v25
    ds_read_b64_tr_b16 v[80:81], v28 offset:0
    ds_read_b64_tr_b16 v[82:83], v28 offset:4096
    ds_read_b64_tr_b16 v[84:85], v28 offset:1024
    ds_read_b64_tr_b16 v[86:87], v28 offset:5120
    ds_read_b64_tr_b16 v[88:89], v29 offset:0
    ds_read_b64_tr_b16 v[90:91], v29 offset:4096
    ds_read_b64_tr_b16 v[92:93], v29 offset:1024
    ds_read_b64_tr_b16 v[94:95], v29 offset:5120
    s_waitcnt lgkmcnt(0)
    s_waitcnt vmcnt(24)
    s_barrier
    s_add_u32 s12, s22, 896
    s_addc_u32 s13, s23, 0
    s_add_u32 m0, s26, 16384
    s_nop 0
    global_load_lds_dwordx4 v20, s[12:13] nt
    s_add_u32 m0, s26, 17408
    s_nop 0
    global_load_lds_dwordx4 v21, s[12:13] nt
    s_add_u32 m0, s26, 18432
    s_nop 0
    global_load_lds_dwordx4 v22, s[12:13] nt
    s_add_u32 m0, s26, 19456
    s_nop 0
    global_load_lds_dwordx4 v23, s[12:13] nt
    v_add_u32 v28, 32768, v26
    ds_read_b64_tr_b16 v[96:97], v28 offset:0
    ds_read_b64_tr_b16 v[98:99], v28 offset:256
    ds_read_b64_tr_b16 v[100:101], v28 offset:4096
    ds_read_b64_tr_b16 v[102:103], v28 offset:4352
    ds_read_b64_tr_b16 v[104:105], v28 offset:8192
    ds_read_b64_tr_b16 v[106:107], v28 offset:8448
    ds_read_b64_tr_b16 v[108:109], v28 offset:12288
    ds_read_b64_tr_b16 v[110:111], v28 offset:12544
    s_waitcnt lgkmcnt(0)
    s_waitcnt vmcnt(24)
    s_barrier
    s_add_u32 s12, s22, 1024
    s_addc_u32 s13, s23, 0
    s_add_u32 m0, s26, 32768
    s_nop 0
    global_load_lds_dwordx4 v20, s[12:13] nt
    s_add_u32 m0, s26, 33792
    s_nop 0
    global_load_lds_dwordx4 v21, s[12:13] nt
    s_add_u32 m0, s26, 34816
    s_nop 0
    global_load_lds_dwordx4 v22, s[12:13] nt
    s_add_u32 m0, s26, 35840
    s_nop 0
    global_load_lds_dwordx4 v23, s[12:13] nt
    v_add_u32 v28, 49152, v26
    ds_read_b64_tr_b16 v[112:113], v28 offset:0
    ds_read_b64_tr_b16 v[114:115], v28 offset:256
    ds_read_b64_tr_b16 v[116:117], v28 offset:4096
    ds_read_b64_tr_b16 v[118:119], v28 offset:4352
    ds_read_b64_tr_b16 v[120:121], v28 offset:8192
    ds_read_b64_tr_b16 v[122:123], v28 offset:8448
    ds_read_b64_tr_b16 v[124:125], v28 offset:12288
    ds_read_b64_tr_b16 v[126:127], v28 offset:12544
    s_waitcnt lgkmcnt(0)
    s_waitcnt vmcnt(24)
    s_barrier
    s_add_u32 s12, s18, 3407872
    s_addc_u32 s13, s19, 0
    s_add_u32 m0, s26, 49152
    s_nop 0
    global_load_lds_dwordx4 v12, s[12:13] nt
    s_add_u32 m0, s26, 50176
    s_nop 0
    global_load_lds_dwordx4 v13, s[12:13] nt
    s_add_u32 m0, s26, 51200
    s_nop 0
    global_load_lds_dwordx4 v14, s[12:13] nt
    s_add_u32 m0, s26, 52224
    s_nop 0
    global_load_lds_dwordx4 v15, s[12:13] nt
    v_add_u32 v28, 65536, v26
    ds_read_b64_tr_b16 v[128:129], v28 offset:0
    ds_read_b64_tr_b16 v[130:131], v28 offset:256
    ds_read_b64_tr_b16 v[132:133], v28 offset:4096
    ds_read_b64_tr_b16 v[134:135], v28 offset:4352
    ds_read_b64_tr_b16 v[136:137], v28 offset:8192
    ds_read_b64_tr_b16 v[138:139], v28 offset:8448
    ds_read_b64_tr_b16 v[140:141], v28 offset:12288
    ds_read_b64_tr_b16 v[142:143], v28 offset:12544
    s_waitcnt lgkmcnt(0)
    s_waitcnt vmcnt(24)
    s_barrier
    s_add_u32 s12, s18, 1310720
    s_addc_u32 s13, s19, 0
    s_add_u32 m0, s26, 65536
    s_nop 0
    global_load_lds_dwordx4 v12, s[12:13] nt
    s_add_u32 m0, s26, 66560
    s_nop 0
    global_load_lds_dwordx4 v13, s[12:13] nt
    s_add_u32 m0, s26, 67584
    s_nop 0
    global_load_lds_dwordx4 v14, s[12:13] nt
    s_add_u32 m0, s26, 68608
    s_nop 0
    global_load_lds_dwordx4 v15, s[12:13] nt
    v_add_u32 v28, 81920, v26
    ds_read_b64_tr_b16 v[144:145], v28 offset:0
    ds_read_b64_tr_b16 v[146:147], v28 offset:256
    ds_read_b64_tr_b16 v[148:149], v28 offset:4096
    ds_read_b64_tr_b16 v[150:151], v28 offset:4352
    ds_read_b64_tr_b16 v[152:153], v28 offset:8192
    ds_read_b64_tr_b16 v[154:155], v28 offset:8448
    ds_read_b64_tr_b16 v[156:157], v28 offset:12288
    ds_read_b64_tr_b16 v[158:159], v28 offset:12544
    s_waitcnt lgkmcnt(0)
    s_waitcnt vmcnt(24)
    s_barrier
    s_add_u32 s12, s18, 2097152
    s_addc_u32 s13, s19, 0
    s_add_u32 m0, s26, 81920
    s_nop 0
    global_load_lds_dwordx4 v12, s[12:13] nt
    s_add_u32 m0, s26, 82944
    s_nop 0
    global_load_lds_dwordx4 v13, s[12:13] nt
    s_add_u32 m0, s26, 83968
    s_nop 0
    global_load_lds_dwordx4 v14, s[12:13] nt
    s_add_u32 m0, s26, 84992
    s_nop 0
    global_load_lds_dwordx4 v15, s[12:13] nt
    v_add_u32 v28, 98304, v26
    ds_read_b64_tr_b16 v[160:161], v28 offset:0
    ds_read_b64_tr_b16 v[162:163], v28 offset:256
    ds_read_b64_tr_b16 v[164:165], v28 offset:4096
    ds_read_b64_tr_b16 v[166:167], v28 offset:4352
    ds_read_b64_tr_b16 v[168:169], v28 offset:8192
    ds_read_b64_tr_b16 v[170:171], v28 offset:8448
    ds_read_b64_tr_b16 v[172:173], v28 offset:12288
    ds_read_b64_tr_b16 v[174:175], v28 offset:12544
    s_waitcnt lgkmcnt(0)
    s_waitcnt vmcnt(24)
    s_barrier
    s_add_u32 s12, s18, 2359296
    s_addc_u32 s13, s19, 0
    s_add_u32 m0, s26, 98304
    s_nop 0
    global_load_lds_dwordx4 v12, s[12:13] nt
    s_add_u32 m0, s26, 99328
    s_nop 0
    global_load_lds_dwordx4 v13, s[12:13] nt
    s_add_u32 m0, s26, 100352
    s_nop 0
    global_load_lds_dwordx4 v14, s[12:13] nt
    s_add_u32 m0, s26, 101376
    s_nop 0
    global_load_lds_dwordx4 v15, s[12:13] nt
    v_add_u32 v28, 114688, v26
    ds_read_b64_tr_b16 v[176:177], v28 offset:0
    ds_read_b64_tr_b16 v[178:179], v28 offset:256
    ds_read_b64_tr_b16 v[180:181], v28 offset:4096
    ds_read_b64_tr_b16 v[182:183], v28 offset:4352
    ds_read_b64_tr_b16 v[184:185], v28 offset:8192
    ds_read_b64_tr_b16 v[186:187], v28 offset:8448
    ds_read_b64_tr_b16 v[188:189], v28 offset:12288
    ds_read_b64_tr_b16 v[190:191], v28 offset:12544
    s_waitcnt lgkmcnt(0)
    s_waitcnt vmcnt(24)
    s_barrier
    s_add_u32 s12, s18, 3145728
    s_addc_u32 s13, s19, 0
    s_add_u32 m0, s26, 114688
    s_nop 0
    global_load_lds_dwordx4 v12, s[12:13] nt
    s_add_u32 m0, s26, 115712
    s_nop 0
    global_load_lds_dwordx4 v13, s[12:13] nt
    s_add_u32 m0, s26, 116736
    s_nop 0
    global_load_lds_dwordx4 v14, s[12:13] nt
    s_add_u32 m0, s26, 117760
    s_nop 0
    global_load_lds_dwordx4 v15, s[12:13] nt
    v_mov_b32 v2, 0x0
    v_bfe_u32 v1, v0, 0, 2
    v_lshl_add_u32 v2, v1, 2, v2
    v_bfe_u32 v1, v0, 2, 1
    v_lshl_add_u32 v2, v1, 7, v2
    global_load_dword v4, v2, s[6:7] sc1
    v_add_u32 v28, 0, v26
    ds_read_b64_tr_b16 v[192:193], v28 offset:0
    ds_read_b64_tr_b16 v[194:195], v28 offset:256
    ds_read_b64_tr_b16 v[196:197], v28 offset:4096
    ds_read_b64_tr_b16 v[198:199], v28 offset:4352
    ds_read_b64_tr_b16 v[200:201], v28 offset:8192
    ds_read_b64_tr_b16 v[202:203], v28 offset:8448
    ds_read_b64_tr_b16 v[204:205], v28 offset:12288
    ds_read_b64_tr_b16 v[206:207], v28 offset:12544
    s_waitcnt lgkmcnt(0)
    s_waitcnt vmcnt(25)
    s_barrier
    s_add_u32 s12, s18, 0
    s_addc_u32 s13, s19, 0
    s_add_u32 m0, s26, 0
    s_nop 0
    global_load_lds_dwordx4 v16, s[12:13] nt
    s_add_u32 m0, s26, 1024
    s_nop 0
    global_load_lds_dwordx4 v17, s[12:13] nt
    s_add_u32 m0, s26, 2048
    s_nop 0
    global_load_lds_dwordx4 v18, s[12:13] nt
    s_add_u32 m0, s26, 3072
    s_nop 0
    global_load_lds_dwordx4 v19, s[12:13] nt
    v_add_u32 v28, 16384, v26
    ds_read_b64_tr_b16 v[208:209], v28 offset:0
    ds_read_b64_tr_b16 v[210:211], v28 offset:256
    ds_read_b64_tr_b16 v[212:213], v28 offset:4096
    ds_read_b64_tr_b16 v[214:215], v28 offset:4352
    ds_read_b64_tr_b16 v[216:217], v28 offset:8192
    ds_read_b64_tr_b16 v[218:219], v28 offset:8448
    ds_read_b64_tr_b16 v[220:221], v28 offset:12288
    ds_read_b64_tr_b16 v[222:223], v28 offset:12544
    s_waitcnt lgkmcnt(0)
    s_waitcnt vmcnt(25)
    s_barrier
    s_add_u32 s12, s18, 0
    s_addc_u32 s13, s19, 0
    s_add_u32 m0, s26, 16384
    s_nop 0
    global_load_lds_dwordx4 v12, s[12:13] nt
    s_add_u32 m0, s26, 17408
    s_nop 0
    global_load_lds_dwordx4 v13, s[12:13] nt
    s_add_u32 m0, s26, 18432
    s_nop 0
    global_load_lds_dwordx4 v14, s[12:13] nt
    s_add_u32 m0, s26, 19456
    s_nop 0
    global_load_lds_dwordx4 v15, s[12:13] nt
    v_add_u32 v28, 32768, v26
    ds_read_b64_tr_b16 v[224:225], v28 offset:0
    ds_read_b64_tr_b16 v[226:227], v28 offset:256
    ds_read_b64_tr_b16 v[228:229], v28 offset:4096
    ds_read_b64_tr_b16 v[230:231], v28 offset:4352
    ds_read_b64_tr_b16 v[232:233], v28 offset:8192
    ds_read_b64_tr_b16 v[234:235], v28 offset:8448
    ds_read_b64_tr_b16 v[236:237], v28 offset:12288
    ds_read_b64_tr_b16 v[238:239], v28 offset:12544
    s_waitcnt lgkmcnt(0)
    s_waitcnt vmcnt(25)
    s_barrier
    s_add_u32 s12, s18, 262144
    s_addc_u32 s13, s19, 0
    s_add_u32 m0, s26, 32768
    s_nop 0
    global_load_lds_dwordx4 v12, s[12:13] nt
    s_add_u32 m0, s26, 33792
    s_nop 0
    global_load_lds_dwordx4 v13, s[12:13] nt
    s_add_u32 m0, s26, 34816
    s_nop 0
    global_load_lds_dwordx4 v14, s[12:13] nt
    s_add_u32 m0, s26, 35840
    s_nop 0
    global_load_lds_dwordx4 v15, s[12:13] nt
    v_add_u32 v28, 49152, v24
    v_add_u32 v29, 49152, v25
    ds_read_b64_tr_b16 v[240:241], v28 offset:0
    ds_read_b64_tr_b16 v[242:243], v28 offset:4096
    ds_read_b64_tr_b16 v[244:245], v28 offset:1024
    ds_read_b64_tr_b16 v[246:247], v28 offset:5120
    ds_read_b64_tr_b16 v[248:249], v29 offset:0
    ds_read_b64_tr_b16 v[250:251], v29 offset:4096
    ds_read_b64_tr_b16 v[252:253], v29 offset:1024
    ds_read_b64_tr_b16 v[254:255], v29 offset:5120
    s_waitcnt lgkmcnt(0)
    s_waitcnt vmcnt(25)
    s_barrier
    s_add_u32 s12, s18, 1048576
    s_addc_u32 s13, s19, 0
    s_add_u32 m0, s26, 49152
    s_nop 0
    global_load_lds_dwordx4 v12, s[12:13] nt
    s_add_u32 m0, s26, 50176
    s_nop 0
    global_load_lds_dwordx4 v13, s[12:13] nt
    s_add_u32 m0, s26, 51200
    s_nop 0
    global_load_lds_dwordx4 v14, s[12:13] nt
    s_add_u32 m0, s26, 52224
    s_nop 0
    global_load_lds_dwordx4 v15, s[12:13] nt
    v_add_u32 v28, 65536, v24
    v_add_u32 v29, 65536, v25
    ds_read_b64_tr_b16 v[32:33], v28 offset:0
    ds_read_b64_tr_b16 v[34:35], v28 offset:4096
    ds_read_b64_tr_b16 v[36:37], v28 offset:1024
    ds_read_b64_tr_b16 v[38:39], v28 offset:5120
    ds_read_b64_tr_b16 v[40:41], v29 offset:0
    ds_read_b64_tr_b16 v[42:43], v29 offset:4096
    ds_read_b64_tr_b16 v[44:45], v29 offset:1024
    ds_read_b64_tr_b16 v[46:47], v29 offset:5120
    s_waitcnt lgkmcnt(0)
    s_waitcnt vmcnt(25)
    s_barrier
    v_add_u32 v28, 65536, v27
    ds_write_b128 v28, v[32:35] offset:0
    ds_write_b128 v28, v[36:39] offset:4096
    ds_write_b128 v28, v[40:43] offset:8192
    ds_write_b128 v28, v[44:47] offset:12288
    v_add_u32 v28, 81920, v24
    v_add_u32 v29, 81920, v25
    ds_read_b64_tr_b16 v[48:49], v28 offset:0
    ds_read_b64_tr_b16 v[50:51], v28 offset:4096
    ds_read_b64_tr_b16 v[52:53], v28 offset:1024
    ds_read_b64_tr_b16 v[54:55], v28 offset:5120
    ds_read_b64_tr_b16 v[56:57], v29 offset:0
    ds_read_b64_tr_b16 v[58:59], v29 offset:4096
    ds_read_b64_tr_b16 v[60:61], v29 offset:1024
    ds_read_b64_tr_b16 v[62:63], v29 offset:5120
    s_waitcnt lgkmcnt(0)
    s_waitcnt vmcnt(21)
    s_barrier
    v_add_u32 v28, 81920, v27
    ds_write_b128 v28, v[48:51] offset:0
    ds_write_b128 v28, v[52:55] offset:4096
    ds_write_b128 v28, v[56:59] offset:8192
    ds_write_b128 v28, v[60:63] offset:12288
    v_add_u32 v28, 98304, v24
    v_add_u32 v29, 98304, v25
    ds_read_b64_tr_b16 v[32:33], v28 offset:0
    ds_read_b64_tr_b16 v[34:35], v28 offset:4096
    ds_read_b64_tr_b16 v[36:37], v28 offset:1024
    ds_read_b64_tr_b16 v[38:39], v28 offset:5120
    ds_read_b64_tr_b16 v[40:41], v29 offset:0
    ds_read_b64_tr_b16 v[42:43], v29 offset:4096
    ds_read_b64_tr_b16 v[44:45], v29 offset:1024
    ds_read_b64_tr_b16 v[46:47], v29 offset:5120
    s_waitcnt lgkmcnt(0)
    s_waitcnt vmcnt(17)
    s_barrier
    v_add_u32 v28, 98304, v27
    ds_write_b128 v28, v[32:35] offset:0
    ds_write_b128 v28, v[36:39] offset:4096
    ds_write_b128 v28, v[40:43] offset:8192
    ds_write_b128 v28, v[44:47] offset:12288
    v_add_u32 v28, 114688, v24
    v_add_u32 v29, 114688, v25
    ds_read_b64_tr_b16 v[48:49], v28 offset:0
    ds_read_b64_tr_b16 v[50:51], v28 offset:4096
    ds_read_b64_tr_b16 v[52:53], v28 offset:1024
    ds_read_b64_tr_b16 v[54:55], v28 offset:5120
    ds_read_b64_tr_b16 v[56:57], v29 offset:0
    ds_read_b64_tr_b16 v[58:59], v29 offset:4096
    ds_read_b64_tr_b16 v[60:61], v29 offset:1024
    ds_read_b64_tr_b16 v[62:63], v29 offset:5120
    s_waitcnt lgkmcnt(0)
    s_waitcnt vmcnt(12)
    s_barrier
    s_lshl_b32 s12, s9, 7
    s_add_u32 s12, s12, 69632
    v_mov_b32 v2, s12
    global_load_dwordx4 v[8:11], v2, s[4:5] sc1
    v_add_u32 v28, 114688, v27
    ds_write_b128 v28, v[48:51] offset:0
    ds_write_b128 v28, v[52:55] offset:4096
    ds_write_b128 v28, v[56:59] offset:8192
    ds_write_b128 v28, v[60:63] offset:12288
    v_add_u32 v28, 0, v24
    v_add_u32 v29, 0, v25
    ds_read_b64_tr_b16 v[32:33], v28 offset:0
    ds_read_b64_tr_b16 v[34:35], v28 offset:4096
    ds_read_b64_tr_b16 v[36:37], v28 offset:1024
    ds_read_b64_tr_b16 v[38:39], v28 offset:5120
    ds_read_b64_tr_b16 v[40:41], v29 offset:0
    ds_read_b64_tr_b16 v[42:43], v29 offset:4096
    ds_read_b64_tr_b16 v[44:45], v29 offset:1024
    ds_read_b64_tr_b16 v[46:47], v29 offset:5120
    s_waitcnt lgkmcnt(0)
    s_waitcnt vmcnt(9)
    s_barrier
    v_add_u32 v28, 0, v27
    ds_write_b128 v28, v[32:35] offset:0
    ds_write_b128 v28, v[36:39] offset:4096
    ds_write_b128 v28, v[40:43] offset:8192
    ds_write_b128 v28, v[44:47] offset:12288
    v_add_u32 v28, 16384, v24
    v_add_u32 v29, 16384, v25
    ds_read_b64_tr_b16 v[48:49], v28 offset:0
    ds_read_b64_tr_b16 v[50:51], v28 offset:4096
    ds_read_b64_tr_b16 v[52:53], v28 offset:1024
    ds_read_b64_tr_b16 v[54:55], v28 offset:5120
    ds_read_b64_tr_b16 v[56:57], v29 offset:0
    ds_read_b64_tr_b16 v[58:59], v29 offset:4096
    ds_read_b64_tr_b16 v[60:61], v29 offset:1024
    ds_read_b64_tr_b16 v[62:63], v29 offset:5120
    s_waitcnt lgkmcnt(0)
    s_waitcnt vmcnt(5)
    s_barrier
    v_add_u32 v28, 16384, v27
    ds_write_b128 v28, v[48:51] offset:0
    ds_write_b128 v28, v[52:55] offset:4096
    ds_write_b128 v28, v[56:59] offset:8192
    ds_write_b128 v28, v[60:63] offset:12288
    v_add_u32 v28, 32768, v24
    v_add_u32 v29, 32768, v25
    ds_read_b64_tr_b16 v[32:33], v28 offset:0
    ds_read_b64_tr_b16 v[34:35], v28 offset:4096
    ds_read_b64_tr_b16 v[36:37], v28 offset:1024
    ds_read_b64_tr_b16 v[38:39], v28 offset:5120
    ds_read_b64_tr_b16 v[40:41], v29 offset:0
    ds_read_b64_tr_b16 v[42:43], v29 offset:4096
    ds_read_b64_tr_b16 v[44:45], v29 offset:1024
    ds_read_b64_tr_b16 v[46:47], v29 offset:5120
    s_waitcnt lgkmcnt(0)
    s_waitcnt vmcnt(1)
    s_barrier
    v_add_u32 v28, 32768, v27
    ds_write_b128 v28, v[32:35] offset:0
    ds_write_b128 v28, v[36:39] offset:4096
    ds_write_b128 v28, v[40:43] offset:8192
    ds_write_b128 v28, v[44:47] offset:12288
    v_add_u32 v28, 49152, v24
    v_add_u32 v29, 49152, v25
    ds_read_b64_tr_b16 v[48:49], v28 offset:0
    ds_read_b64_tr_b16 v[50:51], v28 offset:4096
    ds_read_b64_tr_b16 v[52:53], v28 offset:1024
    ds_read_b64_tr_b16 v[54:55], v28 offset:5120
    ds_read_b64_tr_b16 v[56:57], v29 offset:0
    ds_read_b64_tr_b16 v[58:59], v29 offset:4096
    ds_read_b64_tr_b16 v[60:61], v29 offset:1024
    ds_read_b64_tr_b16 v[62:63], v29 offset:5120
    s_waitcnt lgkmcnt(0)
    s_barrier
    v_add_u32 v28, 49152, v27
    ds_write_b128 v28, v[48:51] offset:0
    ds_write_b128 v28, v[52:55] offset:4096
    ds_write_b128 v28, v[56:59] offset:8192
    ds_write_b128 v28, v[60:63] offset:12288
    s_waitcnt lgkmcnt(0)
    s_waitcnt vmcnt(0)
    s_mov_b32 s54, 0
    v_min3_u32 v6, v8, v9, v10
    v_min_u32 v6, v6, v11
    v_mov_b32 v12, 0x0
    v_bfe_u32 v13, v0, 0, 2
    v_lshl_add_u32 v12, v13, 2, v12
    v_bfe_u32 v13, v0, 2, 1
    v_lshl_add_u32 v12, v13, 7, v12
    s_mov_b32 s12, 0
    v_mov_b32 v13, v4
    v_and_b32 v14, 0xff, v13
    v_cmp_ne_u32 vcc, 32, v14
    s_cbranch_vccnz L_mc_47
    v_readfirstlane_b32 s54, v6
    s_branch L_mc_done_46
L_mc_47:
    global_load_dword v13, v12, s[6:7] sc1
    s_add_u32 s12, s12, 1
    s_cmp_gt_u32 s12, 100000
    s_cbranch_scc1 L_exit
    s_waitcnt vmcnt(0)
    v_and_b32 v14, 0xff, v13
    v_cmp_ne_u32 vcc, 32, v14
    s_cbranch_vccz L_mc_done_46
    v_cmp_lt_u32 vcc, 32, v14
    s_cbranch_vccnz L_exit
    s_sleep 24
    s_branch L_mc_47
L_mc_done_46:
    v_readlane_b32 s12, v13, s8
    s_mul_i32 s13, s3, s3
    s_lshl_b32 s13, s13, 10
    s_add_u32 s13, s13, s3
    s_lshl_b32 s13, s13, 8
    s_add_u32 s13, s13, 1
    s_lshl_b32 s13, s13, 5
    s_cmp_eq_u32 s12, s13
    s_cselect_b32 s11, 1, 0
    v_mov_b32 v2, 0x0
    v_bfe_u32 v12, v0, 0, 6
    v_lshl_add_u32 v2, v12, 4, v2
    v_mov_b32 v3, 0x0
    v_bfe_u32 v12, v0, 0, 1
    v_lshlrev_b32 v12, 4, v12
    v_xor_b32 v3, v3, v12
    v_bfe_i32 v12, v0, 1, 1
    v_and_b32 v12, 0x90, v12
    v_xor_b32 v3, v3, v12
    v_bfe_i32 v12, v0, 2, 1
    v_and_b32 v12, 0x140, v12
    v_xor_b32 v3, v3, v12
    v_bfe_i32 v12, v0, 3, 1
    v_and_b32 v12, 0x260, v12
    v_xor_b32 v3, v3, v12
    v_bfe_u32 v12, v0, 4, 2
    v_lshlrev_b32 v12, 5, v12
    v_xor_b32 v3, v3, v12
    v_mov_b32 v4, 0x6400
    v_bfe_u32 v12, v0, 0, 3
    v_mul_u32_u24 v12, 0x120, v12
    v_add_u32 v4, v4, v12
    v_bfe_u32 v12, v0, 4, 2
    v_lshl_add_u32 v4, v12, 4, v4
    v_mov_b32 v5, 0x6400
    v_bfe_u32 v12, v0, 0, 4
    v_lshl_add_u32 v5, v12, 2, v5
    v_bfe_u32 v12, v0, 4, 1
    v_mul_u32_u24 v12, 0x480, v12
    v_add_u32 v5, v5, v12
    v_bfe_u32 v12, v0, 5, 1
    v_mul_u32_u24 v12, 0x240, v12
    v_add_u32 v5, v5, v12
    v_bfe_u32 v12, v0, 6, 2
    v_lshl_add_u32 v5, v12, 6, v5
    v_mov_b32 v6, 0x0
    v_bfe_i32 v12, v0, 0, 1
    v_and_b32 v12, 0x90, v12
    v_xor_b32 v6, v6, v12
    v_bfe_i32 v12, v0, 1, 1
    v_and_b32 v12, 0x260, v12
    v_xor_b32 v6, v6, v12
    v_bfe_i32 v12, v0, 2, 1
    v_and_b32 v12, 0x140, v12
    v_xor_b32 v6, v6, v12
    v_bfe_u32 v12, v0, 4, 3
    v_lshlrev_b32 v12, 4, v12
    v_xor_b32 v6, v6, v12
    v_bfe_u32 v12, v0, 7, 1
    v_lshlrev_b32 v12, 10, v12
    v_xor_b32 v6, v6, v12
    v_add_u32 v6, 30208, v6
    v_mov_b32 v14, 0x7e00
    v_bfe_u32 v12, v0, 0, 3
    v_lshl_add_u32 v14, v12, 4, v14
    v_bfe_u32 v12, v0, 4, 2
    v_lshl_add_u32 v14, v12, 7, v14
    v_and_b32 v12, 8, v0
    v_cmp_ne_u32 vcc, 0, v12
    s_nop 1
    v_cndmask_b32 v6, v6, v14, vcc
    v_mov_b32 v7, 0x4444
    v_bfe_u32 v12, v0, 0, 1
    v_mul_u32_u24 v12, 0xaaaa, v12
    v_add_u32 v7, v7, v12
    v_lshlrev_b32 v0, 4, v0
    s_and_b32 s12, s10, 1
    s_lshl_b32 s12, s12, 5
    s_add_u32 s37, s12, s9
    v_mov_b32 v14, s37
    v_mov_b32 v15, 0x0
    v_bfe_u32 v12, v14, 0, 2
    v_lshl_add_u32 v15, v12, 6, v15
    v_bfe_u32 v12, v14, 2, 4
    v_lshl_add_u32 v15, v12, 9, v15
    v_mov_b32 v16, 0x2000
    v_bfe_u32 v12, v14, 0, 1
    v_lshl_add_u32 v16, v12, 4, v16
    v_bfe_u32 v12, v14, 1, 4
    v_lshl_add_u32 v16, v12, 6, v16
    v_mov_b32 v17, 0x3a00000
    v_bfe_u32 v12, v14, 0, 6
    v_lshl_add_u32 v17, v12, 12, v17
    v_mov_b32 v18, 0x3a40000
    v_bfe_u32 v12, v14, 0, 3
    v_lshl_add_u32 v18, v12, 5, v18
    v_bfe_u32 v12, v14, 3, 2
    v_lshl_add_u32 v18, v12, 13, v18
    v_readfirstlane_b32 s41, v15
    v_readfirstlane_b32 s12, v16
    v_readfirstlane_b32 s13, v17
    v_readfirstlane_b32 s14, v18
    s_cmp_lt_u32 s10, 2
    s_cselect_b32 s41, s41, s12
    s_cselect_b32 s13, s13, s14
    s_mov_b32 s44, 0x00030003
    s_cselect_b32 s44, 0x00FF00FF, s44
    s_mov_b32 s45, 0
    s_movk_i32 s36, 3072
    s_add_u32 s28, s4, s13
    s_addc_u32 s29, s5, 0
    s_add_u32 s16, s28, 8192
    s_addc_u32 s17, s29, 0
    s_lshl_b32 s12, s10, 5
    s_add_u32 s12, s12, s9
    s_lshl_b32 s13, s12, 9
    s_lshl_b32 s13, s10, 7
    s_add_u32 s13, s13, s9
    s_lshl_b32 s13, s13, 7
    s_add_u32 s13, s13, 60817408
    s_add_u32 s26, s4, s13
    s_addc_u32 s27, s5, 0
    s_add_u32 s90, s26, 65536
    s_addc_u32 s91, s27, 0
    s_add_u32 s92, s26, 131072
    s_addc_u32 s93, s27, 0
    s_add_u32 s94, s26, 196608
    s_addc_u32 s95, s27, 0
    s_lshl_b32 s13, s12, 8
    s_add_u32 s13, s13, 61079552
    s_add_u32 s42, s4, s13
    s_addc_u32 s43, s5, 0
    s_add_u32 s30, s4, 61865984
    s_addc_u32 s31, s5, 0
    s_mov_b32 s46, 0x3e0293ee
    s_bfe_u32 s40, s9, 0x10003
    s_lshl_b32 s12, s9, 14
    s_add_u32 s12, s12, 16777216
    s_add_u32 s88, s4, s12
    s_addc_u32 s89, s5, 0
    s_lshl_b32 s13, s10, 11
    s_add_u32 s32, s88, s13
    s_addc_u32 s33, s89, 0
    s_add_u32 s86, s32, 8192
    s_addc_u32 s87, s33, 0
    s_lshl_b32 s12, s9, 12
    s_add_u32 s12, s12, 50331648
    s_add_u32 s50, s4, s12
    s_addc_u32 s51, s5, 0
    s_lshl_b32 s12, s9, 7
    s_add_u32 s12, s12, 69632
    s_add_u32 s18, s4, s12
    s_addc_u32 s19, s5, 0
    s_lshl_b32 s12, s9, 2
    s_add_u32 s12, s12, 98304
    s_add_u32 s52, s4, s12
    s_addc_u32 s53, s5, 0
    s_lshl_b32 s12, s9, 7
    s_add_u32 s12, s12, 98304
    s_add_u32 s22, s4, s12
    s_addc_u32 s23, s5, 0
    s_lshl_b32 s62, s10, 11
    s_add_u32 s62, s62, 9216
    s_lshl_b32 s63, s10, 10
    s_add_u32 s57, s63, 0
    s_add_u32 s63, s63, 17408
    s_mov_b32 s24, 0
    s_mov_b32 s34, 9216
    s_mov_b32 s35, 0
    s_mul_i32 s12, s9, 9216
    s_add_u32 s12, s12, 60817408
    v_lshl_add_u32 v12, v0, 2, s12
    s_lshl_b32 s12, s9, 10
    s_add_u32 s12, s12, 61865984
    v_add_u32 v13, s12, v2
    s_mov_b32 m0, 32256
    s_nop 0
    global_load_lds_dword v12, s[4:5] sc1
    global_load_lds_dword v13, s[4:5] sc1
    s_mov_b32 s25, 1
    s_cmp_lt_u32 s25, s54
    s_cbranch_scc1 L_kvok_48
    s_mov_b32 s55, 0
    v_bfe_u32 v12, v2, 2, 4
L_kvp_49:
    global_load_dword v13, v12, s[18:19] sc1
    s_add_u32 s55, s55, 1
    s_cmp_gt_u32 s55, 100000
    s_cbranch_scc1 L_exit
    s_waitcnt vmcnt(0)
    v_min_u32_dpp v13, v13, v13 quad_perm:[1,0,3,2] row_mask:0xf bank_mask:0xf
    s_nop 1
    v_min_u32_dpp v13, v13, v13 quad_perm:[2,3,0,1] row_mask:0xf bank_mask:0xf
    s_nop 0
    v_readfirstlane_b32 s54, v13
    s_cmp_lt_u32 s25, s54
    s_cbranch_scc1 L_kvok_48
    s_sleep 4
    s_branch L_kvp_49
L_kvok_48:
    v_lshlrev_b32 v12, 2, v0
    global_load_lds_dword v12, s[88:89]
    s_add_u32 s38, s4, 163840
    s_addc_u32 s39, s5, 0
    s_add_u32 s58, s88, 524288
    s_addc_u32 s59, s89, 0
    s_cmp_eq_u32 s11, 0
    s_cbranch_scc1 L_r_slow
    s_cmp_eq_u32 s10, 1
    s_cbranch_scc1 L_rent_f1
    s_cmp_eq_u32 s10, 2
    s_cbranch_scc1 L_rent_f2
    s_cmp_eq_u32 s10, 3
    s_cbranch_scc1 L_rent_f3
L_rent_f0:
    ds_read_b128 v[40:43], v0 offset:32768
    ds_read_b128 v[44:47], v0 offset:36864
    ds_read_b128 v[48:51], v0 offset:40960
    ds_read_b128 v[52:55], v0 offset:45056
    ds_read_b128 v[56:59], v0 offset:49152
    ds_read_b128 v[60:63], v0 offset:53248
    ds_read_b128 v[28:31], v2 offset:8192
    ds_read_b128 v[32:35], v2 offset:0
    ds_read_b128 v[8:11], v2 offset:7168
    v_mov_b64 v[12:13], 0
    v_mov_b64 v[14:15], 0
    v_mov_b64 v[16:17], 0
    v_mov_b64 v[18:19], 0
    v_mov_b64 v[20:21], 0
    v_mov_b64 v[22:23], 0
    v_mov_b64 v[24:25], 0
    v_mov_b64 v[26:27], 0
    s_mov_b32 m0, s62
    s_mov_b32 s55, 0
    s_mov_b32 s47, s40
    s_mov_b64 s[20:21], s[30:31]
    s_waitcnt lgkmcnt(0)
    v_smfmac_f32_16x16x64_bf16 v[12:15], v[28:31], a[128:135], v7
    v_smfmac_f32_16x16x64_bf16 v[16:19], v[28:31], a[136:143], v7
    s_branch L_rgo_f0
.p2align 6
L_rp2_f0:
    s_waitcnt vmcnt(2)
    v_smfmac_f32_16x16x64_bf16 v[12:15], v[28:31], a[128:135], v7
    v_max_u32 v1, v28, v30
    s_waitcnt vmcnt(1)
    v_max3_u32 v1, v1, v32, v34
    s_waitcnt vmcnt(0)
    v_max3_u32 v1, v1, v8, v10
    v_cmp_eq_u32 vcc, -1, v1
    v_smfmac_f32_16x16x64_bf16 v[16:19], v[28:31], a[136:143], v7
    ds_write_b128 v2, v[28:31] offset:8192
    s_cbranch_vccnz L_rf2_f0
L_rgo_f0:
    ds_write_b128 v2, v[32:35] offset:0
    s_waitcnt lgkmcnt(2)
    v_smfmac_f32_16x16x64_bf16 v[20:23], v[28:31], v[40:47], v7
    ds_write_b128 v2, v[8:11] offset:7168
    ds_read_b128 v[40:43], v0 offset:57344
    v_smfmac_f32_16x16x64_bf16 v[24:27], v[28:31], v[48:55], v7
    v_mov_b64 v[8:9], 0
    v_mov_b64 v[10:11], 0
    ds_read_b128 v[44:47], v0 offset:61440
    v_smfmac_f32_16x16x64_bf16 v[12:15], v[32:35], a[0:7], v7
    s_waitcnt lgkmcnt(2)
    s_barrier
    ds_read_b128 v[28:31], v2 offset:1024
    v_smfmac_f32_16x16x64_bf16 v[20:23], v[32:35], v[56:63], v7
    global_load_lds_dwordx4 v2, s[32:33]
    v_add_u32 v1, 0x10000, v0
    v_smfmac_f32_16x16x64_bf16 v[16:19], v[32:35], a[8:15], v7
    global_load_lds_dwordx4 v2, s[32:33] offset:1024
    s_mov_b32 m0, s63
    ds_read_b128 v[48:51], v1 offset:0
    v_smfmac_f32_16x16x64_bf16 v[8:11], v[32:35], a[144:151], v7
    global_load_lds_dwordx4 v2, s[86:87]
    s_add_u32 m0, s63, 3072
    ds_read_b128 v[52:55], v1 offset:4096
    s_waitcnt lgkmcnt(3)
    v_smfmac_f32_16x16x64_bf16 v[24:27], v[32:35], v[40:47], v7
    global_load_lds_dwordx4 v2, s[86:87] offset:1024
    s_mov_b32 m0, 32256
    ds_read_b128 v[32:35], v2 offset:2048
    s_waitcnt lgkmcnt(3)
    v_smfmac_f32_16x16x64_bf16 v[12:15], v[28:31], a[16:23], v7
    ds_read_b128 v[56:59], v1 offset:8192
    ds_read_b128 v[60:63], v1 offset:12288
    s_waitcnt lgkmcnt(3)
    v_smfmac_f32_16x16x64_bf16 v[20:23], v[28:31], v[48:55], v7
    global_store_dwordx4 v0, v[36:39], s[38:39] sc1
    ds_read_b128 v[40:43], v1 offset:16384
    v_smfmac_f32_16x16x64_bf16 v[16:19], v[28:31], a[24:31], v7
    ds_read_b128 v[44:47], v1 offset:20480
    ds_read_b128 v[48:51], v1 offset:24576
    v_smfmac_f32_16x16x64_bf16 v[8:11], v[28:31], a[160:167], v7
    v_lshlrev_b32 v36, 2, v0
    global_load_lds_dword v36, s[58:59]
    s_mov_b32 m0, 25856
    v_mov_b64 v[36:37], 0
    v_mov_b64 v[38:39], 0
    s_waitcnt lgkmcnt(3)
    v_smfmac_f32_16x16x64_bf16 v[24:27], v[28:31], v[56:63], v7
    ds_read_b128 v[28:31], v2 offset:3072
    ds_read_b128 v[52:55], v1 offset:28672
    v_smfmac_f32_16x16x64_bf16 v[12:15], v[32:35], a[32:39], v7
    ds_read_b128 v[56:59], v1 offset:32768
    ds_read_b128 v[60:63], v1 offset:36864
    s_waitcnt lgkmcnt(5)
    v_smfmac_f32_16x16x64_bf16 v[20:23], v[32:35], v[40:47], v7
    ds_read_b128 v[40:43], v1 offset:40960
    ds_read_b128 v[44:47], v1 offset:45056
    v_smfmac_f32_16x16x64_bf16 v[16:19], v[32:35], a[40:47], v7
    v_smfmac_f32_16x16x64_bf16 v[8:11], v[32:35], a[176:183], v7
    v_smfmac_f32_16x16x64_bf16 v[36:39], v[32:35], a[184:191], v7
    s_waitcnt lgkmcnt(4)
    v_smfmac_f32_16x16x64_bf16 v[24:27], v[32:35], v[48:55], v7
    ds_read_b128 v[32:35], v2 offset:4096
    ds_read_b128 v[48:51], v1 offset:49152
    v_smfmac_f32_16x16x64_bf16 v[12:15], v[28:31], a[48:55], v7
    ds_read_b128 v[52:55], v1 offset:53248
    s_waitcnt lgkmcnt(5)
    v_smfmac_f32_16x16x64_bf16 v[20:23], v[28:31], v[56:63], v7
    ds_read_b128 v[56:59], v1 offset:57344
    ds_read_b128 v[60:63], v1 offset:61440
    v_smfmac_f32_16x16x64_bf16 v[16:19], v[28:31], a[56:63], v7
    v_smfmac_f32_16x16x64_bf16 v[8:11], v[28:31], a[192:199], v7
    v_smfmac_f32_16x16x64_bf16 v[36:39], v[28:31], a[200:207], v7
    s_waitcnt lgkmcnt(5)
    v_smfmac_f32_16x16x64_bf16 v[24:27], v[28:31], v[40:47], v7
    ds_read_b128 v[28:31], v2 offset:5120
    v_add_u32 v1, 0x20000, v0
    s_waitcnt lgkmcnt(5)
    v_smfmac_f32_16x16x64_bf16 v[12:15], v[32:35], a[64:71], v7
    ds_read_b128 v[40:43], v1 offset:0
    ds_read_b128 v[44:47], v1 offset:4096
    s_waitcnt lgkmcnt(5)
    v_smfmac_f32_16x16x64_bf16 v[20:23], v[32:35], v[48:55], v7
    ds_read_b128 v[48:51], v1 offset:8192
    ds_read_b128 v[52:55], v1 offset:12288
    v_smfmac_f32_16x16x64_bf16 v[16:19], v[32:35], a[72:79], v7
    v_smfmac_f32_16x16x64_bf16 v[8:11], v[32:35], a[208:215], v7
    v_smfmac_f32_16x16x64_bf16 v[36:39], v[32:35], a[216:223], v7
    s_waitcnt lgkmcnt(5)
    v_smfmac_f32_16x16x64_bf16 v[24:27], v[32:35], v[56:63], v7
    ds_read_b128 v[32:35], v2 offset:6144
    ds_read_b128 v[56:59], v1 offset:16384
    s_waitcnt lgkmcnt(6)
    v_smfmac_f32_16x16x64_bf16 v[12:15], v[28:31], a[80:87], v7
    ds_read_b128 v[60:63], v1 offset:20480
    s_waitcnt lgkmcnt(5)
    v_smfmac_f32_16x16x64_bf16 v[20:23], v[28:31], v[40:47], v7
    ds_read_b128 v[40:43], v1 offset:24576
    ds_read_b128 v[44:47], v1 offset:28672
    v_smfmac_f32_16x16x64_bf16 v[16:19], v[28:31], a[88:95], v7
    s_waitcnt vmcnt(4)
    s_barrier
    v_smfmac_f32_16x16x64_bf16 v[8:11], v[28:31], a[224:231], v7
    v_smfmac_f32_16x16x64_bf16 v[36:39], v[28:31], a[232:239], v7
    s_waitcnt lgkmcnt(5)
    v_smfmac_f32_16x16x64_bf16 v[24:27], v[28:31], v[48:55], v7
    ds_read_b128 v[28:31], v2 offset:7168
    ds_read_b128 v[48:51], v2 offset:9216
    s_waitcnt lgkmcnt(6)
    v_smfmac_f32_16x16x64_bf16 v[12:15], v[32:35], a[96:103], v7
    ds_read_b128 v[52:55], v2 offset:13312
    s_waitcnt lgkmcnt(5)
    v_smfmac_f32_16x16x64_bf16 v[20:23], v[32:35], v[56:63], v7
    ds_read_b128 v[56:59], v2 offset:10240
    ds_read_b128 v[60:63], v2 offset:14336
    v_smfmac_f32_16x16x64_bf16 v[16:19], v[32:35], a[104:111], v7
    v_smfmac_f32_16x16x64_bf16 v[8:11], v[32:35], a[240:247], v7
    s_waitcnt lgkmcnt(5)
    v_smfmac_f32_16x16x64_bf16 v[24:27], v[32:35], v[40:47], v7
    ds_read_b128 v[40:43], v2 offset:1024
    ds_read_b128 v[44:47], v2 offset:0
    s_waitcnt lgkmcnt(6)
    v_smfmac_f32_16x16x64_bf16 v[12:15], v[28:31], a[112:119], v7
    v_smfmac_f32_16x16x64_bf16 v[16:19], v[28:31], a[120:127], v7
    v_smfmac_f32_16x16x64_bf16 v[20:23], v[28:31], v[240:247], v7
    v_smfmac_f32_16x16x64_bf16 v[24:27], v[28:31], v[248:255], v7
    v_mov_b32 v1, s47
    v_smfmac_f32_16x16x64_bf16 v[8:11], v[28:31], v[64:71], v7
    s_cmp_eq_u32 s24, 63
    s_cbranch_scc1 L_rlast_f0
    s_nop 0
    v_add_f32 v12, v12, v13
    v_add_f32 v14, v14, v15
    v_add_f32 v16, v16, v17
    v_add_f32 v18, v18, v19
    v_cvt_pk_bf16_f32 v13, v12, v16
    v_cvt_pk_bf16_f32 v15, v14, v18
    ds_write2_b32 v5, v13, v15 offset0:0 offset1:72
    v_add_f32 v20, v20, v21
    v_add_f32 v22, v22, v23
    v_add_f32 v24, v24, v25
    v_add_f32 v26, v26, v27
    v_cvt_pk_bf16_f32 v21, v20, v24
    v_cvt_pk_bf16_f32 v23, v22, v26
    ds_write_b32 v5, v21 offset:2304
    ds_write_b32 v5, v23 offset:2592
    ds_read_b128 v[24:27], v4 offset:0
    v_smfmac_f32_16x16x64_bf16 v[36:39], v[28:31], v[72:79], v7
    ds_read_b128 v[28:31], v4 offset:2304
    v_smfmac_f32_16x16x64_bf16 v[36:39], v[32:35], a[248:255], v7
    ds_read_b128 v[32:35], v2 offset:8192
    s_waitcnt lgkmcnt(7)
    v_smfmac_f32_16x16x64_bf16 v[36:39], v[40:43], a[168:175], v7
    s_waitcnt lgkmcnt(6)
    v_smfmac_f32_16x16x64_bf16 v[36:39], v[44:47], a[152:159], v7
    s_waitcnt lgkmcnt(3)
    s_barrier
    ds_read_b128 v[40:43], v4 offset:64
    ds_read_b128 v[44:47], v4 offset:2368
    s_waitcnt lgkmcnt(4)
    v_mfma_f32_16x16x32_bf16 v[12:15], v[48:51], v[24:27], 0
    ds_read_b128 v[48:51], v4 offset:128
    v_mfma_f32_16x16x32_bf16 v[16:19], v[52:55], v[24:27], 0
    ds_read_b128 v[52:55], v2 offset:11264
    s_waitcnt lgkmcnt(5)
    v_mfma_f32_16x16x32_bf16 v[20:23], v[28:31], v[24:27], 0
    ds_read_b128 v[28:31], v2 offset:15360
    ds_read_b128 v[24:27], v4 offset:2432
    s_waitcnt lgkmcnt(5)
    v_mfma_f32_16x16x32_bf16 v[12:15], v[56:59], v[40:43], v[12:15]
    ds_read_b128 v[56:59], v4 offset:192
    v_mfma_f32_16x16x32_bf16 v[16:19], v[60:63], v[40:43], v[16:19]
    ds_read_b128 v[60:63], v2 offset:12288
    s_waitcnt lgkmcnt(6)
    v_mfma_f32_16x16x32_bf16 v[20:23], v[44:47], v[40:43], v[20:23]
    ds_read_b128 v[44:47], v2 offset:16384
    ds_read_b128 v[40:43], v4 offset:2496
    s_waitcnt lgkmcnt(6)
    v_mfma_f32_16x16x32_bf16 v[12:15], v[52:55], v[48:51], v[12:15]
    s_waitcnt vmcnt(2)
    ds_read_b128 v[52:55], v0 offset:17408
    s_waitcnt lgkmcnt(6)
    v_mfma_f32_16x16x32_bf16 v[16:19], v[28:31], v[48:51], v[16:19]
    ds_read_b128 v[28:31], v0 offset:21504
    s_waitcnt lgkmcnt(6)
    v_mfma_f32_16x16x32_bf16 v[20:23], v[24:27], v[48:51], v[20:23]
    s_waitcnt lgkmcnt(4)
    v_mfma_f32_16x16x32_bf16 v[12:15], v[60:63], v[56:59], v[12:15]
    s_waitcnt lgkmcnt(3)
    v_mfma_f32_16x16x32_bf16 v[16:19], v[44:47], v[56:59], v[16:19]
    s_waitcnt lgkmcnt(2)
    v_mfma_f32_16x16x32_bf16 v[20:23], v[40:43], v[56:59], v[20:23]
    v_smfmac_f32_16x16x64_bf16 v[36:39], v[32:35], v[88:95], v7
    v_smfmac_f32_16x16x64_bf16 v[8:11], v[32:35], v[80:87], v7
    v_mov_b32 v49, 0
    v_mov_b32 v50, 0
    s_nop 1
    v_mov_b32_dpp v12, v16 quad_perm:[0,1,2,3] row_mask:0xf bank_mask:0xc
    v_mov_b32_dpp v13, v17 quad_perm:[0,1,2,3] row_mask:0xf bank_mask:0xc
    v_mov_b32_dpp v14, v18 quad_perm:[0,1,2,3] row_mask:0xf bank_mask:0xc
    v_mov_b32_dpp v15, v19 quad_perm:[0,1,2,3] row_mask:0xf bank_mask:0xc
    v_mov_b32_dpp v22, v23 quad_perm:[0,1,2,3] row_mask:0xf bank_mask:0xc
    v_mov_b32_dpp v20, v21 quad_perm:[0,1,2,3] row_mask:0x3 bank_mask:0xc
    v_max3_f32 v16, v12, v13, v14
    v_add_f32 v36, v36, v37
    v_mov_b32_dpp v20, v22 quad_perm:[0,1,2,3] row_mask:0xc bank_mask:0xf
    v_max3_f32 v16, v16, v15, v20
    v_pk_mul_f32 v[12:13], v[12:13], s[46:47] op_sel_hi:[1,0]
    v_pk_mul_f32 v[14:15], v[14:15], s[46:47] op_sel_hi:[1,0]
    v_max_f32_dpp v16, v16, v16 row_ror:8 row_mask:0xf bank_mask:0xf
    v_mov_b32 v17, v16
    v_mul_f32 v20, s46, v20
    v_add_f32 v38, v38, v39
    v_permlane16_swap_b32 v16, v17
    v_max_f32 v16, v16, v17
    v_mov_b32 v17, v16
    v_add_f32 v8, v8, v9
    v_add_f32 v10, v10, v11
    v_cvt_pk_bf16_f32 v22, v8, v10
    v_cvt_pk_bf16_f32 v23, v36, v38
    v_permlane32_swap_b32 v16, v17
    v_max_f32 v16, v16, v17
    v_mul_f32 v16, s46, v16
    v_sub_f32 v12, v12, v16
    v_sub_f32 v13, v13, v16
    v_sub_f32 v14, v14, v16
    v_sub_f32 v15, v15, v16
    v_sub_f32 v20, v20, v16
    v_exp_f32 v12, v12
    v_exp_f32 v13, v13
    v_exp_f32 v14, v14
    v_exp_f32 v15, v15
    v_cvt_pk_bf16_f32 v24, v12, v13
    v_cvt_pk_bf16_f32 v25, v14, v15
    v_exp_f32 v20, v20
    v_mov_b32_dpp v26, v24 row_ror:8 row_mask:0xf bank_mask:0xf
    v_mov_b32_dpp v27, v25 row_ror:8 row_mask:0xf bank_mask:0xf
    v_mov_b32_dpp v21, v20 row_ror:8 row_mask:0xf bank_mask:0xf
    v_add_f32 v18, v12, v13
    s_waitcnt lgkmcnt(0)
    v_mfma_f32_16x16x32_bf16 v[60:63], v[52:55], v[24:27], 0
    v_cvt_pk_bf16_f32 v48, v20, v21
    v_add_f32 v17, v14, v15
    v_mfma_f32_16x16x32_bf16 v[44:47], v[28:31], v[24:27], 0
    v_add_f32 v18, v18, v20
    v_add_f32 v18, v18, v17
    v_cvt_pk_bf16_f32 v51, v20, v21
    v_mfma_f32_16x16x16_bf16 v[60:63], v[22:23], v[48:49], v[60:63]
    v_add_f32_dpp v18, v18, v18 row_ror:8 row_mask:0xf bank_mask:0xf
    v_mov_b32 v17, v18
    v_mfma_f32_16x16x16_bf16 v[44:47], v[22:23], v[50:51], v[44:47]
    v_lshrrev_b32 v9, 2, v2
    v_permlane16_swap_b32 v18, v17
    v_add_f32 v18, v18, v17
    v_mov_b32 v17, v18
    v_and_b32 v8, 0x300, v2
    v_bfe_u32 v10, v2, 1, 7
    v_permlane32_swap_b32 v18, v17
    v_add_f32 v18, v18, v17
    v_rcp_f32 v18, v18
    v_lshl_or_b32 v8, v8, 4, v10
    v_pk_mul_f32 v[60:61], v[60:61], v[18:19] op_sel_hi:[1,0]
    v_pk_mul_f32 v[62:63], v[62:63], v[18:19] op_sel_hi:[1,0]
    v_pk_mul_f32 v[44:45], v[44:45], v[18:19] op_sel_hi:[1,0]
    v_pk_mul_f32 v[46:47], v[46:47], v[18:19] op_sel_hi:[1,0]
    v_cvt_pk_bf16_f32 v12, v60, v61
    v_cvt_pk_bf16_f32 v13, v62, v63
    v_cvt_pk_bf16_f32 v14, v44, v45
    v_cvt_pk_bf16_f32 v15, v46, v47
    ds_write_b128 v6, v[12:15]
    v_mov_b64 v[10:11], 0
    s_nop 1
    v_mfma_f32_32x32x8_bf16 v[28:43], v[10:11], v[10:11], 0
    v_mfma_f32_32x32x8_bf16 v[44:59], v[10:11], v[10:11], 0
    s_waitcnt lgkmcnt(0)
    s_barrier
    ds_read_b128 v[12:15], v3 offset:30208
    ds_read_b128 v[16:19], v3 offset:31232
    v_mov_b64 v[60:61], 0
    ds_write2_b32 v5, v22, v23 offset0:0 offset1:72
    v_mov_b64 v[62:63], 0
    s_waitcnt lgkmcnt(2)
    s_nop 0
    v_smfmac_f32_16x16x64_bf16 v[28:31], v[12:15], v[224:231], v7
    s_waitcnt lgkmcnt(1)
    v_smfmac_f32_16x16x64_bf16 v[28:31], v[16:19], v[232:239], v7
    s_nop 1
    v_smfmac_f32_16x16x64_bf16 v[32:35], v[12:15], v[96:103], v7
    s_nop 1
    v_smfmac_f32_16x16x64_bf16 v[32:35], v[16:19], v[104:111], v7
    s_nop 1
    v_smfmac_f32_16x16x64_bf16 v[36:39], v[12:15], v[112:119], v7
    v_add_f32 v28, v28, v29
    v_add_f32 v29, v30, v31
    v_smfmac_f32_16x16x64_bf16 v[36:39], v[16:19], v[120:127], v7
    v_cvt_pk_bf16_f32 v30, v28, v29
    v_bfi_b32 v30, 1, v1, v30
    global_store_dword v9, v30, s[42:43]
    v_smfmac_f32_16x16x64_bf16 v[40:43], v[12:15], v[128:135], v7
    v_add_f32 v32, v32, v33
    v_add_f32 v33, v34, v35
    v_smfmac_f32_16x16x64_bf16 v[40:43], v[16:19], v[136:143], v7
    s_nop 1
    v_smfmac_f32_16x16x64_bf16 v[44:47], v[12:15], v[144:151], v7
    v_add_f32 v36, v36, v37
    v_add_f32 v37, v38, v39
    v_smfmac_f32_16x16x64_bf16 v[44:47], v[16:19], v[152:159], v7
    v_cvt_pk_bf16_f32 v38, v32, v36
    v_cvt_pk_bf16_f32 v39, v33, v37
    v_bfi_b32 v38, 1, v1, v38
    v_smfmac_f32_16x16x64_bf16 v[48:51], v[12:15], v[160:167], v7
    global_store_dwordx2 v8, v[38:39], s[26:27]
    v_add_f32 v40, v40, v41
    v_add_f32 v41, v42, v43
    v_smfmac_f32_16x16x64_bf16 v[48:51], v[16:19], v[168:175], v7
    v_add_f32 v44, v44, v45
    v_add_f32 v45, v46, v47
    v_smfmac_f32_16x16x64_bf16 v[52:55], v[12:15], v[176:183], v7
    v_cvt_pk_bf16_f32 v46, v40, v44
    v_cvt_pk_bf16_f32 v47, v41, v45
    v_bfi_b32 v46, 1, v1, v46
    v_smfmac_f32_16x16x64_bf16 v[52:55], v[16:19], v[184:191], v7
    global_store_dwordx2 v8, v[46:47], s[90:91]
    v_add_f32 v48, v48, v49
    v_smfmac_f32_16x16x64_bf16 v[56:59], v[12:15], v[192:199], v7
    v_add_f32 v49, v50, v51
    v_smfmac_f32_16x16x64_bf16 v[56:59], v[16:19], v[200:207], v7
    s_nop 1
    v_smfmac_f32_16x16x64_bf16 v[60:63], v[12:15], v[208:215], v7
    v_add_f32 v52, v52, v53
    v_add_f32 v53, v54, v55
    v_smfmac_f32_16x16x64_bf16 v[60:63], v[16:19], v[216:223], v7
    v_cvt_pk_bf16_f32 v54, v48, v52
    v_cvt_pk_bf16_f32 v55, v49, v53
    v_bfi_b32 v54, 1, v1, v54
    global_store_dwordx2 v8, v[54:55], s[92:93]
    v_add_f32 v56, v56, v57
    v_add_f32 v57, v58, v59
    s_nop 1
    v_add_f32 v60, v60, v61
    v_add_f32 v61, v62, v63
    v_cvt_pk_bf16_f32 v62, v56, v60
    v_cvt_pk_bf16_f32 v63, v57, v61
    v_bfi_b32 v62, 1, v1, v62
    global_store_dwordx2 v8, v[62:63], s[94:95]
    s_lshl_b32 s13, s24, 17
    s_add_u32 s38, s50, s13
    s_addc_u32 s39, s51, 0
    s_add_u32 s25, s24, 2
    s_min_u32 s25, s25, 63
    s_lshl_b32 s13, s25, 19
    s_add_u32 s58, s88, s13
    s_addc_u32 s59, s89, 0
    s_add_u32 s86, s86, 524288
    s_addc_u32 s87, s87, 0
    s_add_u32 s32, s32, 524288
    s_addc_u32 s33, s33, 0
    s_add_u32 s14, s30, s34
    s_addc_u32 s15, s31, 0
    s_add_u32 s60, s30, s35
    s_addc_u32 s61, s31, 0
    s_add_u32 s20, s14, 4096
    s_addc_u32 s21, s15, 0
    s_add_u32 s16, s14, 8192
    s_addc_u32 s17, s15, 0
    s_and_b32 s12, s24, 1
    s_xor_b32 s13, s12, 1
    s_xor_b32 s47, s13, s40
    s_add_u32 s24, s24, 1
    s_mov_b32 s35, s34
    s_add_u32 s34, s34, 9216
    s_cmp_eq_u32 s34, 27648
    s_cselect_b32 s34, 0, s34
    s_mov_b32 s55, 0
    ds_read_b128 v[40:43], v0 offset:32768
    ds_read_b128 v[44:47], v0 offset:36864
    ds_read_b128 v[48:51], v0 offset:40960
    ds_read_b128 v[52:55], v0 offset:45056
    ds_read_b128 v[56:59], v0 offset:49152
    ds_read_b128 v[60:63], v0 offset:53248
    s_waitcnt vmcnt(1)
    global_load_dwordx4 v[24:27], v2, s[28:29] offset:0 sc1
    global_load_dwordx4 v[28:31], v2, s[28:29] offset:1024 sc1
    global_load_dwordx4 v[32:35], v2, s[28:29] offset:2048 sc1
    global_load_dwordx4 v[36:39], v2, s[28:29] offset:3072 sc1
    v_bfe_u32 v20, v2, 4, 1
    v_bfe_u32 v21, v2, 5, 1
    v_bfe_u32 v22, v2, 6, 1
    v_lshl_add_u32 v22, v21, 1, v22
    v_lshlrev_b32 v20, 4, v20
    v_mov_b32 v21, 0x3f80
    v_lshlrev_b32 v21, v20, v21
    v_cmp_eq_u32 vcc, 0, v22
    v_mov_b32 v8, 0x0
    v_bfe_u32 v10, v2, 4, 2
    v_cndmask_b32 v12, 0, v21, vcc
    v_cmp_eq_u32 vcc, 1, v22
    v_lshlrev_b32 v10, 3, v10
    v_xor_b32 v8, v8, v10
    v_cndmask_b32 v13, 0, v21, vcc
    v_cmp_eq_u32 vcc, 2, v22
    v_bfe_u32 v10, v2, 6, 1
    v_lshlrev_b32 v10, 8, v10
    v_cndmask_b32 v14, 0, v21, vcc
    v_cmp_eq_u32 vcc, 3, v22
    v_xor_b32 v8, v8, v10
    v_bfe_u32 v10, v2, 8, 1
    v_cndmask_b32 v15, 0, v21, vcc
    v_lshlrev_b32 v10, 5, v10
    v_xor_b32 v8, v8, v10
    v_xor_b32 v8, s41, v8
    v_mov_b64 v[10:11], -1
L_rp1_f0:
    s_waitcnt vmcnt(3)
    v_mfma_f32_16x16x32_bf16 v[16:19], v[12:15], v[24:27], 0
    v_bitop3_b32 v20, v24, v26, s12 bitop3:0x7e
    s_waitcnt vmcnt(2)
    v_mfma_f32_16x16x32_bf16 v[16:19], v[12:15], v[28:31], v[16:19]
    v_bitop3_b32 v21, v28, v30, s13 bitop3:0x7e
    s_waitcnt vmcnt(1)
    v_mfma_f32_16x16x32_bf16 v[16:19], v[12:15], v[32:35], v[16:19]
    v_bitop3_b32 v22, v32, v34, s12 bitop3:0x7e
    v_or3_b32 v20, v20, v21, v22
    s_waitcnt vmcnt(0)
    v_mfma_f32_16x16x32_bf16 v[16:19], v[12:15], v[36:39], v[16:19]
    v_bitop3_b32 v23, v36, v38, s13 bitop3:0x7e
    v_bitop3_b32 v20, v20, v23, 1 bitop3:0xa8
    v_cmp_ne_u32 vcc, 0, v20
    s_nop 4
    v_add_f32_dpp v16, v16, v16 row_ror:8 row_mask:0xf bank_mask:0xf
    v_add_f32_dpp v17, v17, v17 row_ror:8 row_mask:0xf bank_mask:0xf
    v_add_f32_dpp v18, v18, v18 row_ror:8 row_mask:0xf bank_mask:0xf
    v_add_f32_dpp v19, v19, v19 row_ror:8 row_mask:0xf bank_mask:0xf
    v_cvt_pk_bf16_f32 v20, v16, v17
    v_cvt_pk_bf16_f32 v21, v18, v19
    s_mov_b64 exec, s[44:45]
    s_cbranch_vccnz L_rp1_f0_rt
    global_store_dwordx2 v8, v[20:21], s[14:15]
    global_store_dwordx2 v8, v[10:11], s[60:61]
    s_mov_b64 exec, -1
    s_barrier
    s_mov_b32 s55, 0
    ds_read_b32 v36, v5 offset:2304
    ds_read_b32 v37, v5 offset:2592
    ds_read2_b32 v[38:39], v5 offset0:0 offset1:72
    v_mov_b64 v[12:13], 0
    v_mov_b64 v[14:15], 0
    v_mov_b64 v[16:17], 0
    v_mov_b64 v[18:19], 0
    v_mov_b64 v[20:21], 0
    v_mov_b64 v[22:23], 0
    v_mov_b64 v[24:25], 0
    v_mov_b64 v[26:27], 0
    global_load_dwordx4 v[28:31], v2, s[16:17] sc1
    global_load_dwordx4 v[32:35], v2, s[20:21] offset:-4096 sc1
    global_load_dwordx4 v[8:11], v2, s[20:21] offset:3072 sc1
    s_mov_b32 m0, s62
    s_branch L_rp2_f0
L_rf2_f0:
    s_mov_b64 exec, vcc
    global_load_dwordx4 v[28:31], v2, s[16:17] sc1
    global_load_dwordx4 v[32:35], v2, s[20:21] offset:-4096 sc1
    global_load_dwordx4 v[8:11], v2, s[20:21] offset:3072 sc1
    s_mov_b64 exec, -1
    v_mov_b64 v[12:13], 0
    v_mov_b64 v[14:15], 0
    v_mov_b64 v[16:17], 0
    v_mov_b64 v[18:19], 0
    s_add_u32 s55, s55, 1
    s_cmp_gt_u32 s55, 100000
    s_cbranch_scc0 L_rp2_f0
    s_branch L_rx_f0
L_rp1_f0_rt:
    s_mov_b64 exec, vcc
    global_load_dwordx4 v[24:27], v2, s[28:29] offset:0 sc1
    global_load_dwordx4 v[28:31], v2, s[28:29] offset:1024 sc1
    global_load_dwordx4 v[32:35], v2, s[28:29] offset:2048 sc1
    global_load_dwordx4 v[36:39], v2, s[28:29] offset:3072 sc1
    s_mov_b64 exec, -1
    s_cmp_le_u32 s55, 2
    s_cbranch_scc1 L_bo_50
    s_sleep 4
L_bo_50:
    s_add_u32 s55, s55, 1
    s_cmp_gt_u32 s55, 100000
    s_cbranch_scc0 L_rp1_f0
    s_branch L_rx_f0
L_rp2ok_f0:
    s_branch L_rp2_f0
L_rlast_f0:
    s_lshl_b32 s13, s24, 17
    s_add_u32 s38, s50, s13
    s_addc_u32 s39, s51, 0
    s_waitcnt lgkmcnt(0)
    ds_read_b128 v[12:15], v2 offset:8192
    v_smfmac_f32_16x16x64_bf16 v[36:39], v[28:31], v[72:79], v7
    v_smfmac_f32_16x16x64_bf16 v[36:39], v[32:35], a[248:255], v7
    v_smfmac_f32_16x16x64_bf16 v[36:39], v[40:43], a[168:175], v7
    v_smfmac_f32_16x16x64_bf16 v[36:39], v[44:47], a[152:159], v7
    s_waitcnt lgkmcnt(0)
    v_smfmac_f32_16x16x64_bf16 v[36:39], v[12:15], v[88:95], v7
    v_smfmac_f32_16x16x64_bf16 v[8:11], v[12:15], v[80:87], v7
    v_add_f32 v20, v20, v21
    v_add_f32 v22, v22, v23
    v_add_f32 v24, v24, v25
    v_add_f32 v26, v26, v27
    v_cvt_pk_bf16_f32 v16, v20, v24
    v_cvt_pk_bf16_f32 v17, v22, v26
    s_nop 0
    v_add_f32 v36, v36, v37
    v_add_f32 v38, v38, v39
    v_add_f32 v8, v8, v9
    v_add_f32 v10, v10, v11
    v_cvt_pk_bf16_f32 v18, v8, v10
    v_cvt_pk_bf16_f32 v19, v36, v38
    global_store_dwordx4 v0, v[16:19], s[38:39] sc1
L_rx_f0:
    s_endpgm
L_rent_f1:
    v_add_u32 v1, 0x10000, v0
    ds_read_b128 v[40:43], v1 offset:0
    ds_read_b128 v[44:47], v1 offset:4096
    v_add_u32 v1, 0x10000, v0
    ds_read_b128 v[48:51], v1 offset:8192
    ds_read_b128 v[52:55], v1 offset:12288
    v_add_u32 v1, 0x10000, v0
    ds_read_b128 v[56:59], v1 offset:16384
    ds_read_b128 v[60:63], v1 offset:20480
    ds_read_b128 v[28:31], v2 offset:1024
    ds_read_b128 v[32:35], v2 offset:2048
    v_mov_b64 v[8:9], 0
    v_mov_b64 v[10:11], 0
    v_mov_b64 v[12:13], 0
    v_mov_b64 v[14:15], 0
    v_mov_b64 v[16:17], 0
    v_mov_b64 v[18:19], 0
    v_mov_b64 v[20:21], 0
    v_mov_b64 v[22:23], 0
    v_mov_b64 v[24:25], 0
    v_mov_b64 v[26:27], 0
    s_mov_b32 m0, s62
    s_mov_b32 s55, 0
    s_mov_b32 s47, s40
    s_mov_b64 s[20:21], s[30:31]
    s_waitcnt lgkmcnt(0)
    v_smfmac_f32_16x16x64_bf16 v[12:15], v[28:31], a[16:23], v7
    v_smfmac_f32_16x16x64_bf16 v[16:19], v[28:31], a[24:31], v7
    s_branch L_rgo_f1
.p2align 6
L_rp2_f1:
    s_waitcnt vmcnt(1)
    v_smfmac_f32_16x16x64_bf16 v[12:15], v[28:31], a[16:23], v7
    v_max_u32 v1, v28, v30
    s_waitcnt vmcnt(0)
    v_max3_u32 v1, v1, v32, v34
    v_cmp_eq_u32 vcc, -1, v1
    v_smfmac_f32_16x16x64_bf16 v[16:19], v[28:31], a[24:31], v7
    ds_write_b128 v2, v[28:31] offset:1024
    s_cbranch_vccnz L_rf2_f1
L_rgo_f1:
    v_smfmac_f32_16x16x64_bf16 v[8:11], v[28:31], a[160:167], v7
    ds_write_b128 v2, v[32:35] offset:2048
    s_waitcnt lgkmcnt(2)
    v_smfmac_f32_16x16x64_bf16 v[20:23], v[28:31], v[40:47], v7
    v_add_u32 v1, 0x10000, v0
    ds_read_b128 v[40:43], v1 offset:24576
    v_smfmac_f32_16x16x64_bf16 v[24:27], v[28:31], v[48:55], v7
    ds_read_b128 v[44:47], v1 offset:28672
    ds_read_b128 v[48:51], v1 offset:32768
    v_smfmac_f32_16x16x64_bf16 v[12:15], v[32:35], a[32:39], v7
    s_waitcnt lgkmcnt(3)
    s_barrier
    ds_read_b128 v[28:31], v2 offset:3072
    v_smfmac_f32_16x16x64_bf16 v[20:23], v[32:35], v[56:63], v7
    global_load_lds_dwordx4 v2, s[32:33]
    ds_read_b128 v[52:55], v1 offset:36864
    v_smfmac_f32_16x16x64_bf16 v[16:19], v[32:35], a[40:47], v7
    global_load_lds_dwordx4 v2, s[32:33] offset:1024
    s_mov_b32 m0, s63
    ds_read_b128 v[56:59], v1 offset:40960
    v_smfmac_f32_16x16x64_bf16 v[8:11], v[32:35], a[176:183], v7
    global_load_lds_dwordx4 v2, s[86:87]
    s_add_u32 m0, s63, 3072
    ds_read_b128 v[60:63], v1 offset:45056
    s_waitcnt lgkmcnt(5)
    v_smfmac_f32_16x16x64_bf16 v[24:27], v[32:35], v[40:47], v7
    global_load_lds_dwordx4 v2, s[86:87] offset:1024
    s_mov_b32 m0, 32256
    ds_read_b128 v[32:35], v2 offset:4096
    s_waitcnt lgkmcnt(4)
    v_smfmac_f32_16x16x64_bf16 v[12:15], v[28:31], a[48:55], v7
    ds_read_b128 v[40:43], v1 offset:49152
    ds_read_b128 v[44:47], v1 offset:53248
    s_waitcnt lgkmcnt(5)
    v_smfmac_f32_16x16x64_bf16 v[20:23], v[28:31], v[48:55], v7
    global_store_dwordx4 v0, v[36:39], s[38:39] sc1
    ds_read_b128 v[48:51], v1 offset:57344
    v_smfmac_f32_16x16x64_bf16 v[16:19], v[28:31], a[56:63], v7
    ds_read_b128 v[52:55], v1 offset:61440
    v_smfmac_f32_16x16x64_bf16 v[8:11], v[28:31], a[192:199], v7
    v_lshlrev_b32 v36, 2, v0
    global_load_lds_dword v36, s[58:59]
    s_mov_b32 m0, 25856
    v_mov_b64 v[36:37], 0
    v_mov_b64 v[38:39], 0
    s_waitcnt lgkmcnt(5)
    v_smfmac_f32_16x16x64_bf16 v[24:27], v[28:31], v[56:63], v7
    ds_read_b128 v[28:31], v2 offset:5120
    v_add_u32 v1, 0x20000, v0
    s_waitcnt lgkmcnt(5)
    v_smfmac_f32_16x16x64_bf16 v[12:15], v[32:35], a[64:71], v7
    ds_read_b128 v[56:59], v1 offset:0
    ds_read_b128 v[60:63], v1 offset:4096
    s_waitcnt lgkmcnt(5)
    v_smfmac_f32_16x16x64_bf16 v[20:23], v[32:35], v[40:47], v7
    ds_read_b128 v[40:43], v1 offset:8192
    ds_read_b128 v[44:47], v1 offset:12288
    v_smfmac_f32_16x16x64_bf16 v[16:19], v[32:35], a[72:79], v7
    v_smfmac_f32_16x16x64_bf16 v[8:11], v[32:35], a[208:215], v7
    v_smfmac_f32_16x16x64_bf16 v[36:39], v[32:35], a[216:223], v7
    s_waitcnt lgkmcnt(5)
    v_smfmac_f32_16x16x64_bf16 v[24:27], v[32:35], v[48:55], v7
    ds_read_b128 v[32:35], v2 offset:6144
    ds_read_b128 v[48:51], v1 offset:16384
    s_waitcnt lgkmcnt(6)
    v_smfmac_f32_16x16x64_bf16 v[12:15], v[28:31], a[80:87], v7
    ds_read_b128 v[52:55], v1 offset:20480
    s_waitcnt lgkmcnt(5)
    v_smfmac_f32_16x16x64_bf16 v[20:23], v[28:31], v[56:63], v7
    ds_read_b128 v[56:59], v1 offset:24576
    ds_read_b128 v[60:63], v1 offset:28672
    v_smfmac_f32_16x16x64_bf16 v[16:19], v[28:31], a[88:95], v7
    v_smfmac_f32_16x16x64_bf16 v[8:11], v[28:31], a[224:231], v7
    v_smfmac_f32_16x16x64_bf16 v[36:39], v[28:31], a[232:239], v7
    s_waitcnt lgkmcnt(5)
    v_smfmac_f32_16x16x64_bf16 v[24:27], v[28:31], v[40:47], v7
    ds_read_b128 v[28:31], v2 offset:8192
    ds_read_b128 v[40:43], v0 offset:32768
    s_waitcnt lgkmcnt(6)
    v_smfmac_f32_16x16x64_bf16 v[12:15], v[32:35], a[96:103], v7
    ds_read_b128 v[44:47], v0 offset:36864
    s_waitcnt lgkmcnt(5)
    v_smfmac_f32_16x16x64_bf16 v[20:23], v[32:35], v[48:55], v7
    ds_read_b128 v[48:51], v0 offset:40960
    ds_read_b128 v[52:55], v0 offset:45056
    v_smfmac_f32_16x16x64_bf16 v[16:19], v[32:35], a[104:111], v7
    v_smfmac_f32_16x16x64_bf16 v[8:11], v[32:35], a[240:247], v7
    v_smfmac_f32_16x16x64_bf16 v[36:39], v[32:35], a[248:255], v7
    s_waitcnt lgkmcnt(5)
    v_smfmac_f32_16x16x64_bf16 v[24:27], v[32:35], v[56:63], v7
    ds_read_b128 v[32:35], v2 offset:0
    ds_read_b128 v[56:59], v0 offset:49152
    s_waitcnt lgkmcnt(6)
    v_smfmac_f32_16x16x64_bf16 v[12:15], v[28:31], a[128:135], v7
    ds_read_b128 v[60:63], v0 offset:53248
    s_waitcnt lgkmcnt(5)
    v_smfmac_f32_16x16x64_bf16 v[20:23], v[28:31], v[40:47], v7
    ds_read_b128 v[40:43], v0 offset:57344
    ds_read_b128 v[44:47], v0 offset:61440
    v_smfmac_f32_16x16x64_bf16 v[16:19], v[28:31], a[136:143], v7
    s_waitcnt vmcnt(4)
    s_barrier
    v_smfmac_f32_16x16x64_bf16 v[8:11], v[28:31], v[80:87], v7
    v_smfmac_f32_16x16x64_bf16 v[36:39], v[28:31], v[88:95], v7
    s_waitcnt lgkmcnt(5)
    v_smfmac_f32_16x16x64_bf16 v[24:27], v[28:31], v[48:55], v7
    ds_read_b128 v[28:31], v2 offset:7168
    ds_read_b128 v[48:51], v2 offset:10240
    s_waitcnt lgkmcnt(6)
    v_smfmac_f32_16x16x64_bf16 v[12:15], v[32:35], a[0:7], v7
    ds_read_b128 v[52:55], v2 offset:14336
    s_waitcnt lgkmcnt(5)
    v_smfmac_f32_16x16x64_bf16 v[20:23], v[32:35], v[56:63], v7
    ds_read_b128 v[56:59], v2 offset:11264
    ds_read_b128 v[60:63], v2 offset:15360
    v_smfmac_f32_16x16x64_bf16 v[16:19], v[32:35], a[8:15], v7
    v_smfmac_f32_16x16x64_bf16 v[8:11], v[32:35], a[144:151], v7
    s_waitcnt lgkmcnt(5)
    v_smfmac_f32_16x16x64_bf16 v[24:27], v[32:35], v[40:47], v7
    ds_read_b128 v[40:43], v2 offset:3072
    ds_read_b128 v[44:47], v2 offset:2048
    s_waitcnt lgkmcnt(6)
    v_smfmac_f32_16x16x64_bf16 v[12:15], v[28:31], a[112:119], v7
    v_smfmac_f32_16x16x64_bf16 v[16:19], v[28:31], a[120:127], v7
    v_smfmac_f32_16x16x64_bf16 v[20:23], v[28:31], v[240:247], v7
    v_smfmac_f32_16x16x64_bf16 v[24:27], v[28:31], v[248:255], v7
    v_mov_b32 v1, s47
    v_smfmac_f32_16x16x64_bf16 v[8:11], v[28:31], v[64:71], v7
    s_cmp_eq_u32 s24, 63
    s_cbranch_scc1 L_rlast_f1
    s_nop 0
    v_add_f32 v12, v12, v13
    v_add_f32 v14, v14, v15
    v_add_f32 v16, v16, v17
    v_add_f32 v18, v18, v19
    v_cvt_pk_bf16_f32 v13, v12, v16
    v_cvt_pk_bf16_f32 v15, v14, v18
    ds_write2_b32 v5, v13, v15 offset0:0 offset1:72
    v_add_f32 v20, v20, v21
    v_add_f32 v22, v22, v23
    v_add_f32 v24, v24, v25
    v_add_f32 v26, v26, v27
    v_cvt_pk_bf16_f32 v21, v20, v24
    v_cvt_pk_bf16_f32 v23, v22, v26
    ds_write_b32 v5, v21 offset:2304
    ds_write_b32 v5, v23 offset:2592
    ds_read_b128 v[24:27], v4 offset:64
    v_smfmac_f32_16x16x64_bf16 v[36:39], v[28:31], v[72:79], v7
    ds_read_b128 v[28:31], v4 offset:2368
    v_smfmac_f32_16x16x64_bf16 v[36:39], v[32:35], a[152:159], v7
    ds_read_b128 v[32:35], v2 offset:1024
    s_waitcnt lgkmcnt(7)
    v_smfmac_f32_16x16x64_bf16 v[36:39], v[40:43], a[200:207], v7
    s_waitcnt lgkmcnt(6)
    v_smfmac_f32_16x16x64_bf16 v[36:39], v[44:47], a[184:191], v7
    s_waitcnt lgkmcnt(3)
    s_barrier
    ds_read_b128 v[40:43], v4 offset:128
    ds_read_b128 v[44:47], v4 offset:2432
    s_waitcnt lgkmcnt(4)
    v_mfma_f32_16x16x32_bf16 v[12:15], v[48:51], v[24:27], 0
    ds_read_b128 v[48:51], v4 offset:192
    v_mfma_f32_16x16x32_bf16 v[16:19], v[52:55], v[24:27], 0
    ds_read_b128 v[52:55], v2 offset:12288
    s_waitcnt lgkmcnt(5)
    v_mfma_f32_16x16x32_bf16 v[20:23], v[28:31], v[24:27], 0
    ds_read_b128 v[28:31], v2 offset:16384
    ds_read_b128 v[24:27], v4 offset:2496
    s_waitcnt lgkmcnt(5)
    v_mfma_f32_16x16x32_bf16 v[12:15], v[56:59], v[40:43], v[12:15]
    ds_read_b128 v[56:59], v4 offset:0
    v_mfma_f32_16x16x32_bf16 v[16:19], v[60:63], v[40:43], v[16:19]
    ds_read_b128 v[60:63], v2 offset:9216
    s_waitcnt lgkmcnt(6)
    v_mfma_f32_16x16x32_bf16 v[20:23], v[44:47], v[40:43], v[20:23]
    ds_read_b128 v[44:47], v2 offset:13312
    ds_read_b128 v[40:43], v4 offset:2304
    s_waitcnt lgkmcnt(6)
    v_mfma_f32_16x16x32_bf16 v[12:15], v[52:55], v[48:51], v[12:15]
    s_waitcnt vmcnt(2)
    ds_read_b128 v[52:55], v0 offset:17408
    s_waitcnt lgkmcnt(6)
    v_mfma_f32_16x16x32_bf16 v[16:19], v[28:31], v[48:51], v[16:19]
    ds_read_b128 v[28:31], v0 offset:21504
    s_waitcnt lgkmcnt(6)
    v_mfma_f32_16x16x32_bf16 v[20:23], v[24:27], v[48:51], v[20:23]
    s_waitcnt lgkmcnt(4)
    v_mfma_f32_16x16x32_bf16 v[12:15], v[60:63], v[56:59], v[12:15]
    s_waitcnt lgkmcnt(3)
    v_mfma_f32_16x16x32_bf16 v[16:19], v[44:47], v[56:59], v[16:19]
    s_waitcnt lgkmcnt(2)
    v_mfma_f32_16x16x32_bf16 v[20:23], v[40:43], v[56:59], v[20:23]
    v_smfmac_f32_16x16x64_bf16 v[36:39], v[32:35], a[168:175], v7
    v_mov_b32 v49, 0
    v_mov_b32 v50, 0
    v_add_f32 v8, v8, v9
    v_add_f32 v10, v10, v11
    s_nop 0
    v_mov_b32_dpp v12, v16 quad_perm:[0,1,2,3] row_mask:0xf bank_mask:0xc
    v_mov_b32_dpp v13, v17 quad_perm:[0,1,2,3] row_mask:0xf bank_mask:0xc
    v_mov_b32_dpp v14, v18 quad_perm:[0,1,2,3] row_mask:0xf bank_mask:0xc
    v_mov_b32_dpp v15, v19 quad_perm:[0,1,2,3] row_mask:0xf bank_mask:0xc
    v_mov_b32_dpp v22, v23 quad_perm:[0,1,2,3] row_mask:0xf bank_mask:0xc
    v_mov_b32_dpp v20, v21 quad_perm:[0,1,2,3] row_mask:0x3 bank_mask:0xc
    v_max3_f32 v16, v12, v13, v14
    v_add_f32 v36, v36, v37
    v_mov_b32_dpp v20, v22 quad_perm:[0,1,2,3] row_mask:0xc bank_mask:0xf
    v_max3_f32 v16, v16, v15, v20
    v_pk_mul_f32 v[12:13], v[12:13], s[46:47] op_sel_hi:[1,0]
    v_pk_mul_f32 v[14:15], v[14:15], s[46:47] op_sel_hi:[1,0]
    v_max_f32_dpp v16, v16, v16 row_ror:8 row_mask:0xf bank_mask:0xf
    v_mov_b32 v17, v16
    v_mul_f32 v20, s46, v20
    v_add_f32 v38, v38, v39
    v_permlane16_swap_b32 v16, v17
    v_max_f32 v16, v16, v17
    v_mov_b32 v17, v16
    v_cvt_pk_bf16_f32 v22, v8, v10
    v_cvt_pk_bf16_f32 v23, v36, v38
    v_permlane32_swap_b32 v16, v17
    v_max_f32 v16, v16, v17
    v_mul_f32 v16, s46, v16
    v_sub_f32 v12, v12, v16
    v_sub_f32 v13, v13, v16
    v_sub_f32 v14, v14, v16
    v_sub_f32 v15, v15, v16
    v_sub_f32 v20, v20, v16
    v_exp_f32 v12, v12
    v_exp_f32 v13, v13
    v_exp_f32 v14, v14
    v_exp_f32 v15, v15
    v_cvt_pk_bf16_f32 v24, v12, v13
    v_cvt_pk_bf16_f32 v25, v14, v15
    v_exp_f32 v20, v20
    v_mov_b32_dpp v26, v24 row_ror:8 row_mask:0xf bank_mask:0xf
    v_mov_b32_dpp v27, v25 row_ror:8 row_mask:0xf bank_mask:0xf
    v_mov_b32_dpp v21, v20 row_ror:8 row_mask:0xf bank_mask:0xf
    v_add_f32 v18, v12, v13
    s_waitcnt lgkmcnt(0)
    v_mfma_f32_16x16x32_bf16 v[60:63], v[52:55], v[24:27], 0
    v_cvt_pk_bf16_f32 v48, v20, v21
    v_add_f32 v17, v14, v15
    v_mfma_f32_16x16x32_bf16 v[44:47], v[28:31], v[24:27], 0
    v_add_f32 v18, v18, v20
    v_add_f32 v18, v18, v17
    v_cvt_pk_bf16_f32 v51, v20, v21
    v_mfma_f32_16x16x16_bf16 v[60:63], v[22:23], v[48:49], v[60:63]
    v_add_f32_dpp v18, v18, v18 row_ror:8 row_mask:0xf bank_mask:0xf
    v_mov_b32 v17, v18
    v_mfma_f32_16x16x16_bf16 v[44:47], v[22:23], v[50:51], v[44:47]
    v_lshrrev_b32 v9, 2, v2
    v_permlane16_swap_b32 v18, v17
    v_add_f32 v18, v18, v17
    v_mov_b32 v17, v18
    v_and_b32 v8, 0x300, v2
    v_bfe_u32 v10, v2, 1, 7
    v_permlane32_swap_b32 v18, v17
    v_add_f32 v18, v18, v17
    v_rcp_f32 v18, v18
    v_lshl_or_b32 v8, v8, 4, v10
    v_pk_mul_f32 v[60:61], v[60:61], v[18:19] op_sel_hi:[1,0]
    v_pk_mul_f32 v[62:63], v[62:63], v[18:19] op_sel_hi:[1,0]
    v_pk_mul_f32 v[44:45], v[44:45], v[18:19] op_sel_hi:[1,0]
    v_pk_mul_f32 v[46:47], v[46:47], v[18:19] op_sel_hi:[1,0]
    v_cvt_pk_bf16_f32 v12, v60, v61
    v_cvt_pk_bf16_f32 v13, v62, v63
    v_cvt_pk_bf16_f32 v14, v44, v45
    v_cvt_pk_bf16_f32 v15, v46, v47
    ds_write_b128 v6, v[12:15]
    v_mov_b64 v[10:11], 0
    s_nop 1
    v_mfma_f32_32x32x8_bf16 v[28:43], v[10:11], v[10:11], 0
    v_mfma_f32_32x32x8_bf16 v[44:59], v[10:11], v[10:11], 0
    s_waitcnt lgkmcnt(0)
    s_barrier
    ds_read_b128 v[12:15], v3 offset:30208
    ds_read_b128 v[16:19], v3 offset:31232
    v_mov_b64 v[60:61], 0
    ds_write2_b32 v5, v22, v23 offset0:0 offset1:72
    v_mov_b64 v[62:63], 0
    s_waitcnt lgkmcnt(2)
    s_nop 0
    v_smfmac_f32_16x16x64_bf16 v[28:31], v[12:15], v[224:231], v7
    s_waitcnt lgkmcnt(1)
    v_smfmac_f32_16x16x64_bf16 v[28:31], v[16:19], v[232:239], v7
    s_nop 1
    v_smfmac_f32_16x16x64_bf16 v[32:35], v[12:15], v[96:103], v7
    s_nop 1
    v_smfmac_f32_16x16x64_bf16 v[32:35], v[16:19], v[104:111], v7
    s_nop 1
    v_smfmac_f32_16x16x64_bf16 v[36:39], v[12:15], v[112:119], v7
    v_add_f32 v28, v28, v29
    v_add_f32 v29, v30, v31
    v_smfmac_f32_16x16x64_bf16 v[36:39], v[16:19], v[120:127], v7
    v_cvt_pk_bf16_f32 v30, v28, v29
    v_bfi_b32 v30, 1, v1, v30
    global_store_dword v9, v30, s[42:43]
    v_smfmac_f32_16x16x64_bf16 v[40:43], v[12:15], v[128:135], v7
    v_add_f32 v32, v32, v33
    v_add_f32 v33, v34, v35
    v_smfmac_f32_16x16x64_bf16 v[40:43], v[16:19], v[136:143], v7
    s_nop 1
    v_smfmac_f32_16x16x64_bf16 v[44:47], v[12:15], v[144:151], v7
    v_add_f32 v36, v36, v37
    v_add_f32 v37, v38, v39
    v_smfmac_f32_16x16x64_bf16 v[44:47], v[16:19], v[152:159], v7
    v_cvt_pk_bf16_f32 v38, v32, v36
    v_cvt_pk_bf16_f32 v39, v33, v37
    v_bfi_b32 v38, 1, v1, v38
    v_smfmac_f32_16x16x64_bf16 v[48:51], v[12:15], v[160:167], v7
    global_store_dwordx2 v8, v[38:39], s[26:27]
    v_add_f32 v40, v40, v41
    v_add_f32 v41, v42, v43
    v_smfmac_f32_16x16x64_bf16 v[48:51], v[16:19], v[168:175], v7
    v_add_f32 v44, v44, v45
    v_add_f32 v45, v46, v47
    v_smfmac_f32_16x16x64_bf16 v[52:55], v[12:15], v[176:183], v7
    v_cvt_pk_bf16_f32 v46, v40, v44
    v_cvt_pk_bf16_f32 v47, v41, v45
    v_bfi_b32 v46, 1, v1, v46
    v_smfmac_f32_16x16x64_bf16 v[52:55], v[16:19], v[184:191], v7
    global_store_dwordx2 v8, v[46:47], s[90:91]
    v_add_f32 v48, v48, v49
    v_smfmac_f32_16x16x64_bf16 v[56:59], v[12:15], v[192:199], v7
    v_add_f32 v49, v50, v51
    v_smfmac_f32_16x16x64_bf16 v[56:59], v[16:19], v[200:207], v7
    s_nop 1
    v_smfmac_f32_16x16x64_bf16 v[60:63], v[12:15], v[208:215], v7
    v_add_f32 v52, v52, v53
    v_add_f32 v53, v54, v55
    v_smfmac_f32_16x16x64_bf16 v[60:63], v[16:19], v[216:223], v7
    v_cvt_pk_bf16_f32 v54, v48, v52
    v_cvt_pk_bf16_f32 v55, v49, v53
    v_bfi_b32 v54, 1, v1, v54
    global_store_dwordx2 v8, v[54:55], s[92:93]
    v_add_f32 v56, v56, v57
    v_add_f32 v57, v58, v59
    s_nop 1
    v_add_f32 v60, v60, v61
    v_add_f32 v61, v62, v63
    v_cvt_pk_bf16_f32 v62, v56, v60
    v_cvt_pk_bf16_f32 v63, v57, v61
    v_bfi_b32 v62, 1, v1, v62
    global_store_dwordx2 v8, v[62:63], s[94:95]
    s_lshl_b32 s13, s24, 17
    s_add_u32 s38, s50, s13
    s_addc_u32 s39, s51, 0
    s_add_u32 s25, s24, 2
    s_min_u32 s25, s25, 63
    s_lshl_b32 s13, s25, 19
    s_add_u32 s58, s88, s13
    s_addc_u32 s59, s89, 0
    s_add_u32 s86, s86, 524288
    s_addc_u32 s87, s87, 0
    s_add_u32 s32, s32, 524288
    s_addc_u32 s33, s33, 0
    s_add_u32 s14, s30, s34
    s_addc_u32 s15, s31, 0
    s_add_u32 s60, s30, s35
    s_addc_u32 s61, s31, 0
    s_add_u32 s20, s14, 4096
    s_addc_u32 s21, s15, 0
    s_and_b32 s12, s24, 1
    s_xor_b32 s13, s12, 1
    s_xor_b32 s47, s13, s40
    s_add_u32 s24, s24, 1
    s_mov_b32 s35, s34
    s_add_u32 s34, s34, 9216
    s_cmp_eq_u32 s34, 27648
    s_cselect_b32 s34, 0, s34
    s_mov_b32 s55, 0
    v_add_u32 v1, 0x10000, v0
    ds_read_b128 v[40:43], v1 offset:0
    ds_read_b128 v[44:47], v1 offset:4096
    v_add_u32 v1, 0x10000, v0
    ds_read_b128 v[48:51], v1 offset:8192
    ds_read_b128 v[52:55], v1 offset:12288
    v_add_u32 v1, 0x10000, v0
    ds_read_b128 v[56:59], v1 offset:16384
    ds_read_b128 v[60:63], v1 offset:20480
    s_waitcnt vmcnt(0)
    v_bfe_u32 v20, v2, 4, 1
    v_bfe_u32 v21, v2, 5, 1
    v_bfe_u32 v22, v2, 6, 1
    global_load_dwordx4 v[24:27], v2, s[28:29] offset:0 sc1
    global_load_dwordx4 v[28:31], v2, s[28:29] offset:1024 sc1
    global_load_dwordx4 v[32:35], v2, s[28:29] offset:2048 sc1
    global_load_dwordx4 v[36:39], v2, s[28:29] offset:3072 sc1
    v_lshl_add_u32 v22, v21, 1, v22
    v_lshlrev_b32 v20, 4, v20
    v_mov_b32 v21, 0x3f80
    v_lshlrev_b32 v21, v20, v21
    v_cmp_eq_u32 vcc, 0, v22
    v_mov_b32 v8, 0x0
    v_bfe_u32 v10, v2, 4, 2
    v_cndmask_b32 v12, 0, v21, vcc
    v_cmp_eq_u32 vcc, 1, v22
    v_lshlrev_b32 v10, 3, v10
    v_xor_b32 v8, v8, v10
    v_cndmask_b32 v13, 0, v21, vcc
    v_cmp_eq_u32 vcc, 2, v22
    v_bfe_u32 v10, v2, 6, 1
    v_lshlrev_b32 v10, 8, v10
    v_cndmask_b32 v14, 0, v21, vcc
    v_cmp_eq_u32 vcc, 3, v22
    v_xor_b32 v8, v8, v10
    v_bfe_u32 v10, v2, 8, 1
    v_cndmask_b32 v15, 0, v21, vcc
    v_lshlrev_b32 v10, 5, v10
    v_xor_b32 v8, v8, v10
    v_xor_b32 v8, s41, v8
    v_mov_b64 v[10:11], -1
L_rp1_f1:
    s_waitcnt vmcnt(3)
    v_mfma_f32_16x16x32_bf16 v[16:19], v[12:15], v[24:27], 0
    v_bitop3_b32 v20, v24, v26, s12 bitop3:0x7e
    s_waitcnt vmcnt(2)
    v_mfma_f32_16x16x32_bf16 v[16:19], v[12:15], v[28:31], v[16:19]
    v_bitop3_b32 v21, v28, v30, s13 bitop3:0x7e
    s_waitcnt vmcnt(1)
    v_mfma_f32_16x16x32_bf16 v[16:19], v[12:15], v[32:35], v[16:19]
    v_bitop3_b32 v22, v32, v34, s12 bitop3:0x7e
    v_or3_b32 v20, v20, v21, v22
    s_waitcnt vmcnt(0)
    v_mfma_f32_16x16x32_bf16 v[16:19], v[12:15], v[36:39], v[16:19]
    v_bitop3_b32 v23, v36, v38, s13 bitop3:0x7e
    v_bitop3_b32 v20, v20, v23, 1 bitop3:0xa8
    v_cmp_ne_u32 vcc, 0, v20
    s_nop 4
    v_add_f32_dpp v16, v16, v16 row_ror:8 row_mask:0xf bank_mask:0xf
    v_add_f32_dpp v17, v17, v17 row_ror:8 row_mask:0xf bank_mask:0xf
    v_add_f32_dpp v18, v18, v18 row_ror:8 row_mask:0xf bank_mask:0xf
    v_add_f32_dpp v19, v19, v19 row_ror:8 row_mask:0xf bank_mask:0xf
    v_cvt_pk_bf16_f32 v20, v16, v17
    v_cvt_pk_bf16_f32 v21, v18, v19
    s_mov_b64 exec, s[44:45]
    s_cbranch_vccnz L_rp1_f1_rt
    global_store_dwordx2 v8, v[20:21], s[14:15]
    global_store_dwordx2 v8, v[10:11], s[60:61]
    s_mov_b64 exec, -1
    s_barrier
    s_mov_b32 s55, 0
    ds_read_b32 v36, v5 offset:2304
    ds_read_b32 v37, v5 offset:2592
    ds_read2_b32 v[38:39], v5 offset0:0 offset1:72
    v_mov_b64 v[12:13], 0
    v_mov_b64 v[14:15], 0
    v_mov_b64 v[16:17], 0
    v_mov_b64 v[18:19], 0
    v_mov_b64 v[20:21], 0
    v_mov_b64 v[22:23], 0
    v_mov_b64 v[24:25], 0
    v_mov_b64 v[26:27], 0
    global_load_dwordx4 v[28:31], v2, s[20:21] offset:-3072 sc1
    global_load_dwordx4 v[32:35], v2, s[20:21] offset:-2048 sc1
    v_mov_b64 v[8:9], 0
    v_mov_b64 v[10:11], 0
    s_mov_b32 m0, s62
    s_branch L_rp2_f1
L_rf2_f1:
    s_mov_b64 exec, vcc
    global_load_dwordx4 v[28:31], v2, s[20:21] offset:-3072 sc1
    global_load_dwordx4 v[32:35], v2, s[20:21] offset:-2048 sc1
    s_mov_b64 exec, -1
    v_mov_b64 v[12:13], 0
    v_mov_b64 v[14:15], 0
    v_mov_b64 v[16:17], 0
    v_mov_b64 v[18:19], 0
    s_add_u32 s55, s55, 1
    s_cmp_gt_u32 s55, 100000
    s_cbranch_scc0 L_rp2_f1
    s_branch L_rx_f1
L_rp1_f1_rt:
    s_mov_b64 exec, vcc
    global_load_dwordx4 v[24:27], v2, s[28:29] offset:0 sc1
    global_load_dwordx4 v[28:31], v2, s[28:29] offset:1024 sc1
    global_load_dwordx4 v[32:35], v2, s[28:29] offset:2048 sc1
    global_load_dwordx4 v[36:39], v2, s[28:29] offset:3072 sc1
    s_mov_b64 exec, -1
    s_cmp_le_u32 s55, 2
    s_cbranch_scc1 L_bo_51
    s_sleep 4
L_bo_51:
    s_add_u32 s55, s55, 1
    s_cmp_gt_u32 s55, 100000
    s_cbranch_scc0 L_rp1_f1
    s_branch L_rx_f1
L_rp2ok_f1:
    s_branch L_rp2_f1
L_rlast_f1:
    s_lshl_b32 s13, s24, 17
    s_add_u32 s38, s50, s13
    s_addc_u32 s39, s51, 0
    s_waitcnt lgkmcnt(0)
    ds_read_b128 v[12:15], v2 offset:1024
    v_smfmac_f32_16x16x64_bf16 v[36:39], v[28:31], v[72:79], v7
    v_smfmac_f32_16x16x64_bf16 v[36:39], v[32:35], a[152:159], v7
    v_smfmac_f32_16x16x64_bf16 v[36:39], v[40:43], a[200:207], v7
    v_smfmac_f32_16x16x64_bf16 v[36:39], v[44:47], a[184:191], v7
    s_waitcnt lgkmcnt(0)
    v_smfmac_f32_16x16x64_bf16 v[36:39], v[12:15], a[168:175], v7
    v_add_f32 v20, v20, v21
    v_add_f32 v22, v22, v23
    v_add_f32 v24, v24, v25
    v_add_f32 v26, v26, v27
    v_cvt_pk_bf16_f32 v16, v20, v24
    v_cvt_pk_bf16_f32 v17, v22, v26
    s_nop 1
    v_add_f32 v36, v36, v37
    v_add_f32 v38, v38, v39
    v_add_f32 v8, v8, v9
    v_add_f32 v10, v10, v11
    v_cvt_pk_bf16_f32 v18, v8, v10
    v_cvt_pk_bf16_f32 v19, v36, v38
    global_store_dwordx4 v0, v[16:19], s[38:39] sc1
L_rx_f1:
    s_endpgm
L_rent_f2:
    v_add_u32 v1, 0x10000, v0
    ds_read_b128 v[40:43], v1 offset:32768
    ds_read_b128 v[44:47], v1 offset:36864
    v_add_u32 v1, 0x10000, v0
    ds_read_b128 v[48:51], v1 offset:40960
    ds_read_b128 v[52:55], v1 offset:45056
    v_add_u32 v1, 0x10000, v0
    ds_read_b128 v[56:59], v1 offset:49152
    ds_read_b128 v[60:63], v1 offset:53248
    ds_read_b128 v[28:31], v2 offset:3072
    ds_read_b128 v[32:35], v2 offset:4096
    v_mov_b64 v[8:9], 0
    v_mov_b64 v[10:11], 0
    v_mov_b64 v[12:13], 0
    v_mov_b64 v[14:15], 0
    v_mov_b64 v[16:17], 0
    v_mov_b64 v[18:19], 0
    v_mov_b64 v[20:21], 0
    v_mov_b64 v[22:23], 0
    v_mov_b64 v[24:25], 0
    v_mov_b64 v[26:27], 0
    s_mov_b32 m0, s62
    s_mov_b32 s55, 0
    s_mov_b32 s47, s40
    s_mov_b64 s[20:21], s[30:31]
    s_waitcnt lgkmcnt(0)
    v_smfmac_f32_16x16x64_bf16 v[12:15], v[28:31], a[48:55], v7
    v_smfmac_f32_16x16x64_bf16 v[16:19], v[28:31], a[56:63], v7
    s_branch L_rgo_f2
.p2align 6
L_rp2_f2:
    s_waitcnt vmcnt(1)
    v_smfmac_f32_16x16x64_bf16 v[12:15], v[28:31], a[48:55], v7
    v_max_u32 v1, v28, v30
    s_waitcnt vmcnt(0)
    v_max3_u32 v1, v1, v32, v34
    v_cmp_eq_u32 vcc, -1, v1
    v_smfmac_f32_16x16x64_bf16 v[16:19], v[28:31], a[56:63], v7
    ds_write_b128 v2, v[28:31] offset:3072
    s_cbranch_vccnz L_rf2_f2
L_rgo_f2:
    v_smfmac_f32_16x16x64_bf16 v[8:11], v[28:31], a[192:199], v7
    ds_write_b128 v2, v[32:35] offset:4096
    s_waitcnt lgkmcnt(2)
    v_smfmac_f32_16x16x64_bf16 v[20:23], v[28:31], v[40:47], v7
    v_add_u32 v1, 0x10000, v0
    ds_read_b128 v[40:43], v1 offset:57344
    v_smfmac_f32_16x16x64_bf16 v[24:27], v[28:31], v[48:55], v7
    ds_read_b128 v[44:47], v1 offset:61440
    v_add_u32 v1, 0x20000, v0
    v_smfmac_f32_16x16x64_bf16 v[12:15], v[32:35], a[64:71], v7
    s_waitcnt lgkmcnt(2)
    s_barrier
    ds_read_b128 v[28:31], v2 offset:5120
    v_smfmac_f32_16x16x64_bf16 v[20:23], v[32:35], v[56:63], v7
    global_load_lds_dwordx4 v2, s[32:33]
    ds_read_b128 v[48:51], v1 offset:0
    v_smfmac_f32_16x16x64_bf16 v[16:19], v[32:35], a[72:79], v7
    global_load_lds_dwordx4 v2, s[32:33] offset:1024
    s_mov_b32 m0, s63
    ds_read_b128 v[52:55], v1 offset:4096
    v_smfmac_f32_16x16x64_bf16 v[8:11], v[32:35], a[208:215], v7
    global_load_lds_dwordx4 v2, s[86:87]
    s_add_u32 m0, s63, 3072
    ds_read_b128 v[56:59], v1 offset:8192
    s_waitcnt lgkmcnt(4)
    v_smfmac_f32_16x16x64_bf16 v[24:27], v[32:35], v[40:47], v7
    global_load_lds_dwordx4 v2, s[86:87] offset:1024
    s_mov_b32 m0, 32256
    ds_read_b128 v[32:35], v2 offset:6144
    s_waitcnt lgkmcnt(4)
    v_smfmac_f32_16x16x64_bf16 v[12:15], v[28:31], a[80:87], v7
    ds_read_b128 v[60:63], v1 offset:12288
    ds_read_b128 v[40:43], v1 offset:16384
    s_waitcnt lgkmcnt(4)
    v_smfmac_f32_16x16x64_bf16 v[20:23], v[28:31], v[48:55], v7
    global_store_dwordx4 v0, v[36:39], s[38:39] sc1
    ds_read_b128 v[44:47], v1 offset:20480
    v_smfmac_f32_16x16x64_bf16 v[16:19], v[28:31], a[88:95], v7
    ds_read_b128 v[48:51], v1 offset:24576
    ds_read_b128 v[52:55], v1 offset:28672
    v_smfmac_f32_16x16x64_bf16 v[8:11], v[28:31], a[224:231], v7
    v_lshlrev_b32 v36, 2, v0
    global_load_lds_dword v36, s[58:59]
    s_mov_b32 m0, 25856
    v_mov_b64 v[36:37], 0
    v_mov_b64 v[38:39], 0
    s_waitcnt lgkmcnt(4)
    v_smfmac_f32_16x16x64_bf16 v[24:27], v[28:31], v[56:63], v7
    ds_read_b128 v[28:31], v2 offset:8192
    ds_read_b128 v[56:59], v0 offset:32768
    v_smfmac_f32_16x16x64_bf16 v[12:15], v[32:35], a[96:103], v7
    ds_read_b128 v[60:63], v0 offset:36864
    s_waitcnt lgkmcnt(5)
    v_smfmac_f32_16x16x64_bf16 v[20:23], v[32:35], v[40:47], v7
    ds_read_b128 v[40:43], v0 offset:40960
    ds_read_b128 v[44:47], v0 offset:45056
    v_smfmac_f32_16x16x64_bf16 v[16:19], v[32:35], a[104:111], v7
    v_smfmac_f32_16x16x64_bf16 v[8:11], v[32:35], a[240:247], v7
    v_smfmac_f32_16x16x64_bf16 v[36:39], v[32:35], a[248:255], v7
    s_waitcnt lgkmcnt(5)
    v_smfmac_f32_16x16x64_bf16 v[24:27], v[32:35], v[48:55], v7
    ds_read_b128 v[32:35], v2 offset:0
    ds_read_b128 v[48:51], v0 offset:49152
    s_waitcnt lgkmcnt(6)
    v_smfmac_f32_16x16x64_bf16 v[12:15], v[28:31], a[128:135], v7
    ds_read_b128 v[52:55], v0 offset:53248
    s_waitcnt lgkmcnt(5)
    v_smfmac_f32_16x16x64_bf16 v[20:23], v[28:31], v[56:63], v7
    ds_read_b128 v[56:59], v0 offset:57344
    ds_read_b128 v[60:63], v0 offset:61440
    v_smfmac_f32_16x16x64_bf16 v[16:19], v[28:31], a[136:143], v7
    v_smfmac_f32_16x16x64_bf16 v[8:11], v[28:31], v[80:87], v7
    v_smfmac_f32_16x16x64_bf16 v[36:39], v[28:31], v[88:95], v7
    s_waitcnt lgkmcnt(5)
    v_smfmac_f32_16x16x64_bf16 v[24:27], v[28:31], v[40:47], v7
    ds_read_b128 v[28:31], v2 offset:1024
    v_add_u32 v1, 0x10000, v0
    s_waitcnt lgkmcnt(5)
    v_smfmac_f32_16x16x64_bf16 v[12:15], v[32:35], a[0:7], v7
    ds_read_b128 v[40:43], v1 offset:0
    ds_read_b128 v[44:47], v1 offset:4096
    s_waitcnt lgkmcnt(5)
    v_smfmac_f32_16x16x64_bf16 v[20:23], v[32:35], v[48:55], v7
    ds_read_b128 v[48:51], v1 offset:8192
    ds_read_b128 v[52:55], v1 offset:12288
    v_smfmac_f32_16x16x64_bf16 v[16:19], v[32:35], a[8:15], v7
    v_smfmac_f32_16x16x64_bf16 v[8:11], v[32:35], a[144:151], v7
    v_smfmac_f32_16x16x64_bf16 v[36:39], v[32:35], a[152:159], v7
    s_waitcnt lgkmcnt(5)
    v_smfmac_f32_16x16x64_bf16 v[24:27], v[32:35], v[56:63], v7
    ds_read_b128 v[32:35], v2 offset:2048
    ds_read_b128 v[56:59], v1 offset:16384
    s_waitcnt lgkmcnt(6)
    v_smfmac_f32_16x16x64_bf16 v[12:15], v[28:31], a[16:23], v7
    ds_read_b128 v[60:63], v1 offset:20480
    s_waitcnt lgkmcnt(5)
    v_smfmac_f32_16x16x64_bf16 v[20:23], v[28:31], v[40:47], v7
    ds_read_b128 v[40:43], v1 offset:24576
    ds_read_b128 v[44:47], v1 offset:28672
    v_smfmac_f32_16x16x64_bf16 v[16:19], v[28:31], a[24:31], v7
    s_waitcnt vmcnt(4)
    s_barrier
    v_smfmac_f32_16x16x64_bf16 v[8:11], v[28:31], a[160:167], v7
    v_smfmac_f32_16x16x64_bf16 v[36:39], v[28:31], a[168:175], v7
    s_waitcnt lgkmcnt(5)
    v_smfmac_f32_16x16x64_bf16 v[24:27], v[28:31], v[48:55], v7
    ds_read_b128 v[28:31], v2 offset:7168
    ds_read_b128 v[48:51], v2 offset:11264
    s_waitcnt lgkmcnt(6)
    v_smfmac_f32_16x16x64_bf16 v[12:15], v[32:35], a[32:39], v7
    ds_read_b128 v[52:55], v2 offset:15360
    s_waitcnt lgkmcnt(5)
    v_smfmac_f32_16x16x64_bf16 v[20:23], v[32:35], v[56:63], v7
    ds_read_b128 v[56:59], v2 offset:12288
    ds_read_b128 v[60:63], v2 offset:16384
    v_smfmac_f32_16x16x64_bf16 v[16:19], v[32:35], a[40:47], v7
    v_smfmac_f32_16x16x64_bf16 v[8:11], v[32:35], a[176:183], v7
    s_waitcnt lgkmcnt(5)
    v_smfmac_f32_16x16x64_bf16 v[24:27], v[32:35], v[40:47], v7
    ds_read_b128 v[40:43], v2 offset:5120
    ds_read_b128 v[44:47], v2 offset:4096
    s_waitcnt lgkmcnt(6)
    v_smfmac_f32_16x16x64_bf16 v[12:15], v[28:31], a[112:119], v7
    v_smfmac_f32_16x16x64_bf16 v[16:19], v[28:31], a[120:127], v7
    v_smfmac_f32_16x16x64_bf16 v[20:23], v[28:31], v[240:247], v7
    v_smfmac_f32_16x16x64_bf16 v[24:27], v[28:31], v[248:255], v7
    v_mov_b32 v1, s47
    v_smfmac_f32_16x16x64_bf16 v[8:11], v[28:31], v[64:71], v7
    s_cmp_eq_u32 s24, 63
    s_cbranch_scc1 L_rlast_f2
    s_nop 0
    v_add_f32 v12, v12, v13
    v_add_f32 v14, v14, v15
    v_add_f32 v16, v16, v17
    v_add_f32 v18, v18, v19
    v_cvt_pk_bf16_f32 v13, v12, v16
    v_cvt_pk_bf16_f32 v15, v14, v18
    ds_write2_b32 v5, v13, v15 offset0:0 offset1:72
    v_add_f32 v20, v20, v21
    v_add_f32 v22, v22, v23
    v_add_f32 v24, v24, v25
    v_add_f32 v26, v26, v27
    v_cvt_pk_bf16_f32 v21, v20, v24
    v_cvt_pk_bf16_f32 v23, v22, v26
    ds_write_b32 v5, v21 offset:2304
    ds_write_b32 v5, v23 offset:2592
    ds_read_b128 v[24:27], v4 offset:128
    v_smfmac_f32_16x16x64_bf16 v[36:39], v[28:31], v[72:79], v7
    ds_read_b128 v[28:31], v4 offset:2432
    v_smfmac_f32_16x16x64_bf16 v[36:39], v[32:35], a[184:191], v7
    ds_read_b128 v[32:35], v2 offset:3072
    s_waitcnt lgkmcnt(7)
    v_smfmac_f32_16x16x64_bf16 v[36:39], v[40:43], a[232:239], v7
    s_waitcnt lgkmcnt(6)
    v_smfmac_f32_16x16x64_bf16 v[36:39], v[44:47], a[216:223], v7
    s_waitcnt lgkmcnt(3)
    s_barrier
    ds_read_b128 v[40:43], v4 offset:192
    ds_read_b128 v[44:47], v4 offset:2496
    s_waitcnt lgkmcnt(4)
    v_mfma_f32_16x16x32_bf16 v[12:15], v[48:51], v[24:27], 0
    ds_read_b128 v[48:51], v4 offset:0
    v_mfma_f32_16x16x32_bf16 v[16:19], v[52:55], v[24:27], 0
    ds_read_b128 v[52:55], v2 offset:9216
    s_waitcnt lgkmcnt(5)
    v_mfma_f32_16x16x32_bf16 v[20:23], v[28:31], v[24:27], 0
    ds_read_b128 v[28:31], v2 offset:13312
    ds_read_b128 v[24:27], v4 offset:2304
    s_waitcnt lgkmcnt(5)
    v_mfma_f32_16x16x32_bf16 v[12:15], v[56:59], v[40:43], v[12:15]
    ds_read_b128 v[56:59], v4 offset:64
    v_mfma_f32_16x16x32_bf16 v[16:19], v[60:63], v[40:43], v[16:19]
    ds_read_b128 v[60:63], v2 offset:10240
    s_waitcnt lgkmcnt(6)
    v_mfma_f32_16x16x32_bf16 v[20:23], v[44:47], v[40:43], v[20:23]
    ds_read_b128 v[44:47], v2 offset:14336
    ds_read_b128 v[40:43], v4 offset:2368
    s_waitcnt lgkmcnt(6)
    v_mfma_f32_16x16x32_bf16 v[12:15], v[52:55], v[48:51], v[12:15]
    s_waitcnt vmcnt(2)
    ds_read_b128 v[52:55], v0 offset:17408
    s_waitcnt lgkmcnt(6)
    v_mfma_f32_16x16x32_bf16 v[16:19], v[28:31], v[48:51], v[16:19]
    ds_read_b128 v[28:31], v0 offset:21504
    s_waitcnt lgkmcnt(6)
    v_mfma_f32_16x16x32_bf16 v[20:23], v[24:27], v[48:51], v[20:23]
    s_waitcnt lgkmcnt(4)
    v_mfma_f32_16x16x32_bf16 v[12:15], v[60:63], v[56:59], v[12:15]
    s_waitcnt lgkmcnt(3)
    v_mfma_f32_16x16x32_bf16 v[16:19], v[44:47], v[56:59], v[16:19]
    s_waitcnt lgkmcnt(2)
    v_mfma_f32_16x16x32_bf16 v[20:23], v[40:43], v[56:59], v[20:23]
    v_smfmac_f32_16x16x64_bf16 v[36:39], v[32:35], a[200:207], v7
    v_mov_b32 v49, 0
    v_mov_b32 v50, 0
    v_add_f32 v8, v8, v9
    v_add_f32 v10, v10, v11
    s_nop 0
    v_mov_b32_dpp v12, v16 quad_perm:[0,1,2,3] row_mask:0xf bank_mask:0xc
    v_mov_b32_dpp v13, v17 quad_perm:[0,1,2,3] row_mask:0xf bank_mask:0xc
    v_mov_b32_dpp v14, v18 quad_perm:[0,1,2,3] row_mask:0xf bank_mask:0xc
    v_mov_b32_dpp v15, v19 quad_perm:[0,1,2,3] row_mask:0xf bank_mask:0xc
    v_mov_b32_dpp v22, v23 quad_perm:[0,1,2,3] row_mask:0xf bank_mask:0xc
    v_mov_b32_dpp v20, v21 quad_perm:[0,1,2,3] row_mask:0x3 bank_mask:0xc
    v_max3_f32 v16, v12, v13, v14
    v_add_f32 v36, v36, v37
    v_mov_b32_dpp v20, v22 quad_perm:[0,1,2,3] row_mask:0xc bank_mask:0xf
    v_max3_f32 v16, v16, v15, v20
    v_pk_mul_f32 v[12:13], v[12:13], s[46:47] op_sel_hi:[1,0]
    v_pk_mul_f32 v[14:15], v[14:15], s[46:47] op_sel_hi:[1,0]
    v_max_f32_dpp v16, v16, v16 row_ror:8 row_mask:0xf bank_mask:0xf
    v_mov_b32 v17, v16
    v_mul_f32 v20, s46, v20
    v_add_f32 v38, v38, v39
    v_permlane16_swap_b32 v16, v17
    v_max_f32 v16, v16, v17
    v_mov_b32 v17, v16
    v_cvt_pk_bf16_f32 v22, v8, v10
    v_cvt_pk_bf16_f32 v23, v36, v38
    v_permlane32_swap_b32 v16, v17
    v_max_f32 v16, v16, v17
    v_mul_f32 v16, s46, v16
    v_sub_f32 v12, v12, v16
    v_sub_f32 v13, v13, v16
    v_sub_f32 v14, v14, v16
    v_sub_f32 v15, v15, v16
    v_sub_f32 v20, v20, v16
    v_exp_f32 v12, v12
    v_exp_f32 v13, v13
    v_exp_f32 v14, v14
    v_exp_f32 v15, v15
    v_cvt_pk_bf16_f32 v24, v12, v13
    v_cvt_pk_bf16_f32 v25, v14, v15
    v_exp_f32 v20, v20
    v_mov_b32_dpp v26, v24 row_ror:8 row_mask:0xf bank_mask:0xf
    v_mov_b32_dpp v27, v25 row_ror:8 row_mask:0xf bank_mask:0xf
    v_mov_b32_dpp v21, v20 row_ror:8 row_mask:0xf bank_mask:0xf
    v_add_f32 v18, v12, v13
    s_waitcnt lgkmcnt(0)
    v_mfma_f32_16x16x32_bf16 v[60:63], v[52:55], v[24:27], 0
    v_cvt_pk_bf16_f32 v48, v20, v21
    v_add_f32 v17, v14, v15
    v_mfma_f32_16x16x32_bf16 v[44:47], v[28:31], v[24:27], 0
    v_add_f32 v18, v18, v20
    v_add_f32 v18, v18, v17
    v_cvt_pk_bf16_f32 v51, v20, v21
    v_mfma_f32_16x16x16_bf16 v[60:63], v[22:23], v[48:49], v[60:63]
    v_add_f32_dpp v18, v18, v18 row_ror:8 row_mask:0xf bank_mask:0xf
    v_mov_b32 v17, v18
    v_mfma_f32_16x16x16_bf16 v[44:47], v[22:23], v[50:51], v[44:47]
    v_lshrrev_b32 v9, 2, v2
    v_permlane16_swap_b32 v18, v17
    v_add_f32 v18, v18, v17
    v_mov_b32 v17, v18
    v_and_b32 v8, 0x300, v2
    v_bfe_u32 v10, v2, 1, 7
    v_permlane32_swap_b32 v18, v17
    v_add_f32 v18, v18, v17
    v_rcp_f32 v18, v18
    v_lshl_or_b32 v8, v8, 4, v10
    v_pk_mul_f32 v[60:61], v[60:61], v[18:19] op_sel_hi:[1,0]
    v_pk_mul_f32 v[62:63], v[62:63], v[18:19] op_sel_hi:[1,0]
    v_pk_mul_f32 v[44:45], v[44:45], v[18:19] op_sel_hi:[1,0]
    v_pk_mul_f32 v[46:47], v[46:47], v[18:19] op_sel_hi:[1,0]
    v_cvt_pk_bf16_f32 v12, v60, v61
    v_cvt_pk_bf16_f32 v13, v62, v63
    v_cvt_pk_bf16_f32 v14, v44, v45
    v_cvt_pk_bf16_f32 v15, v46, v47
    ds_write_b128 v6, v[12:15]
    v_mov_b64 v[10:11], 0
    s_nop 1
    v_mfma_f32_32x32x8_bf16 v[28:43], v[10:11], v[10:11], 0
    v_mfma_f32_32x32x8_bf16 v[44:59], v[10:11], v[10:11], 0
    s_waitcnt lgkmcnt(0)
    s_barrier
    ds_read_b128 v[12:15], v3 offset:30208
    ds_read_b128 v[16:19], v3 offset:31232
    v_mov_b64 v[60:61], 0
    ds_write2_b32 v5, v22, v23 offset0:0 offset1:72
    v_mov_b64 v[62:63], 0
    s_waitcnt lgkmcnt(2)
    s_nop 0
    v_smfmac_f32_16x16x64_bf16 v[28:31], v[12:15], v[224:231], v7
    s_waitcnt lgkmcnt(1)
    v_smfmac_f32_16x16x64_bf16 v[28:31], v[16:19], v[232:239], v7
    s_nop 1
    v_smfmac_f32_16x16x64_bf16 v[32:35], v[12:15], v[96:103], v7
    s_nop 1
    v_smfmac_f32_16x16x64_bf16 v[32:35], v[16:19], v[104:111], v7
    s_nop 1
    v_smfmac_f32_16x16x64_bf16 v[36:39], v[12:15], v[112:119], v7
    v_add_f32 v28, v28, v29
    v_add_f32 v29, v30, v31
    v_smfmac_f32_16x16x64_bf16 v[36:39], v[16:19], v[120:127], v7
    v_cvt_pk_bf16_f32 v30, v28, v29
    v_bfi_b32 v30, 1, v1, v30
    global_store_dword v9, v30, s[42:43]
    v_smfmac_f32_16x16x64_bf16 v[40:43], v[12:15], v[128:135], v7
    v_add_f32 v32, v32, v33
    v_add_f32 v33, v34, v35
    v_smfmac_f32_16x16x64_bf16 v[40:43], v[16:19], v[136:143], v7
    s_nop 1
    v_smfmac_f32_16x16x64_bf16 v[44:47], v[12:15], v[144:151], v7
    v_add_f32 v36, v36, v37
    v_add_f32 v37, v38, v39
    v_smfmac_f32_16x16x64_bf16 v[44:47], v[16:19], v[152:159], v7
    v_cvt_pk_bf16_f32 v38, v32, v36
    v_cvt_pk_bf16_f32 v39, v33, v37
    v_bfi_b32 v38, 1, v1, v38
    v_smfmac_f32_16x16x64_bf16 v[48:51], v[12:15], v[160:167], v7
    global_store_dwordx2 v8, v[38:39], s[26:27]
    v_add_f32 v40, v40, v41
    v_add_f32 v41, v42, v43
    v_smfmac_f32_16x16x64_bf16 v[48:51], v[16:19], v[168:175], v7
    v_add_f32 v44, v44, v45
    v_add_f32 v45, v46, v47
    v_smfmac_f32_16x16x64_bf16 v[52:55], v[12:15], v[176:183], v7
    v_cvt_pk_bf16_f32 v46, v40, v44
    v_cvt_pk_bf16_f32 v47, v41, v45
    v_bfi_b32 v46, 1, v1, v46
    v_smfmac_f32_16x16x64_bf16 v[52:55], v[16:19], v[184:191], v7
    global_store_dwordx2 v8, v[46:47], s[90:91]
    v_add_f32 v48, v48, v49
    v_smfmac_f32_16x16x64_bf16 v[56:59], v[12:15], v[192:199], v7
    v_add_f32 v49, v50, v51
    v_smfmac_f32_16x16x64_bf16 v[56:59], v[16:19], v[200:207], v7
    s_nop 1
    v_smfmac_f32_16x16x64_bf16 v[60:63], v[12:15], v[208:215], v7
    v_add_f32 v52, v52, v53
    v_add_f32 v53, v54, v55
    v_smfmac_f32_16x16x64_bf16 v[60:63], v[16:19], v[216:223], v7
    v_cvt_pk_bf16_f32 v54, v48, v52
    v_cvt_pk_bf16_f32 v55, v49, v53
    v_bfi_b32 v54, 1, v1, v54
    global_store_dwordx2 v8, v[54:55], s[92:93]
    v_add_f32 v56, v56, v57
    v_add_f32 v57, v58, v59
    s_nop 1
    v_add_f32 v60, v60, v61
    v_add_f32 v61, v62, v63
    v_cvt_pk_bf16_f32 v62, v56, v60
    v_cvt_pk_bf16_f32 v63, v57, v61
    v_bfi_b32 v62, 1, v1, v62
    global_store_dwordx2 v8, v[62:63], s[94:95]
    v_mov_b32 v9, 0x0
    v_bfe_u32 v10, v2, 4, 1
    v_lshl_add_u32 v9, v10, 4, v9
    v_bfe_u32 v10, v2, 5, 5
    v_lshl_add_u32 v9, v10, 8, v9
    global_load_dwordx4 v[24:27], v9, s[28:29] sc1
    s_lshl_b32 s13, s24, 17
    s_add_u32 s38, s50, s13
    s_addc_u32 s39, s51, 0
    s_add_u32 s25, s24, 2
    s_min_u32 s25, s25, 63
    s_lshl_b32 s13, s25, 19
    s_add_u32 s58, s88, s13
    s_addc_u32 s59, s89, 0
    s_add_u32 s86, s86, 524288
    s_addc_u32 s87, s87, 0
    s_add_u32 s32, s32, 524288
    s_addc_u32 s33, s33, 0
    s_add_u32 s14, s30, s34
    s_addc_u32 s15, s31, 0
    s_add_u32 s60, s30, s35
    s_addc_u32 s61, s31, 0
    s_add_u32 s20, s14, 4096
    s_addc_u32 s21, s15, 0
    s_and_b32 s12, s24, 1
    s_xor_b32 s13, s12, 1
    s_xor_b32 s47, s13, s40
    s_add_u32 s24, s24, 1
    s_mov_b32 s35, s34
    s_add_u32 s34, s34, 9216
    s_cmp_eq_u32 s34, 27648
    s_cselect_b32 s34, 0, s34
    s_mov_b32 s55, 0
    v_add_u32 v1, 0x10000, v0
    ds_read_b128 v[40:43], v1 offset:32768
    ds_read_b128 v[44:47], v1 offset:36864
    v_add_u32 v1, 0x10000, v0
    ds_read_b128 v[48:51], v1 offset:40960
    ds_read_b128 v[52:55], v1 offset:45056
    v_add_u32 v1, 0x10000, v0
    ds_read_b128 v[56:59], v1 offset:49152
    ds_read_b128 v[60:63], v1 offset:53248
    v_bfe_u32 v20, v2, 6, 1
    v_bfe_u32 v22, v2, 4, 2
    v_bfe_u32 v23, v2, 8, 1
    v_xor_b32 v23, s12, v23
    v_lshlrev_b32 v20, 4, v20
    v_mov_b32 v21, 0x3f80
    v_lshlrev_b32 v21, v20, v21
    v_cmp_eq_u32 vcc, 0, v22
    v_mov_b32 v8, 0x0
    v_bfe_u32 v10, v2, 4, 1
    v_cndmask_b32 v12, 0, v21, vcc
    v_cmp_eq_u32 vcc, 1, v22
    v_lshlrev_b32 v10, 3, v10
    v_xor_b32 v8, v8, v10
    v_cndmask_b32 v13, 0, v21, vcc
    v_cmp_eq_u32 vcc, 2, v22
    v_bfe_u32 v10, v2, 8, 1
    v_lshlrev_b32 v10, 5, v10
    v_cndmask_b32 v14, 0, v21, vcc
    v_cmp_eq_u32 vcc, 3, v22
    v_xor_b32 v8, v8, v10
    v_xor_b32 v8, s41, v8
    v_cndmask_b32 v15, 0, v21, vcc
    v_mov_b64 v[10:11], -1
L_rp1_f2:
    s_waitcnt vmcnt(0)
    v_mfma_f32_16x16x32_bf16 v[16:19], v[12:15], v[24:27], 0
    v_bitop3_b32 v20, v24, v25, v23 bitop3:0x7e
    v_bitop3_b32 v21, v26, v27, v23 bitop3:0x7e
    v_bitop3_b32 v20, v20, v21, 1 bitop3:0xa8
    v_cmp_ne_u32 vcc, 0, v20
    s_nop 3
    v_add_f32_dpp v16, v16, v16 row_ror:8 row_mask:0xf bank_mask:0xf
    v_add_f32_dpp v17, v17, v17 row_ror:8 row_mask:0xf bank_mask:0xf
    v_add_f32_dpp v18, v18, v18 row_ror:8 row_mask:0xf bank_mask:0xf
    v_add_f32_dpp v19, v19, v19 row_ror:8 row_mask:0xf bank_mask:0xf
    v_add_f32_dpp v16, v16, v16 row_ror:4 row_mask:0xf bank_mask:0xf
    v_add_f32_dpp v17, v17, v17 row_ror:4 row_mask:0xf bank_mask:0xf
    v_add_f32_dpp v18, v18, v18 row_ror:4 row_mask:0xf bank_mask:0xf
    v_add_f32_dpp v19, v19, v19 row_ror:4 row_mask:0xf bank_mask:0xf
    v_add_f32_dpp v16, v16, v16 quad_perm:[2,3,0,1] row_mask:0xf bank_mask:0xf
    v_add_f32_dpp v17, v17, v17 quad_perm:[2,3,0,1] row_mask:0xf bank_mask:0xf
    v_add_f32_dpp v18, v18, v18 quad_perm:[2,3,0,1] row_mask:0xf bank_mask:0xf
    v_add_f32_dpp v19, v19, v19 quad_perm:[2,3,0,1] row_mask:0xf bank_mask:0xf
    v_cvt_pk_bf16_f32 v20, v16, v17
    v_cvt_pk_bf16_f32 v21, v18, v19
    s_mov_b64 exec, s[44:45]
    s_cbranch_vccnz L_rp1_f2_rt
    global_store_dwordx2 v8, v[20:21], s[14:15]
    global_store_dwordx2 v8, v[10:11], s[60:61]
    s_mov_b64 exec, -1
    s_barrier
    s_mov_b32 s55, 0
    ds_read_b32 v36, v5 offset:2304
    ds_read_b32 v37, v5 offset:2592
    ds_read2_b32 v[38:39], v5 offset0:0 offset1:72
    v_mov_b64 v[12:13], 0
    v_mov_b64 v[14:15], 0
    v_mov_b64 v[16:17], 0
    v_mov_b64 v[18:19], 0
    v_mov_b64 v[20:21], 0
    v_mov_b64 v[22:23], 0
    v_mov_b64 v[24:25], 0
    v_mov_b64 v[26:27], 0
    global_load_dwordx4 v[28:31], v2, s[20:21] offset:-1024 sc1
    global_load_dwordx4 v[32:35], v2, s[20:21] offset:0 sc1
    v_mov_b64 v[8:9], 0
    v_mov_b64 v[10:11], 0
    s_mov_b32 m0, s62
    s_branch L_rp2_f2
L_rf2_f2:
    s_mov_b64 exec, vcc
    global_load_dwordx4 v[28:31], v2, s[20:21] offset:-1024 sc1
    global_load_dwordx4 v[32:35], v2, s[20:21] offset:0 sc1
    s_mov_b64 exec, -1
    v_mov_b64 v[12:13], 0
    v_mov_b64 v[14:15], 0
    v_mov_b64 v[16:17], 0
    v_mov_b64 v[18:19], 0
    s_add_u32 s55, s55, 1
    s_cmp_gt_u32 s55, 100000
    s_cbranch_scc0 L_rp2_f2
    s_branch L_rx_f2
L_rp1_f2_rt:
    s_mov_b64 exec, vcc
    global_load_dwordx4 v[24:27], v9, s[28:29] sc1
    s_mov_b64 exec, -1
    s_cmp_le_u32 s55, 2
    s_cbranch_scc1 L_bo_52
    s_sleep 4
L_bo_52:
    s_add_u32 s55, s55, 1
    s_cmp_gt_u32 s55, 100000
    s_cbranch_scc0 L_rp1_f2
    s_branch L_rx_f2
L_rp2ok_f2:
    s_branch L_rp2_f2
L_rlast_f2:
    s_lshl_b32 s13, s24, 17
    s_add_u32 s38, s50, s13
    s_addc_u32 s39, s51, 0
    s_waitcnt lgkmcnt(0)
    ds_read_b128 v[12:15], v2 offset:3072
    v_smfmac_f32_16x16x64_bf16 v[36:39], v[28:31], v[72:79], v7
    v_smfmac_f32_16x16x64_bf16 v[36:39], v[32:35], a[184:191], v7
    v_smfmac_f32_16x16x64_bf16 v[36:39], v[40:43], a[232:239], v7
    v_smfmac_f32_16x16x64_bf16 v[36:39], v[44:47], a[216:223], v7
    s_waitcnt lgkmcnt(0)
    v_smfmac_f32_16x16x64_bf16 v[36:39], v[12:15], a[200:207], v7
    v_add_f32 v20, v20, v21
    v_add_f32 v22, v22, v23
    v_add_f32 v24, v24, v25
    v_add_f32 v26, v26, v27
    v_cvt_pk_bf16_f32 v16, v20, v24
    v_cvt_pk_bf16_f32 v17, v22, v26
    s_nop 1
    v_add_f32 v36, v36, v37
    v_add_f32 v38, v38, v39
    v_add_f32 v8, v8, v9
    v_add_f32 v10, v10, v11
    v_cvt_pk_bf16_f32 v18, v8, v10
    v_cvt_pk_bf16_f32 v19, v36, v38
    global_store_dwordx4 v0, v[16:19], s[38:39] sc1
L_rx_f2:
    s_endpgm
L_rent_f3:
    v_add_u32 v1, 0x20000, v0
    ds_read_b128 v[40:43], v1 offset:0
    ds_read_b128 v[44:47], v1 offset:4096
    v_add_u32 v1, 0x20000, v0
    ds_read_b128 v[48:51], v1 offset:8192
    ds_read_b128 v[52:55], v1 offset:12288
    v_add_u32 v1, 0x20000, v0
    ds_read_b128 v[56:59], v1 offset:16384
    ds_read_b128 v[60:63], v1 offset:20480
    ds_read_b128 v[28:31], v2 offset:5120
    ds_read_b128 v[32:35], v2 offset:6144
    v_mov_b64 v[8:9], 0
    v_mov_b64 v[10:11], 0
    v_mov_b64 v[12:13], 0
    v_mov_b64 v[14:15], 0
    v_mov_b64 v[16:17], 0
    v_mov_b64 v[18:19], 0
    v_mov_b64 v[20:21], 0
    v_mov_b64 v[22:23], 0
    v_mov_b64 v[24:25], 0
    v_mov_b64 v[26:27], 0
    s_mov_b32 m0, s62
    s_mov_b32 s55, 0
    s_mov_b32 s47, s40
    s_mov_b64 s[20:21], s[30:31]
    s_waitcnt lgkmcnt(0)
    v_smfmac_f32_16x16x64_bf16 v[12:15], v[28:31], a[80:87], v7
    v_smfmac_f32_16x16x64_bf16 v[16:19], v[28:31], a[88:95], v7
    s_branch L_rgo_f3
.p2align 6
L_rp2_f3:
    s_waitcnt vmcnt(1)
    v_smfmac_f32_16x16x64_bf16 v[12:15], v[28:31], a[80:87], v7
    v_max_u32 v1, v28, v30
    s_waitcnt vmcnt(0)
    v_max3_u32 v1, v1, v32, v34
    v_cmp_eq_u32 vcc, -1, v1
    v_smfmac_f32_16x16x64_bf16 v[16:19], v[28:31], a[88:95], v7
    ds_write_b128 v2, v[28:31] offset:5120
    s_cbranch_vccnz L_rf2_f3
L_rgo_f3:
    v_smfmac_f32_16x16x64_bf16 v[8:11], v[28:31], a[224:231], v7
    ds_write_b128 v2, v[32:35] offset:6144
    s_waitcnt lgkmcnt(2)
    v_smfmac_f32_16x16x64_bf16 v[20:23], v[28:31], v[40:47], v7
    v_add_u32 v1, 0x20000, v0
    ds_read_b128 v[40:43], v1 offset:24576
    v_smfmac_f32_16x16x64_bf16 v[24:27], v[28:31], v[48:55], v7
    ds_read_b128 v[44:47], v1 offset:28672
    ds_read_b128 v[48:51], v0 offset:32768
    v_smfmac_f32_16x16x64_bf16 v[12:15], v[32:35], a[96:103], v7
    s_waitcnt lgkmcnt(3)
    s_barrier
    ds_read_b128 v[28:31], v2 offset:8192
    v_smfmac_f32_16x16x64_bf16 v[20:23], v[32:35], v[56:63], v7
    global_load_lds_dwordx4 v2, s[32:33]
    ds_read_b128 v[52:55], v0 offset:36864
    v_smfmac_f32_16x16x64_bf16 v[16:19], v[32:35], a[104:111], v7
    global_load_lds_dwordx4 v2, s[32:33] offset:1024
    s_mov_b32 m0, s63
    ds_read_b128 v[56:59], v0 offset:40960
    v_smfmac_f32_16x16x64_bf16 v[8:11], v[32:35], a[240:247], v7
    global_load_lds_dwordx4 v2, s[86:87]
    s_add_u32 m0, s63, 3072
    ds_read_b128 v[60:63], v0 offset:45056
    s_waitcnt lgkmcnt(5)
    v_smfmac_f32_16x16x64_bf16 v[24:27], v[32:35], v[40:47], v7
    global_load_lds_dwordx4 v2, s[86:87] offset:1024
    s_mov_b32 m0, 32256
    ds_read_b128 v[32:35], v2 offset:0
    s_waitcnt lgkmcnt(4)
    v_smfmac_f32_16x16x64_bf16 v[12:15], v[28:31], a[128:135], v7
    ds_read_b128 v[40:43], v0 offset:49152
    ds_read_b128 v[44:47], v0 offset:53248
    s_waitcnt lgkmcnt(5)
    v_smfmac_f32_16x16x64_bf16 v[20:23], v[28:31], v[48:55], v7
    global_store_dwordx4 v0, v[36:39], s[38:39] sc1
    ds_read_b128 v[48:51], v0 offset:57344
    v_smfmac_f32_16x16x64_bf16 v[16:19], v[28:31], a[136:143], v7
    ds_read_b128 v[52:55], v0 offset:61440
    v_smfmac_f32_16x16x64_bf16 v[8:11], v[28:31], v[80:87], v7
    v_lshlrev_b32 v36, 2, v0
    global_load_lds_dword v36, s[58:59]
    s_mov_b32 m0, 25856
    v_mov_b64 v[36:37], 0
    v_mov_b64 v[38:39], 0
    s_waitcnt lgkmcnt(5)
    v_smfmac_f32_16x16x64_bf16 v[24:27], v[28:31], v[56:63], v7
    ds_read_b128 v[28:31], v2 offset:1024
    v_add_u32 v1, 0x10000, v0
    s_waitcnt lgkmcnt(5)
    v_smfmac_f32_16x16x64_bf16 v[12:15], v[32:35], a[0:7], v7
    ds_read_b128 v[56:59], v1 offset:0
    ds_read_b128 v[60:63], v1 offset:4096
    s_waitcnt lgkmcnt(5)
    v_smfmac_f32_16x16x64_bf16 v[20:23], v[32:35], v[40:47], v7
    ds_read_b128 v[40:43], v1 offset:8192
    ds_read_b128 v[44:47], v1 offset:12288
    v_smfmac_f32_16x16x64_bf16 v[16:19], v[32:35], a[8:15], v7
    s_mov_b64 exec, 1
    global_load_lds_dwordx4 v2, s[18:19] sc1
    s_mov_b64 exec, -1
    v_smfmac_f32_16x16x64_bf16 v[8:11], v[32:35], a[144:151], v7
    v_smfmac_f32_16x16x64_bf16 v[36:39], v[32:35], a[152:159], v7
    s_waitcnt lgkmcnt(5)
    v_smfmac_f32_16x16x64_bf16 v[24:27], v[32:35], v[48:55], v7
    ds_read_b128 v[32:35], v2 offset:2048
    ds_read_b128 v[48:51], v1 offset:16384
    s_waitcnt lgkmcnt(6)
    v_smfmac_f32_16x16x64_bf16 v[12:15], v[28:31], a[16:23], v7
    ds_read_b128 v[52:55], v1 offset:20480
    s_waitcnt lgkmcnt(5)
    v_smfmac_f32_16x16x64_bf16 v[20:23], v[28:31], v[56:63], v7
    ds_read_b128 v[56:59], v1 offset:24576
    ds_read_b128 v[60:63], v1 offset:28672
    v_smfmac_f32_16x16x64_bf16 v[16:19], v[28:31], a[24:31], v7
    v_smfmac_f32_16x16x64_bf16 v[8:11], v[28:31], a[160:167], v7
    v_smfmac_f32_16x16x64_bf16 v[36:39], v[28:31], a[168:175], v7
    s_waitcnt lgkmcnt(5)
    v_smfmac_f32_16x16x64_bf16 v[24:27], v[28:31], v[40:47], v7
    ds_read_b128 v[28:31], v2 offset:3072
    ds_read_b128 v[40:43], v1 offset:32768
    s_waitcnt lgkmcnt(6)
    v_smfmac_f32_16x16x64_bf16 v[12:15], v[32:35], a[32:39], v7
    ds_read_b128 v[44:47], v1 offset:36864
    s_waitcnt lgkmcnt(5)
    v_smfmac_f32_16x16x64_bf16 v[20:23], v[32:35], v[48:55], v7
    ds_read_b128 v[48:51], v1 offset:40960
    ds_read_b128 v[52:55], v1 offset:45056
    v_smfmac_f32_16x16x64_bf16 v[16:19], v[32:35], a[40:47], v7
    v_smfmac_f32_16x16x64_bf16 v[8:11], v[32:35], a[176:183], v7
    v_smfmac_f32_16x16x64_bf16 v[36:39], v[32:35], a[184:191], v7
    s_waitcnt lgkmcnt(5)
    v_smfmac_f32_16x16x64_bf16 v[24:27], v[32:35], v[56:63], v7
    ds_read_b128 v[32:35], v2 offset:4096
    ds_read_b128 v[56:59], v1 offset:49152
    s_waitcnt lgkmcnt(6)
    v_smfmac_f32_16x16x64_bf16 v[12:15], v[28:31], a[48:55], v7
    ds_read_b128 v[60:63], v1 offset:53248
    s_waitcnt lgkmcnt(5)
    v_smfmac_f32_16x16x64_bf16 v[20:23], v[28:31], v[40:47], v7
    ds_read_b128 v[40:43], v1 offset:57344
    ds_read_b128 v[44:47], v1 offset:61440
    v_smfmac_f32_16x16x64_bf16 v[16:19], v[28:31], a[56:63], v7
    s_waitcnt vmcnt(5)
    s_barrier
    v_smfmac_f32_16x16x64_bf16 v[8:11], v[28:31], a[192:199], v7
    v_smfmac_f32_16x16x64_bf16 v[36:39], v[28:31], a[200:207], v7
    s_waitcnt lgkmcnt(5)
    v_smfmac_f32_16x16x64_bf16 v[24:27], v[28:31], v[48:55], v7
    ds_read_b128 v[28:31], v2 offset:7168
    ds_read_b128 v[48:51], v2 offset:12288
    s_waitcnt lgkmcnt(6)
    v_smfmac_f32_16x16x64_bf16 v[12:15], v[32:35], a[64:71], v7
    ds_read_b128 v[52:55], v2 offset:16384
    s_waitcnt lgkmcnt(5)
    v_smfmac_f32_16x16x64_bf16 v[20:23], v[32:35], v[56:63], v7
    ds_read_b128 v[56:59], v2 offset:9216
    ds_read_b128 v[60:63], v2 offset:13312
    v_smfmac_f32_16x16x64_bf16 v[16:19], v[32:35], a[72:79], v7
    v_smfmac_f32_16x16x64_bf16 v[8:11], v[32:35], a[208:215], v7
    s_waitcnt lgkmcnt(5)
    v_smfmac_f32_16x16x64_bf16 v[24:27], v[32:35], v[40:47], v7
    ds_read_b128 v[40:43], v2 offset:8192
    ds_read_b128 v[44:47], v2 offset:6144
    s_waitcnt lgkmcnt(6)
    v_smfmac_f32_16x16x64_bf16 v[12:15], v[28:31], a[112:119], v7
    v_smfmac_f32_16x16x64_bf16 v[16:19], v[28:31], a[120:127], v7
    v_smfmac_f32_16x16x64_bf16 v[20:23], v[28:31], v[240:247], v7
    v_smfmac_f32_16x16x64_bf16 v[24:27], v[28:31], v[248:255], v7
    v_mov_b32 v1, s47
    v_smfmac_f32_16x16x64_bf16 v[8:11], v[28:31], v[64:71], v7
    s_cmp_eq_u32 s24, 63
    s_cbranch_scc1 L_rlast_f3
    s_nop 0
    v_add_f32 v12, v12, v13
    v_add_f32 v14, v14, v15
    v_add_f32 v16, v16, v17
    v_add_f32 v18, v18, v19
    v_cvt_pk_bf16_f32 v13, v12, v16
    v_cvt_pk_bf16_f32 v15, v14, v18
    ds_write2_b32 v5, v13, v15 offset0:0 offset1:72
    v_add_f32 v20, v20, v21
    v_add_f32 v22, v22, v23
    v_add_f32 v24, v24, v25
    v_add_f32 v26, v26, v27
    v_cvt_pk_bf16_f32 v21, v20, v24
    v_cvt_pk_bf16_f32 v23, v22, v26
    ds_write_b32 v5, v21 offset:2304
    ds_write_b32 v5, v23 offset:2592
    ds_read_b128 v[24:27], v4 offset:192
    v_smfmac_f32_16x16x64_bf16 v[36:39], v[28:31], v[72:79], v7
    ds_read_b128 v[28:31], v4 offset:2496
    v_smfmac_f32_16x16x64_bf16 v[36:39], v[32:35], a[216:223], v7
    ds_read_b128 v[32:35], v2 offset:5120
    s_waitcnt lgkmcnt(7)
    v_smfmac_f32_16x16x64_bf16 v[36:39], v[40:43], v[88:95], v7
    s_waitcnt lgkmcnt(6)
    v_smfmac_f32_16x16x64_bf16 v[36:39], v[44:47], a[248:255], v7
    s_waitcnt lgkmcnt(3)
    s_barrier
    ds_read_b128 v[40:43], v4 offset:0
    ds_read_b128 v[44:47], v4 offset:2304
    s_waitcnt lgkmcnt(4)
    v_mfma_f32_16x16x32_bf16 v[12:15], v[48:51], v[24:27], 0
    ds_read_b128 v[48:51], v4 offset:64
    v_mfma_f32_16x16x32_bf16 v[16:19], v[52:55], v[24:27], 0
    ds_read_b128 v[52:55], v2 offset:10240
    s_waitcnt lgkmcnt(5)
    v_mfma_f32_16x16x32_bf16 v[20:23], v[28:31], v[24:27], 0
    ds_read_b128 v[28:31], v2 offset:14336
    ds_read_b128 v[24:27], v4 offset:2368
    s_waitcnt lgkmcnt(5)
    v_mfma_f32_16x16x32_bf16 v[12:15], v[56:59], v[40:43], v[12:15]
    ds_read_b128 v[56:59], v4 offset:128
    v_mfma_f32_16x16x32_bf16 v[16:19], v[60:63], v[40:43], v[16:19]
    ds_read_b128 v[60:63], v2 offset:11264
    s_waitcnt lgkmcnt(6)
    v_mfma_f32_16x16x32_bf16 v[20:23], v[44:47], v[40:43], v[20:23]
    ds_read_b128 v[44:47], v2 offset:15360
    ds_read_b128 v[40:43], v4 offset:2432
    s_waitcnt lgkmcnt(6)
    v_mfma_f32_16x16x32_bf16 v[12:15], v[52:55], v[48:51], v[12:15]
    s_waitcnt vmcnt(3)
    ds_read_b128 v[52:55], v0 offset:17408
    s_waitcnt lgkmcnt(6)
    v_mfma_f32_16x16x32_bf16 v[16:19], v[28:31], v[48:51], v[16:19]
    ds_read_b128 v[28:31], v0 offset:21504
    s_waitcnt lgkmcnt(6)
    v_mfma_f32_16x16x32_bf16 v[20:23], v[24:27], v[48:51], v[20:23]
    s_waitcnt lgkmcnt(4)
    v_mfma_f32_16x16x32_bf16 v[12:15], v[60:63], v[56:59], v[12:15]
    s_waitcnt lgkmcnt(3)
    v_mfma_f32_16x16x32_bf16 v[16:19], v[44:47], v[56:59], v[16:19]
    s_waitcnt lgkmcnt(2)
    v_mfma_f32_16x16x32_bf16 v[20:23], v[40:43], v[56:59], v[20:23]
    v_smfmac_f32_16x16x64_bf16 v[36:39], v[32:35], a[232:239], v7
    v_mov_b32 v49, 0
    v_mov_b32 v50, 0
    v_add_f32 v8, v8, v9
    v_add_f32 v10, v10, v11
    s_nop 0
    v_mov_b32_dpp v12, v16 quad_perm:[0,1,2,3] row_mask:0xf bank_mask:0xc
    v_mov_b32_dpp v13, v17 quad_perm:[0,1,2,3] row_mask:0xf bank_mask:0xc
    v_mov_b32_dpp v14, v18 quad_perm:[0,1,2,3] row_mask:0xf bank_mask:0xc
    v_mov_b32_dpp v15, v19 quad_perm:[0,1,2,3] row_mask:0xf bank_mask:0xc
    v_mov_b32_dpp v22, v23 quad_perm:[0,1,2,3] row_mask:0xf bank_mask:0xc
    v_mov_b32_dpp v20, v21 quad_perm:[0,1,2,3] row_mask:0x3 bank_mask:0xc
    v_max3_f32 v16, v12, v13, v14
    v_add_f32 v36, v36, v37
    v_mov_b32_dpp v20, v22 quad_perm:[0,1,2,3] row_mask:0xc bank_mask:0xf
    v_max3_f32 v16, v16, v15, v20
    v_pk_mul_f32 v[12:13], v[12:13], s[46:47] op_sel_hi:[1,0]
    v_pk_mul_f32 v[14:15], v[14:15], s[46:47] op_sel_hi:[1,0]
    v_max_f32_dpp v16, v16, v16 row_ror:8 row_mask:0xf bank_mask:0xf
    v_mov_b32 v17, v16
    v_mul_f32 v20, s46, v20
    v_add_f32 v38, v38, v39
    v_permlane16_swap_b32 v16, v17
    v_max_f32 v16, v16, v17
    v_mov_b32 v17, v16
    v_cvt_pk_bf16_f32 v22, v8, v10
    v_cvt_pk_bf16_f32 v23, v36, v38
    v_permlane32_swap_b32 v16, v17
    v_max_f32 v16, v16, v17
    v_mul_f32 v16, s46, v16
    v_sub_f32 v12, v12, v16
    v_sub_f32 v13, v13, v16
    v_sub_f32 v14, v14, v16
    v_sub_f32 v15, v15, v16
    v_sub_f32 v20, v20, v16
    v_exp_f32 v12, v12
    v_exp_f32 v13, v13
    v_exp_f32 v14, v14
    v_exp_f32 v15, v15
    v_cvt_pk_bf16_f32 v24, v12, v13
    v_cvt_pk_bf16_f32 v25, v14, v15
    v_exp_f32 v20, v20
    v_mov_b32_dpp v26, v24 row_ror:8 row_mask:0xf bank_mask:0xf
    v_mov_b32_dpp v27, v25 row_ror:8 row_mask:0xf bank_mask:0xf
    v_mov_b32_dpp v21, v20 row_ror:8 row_mask:0xf bank_mask:0xf
    v_add_f32 v18, v12, v13
    s_waitcnt lgkmcnt(0)
    v_mfma_f32_16x16x32_bf16 v[60:63], v[52:55], v[24:27], 0
    v_cvt_pk_bf16_f32 v48, v20, v21
    v_add_f32 v17, v14, v15
    v_mfma_f32_16x16x32_bf16 v[44:47], v[28:31], v[24:27], 0
    v_add_f32 v18, v18, v20
    v_add_f32 v18, v18, v17
    v_cvt_pk_bf16_f32 v51, v20, v21
    v_mfma_f32_16x16x16_bf16 v[60:63], v[22:23], v[48:49], v[60:63]
    v_add_f32_dpp v18, v18, v18 row_ror:8 row_mask:0xf bank_mask:0xf
    v_mov_b32 v17, v18
    v_mfma_f32_16x16x16_bf16 v[44:47], v[22:23], v[50:51], v[44:47]
    v_lshrrev_b32 v9, 2, v2
    v_permlane16_swap_b32 v18, v17
    v_add_f32 v18, v18, v17
    v_mov_b32 v17, v18
    v_and_b32 v8, 0x300, v2
    v_bfe_u32 v10, v2, 1, 7
    v_permlane32_swap_b32 v18, v17
    v_add_f32 v18, v18, v17
    v_rcp_f32 v18, v18
    v_lshl_or_b32 v8, v8, 4, v10
    v_pk_mul_f32 v[60:61], v[60:61], v[18:19] op_sel_hi:[1,0]
    v_pk_mul_f32 v[62:63], v[62:63], v[18:19] op_sel_hi:[1,0]
    v_pk_mul_f32 v[44:45], v[44:45], v[18:19] op_sel_hi:[1,0]
    v_pk_mul_f32 v[46:47], v[46:47], v[18:19] op_sel_hi:[1,0]
    v_cvt_pk_bf16_f32 v12, v60, v61
    v_cvt_pk_bf16_f32 v13, v62, v63
    v_cvt_pk_bf16_f32 v14, v44, v45
    v_cvt_pk_bf16_f32 v15, v46, v47
    ds_write_b128 v6, v[12:15]
    v_mov_b64 v[10:11], 0
    s_nop 1
    v_mfma_f32_32x32x8_bf16 v[28:43], v[10:11], v[10:11], 0
    v_mfma_f32_32x32x8_bf16 v[44:59], v[10:11], v[10:11], 0
    s_waitcnt lgkmcnt(0)
    s_barrier
    ds_read_b128 v[12:15], v3 offset:30208
    ds_read_b128 v[16:19], v3 offset:31232
    v_mov_b64 v[60:61], 0
    ds_write2_b32 v5, v22, v23 offset0:0 offset1:72
    v_mov_b64 v[62:63], 0
    s_waitcnt lgkmcnt(2)
    s_nop 0
    v_smfmac_f32_16x16x64_bf16 v[28:31], v[12:15], v[224:231], v7
    s_waitcnt lgkmcnt(1)
    v_smfmac_f32_16x16x64_bf16 v[28:31], v[16:19], v[232:239], v7
    s_nop 1
    v_smfmac_f32_16x16x64_bf16 v[32:35], v[12:15], v[96:103], v7
    s_nop 1
    v_smfmac_f32_16x16x64_bf16 v[32:35], v[16:19], v[104:111], v7
    s_nop 1
    v_smfmac_f32_16x16x64_bf16 v[36:39], v[12:15], v[112:119], v7
    v_add_f32 v28, v28, v29
    v_add_f32 v29, v30, v31
    v_smfmac_f32_16x16x64_bf16 v[36:39], v[16:19], v[120:127], v7
    v_cvt_pk_bf16_f32 v30, v28, v29
    v_bfi_b32 v30, 1, v1, v30
    global_store_dword v9, v30, s[42:43]
    v_smfmac_f32_16x16x64_bf16 v[40:43], v[12:15], v[128:135], v7
    v_add_f32 v32, v32, v33
    v_add_f32 v33, v34, v35
    v_smfmac_f32_16x16x64_bf16 v[40:43], v[16:19], v[136:143], v7
    s_nop 1
    v_smfmac_f32_16x16x64_bf16 v[44:47], v[12:15], v[144:151], v7
    v_add_f32 v36, v36, v37
    v_add_f32 v37, v38, v39
    v_smfmac_f32_16x16x64_bf16 v[44:47], v[16:19], v[152:159], v7
    v_cvt_pk_bf16_f32 v38, v32, v36
    v_cvt_pk_bf16_f32 v39, v33, v37
    v_bfi_b32 v38, 1, v1, v38
    v_smfmac_f32_16x16x64_bf16 v[48:51], v[12:15], v[160:167], v7
    global_store_dwordx2 v8, v[38:39], s[26:27]
    v_add_f32 v40, v40, v41
    v_add_f32 v41, v42, v43
    v_smfmac_f32_16x16x64_bf16 v[48:51], v[16:19], v[168:175], v7
    v_add_f32 v44, v44, v45
    v_add_f32 v45, v46, v47
    v_smfmac_f32_16x16x64_bf16 v[52:55], v[12:15], v[176:183], v7
    v_cvt_pk_bf16_f32 v46, v40, v44
    v_cvt_pk_bf16_f32 v47, v41, v45
    v_bfi_b32 v46, 1, v1, v46
    v_smfmac_f32_16x16x64_bf16 v[52:55], v[16:19], v[184:191], v7
    global_store_dwordx2 v8, v[46:47], s[90:91]
    v_add_f32 v48, v48, v49
    v_smfmac_f32_16x16x64_bf16 v[56:59], v[12:15], v[192:199], v7
    v_add_f32 v49, v50, v51
    v_smfmac_f32_16x16x64_bf16 v[56:59], v[16:19], v[200:207], v7
    s_nop 1
    v_smfmac_f32_16x16x64_bf16 v[60:63], v[12:15], v[208:215], v7
    v_add_f32 v52, v52, v53
    v_add_f32 v53, v54, v55
    v_smfmac_f32_16x16x64_bf16 v[60:63], v[16:19], v[216:223], v7
    v_cvt_pk_bf16_f32 v54, v48, v52
    v_cvt_pk_bf16_f32 v55, v49, v53
    v_bfi_b32 v54, 1, v1, v54
    global_store_dwordx2 v8, v[54:55], s[92:93]
    v_add_f32 v56, v56, v57
    v_add_f32 v57, v58, v59
    s_nop 1
    v_add_f32 v60, v60, v61
    v_add_f32 v61, v62, v63
    v_cvt_pk_bf16_f32 v62, v56, v60
    v_cvt_pk_bf16_f32 v63, v57, v61
    v_bfi_b32 v62, 1, v1, v62
    global_store_dwordx2 v8, v[62:63], s[94:95]
    s_lshl_b32 s13, s24, 17
    s_add_u32 s38, s50, s13
    s_addc_u32 s39, s51, 0
    s_add_u32 s25, s24, 2
    s_min_u32 s25, s25, 63
    s_lshl_b32 s13, s25, 19
    s_add_u32 s58, s88, s13
    s_addc_u32 s59, s89, 0
    s_add_u32 s86, s86, 524288
    s_addc_u32 s87, s87, 0
    s_add_u32 s32, s32, 524288
    s_addc_u32 s33, s33, 0
    s_add_u32 s14, s30, s34
    s_addc_u32 s15, s31, 0
    s_add_u32 s60, s30, s35
    s_addc_u32 s61, s31, 0
    s_add_u32 s20, s14, 4096
    s_addc_u32 s21, s15, 0
    s_and_b32 s12, s24, 1
    s_xor_b32 s13, s12, 1
    s_xor_b32 s47, s13, s40
    s_add_u32 s24, s24, 1
    s_mov_b32 s35, s34
    s_add_u32 s34, s34, 9216
    s_cmp_eq_u32 s34, 27648
    s_cselect_b32 s34, 0, s34
    s_mov_b32 s55, 0
    v_add_u32 v1, 0x20000, v0
    ds_read_b128 v[40:43], v1 offset:0
    ds_read_b128 v[44:47], v1 offset:4096
    v_add_u32 v1, 0x20000, v0
    ds_read_b128 v[48:51], v1 offset:8192
    ds_read_b128 v[52:55], v1 offset:12288
    v_add_u32 v1, 0x20000, v0
    ds_read_b128 v[56:59], v1 offset:16384
    ds_read_b128 v[60:63], v1 offset:20480
    v_mov_b32 v28, 25856
    s_waitcnt vmcnt(5)
    ds_read_b128 v[28:31], v28
    s_waitcnt lgkmcnt(0)
    v_min3_u32 v28, v28, v29, v30
    v_min_u32 v28, v28, v31
    s_nop 0
    v_readfirstlane_b32 s12, v28
    s_max_u32 s54, s54, s12
    s_cmp_lt_u32 s25, s54
    s_cbranch_scc1 L_kvok_53
    s_mov_b32 s55, 0
    v_bfe_u32 v28, v2, 2, 4
L_kvp_54:
    global_load_dword v29, v28, s[18:19] sc1
    s_add_u32 s55, s55, 1
    s_cmp_gt_u32 s55, 100000
    s_cbranch_scc1 L_rx_f3
    s_waitcnt vmcnt(0)
    v_min_u32_dpp v29, v29, v29 quad_perm:[1,0,3,2] row_mask:0xf bank_mask:0xf
    s_nop 1
    v_min_u32_dpp v29, v29, v29 quad_perm:[2,3,0,1] row_mask:0xf bank_mask:0xf
    s_nop 0
    v_readfirstlane_b32 s54, v29
    s_cmp_lt_u32 s25, s54
    s_cbranch_scc1 L_kvok_53
    s_sleep 4
    s_branch L_kvp_54
L_kvok_53:
    s_barrier
    s_mov_b32 s55, 0
    ds_read_b32 v36, v5 offset:2304
    ds_read_b32 v37, v5 offset:2592
    ds_read2_b32 v[38:39], v5 offset0:0 offset1:72
    v_mov_b64 v[12:13], 0
    v_mov_b64 v[14:15], 0
    v_mov_b64 v[16:17], 0
    v_mov_b64 v[18:19], 0
    v_mov_b64 v[20:21], 0
    v_mov_b64 v[22:23], 0
    v_mov_b64 v[24:25], 0
    v_mov_b64 v[26:27], 0
    global_load_dwordx4 v[28:31], v2, s[20:21] offset:1024 sc1
    global_load_dwordx4 v[32:35], v2, s[20:21] offset:2048 sc1
    v_mov_b64 v[8:9], 0
    v_mov_b64 v[10:11], 0
    s_mov_b32 m0, s62
    s_branch L_rp2_f3
L_rf2_f3:
    s_mov_b64 exec, vcc
    global_load_dwordx4 v[28:31], v2, s[20:21] offset:1024 sc1
    global_load_dwordx4 v[32:35], v2, s[20:21] offset:2048 sc1
    s_mov_b64 exec, -1
    v_mov_b64 v[12:13], 0
    v_mov_b64 v[14:15], 0
    v_mov_b64 v[16:17], 0
    v_mov_b64 v[18:19], 0
    s_add_u32 s55, s55, 1
    s_cmp_gt_u32 s55, 100000
    s_cbranch_scc0 L_rp2_f3
    s_branch L_rx_f3
L_rp2ok_f3:
    s_branch L_rp2_f3
L_rlast_f3:
    s_lshl_b32 s13, s24, 17
    s_add_u32 s38, s50, s13
    s_addc_u32 s39, s51, 0
    s_waitcnt lgkmcnt(0)
    ds_read_b128 v[12:15], v2 offset:5120
    v_smfmac_f32_16x16x64_bf16 v[36:39], v[28:31], v[72:79], v7
    v_smfmac_f32_16x16x64_bf16 v[36:39], v[32:35], a[216:223], v7
    v_smfmac_f32_16x16x64_bf16 v[36:39], v[40:43], v[88:95], v7
    v_smfmac_f32_16x16x64_bf16 v[36:39], v[44:47], a[248:255], v7
    s_waitcnt lgkmcnt(0)
    v_smfmac_f32_16x16x64_bf16 v[36:39], v[12:15], a[232:239], v7
    v_add_f32 v20, v20, v21
    v_add_f32 v22, v22, v23
    v_add_f32 v24, v24, v25
    v_add_f32 v26, v26, v27
    v_cvt_pk_bf16_f32 v16, v20, v24
    v_cvt_pk_bf16_f32 v17, v22, v26
    s_nop 1
    v_add_f32 v36, v36, v37
    v_add_f32 v38, v38, v39
    v_add_f32 v8, v8, v9
    v_add_f32 v10, v10, v11
    v_cvt_pk_bf16_f32 v18, v8, v10
    v_cvt_pk_bf16_f32 v19, v36, v38
    global_store_dwordx4 v0, v[16:19], s[38:39] sc1
L_rx_f3:
    s_endpgm
L_r_slow:
    s_cmp_eq_u32 s10, 1
    s_cbranch_scc1 L_rent_s1
    s_cmp_eq_u32 s10, 2
    s_cbranch_scc1 L_rent_s2
    s_cmp_eq_u32 s10, 3
    s_cbranch_scc1 L_rent_s3
L_rent_s0:
    ds_read_b128 v[40:43], v0 offset:32768
    ds_read_b128 v[44:47], v0 offset:36864
    ds_read_b128 v[48:51], v0 offset:40960
    ds_read_b128 v[52:55], v0 offset:45056
    ds_read_b128 v[56:59], v0 offset:49152
    ds_read_b128 v[60:63], v0 offset:53248
    ds_read_b128 v[28:31], v2 offset:8192
    ds_read_b128 v[32:35], v2 offset:0
    ds_read_b128 v[8:11], v2 offset:7168
    v_mov_b64 v[12:13], 0
    v_mov_b64 v[14:15], 0
    v_mov_b64 v[16:17], 0
    v_mov_b64 v[18:19], 0
    v_mov_b64 v[20:21], 0
    v_mov_b64 v[22:23], 0
    v_mov_b64 v[24:25], 0
    v_mov_b64 v[26:27], 0
    s_mov_b32 m0, s62
    s_mov_b32 s55, 0
    s_mov_b32 s47, s40
    s_mov_b64 s[20:21], s[30:31]
    s_waitcnt lgkmcnt(0)
    v_smfmac_f32_16x16x64_bf16 v[12:15], v[28:31], a[128:135], v7
    v_smfmac_f32_16x16x64_bf16 v[16:19], v[28:31], a[136:143], v7
    s_branch L_rgo_s0
.p2align 6
L_rp2_s0:
    s_waitcnt vmcnt(2)
    v_smfmac_f32_16x16x64_bf16 v[12:15], v[28:31], a[128:135], v7
    v_max_u32 v1, v28, v30
    s_waitcnt vmcnt(1)
    v_max3_u32 v1, v1, v32, v34
    s_waitcnt vmcnt(0)
    v_max3_u32 v1, v1, v8, v10
    v_cmp_eq_u32 vcc, -1, v1
    v_smfmac_f32_16x16x64_bf16 v[16:19], v[28:31], a[136:143], v7
    ds_write_b128 v2, v[28:31] offset:8192
    s_cbranch_vccnz L_rf2_s0
L_rgo_s0:
    ds_write_b128 v2, v[32:35] offset:0
    s_waitcnt lgkmcnt(2)
    v_smfmac_f32_16x16x64_bf16 v[20:23], v[28:31], v[40:47], v7
    ds_write_b128 v2, v[8:11] offset:7168
    ds_read_b128 v[40:43], v0 offset:57344
    v_smfmac_f32_16x16x64_bf16 v[24:27], v[28:31], v[48:55], v7
    v_mov_b64 v[8:9], 0
    v_mov_b64 v[10:11], 0
    ds_read_b128 v[44:47], v0 offset:61440
    v_smfmac_f32_16x16x64_bf16 v[12:15], v[32:35], a[0:7], v7
    s_waitcnt lgkmcnt(2)
    s_barrier
    ds_read_b128 v[28:31], v2 offset:1024
    v_smfmac_f32_16x16x64_bf16 v[20:23], v[32:35], v[56:63], v7
    global_load_lds_dwordx4 v2, s[32:33]
    v_add_u32 v1, 0x10000, v0
    v_smfmac_f32_16x16x64_bf16 v[16:19], v[32:35], a[8:15], v7
    global_load_lds_dwordx4 v2, s[32:33] offset:1024
    s_mov_b32 m0, s63
    ds_read_b128 v[48:51], v1 offset:0
    v_smfmac_f32_16x16x64_bf16 v[8:11], v[32:35], a[144:151], v7
    global_load_lds_dwordx4 v2, s[86:87]
    s_add_u32 m0, s63, 3072
    ds_read_b128 v[52:55], v1 offset:4096
    s_waitcnt lgkmcnt(3)
    v_smfmac_f32_16x16x64_bf16 v[24:27], v[32:35], v[40:47], v7
    global_load_lds_dwordx4 v2, s[86:87] offset:1024
    s_mov_b32 m0, 32256
    ds_read_b128 v[32:35], v2 offset:2048
    s_waitcnt lgkmcnt(3)
    v_smfmac_f32_16x16x64_bf16 v[12:15], v[28:31], a[16:23], v7
    ds_read_b128 v[56:59], v1 offset:8192
    ds_read_b128 v[60:63], v1 offset:12288
    s_waitcnt lgkmcnt(3)
    v_smfmac_f32_16x16x64_bf16 v[20:23], v[28:31], v[48:55], v7
    global_store_dwordx4 v0, v[36:39], s[38:39] sc1
    ds_read_b128 v[40:43], v1 offset:16384
    v_smfmac_f32_16x16x64_bf16 v[16:19], v[28:31], a[24:31], v7
    ds_read_b128 v[44:47], v1 offset:20480
    ds_read_b128 v[48:51], v1 offset:24576
    v_smfmac_f32_16x16x64_bf16 v[8:11], v[28:31], a[160:167], v7
    v_lshlrev_b32 v36, 2, v0
    global_load_lds_dword v36, s[58:59]
    s_mov_b32 m0, 25856
    v_mov_b64 v[36:37], 0
    v_mov_b64 v[38:39], 0
    s_waitcnt lgkmcnt(3)
    v_smfmac_f32_16x16x64_bf16 v[24:27], v[28:31], v[56:63], v7
    ds_read_b128 v[28:31], v2 offset:3072
    ds_read_b128 v[52:55], v1 offset:28672
    v_smfmac_f32_16x16x64_bf16 v[12:15], v[32:35], a[32:39], v7
    ds_read_b128 v[56:59], v1 offset:32768
    ds_read_b128 v[60:63], v1 offset:36864
    s_waitcnt lgkmcnt(5)
    v_smfmac_f32_16x16x64_bf16 v[20:23], v[32:35], v[40:47], v7
    ds_read_b128 v[40:43], v1 offset:40960
    ds_read_b128 v[44:47], v1 offset:45056
    v_smfmac_f32_16x16x64_bf16 v[16:19], v[32:35], a[40:47], v7
    v_smfmac_f32_16x16x64_bf16 v[8:11], v[32:35], a[176:183], v7
    v_smfmac_f32_16x16x64_bf16 v[36:39], v[32:35], a[184:191], v7
    s_waitcnt lgkmcnt(4)
    v_smfmac_f32_16x16x64_bf16 v[24:27], v[32:35], v[48:55], v7
    ds_read_b128 v[32:35], v2 offset:4096
    ds_read_b128 v[48:51], v1 offset:49152
    v_smfmac_f32_16x16x64_bf16 v[12:15], v[28:31], a[48:55], v7
    ds_read_b128 v[52:55], v1 offset:53248
    s_waitcnt lgkmcnt(5)
    v_smfmac_f32_16x16x64_bf16 v[20:23], v[28:31], v[56:63], v7
    ds_read_b128 v[56:59], v1 offset:57344
    ds_read_b128 v[60:63], v1 offset:61440
    v_smfmac_f32_16x16x64_bf16 v[16:19], v[28:31], a[56:63], v7
    v_smfmac_f32_16x16x64_bf16 v[8:11], v[28:31], a[192:199], v7
    v_smfmac_f32_16x16x64_bf16 v[36:39], v[28:31], a[200:207], v7
    s_waitcnt lgkmcnt(5)
    v_smfmac_f32_16x16x64_bf16 v[24:27], v[28:31], v[40:47], v7
    ds_read_b128 v[28:31], v2 offset:5120
    v_add_u32 v1, 0x20000, v0
    s_waitcnt lgkmcnt(5)
    v_smfmac_f32_16x16x64_bf16 v[12:15], v[32:35], a[64:71], v7
    ds_read_b128 v[40:43], v1 offset:0
    ds_read_b128 v[44:47], v1 offset:4096
    s_waitcnt lgkmcnt(5)
    v_smfmac_f32_16x16x64_bf16 v[20:23], v[32:35], v[48:55], v7
    ds_read_b128 v[48:51], v1 offset:8192
    ds_read_b128 v[52:55], v1 offset:12288
    v_smfmac_f32_16x16x64_bf16 v[16:19], v[32:35], a[72:79], v7
    v_smfmac_f32_16x16x64_bf16 v[8:11], v[32:35], a[208:215], v7
    v_smfmac_f32_16x16x64_bf16 v[36:39], v[32:35], a[216:223], v7
    s_waitcnt lgkmcnt(5)
    v_smfmac_f32_16x16x64_bf16 v[24:27], v[32:35], v[56:63], v7
    ds_read_b128 v[32:35], v2 offset:6144
    ds_read_b128 v[56:59], v1 offset:16384
    s_waitcnt lgkmcnt(6)
    v_smfmac_f32_16x16x64_bf16 v[12:15], v[28:31], a[80:87], v7
    ds_read_b128 v[60:63], v1 offset:20480
    s_waitcnt lgkmcnt(5)
    v_smfmac_f32_16x16x64_bf16 v[20:23], v[28:31], v[40:47], v7
    ds_read_b128 v[40:43], v1 offset:24576
    ds_read_b128 v[44:47], v1 offset:28672
    v_smfmac_f32_16x16x64_bf16 v[16:19], v[28:31], a[88:95], v7
    s_waitcnt vmcnt(4)
    s_barrier
    v_smfmac_f32_16x16x64_bf16 v[8:11], v[28:31], a[224:231], v7
    v_smfmac_f32_16x16x64_bf16 v[36:39], v[28:31], a[232:239], v7
    s_waitcnt lgkmcnt(5)
    v_smfmac_f32_16x16x64_bf16 v[24:27], v[28:31], v[48:55], v7
    ds_read_b128 v[28:31], v2 offset:7168
    ds_read_b128 v[48:51], v2 offset:9216
    s_waitcnt lgkmcnt(6)
    v_smfmac_f32_16x16x64_bf16 v[12:15], v[32:35], a[96:103], v7
    ds_read_b128 v[52:55], v2 offset:13312
    s_waitcnt lgkmcnt(5)
    v_smfmac_f32_16x16x64_bf16 v[20:23], v[32:35], v[56:63], v7
    ds_read_b128 v[56:59], v2 offset:10240
    ds_read_b128 v[60:63], v2 offset:14336
    v_smfmac_f32_16x16x64_bf16 v[16:19], v[32:35], a[104:111], v7
    v_smfmac_f32_16x16x64_bf16 v[8:11], v[32:35], a[240:247], v7
    s_waitcnt lgkmcnt(5)
    v_smfmac_f32_16x16x64_bf16 v[24:27], v[32:35], v[40:47], v7
    ds_read_b128 v[40:43], v2 offset:1024
    ds_read_b128 v[44:47], v2 offset:0
    s_waitcnt lgkmcnt(6)
    v_smfmac_f32_16x16x64_bf16 v[12:15], v[28:31], a[112:119], v7
    v_smfmac_f32_16x16x64_bf16 v[16:19], v[28:31], a[120:127], v7
    v_smfmac_f32_16x16x64_bf16 v[20:23], v[28:31], v[240:247], v7
    v_smfmac_f32_16x16x64_bf16 v[24:27], v[28:31], v[248:255], v7
    v_mov_b32 v1, s47
    v_smfmac_f32_16x16x64_bf16 v[8:11], v[28:31], v[64:71], v7
    s_cmp_eq_u32 s24, 63
    s_cbranch_scc1 L_rlast_s0
    s_nop 0
    v_add_f32 v12, v12, v13
    v_add_f32 v14, v14, v15
    v_add_f32 v16, v16, v17
    v_add_f32 v18, v18, v19
    v_cvt_pk_bf16_f32 v13, v12, v16
    v_cvt_pk_bf16_f32 v15, v14, v18
    ds_write2_b32 v5, v13, v15 offset0:0 offset1:72
    v_add_f32 v20, v20, v21
    v_add_f32 v22, v22, v23
    v_add_f32 v24, v24, v25
    v_add_f32 v26, v26, v27
    v_cvt_pk_bf16_f32 v21, v20, v24
    v_cvt_pk_bf16_f32 v23, v22, v26
    ds_write_b32 v5, v21 offset:2304
    ds_write_b32 v5, v23 offset:2592
    ds_read_b128 v[24:27], v4 offset:0
    v_smfmac_f32_16x16x64_bf16 v[36:39], v[28:31], v[72:79], v7
    ds_read_b128 v[28:31], v4 offset:2304
    v_smfmac_f32_16x16x64_bf16 v[36:39], v[32:35], a[248:255], v7
    ds_read_b128 v[32:35], v2 offset:8192
    s_waitcnt lgkmcnt(7)
    v_smfmac_f32_16x16x64_bf16 v[36:39], v[40:43], a[168:175], v7
    s_waitcnt lgkmcnt(6)
    v_smfmac_f32_16x16x64_bf16 v[36:39], v[44:47], a[152:159], v7
    s_waitcnt lgkmcnt(3)
    s_barrier
    ds_read_b128 v[40:43], v4 offset:64
    ds_read_b128 v[44:47], v4 offset:2368
    s_waitcnt lgkmcnt(4)
    v_mfma_f32_16x16x32_bf16 v[12:15], v[48:51], v[24:27], 0
    ds_read_b128 v[48:51], v4 offset:128
    v_mfma_f32_16x16x32_bf16 v[16:19], v[52:55], v[24:27], 0
    ds_read_b128 v[52:55], v2 offset:11264
    s_waitcnt lgkmcnt(5)
    v_mfma_f32_16x16x32_bf16 v[20:23], v[28:31], v[24:27], 0
    ds_read_b128 v[28:31], v2 offset:15360
    ds_read_b128 v[24:27], v4 offset:2432
    s_waitcnt lgkmcnt(5)
    v_mfma_f32_16x16x32_bf16 v[12:15], v[56:59], v[40:43], v[12:15]
    ds_read_b128 v[56:59], v4 offset:192
    v_mfma_f32_16x16x32_bf16 v[16:19], v[60:63], v[40:43], v[16:19]
    ds_read_b128 v[60:63], v2 offset:12288
    s_waitcnt lgkmcnt(6)
    v_mfma_f32_16x16x32_bf16 v[20:23], v[44:47], v[40:43], v[20:23]
    ds_read_b128 v[44:47], v2 offset:16384
    ds_read_b128 v[40:43], v4 offset:2496
    s_waitcnt lgkmcnt(6)
    v_mfma_f32_16x16x32_bf16 v[12:15], v[52:55], v[48:51], v[12:15]
    s_waitcnt vmcnt(2)
    ds_read_b128 v[52:55], v0 offset:17408
    s_waitcnt lgkmcnt(6)
    v_mfma_f32_16x16x32_bf16 v[16:19], v[28:31], v[48:51], v[16:19]
    ds_read_b128 v[28:31], v0 offset:21504
    s_waitcnt lgkmcnt(6)
    v_mfma_f32_16x16x32_bf16 v[20:23], v[24:27], v[48:51], v[20:23]
    s_waitcnt lgkmcnt(4)
    v_mfma_f32_16x16x32_bf16 v[12:15], v[60:63], v[56:59], v[12:15]
    s_waitcnt lgkmcnt(3)
    v_mfma_f32_16x16x32_bf16 v[16:19], v[44:47], v[56:59], v[16:19]
    s_waitcnt lgkmcnt(2)
    v_mfma_f32_16x16x32_bf16 v[20:23], v[40:43], v[56:59], v[20:23]
    v_smfmac_f32_16x16x64_bf16 v[36:39], v[32:35], v[88:95], v7
    v_smfmac_f32_16x16x64_bf16 v[8:11], v[32:35], v[80:87], v7
    v_mov_b32 v49, 0
    v_mov_b32 v50, 0
    s_nop 1
    v_mov_b32_dpp v12, v16 quad_perm:[0,1,2,3] row_mask:0xf bank_mask:0xc
    v_mov_b32_dpp v13, v17 quad_perm:[0,1,2,3] row_mask:0xf bank_mask:0xc
    v_mov_b32_dpp v14, v18 quad_perm:[0,1,2,3] row_mask:0xf bank_mask:0xc
    v_mov_b32_dpp v15, v19 quad_perm:[0,1,2,3] row_mask:0xf bank_mask:0xc
    v_mov_b32_dpp v22, v23 quad_perm:[0,1,2,3] row_mask:0xf bank_mask:0xc
    v_mov_b32_dpp v20, v21 quad_perm:[0,1,2,3] row_mask:0x3 bank_mask:0xc
    v_max3_f32 v16, v12, v13, v14
    v_add_f32 v36, v36, v37
    v_mov_b32_dpp v20, v22 quad_perm:[0,1,2,3] row_mask:0xc bank_mask:0xf
    v_max3_f32 v16, v16, v15, v20
    v_pk_mul_f32 v[12:13], v[12:13], s[46:47] op_sel_hi:[1,0]
    v_pk_mul_f32 v[14:15], v[14:15], s[46:47] op_sel_hi:[1,0]
    v_max_f32_dpp v16, v16, v16 row_ror:8 row_mask:0xf bank_mask:0xf
    v_mov_b32 v17, v16
    v_mul_f32 v20, s46, v20
    v_add_f32 v38, v38, v39
    v_permlane16_swap_b32 v16, v17
    v_max_f32 v16, v16, v17
    v_mov_b32 v17, v16
    v_add_f32 v8, v8, v9
    v_add_f32 v10, v10, v11
    v_cvt_pk_bf16_f32 v22, v8, v10
    v_cvt_pk_bf16_f32 v23, v36, v38
    v_permlane32_swap_b32 v16, v17
    v_max_f32 v16, v16, v17
    v_mul_f32 v16, s46, v16
    v_sub_f32 v12, v12, v16
    v_sub_f32 v13, v13, v16
    v_sub_f32 v14, v14, v16
    v_sub_f32 v15, v15, v16
    v_sub_f32 v20, v20, v16
    v_exp_f32 v12, v12
    v_exp_f32 v13, v13
    v_exp_f32 v14, v14
    v_exp_f32 v15, v15
    v_cvt_pk_bf16_f32 v24, v12, v13
    v_cvt_pk_bf16_f32 v25, v14, v15
    v_exp_f32 v20, v20
    v_mov_b32_dpp v26, v24 row_ror:8 row_mask:0xf bank_mask:0xf
    v_mov_b32_dpp v27, v25 row_ror:8 row_mask:0xf bank_mask:0xf
    v_mov_b32_dpp v21, v20 row_ror:8 row_mask:0xf bank_mask:0xf
    v_add_f32 v18, v12, v13
    s_waitcnt lgkmcnt(0)
    v_mfma_f32_16x16x32_bf16 v[60:63], v[52:55], v[24:27], 0
    v_cvt_pk_bf16_f32 v48, v20, v21
    v_add_f32 v17, v14, v15
    v_mfma_f32_16x16x32_bf16 v[44:47], v[28:31], v[24:27], 0
    v_add_f32 v18, v18, v20
    v_add_f32 v18, v18, v17
    v_cvt_pk_bf16_f32 v51, v20, v21
    v_mfma_f32_16x16x16_bf16 v[60:63], v[22:23], v[48:49], v[60:63]
    v_add_f32_dpp v18, v18, v18 row_ror:8 row_mask:0xf bank_mask:0xf
    v_mov_b32 v17, v18
    v_mfma_f32_16x16x16_bf16 v[44:47], v[22:23], v[50:51], v[44:47]
    v_lshrrev_b32 v9, 2, v2
    v_permlane16_swap_b32 v18, v17
    v_add_f32 v18, v18, v17
    v_mov_b32 v17, v18
    v_and_b32 v8, 0x300, v2
    v_bfe_u32 v10, v2, 1, 7
    v_permlane32_swap_b32 v18, v17
    v_add_f32 v18, v18, v17
    v_rcp_f32 v18, v18
    v_lshl_or_b32 v8, v8, 4, v10
    v_pk_mul_f32 v[60:61], v[60:61], v[18:19] op_sel_hi:[1,0]
    v_pk_mul_f32 v[62:63], v[62:63], v[18:19] op_sel_hi:[1,0]
    v_pk_mul_f32 v[44:45], v[44:45], v[18:19] op_sel_hi:[1,0]
    v_pk_mul_f32 v[46:47], v[46:47], v[18:19] op_sel_hi:[1,0]
    v_cvt_pk_bf16_f32 v12, v60, v61
    v_cvt_pk_bf16_f32 v13, v62, v63
    v_cvt_pk_bf16_f32 v14, v44, v45
    v_cvt_pk_bf16_f32 v15, v46, v47
    ds_write_b128 v6, v[12:15]
    v_mov_b64 v[10:11], 0
    s_nop 1
    v_mfma_f32_32x32x8_bf16 v[28:43], v[10:11], v[10:11], 0
    v_mfma_f32_32x32x8_bf16 v[44:59], v[10:11], v[10:11], 0
    s_waitcnt lgkmcnt(0)
    s_barrier
    ds_read_b128 v[12:15], v3 offset:30208
    ds_read_b128 v[16:19], v3 offset:31232
    v_mov_b64 v[60:61], 0
    ds_write2_b32 v5, v22, v23 offset0:0 offset1:72
    v_mov_b64 v[62:63], 0
    s_waitcnt lgkmcnt(2)
    s_nop 0
    v_smfmac_f32_16x16x64_bf16 v[28:31], v[12:15], v[224:231], v7
    s_waitcnt lgkmcnt(1)
    v_smfmac_f32_16x16x64_bf16 v[28:31], v[16:19], v[232:239], v7
    s_nop 1
    v_smfmac_f32_16x16x64_bf16 v[32:35], v[12:15], v[96:103], v7
    s_nop 1
    v_smfmac_f32_16x16x64_bf16 v[32:35], v[16:19], v[104:111], v7
    s_nop 1
    v_smfmac_f32_16x16x64_bf16 v[36:39], v[12:15], v[112:119], v7
    v_add_f32 v28, v28, v29
    v_add_f32 v29, v30, v31
    v_smfmac_f32_16x16x64_bf16 v[36:39], v[16:19], v[120:127], v7
    v_cvt_pk_bf16_f32 v30, v28, v29
    v_bfi_b32 v30, 1, v1, v30
    global_store_dword v9, v30, s[42:43] sc1
    v_smfmac_f32_16x16x64_bf16 v[40:43], v[12:15], v[128:135], v7
    v_add_f32 v32, v32, v33
    v_add_f32 v33, v34, v35
    v_smfmac_f32_16x16x64_bf16 v[40:43], v[16:19], v[136:143], v7
    s_nop 1
    v_smfmac_f32_16x16x64_bf16 v[44:47], v[12:15], v[144:151], v7
    v_add_f32 v36, v36, v37
    v_add_f32 v37, v38, v39
    v_smfmac_f32_16x16x64_bf16 v[44:47], v[16:19], v[152:159], v7
    v_cvt_pk_bf16_f32 v38, v32, v36
    v_cvt_pk_bf16_f32 v39, v33, v37
    v_bfi_b32 v38, 1, v1, v38
    v_smfmac_f32_16x16x64_bf16 v[48:51], v[12:15], v[160:167], v7
    global_store_dwordx2 v8, v[38:39], s[26:27] sc1
    v_add_f32 v40, v40, v41
    v_add_f32 v41, v42, v43
    v_smfmac_f32_16x16x64_bf16 v[48:51], v[16:19], v[168:175], v7
    v_add_f32 v44, v44, v45
    v_add_f32 v45, v46, v47
    v_smfmac_f32_16x16x64_bf16 v[52:55], v[12:15], v[176:183], v7
    v_cvt_pk_bf16_f32 v46, v40, v44
    v_cvt_pk_bf16_f32 v47, v41, v45
    v_bfi_b32 v46, 1, v1, v46
    v_smfmac_f32_16x16x64_bf16 v[52:55], v[16:19], v[184:191], v7
    global_store_dwordx2 v8, v[46:47], s[90:91] sc1
    v_add_f32 v48, v48, v49
    v_smfmac_f32_16x16x64_bf16 v[56:59], v[12:15], v[192:199], v7
    v_add_f32 v49, v50, v51
    v_smfmac_f32_16x16x64_bf16 v[56:59], v[16:19], v[200:207], v7
    s_nop 1
    v_smfmac_f32_16x16x64_bf16 v[60:63], v[12:15], v[208:215], v7
    v_add_f32 v52, v52, v53
    v_add_f32 v53, v54, v55
    v_smfmac_f32_16x16x64_bf16 v[60:63], v[16:19], v[216:223], v7
    v_cvt_pk_bf16_f32 v54, v48, v52
    v_cvt_pk_bf16_f32 v55, v49, v53
    v_bfi_b32 v54, 1, v1, v54
    global_store_dwordx2 v8, v[54:55], s[92:93] sc1
    v_add_f32 v56, v56, v57
    v_add_f32 v57, v58, v59
    s_nop 1
    v_add_f32 v60, v60, v61
    v_add_f32 v61, v62, v63
    v_cvt_pk_bf16_f32 v62, v56, v60
    v_cvt_pk_bf16_f32 v63, v57, v61
    v_bfi_b32 v62, 1, v1, v62
    global_store_dwordx2 v8, v[62:63], s[94:95] sc1
    s_lshl_b32 s13, s24, 17
    s_add_u32 s38, s50, s13
    s_addc_u32 s39, s51, 0
    s_add_u32 s25, s24, 2
    s_min_u32 s25, s25, 63
    s_lshl_b32 s13, s25, 19
    s_add_u32 s58, s88, s13
    s_addc_u32 s59, s89, 0
    s_add_u32 s86, s86, 524288
    s_addc_u32 s87, s87, 0
    s_add_u32 s32, s32, 524288
    s_addc_u32 s33, s33, 0
    s_add_u32 s14, s30, s34
    s_addc_u32 s15, s31, 0
    s_add_u32 s60, s30, s35
    s_addc_u32 s61, s31, 0
    s_add_u32 s20, s14, 4096
    s_addc_u32 s21, s15, 0
    s_add_u32 s16, s14, 8192
    s_addc_u32 s17, s15, 0
    s_and_b32 s12, s24, 1
    s_xor_b32 s13, s12, 1
    s_xor_b32 s47, s13, s40
    s_add_u32 s24, s24, 1
    s_mov_b32 s35, s34
    s_add_u32 s34, s34, 9216
    s_cmp_eq_u32 s34, 27648
    s_cselect_b32 s34, 0, s34
    s_mov_b32 s55, 0
    ds_read_b128 v[40:43], v0 offset:32768
    ds_read_b128 v[44:47], v0 offset:36864
    ds_read_b128 v[48:51], v0 offset:40960
    ds_read_b128 v[52:55], v0 offset:45056
    ds_read_b128 v[56:59], v0 offset:49152
    ds_read_b128 v[60:63], v0 offset:53248
    s_waitcnt vmcnt(1)
    global_load_dwordx4 v[24:27], v2, s[28:29] offset:0 sc1
    global_load_dwordx4 v[28:31], v2, s[28:29] offset:1024 sc1
    global_load_dwordx4 v[32:35], v2, s[28:29] offset:2048 sc1
    global_load_dwordx4 v[36:39], v2, s[28:29] offset:3072 sc1
    v_bfe_u32 v20, v2, 4, 1
    v_bfe_u32 v21, v2, 5, 1
    v_bfe_u32 v22, v2, 6, 1
    v_lshl_add_u32 v22, v21, 1, v22
    v_lshlrev_b32 v20, 4, v20
    v_mov_b32 v21, 0x3f80
    v_lshlrev_b32 v21, v20, v21
    v_cmp_eq_u32 vcc, 0, v22
    v_mov_b32 v8, 0x0
    v_bfe_u32 v10, v2, 4, 2
    v_cndmask_b32 v12, 0, v21, vcc
    v_cmp_eq_u32 vcc, 1, v22
    v_lshlrev_b32 v10, 3, v10
    v_xor_b32 v8, v8, v10
    v_cndmask_b32 v13, 0, v21, vcc
    v_cmp_eq_u32 vcc, 2, v22
    v_bfe_u32 v10, v2, 6, 1
    v_lshlrev_b32 v10, 8, v10
    v_cndmask_b32 v14, 0, v21, vcc
    v_cmp_eq_u32 vcc, 3, v22
    v_xor_b32 v8, v8, v10
    v_bfe_u32 v10, v2, 8, 1
    v_cndmask_b32 v15, 0, v21, vcc
    v_lshlrev_b32 v10, 5, v10
    v_xor_b32 v8, v8, v10
    v_xor_b32 v8, s41, v8
    v_mov_b64 v[10:11], -1
L_rp1_s0:
    s_waitcnt vmcnt(3)
    v_mfma_f32_16x16x32_bf16 v[16:19], v[12:15], v[24:27], 0
    v_bitop3_b32 v20, v24, v26, s12 bitop3:0x7e
    s_waitcnt vmcnt(2)
    v_mfma_f32_16x16x32_bf16 v[16:19], v[12:15], v[28:31], v[16:19]
    v_bitop3_b32 v21, v28, v30, s13 bitop3:0x7e
    s_waitcnt vmcnt(1)
    v_mfma_f32_16x16x32_bf16 v[16:19], v[12:15], v[32:35], v[16:19]
    v_bitop3_b32 v22, v32, v34, s12 bitop3:0x7e
    v_or3_b32 v20, v20, v21, v22
    s_waitcnt vmcnt(0)
    v_mfma_f32_16x16x32_bf16 v[16:19], v[12:15], v[36:39], v[16:19]
    v_bitop3_b32 v23, v36, v38, s13 bitop3:0x7e
    v_bitop3_b32 v20, v20, v23, 1 bitop3:0xa8
    v_cmp_ne_u32 vcc, 0, v20
    s_nop 4
    v_add_f32_dpp v16, v16, v16 row_ror:8 row_mask:0xf bank_mask:0xf
    v_add_f32_dpp v17, v17, v17 row_ror:8 row_mask:0xf bank_mask:0xf
    v_add_f32_dpp v18, v18, v18 row_ror:8 row_mask:0xf bank_mask:0xf
    v_add_f32_dpp v19, v19, v19 row_ror:8 row_mask:0xf bank_mask:0xf
    v_cvt_pk_bf16_f32 v20, v16, v17
    v_cvt_pk_bf16_f32 v21, v18, v19
    s_mov_b64 exec, s[44:45]
    s_cbranch_vccnz L_rp1_s0_rt
    global_store_dwordx2 v8, v[20:21], s[14:15] sc1
    global_store_dwordx2 v8, v[10:11], s[60:61] sc1
    s_mov_b64 exec, -1
    s_barrier
    s_mov_b32 s55, 0
    ds_read_b32 v36, v5 offset:2304
    ds_read_b32 v37, v5 offset:2592
    ds_read2_b32 v[38:39], v5 offset0:0 offset1:72
    v_mov_b64 v[12:13], 0
    v_mov_b64 v[14:15], 0
    v_mov_b64 v[16:17], 0
    v_mov_b64 v[18:19], 0
    v_mov_b64 v[20:21], 0
    v_mov_b64 v[22:23], 0
    v_mov_b64 v[24:25], 0
    v_mov_b64 v[26:27], 0
    global_load_dwordx4 v[28:31], v2, s[16:17] sc1
    global_load_dwordx4 v[32:35], v2, s[20:21] offset:-4096 sc1
    global_load_dwordx4 v[8:11], v2, s[20:21] offset:3072 sc1
    s_mov_b32 m0, s62
    s_branch L_rp2_s0
L_rf2_s0:
    s_mov_b64 exec, vcc
    global_load_dwordx4 v[28:31], v2, s[16:17] sc1
    global_load_dwordx4 v[32:35], v2, s[20:21] offset:-4096 sc1
    global_load_dwordx4 v[8:11], v2, s[20:21] offset:3072 sc1
    s_mov_b64 exec, -1
    v_mov_b64 v[12:13], 0
    v_mov_b64 v[14:15], 0
    v_mov_b64 v[16:17], 0
    v_mov_b64 v[18:19], 0
    s_add_u32 s55, s55, 1
    s_cmp_gt_u32 s55, 100000
    s_cbranch_scc0 L_rp2_s0
    s_branch L_rx_s0
L_rp1_s0_rt:
    s_mov_b64 exec, vcc
    global_load_dwordx4 v[24:27], v2, s[28:29] offset:0 sc1
    global_load_dwordx4 v[28:31], v2, s[28:29] offset:1024 sc1
    global_load_dwordx4 v[32:35], v2, s[28:29] offset:2048 sc1
    global_load_dwordx4 v[36:39], v2, s[28:29] offset:3072 sc1
    s_mov_b64 exec, -1
    s_cmp_le_u32 s55, 2
    s_cbranch_scc1 L_bo_55
    s_sleep 4
L_bo_55:
    s_add_u32 s55, s55, 1
    s_cmp_gt_u32 s55, 100000
    s_cbranch_scc0 L_rp1_s0
    s_branch L_rx_s0
L_rp2ok_s0:
    s_branch L_rp2_s0
L_rlast_s0:
    s_lshl_b32 s13, s24, 17
    s_add_u32 s38, s50, s13
    s_addc_u32 s39, s51, 0
    s_waitcnt lgkmcnt(0)
    ds_read_b128 v[12:15], v2 offset:8192
    v_smfmac_f32_16x16x64_bf16 v[36:39], v[28:31], v[72:79], v7
    v_smfmac_f32_16x16x64_bf16 v[36:39], v[32:35], a[248:255], v7
    v_smfmac_f32_16x16x64_bf16 v[36:39], v[40:43], a[168:175], v7
    v_smfmac_f32_16x16x64_bf16 v[36:39], v[44:47], a[152:159], v7
    s_waitcnt lgkmcnt(0)
    v_smfmac_f32_16x16x64_bf16 v[36:39], v[12:15], v[88:95], v7
    v_smfmac_f32_16x16x64_bf16 v[8:11], v[12:15], v[80:87], v7
    v_add_f32 v20, v20, v21
    v_add_f32 v22, v22, v23
    v_add_f32 v24, v24, v25
    v_add_f32 v26, v26, v27
    v_cvt_pk_bf16_f32 v16, v20, v24
    v_cvt_pk_bf16_f32 v17, v22, v26
    s_nop 0
    v_add_f32 v36, v36, v37
    v_add_f32 v38, v38, v39
    v_add_f32 v8, v8, v9
    v_add_f32 v10, v10, v11
    v_cvt_pk_bf16_f32 v18, v8, v10
    v_cvt_pk_bf16_f32 v19, v36, v38
    global_store_dwordx4 v0, v[16:19], s[38:39] sc1
L_rx_s0:
    s_endpgm
L_rent_s1:
    v_add_u32 v1, 0x10000, v0
    ds_read_b128 v[40:43], v1 offset:0
    ds_read_b128 v[44:47], v1 offset:4096
    v_add_u32 v1, 0x10000, v0
    ds_read_b128 v[48:51], v1 offset:8192
    ds_read_b128 v[52:55], v1 offset:12288
    v_add_u32 v1, 0x10000, v0
    ds_read_b128 v[56:59], v1 offset:16384
    ds_read_b128 v[60:63], v1 offset:20480
    ds_read_b128 v[28:31], v2 offset:1024
    ds_read_b128 v[32:35], v2 offset:2048
    v_mov_b64 v[8:9], 0
    v_mov_b64 v[10:11], 0
    v_mov_b64 v[12:13], 0
    v_mov_b64 v[14:15], 0
    v_mov_b64 v[16:17], 0
    v_mov_b64 v[18:19], 0
    v_mov_b64 v[20:21], 0
    v_mov_b64 v[22:23], 0
    v_mov_b64 v[24:25], 0
    v_mov_b64 v[26:27], 0
    s_mov_b32 m0, s62
    s_mov_b32 s55, 0
    s_mov_b32 s47, s40
    s_mov_b64 s[20:21], s[30:31]
    s_waitcnt lgkmcnt(0)
    v_smfmac_f32_16x16x64_bf16 v[12:15], v[28:31], a[16:23], v7
    v_smfmac_f32_16x16x64_bf16 v[16:19], v[28:31], a[24:31], v7
    s_branch L_rgo_s1
.p2align 6
L_rp2_s1:
    s_waitcnt vmcnt(1)
    v_smfmac_f32_16x16x64_bf16 v[12:15], v[28:31], a[16:23], v7
    v_max_u32 v1, v28, v30
    s_waitcnt vmcnt(0)
    v_max3_u32 v1, v1, v32, v34
    v_cmp_eq_u32 vcc, -1, v1
    v_smfmac_f32_16x16x64_bf16 v[16:19], v[28:31], a[24:31], v7
    ds_write_b128 v2, v[28:31] offset:1024
    s_cbranch_vccnz L_rf2_s1
L_rgo_s1:
    v_smfmac_f32_16x16x64_bf16 v[8:11], v[28:31], a[160:167], v7
    ds_write_b128 v2, v[32:35] offset:2048
    s_waitcnt lgkmcnt(2)
    v_smfmac_f32_16x16x64_bf16 v[20:23], v[28:31], v[40:47], v7
    v_add_u32 v1, 0x10000, v0
    ds_read_b128 v[40:43], v1 offset:24576
    v_smfmac_f32_16x16x64_bf16 v[24:27], v[28:31], v[48:55], v7
    ds_read_b128 v[44:47], v1 offset:28672
    ds_read_b128 v[48:51], v1 offset:32768
    v_smfmac_f32_16x16x64_bf16 v[12:15], v[32:35], a[32:39], v7
    s_waitcnt lgkmcnt(3)
    s_barrier
    ds_read_b128 v[28:31], v2 offset:3072
    v_smfmac_f32_16x16x64_bf16 v[20:23], v[32:35], v[56:63], v7
    global_load_lds_dwordx4 v2, s[32:33]
    ds_read_b128 v[52:55], v1 offset:36864
    v_smfmac_f32_16x16x64_bf16 v[16:19], v[32:35], a[40:47], v7
    global_load_lds_dwordx4 v2, s[32:33] offset:1024
    s_mov_b32 m0, s63
    ds_read_b128 v[56:59], v1 offset:40960
    v_smfmac_f32_16x16x64_bf16 v[8:11], v[32:35], a[176:183], v7
    global_load_lds_dwordx4 v2, s[86:87]
    s_add_u32 m0, s63, 3072
    ds_read_b128 v[60:63], v1 offset:45056
    s_waitcnt lgkmcnt(5)
    v_smfmac_f32_16x16x64_bf16 v[24:27], v[32:35], v[40:47], v7
    global_load_lds_dwordx4 v2, s[86:87] offset:1024
    s_mov_b32 m0, 32256
    ds_read_b128 v[32:35], v2 offset:4096
    s_waitcnt lgkmcnt(4)
    v_smfmac_f32_16x16x64_bf16 v[12:15], v[28:31], a[48:55], v7
    ds_read_b128 v[40:43], v1 offset:49152
    ds_read_b128 v[44:47], v1 offset:53248
    s_waitcnt lgkmcnt(5)
    v_smfmac_f32_16x16x64_bf16 v[20:23], v[28:31], v[48:55], v7
    global_store_dwordx4 v0, v[36:39], s[38:39] sc1
    ds_read_b128 v[48:51], v1 offset:57344
    v_smfmac_f32_16x16x64_bf16 v[16:19], v[28:31], a[56:63], v7
    ds_read_b128 v[52:55], v1 offset:61440
    v_smfmac_f32_16x16x64_bf16 v[8:11], v[28:31], a[192:199], v7
    v_lshlrev_b32 v36, 2, v0
    global_load_lds_dword v36, s[58:59]
    s_mov_b32 m0, 25856
    v_mov_b64 v[36:37], 0
    v_mov_b64 v[38:39], 0
    s_waitcnt lgkmcnt(5)
    v_smfmac_f32_16x16x64_bf16 v[24:27], v[28:31], v[56:63], v7
    ds_read_b128 v[28:31], v2 offset:5120
    v_add_u32 v1, 0x20000, v0
    s_waitcnt lgkmcnt(5)
    v_smfmac_f32_16x16x64_bf16 v[12:15], v[32:35], a[64:71], v7
    ds_read_b128 v[56:59], v1 offset:0
    ds_read_b128 v[60:63], v1 offset:4096
    s_waitcnt lgkmcnt(5)
    v_smfmac_f32_16x16x64_bf16 v[20:23], v[32:35], v[40:47], v7
    ds_read_b128 v[40:43], v1 offset:8192
    ds_read_b128 v[44:47], v1 offset:12288
    v_smfmac_f32_16x16x64_bf16 v[16:19], v[32:35], a[72:79], v7
    v_smfmac_f32_16x16x64_bf16 v[8:11], v[32:35], a[208:215], v7
    v_smfmac_f32_16x16x64_bf16 v[36:39], v[32:35], a[216:223], v7
    s_waitcnt lgkmcnt(5)
    v_smfmac_f32_16x16x64_bf16 v[24:27], v[32:35], v[48:55], v7
    ds_read_b128 v[32:35], v2 offset:6144
    ds_read_b128 v[48:51], v1 offset:16384
    s_waitcnt lgkmcnt(6)
    v_smfmac_f32_16x16x64_bf16 v[12:15], v[28:31], a[80:87], v7
    ds_read_b128 v[52:55], v1 offset:20480
    s_waitcnt lgkmcnt(5)
    v_smfmac_f32_16x16x64_bf16 v[20:23], v[28:31], v[56:63], v7
    ds_read_b128 v[56:59], v1 offset:24576
    ds_read_b128 v[60:63], v1 offset:28672
    v_smfmac_f32_16x16x64_bf16 v[16:19], v[28:31], a[88:95], v7
    v_smfmac_f32_16x16x64_bf16 v[8:11], v[28:31], a[224:231], v7
    v_smfmac_f32_16x16x64_bf16 v[36:39], v[28:31], a[232:239], v7
    s_waitcnt lgkmcnt(5)
    v_smfmac_f32_16x16x64_bf16 v[24:27], v[28:31], v[40:47], v7
    ds_read_b128 v[28:31], v2 offset:8192
    ds_read_b128 v[40:43], v0 offset:32768
    s_waitcnt lgkmcnt(6)
    v_smfmac_f32_16x16x64_bf16 v[12:15], v[32:35], a[96:103], v7
    ds_read_b128 v[44:47], v0 offset:36864
    s_waitcnt lgkmcnt(5)
    v_smfmac_f32_16x16x64_bf16 v[20:23], v[32:35], v[48:55], v7
    ds_read_b128 v[48:51], v0 offset:40960
    ds_read_b128 v[52:55], v0 offset:45056
    v_smfmac_f32_16x16x64_bf16 v[16:19], v[32:35], a[104:111], v7
    v_smfmac_f32_16x16x64_bf16 v[8:11], v[32:35], a[240:247], v7
    v_smfmac_f32_16x16x64_bf16 v[36:39], v[32:35], a[248:255], v7
    s_waitcnt lgkmcnt(5)
    v_smfmac_f32_16x16x64_bf16 v[24:27], v[32:35], v[56:63], v7
    ds_read_b128 v[32:35], v2 offset:0
    ds_read_b128 v[56:59], v0 offset:49152
    s_waitcnt lgkmcnt(6)
    v_smfmac_f32_16x16x64_bf16 v[12:15], v[28:31], a[128:135], v7
    ds_read_b128 v[60:63], v0 offset:53248
    s_waitcnt lgkmcnt(5)
    v_smfmac_f32_16x16x64_bf16 v[20:23], v[28:31], v[40:47], v7
    ds_read_b128 v[40:43], v0 offset:57344
    ds_read_b128 v[44:47], v0 offset:61440
    v_smfmac_f32_16x16x64_bf16 v[16:19], v[28:31], a[136:143], v7
    s_waitcnt vmcnt(4)
    s_barrier
    v_smfmac_f32_16x16x64_bf16 v[8:11], v[28:31], v[80:87], v7
    v_smfmac_f32_16x16x64_bf16 v[36:39], v[28:31], v[88:95], v7
    s_waitcnt lgkmcnt(5)
    v_smfmac_f32_16x16x64_bf16 v[24:27], v[28:31], v[48:55], v7
    ds_read_b128 v[28:31], v2 offset:7168
    ds_read_b128 v[48:51], v2 offset:10240
    s_waitcnt lgkmcnt(6)
    v_smfmac_f32_16x16x64_bf16 v[12:15], v[32:35], a[0:7], v7
    ds_read_b128 v[52:55], v2 offset:14336
    s_waitcnt lgkmcnt(5)
    v_smfmac_f32_16x16x64_bf16 v[20:23], v[32:35], v[56:63], v7
    ds_read_b128 v[56:59], v2 offset:11264
    ds_read_b128 v[60:63], v2 offset:15360
    v_smfmac_f32_16x16x64_bf16 v[16:19], v[32:35], a[8:15], v7
    v_smfmac_f32_16x16x64_bf16 v[8:11], v[32:35], a[144:151], v7
    s_waitcnt lgkmcnt(5)
    v_smfmac_f32_16x16x64_bf16 v[24:27], v[32:35], v[40:47], v7
    ds_read_b128 v[40:43], v2 offset:3072
    ds_read_b128 v[44:47], v2 offset:2048
    s_waitcnt lgkmcnt(6)
    v_smfmac_f32_16x16x64_bf16 v[12:15], v[28:31], a[112:119], v7
    v_smfmac_f32_16x16x64_bf16 v[16:19], v[28:31], a[120:127], v7
    v_smfmac_f32_16x16x64_bf16 v[20:23], v[28:31], v[240:247], v7
    v_smfmac_f32_16x16x64_bf16 v[24:27], v[28:31], v[248:255], v7
    v_mov_b32 v1, s47
    v_smfmac_f32_16x16x64_bf16 v[8:11], v[28:31], v[64:71], v7
    s_cmp_eq_u32 s24, 63
    s_cbranch_scc1 L_rlast_s1
    s_nop 0
    v_add_f32 v12, v12, v13
    v_add_f32 v14, v14, v15
    v_add_f32 v16, v16, v17
    v_add_f32 v18, v18, v19
    v_cvt_pk_bf16_f32 v13, v12, v16
    v_cvt_pk_bf16_f32 v15, v14, v18
    ds_write2_b32 v5, v13, v15 offset0:0 offset1:72
    v_add_f32 v20, v20, v21
    v_add_f32 v22, v22, v23
    v_add_f32 v24, v24, v25
    v_add_f32 v26, v26, v27
    v_cvt_pk_bf16_f32 v21, v20, v24
    v_cvt_pk_bf16_f32 v23, v22, v26
    ds_write_b32 v5, v21 offset:2304
    ds_write_b32 v5, v23 offset:2592
    ds_read_b128 v[24:27], v4 offset:64
    v_smfmac_f32_16x16x64_bf16 v[36:39], v[28:31], v[72:79], v7
    ds_read_b128 v[28:31], v4 offset:2368
    v_smfmac_f32_16x16x64_bf16 v[36:39], v[32:35], a[152:159], v7
    ds_read_b128 v[32:35], v2 offset:1024
    s_waitcnt lgkmcnt(7)
    v_smfmac_f32_16x16x64_bf16 v[36:39], v[40:43], a[200:207], v7
    s_waitcnt lgkmcnt(6)
    v_smfmac_f32_16x16x64_bf16 v[36:39], v[44:47], a[184:191], v7
    s_waitcnt lgkmcnt(3)
    s_barrier
    ds_read_b128 v[40:43], v4 offset:128
    ds_read_b128 v[44:47], v4 offset:2432
    s_waitcnt lgkmcnt(4)
    v_mfma_f32_16x16x32_bf16 v[12:15], v[48:51], v[24:27], 0
    ds_read_b128 v[48:51], v4 offset:192
    v_mfma_f32_16x16x32_bf16 v[16:19], v[52:55], v[24:27], 0
    ds_read_b128 v[52:55], v2 offset:12288
    s_waitcnt lgkmcnt(5)
    v_mfma_f32_16x16x32_bf16 v[20:23], v[28:31], v[24:27], 0
    ds_read_b128 v[28:31], v2 offset:16384
    ds_read_b128 v[24:27], v4 offset:2496
    s_waitcnt lgkmcnt(5)
    v_mfma_f32_16x16x32_bf16 v[12:15], v[56:59], v[40:43], v[12:15]
    ds_read_b128 v[56:59], v4 offset:0
    v_mfma_f32_16x16x32_bf16 v[16:19], v[60:63], v[40:43], v[16:19]
    ds_read_b128 v[60:63], v2 offset:9216
    s_waitcnt lgkmcnt(6)
    v_mfma_f32_16x16x32_bf16 v[20:23], v[44:47], v[40:43], v[20:23]
    ds_read_b128 v[44:47], v2 offset:13312
    ds_read_b128 v[40:43], v4 offset:2304
    s_waitcnt lgkmcnt(6)
    v_mfma_f32_16x16x32_bf16 v[12:15], v[52:55], v[48:51], v[12:15]
    s_waitcnt vmcnt(2)
    ds_read_b128 v[52:55], v0 offset:17408
    s_waitcnt lgkmcnt(6)
    v_mfma_f32_16x16x32_bf16 v[16:19], v[28:31], v[48:51], v[16:19]
    ds_read_b128 v[28:31], v0 offset:21504
    s_waitcnt lgkmcnt(6)
    v_mfma_f32_16x16x32_bf16 v[20:23], v[24:27], v[48:51], v[20:23]
    s_waitcnt lgkmcnt(4)
    v_mfma_f32_16x16x32_bf16 v[12:15], v[60:63], v[56:59], v[12:15]
    s_waitcnt lgkmcnt(3)
    v_mfma_f32_16x16x32_bf16 v[16:19], v[44:47], v[56:59], v[16:19]
    s_waitcnt lgkmcnt(2)
    v_mfma_f32_16x16x32_bf16 v[20:23], v[40:43], v[56:59], v[20:23]
    v_smfmac_f32_16x16x64_bf16 v[36:39], v[32:35], a[168:175], v7
    v_mov_b32 v49, 0
    v_mov_b32 v50, 0
    v_add_f32 v8, v8, v9
    v_add_f32 v10, v10, v11
    s_nop 0
    v_mov_b32_dpp v12, v16 quad_perm:[0,1,2,3] row_mask:0xf bank_mask:0xc
    v_mov_b32_dpp v13, v17 quad_perm:[0,1,2,3] row_mask:0xf bank_mask:0xc
    v_mov_b32_dpp v14, v18 quad_perm:[0,1,2,3] row_mask:0xf bank_mask:0xc
    v_mov_b32_dpp v15, v19 quad_perm:[0,1,2,3] row_mask:0xf bank_mask:0xc
    v_mov_b32_dpp v22, v23 quad_perm:[0,1,2,3] row_mask:0xf bank_mask:0xc
    v_mov_b32_dpp v20, v21 quad_perm:[0,1,2,3] row_mask:0x3 bank_mask:0xc
    v_max3_f32 v16, v12, v13, v14
    v_add_f32 v36, v36, v37
    v_mov_b32_dpp v20, v22 quad_perm:[0,1,2,3] row_mask:0xc bank_mask:0xf
    v_max3_f32 v16, v16, v15, v20
    v_pk_mul_f32 v[12:13], v[12:13], s[46:47] op_sel_hi:[1,0]
    v_pk_mul_f32 v[14:15], v[14:15], s[46:47] op_sel_hi:[1,0]
    v_max_f32_dpp v16, v16, v16 row_ror:8 row_mask:0xf bank_mask:0xf
    v_mov_b32 v17, v16
    v_mul_f32 v20, s46, v20
    v_add_f32 v38, v38, v39
    v_permlane16_swap_b32 v16, v17
    v_max_f32 v16, v16, v17
    v_mov_b32 v17, v16
    v_cvt_pk_bf16_f32 v22, v8, v10
    v_cvt_pk_bf16_f32 v23, v36, v38
    v_permlane32_swap_b32 v16, v17
    v_max_f32 v16, v16, v17
    v_mul_f32 v16, s46, v16
    v_sub_f32 v12, v12, v16
    v_sub_f32 v13, v13, v16
    v_sub_f32 v14, v14, v16
    v_sub_f32 v15, v15, v16
    v_sub_f32 v20, v20, v16
    v_exp_f32 v12, v12
    v_exp_f32 v13, v13
    v_exp_f32 v14, v14
    v_exp_f32 v15, v15
    v_cvt_pk_bf16_f32 v24, v12, v13
    v_cvt_pk_bf16_f32 v25, v14, v15
    v_exp_f32 v20, v20
    v_mov_b32_dpp v26, v24 row_ror:8 row_mask:0xf bank_mask:0xf
    v_mov_b32_dpp v27, v25 row_ror:8 row_mask:0xf bank_mask:0xf
    v_mov_b32_dpp v21, v20 row_ror:8 row_mask:0xf bank_mask:0xf
    v_add_f32 v18, v12, v13
    s_waitcnt lgkmcnt(0)
    v_mfma_f32_16x16x32_bf16 v[60:63], v[52:55], v[24:27], 0
    v_cvt_pk_bf16_f32 v48, v20, v21
    v_add_f32 v17, v14, v15
    v_mfma_f32_16x16x32_bf16 v[44:47], v[28:31], v[24:27], 0
    v_add_f32 v18, v18, v20
    v_add_f32 v18, v18, v17
    v_cvt_pk_bf16_f32 v51, v20, v21
    v_mfma_f32_16x16x16_bf16 v[60:63], v[22:23], v[48:49], v[60:63]
    v_add_f32_dpp v18, v18, v18 row_ror:8 row_mask:0xf bank_mask:0xf
    v_mov_b32 v17, v18
    v_mfma_f32_16x16x16_bf16 v[44:47], v[22:23], v[50:51], v[44:47]
    v_lshrrev_b32 v9, 2, v2
    v_permlane16_swap_b32 v18, v17
    v_add_f32 v18, v18, v17
    v_mov_b32 v17, v18
    v_and_b32 v8, 0x300, v2
    v_bfe_u32 v10, v2, 1, 7
    v_permlane32_swap_b32 v18, v17
    v_add_f32 v18, v18, v17
    v_rcp_f32 v18, v18
    v_lshl_or_b32 v8, v8, 4, v10
    v_pk_mul_f32 v[60:61], v[60:61], v[18:19] op_sel_hi:[1,0]
    v_pk_mul_f32 v[62:63], v[62:63], v[18:19] op_sel_hi:[1,0]
    v_pk_mul_f32 v[44:45], v[44:45], v[18:19] op_sel_hi:[1,0]
    v_pk_mul_f32 v[46:47], v[46:47], v[18:19] op_sel_hi:[1,0]
    v_cvt_pk_bf16_f32 v12, v60, v61
    v_cvt_pk_bf16_f32 v13, v62, v63
    v_cvt_pk_bf16_f32 v14, v44, v45
    v_cvt_pk_bf16_f32 v15, v46, v47
    ds_write_b128 v6, v[12:15]
    v_mov_b64 v[10:11], 0
    s_nop 1
    v_mfma_f32_32x32x8_bf16 v[28:43], v[10:11], v[10:11], 0
    v_mfma_f32_32x32x8_bf16 v[44:59], v[10:11], v[10:11], 0
    s_waitcnt lgkmcnt(0)
    s_barrier
    ds_read_b128 v[12:15], v3 offset:30208
    ds_read_b128 v[16:19], v3 offset:31232
    v_mov_b64 v[60:61], 0
    ds_write2_b32 v5, v22, v23 offset0:0 offset1:72
    v_mov_b64 v[62:63], 0
    s_waitcnt lgkmcnt(2)
    s_nop 0
    v_smfmac_f32_16x16x64_bf16 v[28:31], v[12:15], v[224:231], v7
    s_waitcnt lgkmcnt(1)
    v_smfmac_f32_16x16x64_bf16 v[28:31], v[16:19], v[232:239], v7
    s_nop 1
    v_smfmac_f32_16x16x64_bf16 v[32:35], v[12:15], v[96:103], v7
    s_nop 1
    v_smfmac_f32_16x16x64_bf16 v[32:35], v[16:19], v[104:111], v7
    s_nop 1
    v_smfmac_f32_16x16x64_bf16 v[36:39], v[12:15], v[112:119], v7
    v_add_f32 v28, v28, v29
    v_add_f32 v29, v30, v31
    v_smfmac_f32_16x16x64_bf16 v[36:39], v[16:19], v[120:127], v7
    v_cvt_pk_bf16_f32 v30, v28, v29
    v_bfi_b32 v30, 1, v1, v30
    global_store_dword v9, v30, s[42:43] sc1
    v_smfmac_f32_16x16x64_bf16 v[40:43], v[12:15], v[128:135], v7
    v_add_f32 v32, v32, v33
    v_add_f32 v33, v34, v35
    v_smfmac_f32_16x16x64_bf16 v[40:43], v[16:19], v[136:143], v7
    s_nop 1
    v_smfmac_f32_16x16x64_bf16 v[44:47], v[12:15], v[144:151], v7
    v_add_f32 v36, v36, v37
    v_add_f32 v37, v38, v39
    v_smfmac_f32_16x16x64_bf16 v[44:47], v[16:19], v[152:159], v7
    v_cvt_pk_bf16_f32 v38, v32, v36
    v_cvt_pk_bf16_f32 v39, v33, v37
    v_bfi_b32 v38, 1, v1, v38
    v_smfmac_f32_16x16x64_bf16 v[48:51], v[12:15], v[160:167], v7
    global_store_dwordx2 v8, v[38:39], s[26:27] sc1
    v_add_f32 v40, v40, v41
    v_add_f32 v41, v42, v43
    v_smfmac_f32_16x16x64_bf16 v[48:51], v[16:19], v[168:175], v7
    v_add_f32 v44, v44, v45
    v_add_f32 v45, v46, v47
    v_smfmac_f32_16x16x64_bf16 v[52:55], v[12:15], v[176:183], v7
    v_cvt_pk_bf16_f32 v46, v40, v44
    v_cvt_pk_bf16_f32 v47, v41, v45
    v_bfi_b32 v46, 1, v1, v46
    v_smfmac_f32_16x16x64_bf16 v[52:55], v[16:19], v[184:191], v7
    global_store_dwordx2 v8, v[46:47], s[90:91] sc1
    v_add_f32 v48, v48, v49
    v_smfmac_f32_16x16x64_bf16 v[56:59], v[12:15], v[192:199], v7
    v_add_f32 v49, v50, v51
    v_smfmac_f32_16x16x64_bf16 v[56:59], v[16:19], v[200:207], v7
    s_nop 1
    v_smfmac_f32_16x16x64_bf16 v[60:63], v[12:15], v[208:215], v7
    v_add_f32 v52, v52, v53
    v_add_f32 v53, v54, v55
    v_smfmac_f32_16x16x64_bf16 v[60:63], v[16:19], v[216:223], v7
    v_cvt_pk_bf16_f32 v54, v48, v52
    v_cvt_pk_bf16_f32 v55, v49, v53
    v_bfi_b32 v54, 1, v1, v54
    global_store_dwordx2 v8, v[54:55], s[92:93] sc1
    v_add_f32 v56, v56, v57
    v_add_f32 v57, v58, v59
    s_nop 1
    v_add_f32 v60, v60, v61
    v_add_f32 v61, v62, v63
    v_cvt_pk_bf16_f32 v62, v56, v60
    v_cvt_pk_bf16_f32 v63, v57, v61
    v_bfi_b32 v62, 1, v1, v62
    global_store_dwordx2 v8, v[62:63], s[94:95] sc1
    s_lshl_b32 s13, s24, 17
    s_add_u32 s38, s50, s13
    s_addc_u32 s39, s51, 0
    s_add_u32 s25, s24, 2
    s_min_u32 s25, s25, 63
    s_lshl_b32 s13, s25, 19
    s_add_u32 s58, s88, s13
    s_addc_u32 s59, s89, 0
    s_add_u32 s86, s86, 524288
    s_addc_u32 s87, s87, 0
    s_add_u32 s32, s32, 524288
    s_addc_u32 s33, s33, 0
    s_add_u32 s14, s30, s34
    s_addc_u32 s15, s31, 0
    s_add_u32 s60, s30, s35
    s_addc_u32 s61, s31, 0
    s_add_u32 s20, s14, 4096
    s_addc_u32 s21, s15, 0
    s_and_b32 s12, s24, 1
    s_xor_b32 s13, s12, 1
    s_xor_b32 s47, s13, s40
    s_add_u32 s24, s24, 1
    s_mov_b32 s35, s34
    s_add_u32 s34, s34, 9216
    s_cmp_eq_u32 s34, 27648
    s_cselect_b32 s34, 0, s34
    s_mov_b32 s55, 0
    v_add_u32 v1, 0x10000, v0
    ds_read_b128 v[40:43], v1 offset:0
    ds_read_b128 v[44:47], v1 offset:4096
    v_add_u32 v1, 0x10000, v0
    ds_read_b128 v[48:51], v1 offset:8192
    ds_read_b128 v[52:55], v1 offset:12288
    v_add_u32 v1, 0x10000, v0
    ds_read_b128 v[56:59], v1 offset:16384
    ds_read_b128 v[60:63], v1 offset:20480
    s_waitcnt vmcnt(0)
    v_bfe_u32 v20, v2, 4, 1
    v_bfe_u32 v21, v2, 5, 1
    v_bfe_u32 v22, v2, 6, 1
    global_load_dwordx4 v[24:27], v2, s[28:29] offset:0 sc1
    global_load_dwordx4 v[28:31], v2, s[28:29] offset:1024 sc1
    global_load_dwordx4 v[32:35], v2, s[28:29] offset:2048 sc1
    global_load_dwordx4 v[36:39], v2, s[28:29] offset:3072 sc1
    v_lshl_add_u32 v22, v21, 1, v22
    v_lshlrev_b32 v20, 4, v20
    v_mov_b32 v21, 0x3f80
    v_lshlrev_b32 v21, v20, v21
    v_cmp_eq_u32 vcc, 0, v22
    v_mov_b32 v8, 0x0
    v_bfe_u32 v10, v2, 4, 2
    v_cndmask_b32 v12, 0, v21, vcc
    v_cmp_eq_u32 vcc, 1, v22
    v_lshlrev_b32 v10, 3, v10
    v_xor_b32 v8, v8, v10
    v_cndmask_b32 v13, 0, v21, vcc
    v_cmp_eq_u32 vcc, 2, v22
    v_bfe_u32 v10, v2, 6, 1
    v_lshlrev_b32 v10, 8, v10
    v_cndmask_b32 v14, 0, v21, vcc
    v_cmp_eq_u32 vcc, 3, v22
    v_xor_b32 v8, v8, v10
    v_bfe_u32 v10, v2, 8, 1
    v_cndmask_b32 v15, 0, v21, vcc
    v_lshlrev_b32 v10, 5, v10
    v_xor_b32 v8, v8, v10
    v_xor_b32 v8, s41, v8
    v_mov_b64 v[10:11], -1
L_rp1_s1:
    s_waitcnt vmcnt(3)
    v_mfma_f32_16x16x32_bf16 v[16:19], v[12:15], v[24:27], 0
    v_bitop3_b32 v20, v24, v26, s12 bitop3:0x7e
    s_waitcnt vmcnt(2)
    v_mfma_f32_16x16x32_bf16 v[16:19], v[12:15], v[28:31], v[16:19]
    v_bitop3_b32 v21, v28, v30, s13 bitop3:0x7e
    s_waitcnt vmcnt(1)
    v_mfma_f32_16x16x32_bf16 v[16:19], v[12:15], v[32:35], v[16:19]
    v_bitop3_b32 v22, v32, v34, s12 bitop3:0x7e
    v_or3_b32 v20, v20, v21, v22
    s_waitcnt vmcnt(0)
    v_mfma_f32_16x16x32_bf16 v[16:19], v[12:15], v[36:39], v[16:19]
    v_bitop3_b32 v23, v36, v38, s13 bitop3:0x7e
    v_bitop3_b32 v20, v20, v23, 1 bitop3:0xa8
    v_cmp_ne_u32 vcc, 0, v20
    s_nop 4
    v_add_f32_dpp v16, v16, v16 row_ror:8 row_mask:0xf bank_mask:0xf
    v_add_f32_dpp v17, v17, v17 row_ror:8 row_mask:0xf bank_mask:0xf
    v_add_f32_dpp v18, v18, v18 row_ror:8 row_mask:0xf bank_mask:0xf
    v_add_f32_dpp v19, v19, v19 row_ror:8 row_mask:0xf bank_mask:0xf
    v_cvt_pk_bf16_f32 v20, v16, v17
    v_cvt_pk_bf16_f32 v21, v18, v19
    s_mov_b64 exec, s[44:45]
    s_cbranch_vccnz L_rp1_s1_rt
    global_store_dwordx2 v8, v[20:21], s[14:15] sc1
    global_store_dwordx2 v8, v[10:11], s[60:61] sc1
    s_mov_b64 exec, -1
    s_barrier
    s_mov_b32 s55, 0
    ds_read_b32 v36, v5 offset:2304
    ds_read_b32 v37, v5 offset:2592
    ds_read2_b32 v[38:39], v5 offset0:0 offset1:72
    v_mov_b64 v[12:13], 0
    v_mov_b64 v[14:15], 0
    v_mov_b64 v[16:17], 0
    v_mov_b64 v[18:19], 0
    v_mov_b64 v[20:21], 0
    v_mov_b64 v[22:23], 0
    v_mov_b64 v[24:25], 0
    v_mov_b64 v[26:27], 0
    global_load_dwordx4 v[28:31], v2, s[20:21] offset:-3072 sc1
    global_load_dwordx4 v[32:35], v2, s[20:21] offset:-2048 sc1
    v_mov_b64 v[8:9], 0
    v_mov_b64 v[10:11], 0
    s_mov_b32 m0, s62
    s_branch L_rp2_s1
L_rf2_s1:
    s_mov_b64 exec, vcc
    global_load_dwordx4 v[28:31], v2, s[20:21] offset:-3072 sc1
    global_load_dwordx4 v[32:35], v2, s[20:21] offset:-2048 sc1
    s_mov_b64 exec, -1
    v_mov_b64 v[12:13], 0
    v_mov_b64 v[14:15], 0
    v_mov_b64 v[16:17], 0
    v_mov_b64 v[18:19], 0
    s_add_u32 s55, s55, 1
    s_cmp_gt_u32 s55, 100000
    s_cbranch_scc0 L_rp2_s1
    s_branch L_rx_s1
L_rp1_s1_rt:
    s_mov_b64 exec, vcc
    global_load_dwordx4 v[24:27], v2, s[28:29] offset:0 sc1
    global_load_dwordx4 v[28:31], v2, s[28:29] offset:1024 sc1
    global_load_dwordx4 v[32:35], v2, s[28:29] offset:2048 sc1
    global_load_dwordx4 v[36:39], v2, s[28:29] offset:3072 sc1
    s_mov_b64 exec, -1
    s_cmp_le_u32 s55, 2
    s_cbranch_scc1 L_bo_56
    s_sleep 4
L_bo_56:
    s_add_u32 s55, s55, 1
    s_cmp_gt_u32 s55, 100000
    s_cbranch_scc0 L_rp1_s1
    s_branch L_rx_s1
L_rp2ok_s1:
    s_branch L_rp2_s1
L_rlast_s1:
    s_lshl_b32 s13, s24, 17
    s_add_u32 s38, s50, s13
    s_addc_u32 s39, s51, 0
    s_waitcnt lgkmcnt(0)
    ds_read_b128 v[12:15], v2 offset:1024
    v_smfmac_f32_16x16x64_bf16 v[36:39], v[28:31], v[72:79], v7
    v_smfmac_f32_16x16x64_bf16 v[36:39], v[32:35], a[152:159], v7
    v_smfmac_f32_16x16x64_bf16 v[36:39], v[40:43], a[200:207], v7
    v_smfmac_f32_16x16x64_bf16 v[36:39], v[44:47], a[184:191], v7
    s_waitcnt lgkmcnt(0)
    v_smfmac_f32_16x16x64_bf16 v[36:39], v[12:15], a[168:175], v7
    v_add_f32 v20, v20, v21
    v_add_f32 v22, v22, v23
    v_add_f32 v24, v24, v25
    v_add_f32 v26, v26, v27
    v_cvt_pk_bf16_f32 v16, v20, v24
    v_cvt_pk_bf16_f32 v17, v22, v26
    s_nop 1
    v_add_f32 v36, v36, v37
    v_add_f32 v38, v38, v39
    v_add_f32 v8, v8, v9
    v_add_f32 v10, v10, v11
    v_cvt_pk_bf16_f32 v18, v8, v10
    v_cvt_pk_bf16_f32 v19, v36, v38
    global_store_dwordx4 v0, v[16:19], s[38:39] sc1
L_rx_s1:
    s_endpgm
L_rent_s2:
    v_add_u32 v1, 0x10000, v0
    ds_read_b128 v[40:43], v1 offset:32768
    ds_read_b128 v[44:47], v1 offset:36864
    v_add_u32 v1, 0x10000, v0
    ds_read_b128 v[48:51], v1 offset:40960
    ds_read_b128 v[52:55], v1 offset:45056
    v_add_u32 v1, 0x10000, v0
    ds_read_b128 v[56:59], v1 offset:49152
    ds_read_b128 v[60:63], v1 offset:53248
    ds_read_b128 v[28:31], v2 offset:3072
    ds_read_b128 v[32:35], v2 offset:4096
    v_mov_b64 v[8:9], 0
    v_mov_b64 v[10:11], 0
    v_mov_b64 v[12:13], 0
    v_mov_b64 v[14:15], 0
    v_mov_b64 v[16:17], 0
    v_mov_b64 v[18:19], 0
    v_mov_b64 v[20:21], 0
    v_mov_b64 v[22:23], 0
    v_mov_b64 v[24:25], 0
    v_mov_b64 v[26:27], 0
    s_mov_b32 m0, s62
    s_mov_b32 s55, 0
    s_mov_b32 s47, s40
    s_mov_b64 s[20:21], s[30:31]
    s_waitcnt lgkmcnt(0)
    v_smfmac_f32_16x16x64_bf16 v[12:15], v[28:31], a[48:55], v7
    v_smfmac_f32_16x16x64_bf16 v[16:19], v[28:31], a[56:63], v7
    s_branch L_rgo_s2
.p2align 6
L_rp2_s2:
    s_waitcnt vmcnt(1)
    v_smfmac_f32_16x16x64_bf16 v[12:15], v[28:31], a[48:55], v7
    v_max_u32 v1, v28, v30
    s_waitcnt vmcnt(0)
    v_max3_u32 v1, v1, v32, v34
    v_cmp_eq_u32 vcc, -1, v1
    v_smfmac_f32_16x16x64_bf16 v[16:19], v[28:31], a[56:63], v7
    ds_write_b128 v2, v[28:31] offset:3072
    s_cbranch_vccnz L_rf2_s2
L_rgo_s2:
    v_smfmac_f32_16x16x64_bf16 v[8:11], v[28:31], a[192:199], v7
    ds_write_b128 v2, v[32:35] offset:4096
    s_waitcnt lgkmcnt(2)
    v_smfmac_f32_16x16x64_bf16 v[20:23], v[28:31], v[40:47], v7
    v_add_u32 v1, 0x10000, v0
    ds_read_b128 v[40:43], v1 offset:57344
    v_smfmac_f32_16x16x64_bf16 v[24:27], v[28:31], v[48:55], v7
    ds_read_b128 v[44:47], v1 offset:61440
    v_add_u32 v1, 0x20000, v0
    v_smfmac_f32_16x16x64_bf16 v[12:15], v[32:35], a[64:71], v7
    s_waitcnt lgkmcnt(2)
    s_barrier
    ds_read_b128 v[28:31], v2 offset:5120
    v_smfmac_f32_16x16x64_bf16 v[20:23], v[32:35], v[56:63], v7
    global_load_lds_dwordx4 v2, s[32:33]
    ds_read_b128 v[48:51], v1 offset:0
    v_smfmac_f32_16x16x64_bf16 v[16:19], v[32:35], a[72:79], v7
    global_load_lds_dwordx4 v2, s[32:33] offset:1024
    s_mov_b32 m0, s63
    ds_read_b128 v[52:55], v1 offset:4096
    v_smfmac_f32_16x16x64_bf16 v[8:11], v[32:35], a[208:215], v7
    global_load_lds_dwordx4 v2, s[86:87]
    s_add_u32 m0, s63, 3072
    ds_read_b128 v[56:59], v1 offset:8192
    s_waitcnt lgkmcnt(4)
    v_smfmac_f32_16x16x64_bf16 v[24:27], v[32:35], v[40:47], v7
    global_load_lds_dwordx4 v2, s[86:87] offset:1024
    s_mov_b32 m0, 32256
    ds_read_b128 v[32:35], v2 offset:6144
    s_waitcnt lgkmcnt(4)
    v_smfmac_f32_16x16x64_bf16 v[12:15], v[28:31], a[80:87], v7
    ds_read_b128 v[60:63], v1 offset:12288
    ds_read_b128 v[40:43], v1 offset:16384
    s_waitcnt lgkmcnt(4)
    v_smfmac_f32_16x16x64_bf16 v[20:23], v[28:31], v[48:55], v7
    global_store_dwordx4 v0, v[36:39], s[38:39] sc1
    ds_read_b128 v[44:47], v1 offset:20480
    v_smfmac_f32_16x16x64_bf16 v[16:19], v[28:31], a[88:95], v7
    ds_read_b128 v[48:51], v1 offset:24576
    ds_read_b128 v[52:55], v1 offset:28672
    v_smfmac_f32_16x16x64_bf16 v[8:11], v[28:31], a[224:231], v7
    v_lshlrev_b32 v36, 2, v0
    global_load_lds_dword v36, s[58:59]
    s_mov_b32 m0, 25856
    v_mov_b64 v[36:37], 0
    v_mov_b64 v[38:39], 0
    s_waitcnt lgkmcnt(4)
    v_smfmac_f32_16x16x64_bf16 v[24:27], v[28:31], v[56:63], v7
    ds_read_b128 v[28:31], v2 offset:8192
    ds_read_b128 v[56:59], v0 offset:32768
    v_smfmac_f32_16x16x64_bf16 v[12:15], v[32:35], a[96:103], v7
    ds_read_b128 v[60:63], v0 offset:36864
    s_waitcnt lgkmcnt(5)
    v_smfmac_f32_16x16x64_bf16 v[20:23], v[32:35], v[40:47], v7
    ds_read_b128 v[40:43], v0 offset:40960
    ds_read_b128 v[44:47], v0 offset:45056
    v_smfmac_f32_16x16x64_bf16 v[16:19], v[32:35], a[104:111], v7
    v_smfmac_f32_16x16x64_bf16 v[8:11], v[32:35], a[240:247], v7
    v_smfmac_f32_16x16x64_bf16 v[36:39], v[32:35], a[248:255], v7
    s_waitcnt lgkmcnt(5)
    v_smfmac_f32_16x16x64_bf16 v[24:27], v[32:35], v[48:55], v7
    ds_read_b128 v[32:35], v2 offset:0
    ds_read_b128 v[48:51], v0 offset:49152
    s_waitcnt lgkmcnt(6)
    v_smfmac_f32_16x16x64_bf16 v[12:15], v[28:31], a[128:135], v7
    ds_read_b128 v[52:55], v0 offset:53248
    s_waitcnt lgkmcnt(5)
    v_smfmac_f32_16x16x64_bf16 v[20:23], v[28:31], v[56:63], v7
    ds_read_b128 v[56:59], v0 offset:57344
    ds_read_b128 v[60:63], v0 offset:61440
    v_smfmac_f32_16x16x64_bf16 v[16:19], v[28:31], a[136:143], v7
    v_smfmac_f32_16x16x64_bf16 v[8:11], v[28:31], v[80:87], v7
    v_smfmac_f32_16x16x64_bf16 v[36:39], v[28:31], v[88:95], v7
    s_waitcnt lgkmcnt(5)
    v_smfmac_f32_16x16x64_bf16 v[24:27], v[28:31], v[40:47], v7
    ds_read_b128 v[28:31], v2 offset:1024
    v_add_u32 v1, 0x10000, v0
    s_waitcnt lgkmcnt(5)
    v_smfmac_f32_16x16x64_bf16 v[12:15], v[32:35], a[0:7], v7
    ds_read_b128 v[40:43], v1 offset:0
    ds_read_b128 v[44:47], v1 offset:4096
    s_waitcnt lgkmcnt(5)
    v_smfmac_f32_16x16x64_bf16 v[20:23], v[32:35], v[48:55], v7
    ds_read_b128 v[48:51], v1 offset:8192
    ds_read_b128 v[52:55], v1 offset:12288
    v_smfmac_f32_16x16x64_bf16 v[16:19], v[32:35], a[8:15], v7
    v_smfmac_f32_16x16x64_bf16 v[8:11], v[32:35], a[144:151], v7
    v_smfmac_f32_16x16x64_bf16 v[36:39], v[32:35], a[152:159], v7
    s_waitcnt lgkmcnt(5)
    v_smfmac_f32_16x16x64_bf16 v[24:27], v[32:35], v[56:63], v7
    ds_read_b128 v[32:35], v2 offset:2048
    ds_read_b128 v[56:59], v1 offset:16384
    s_waitcnt lgkmcnt(6)
    v_smfmac_f32_16x16x64_bf16 v[12:15], v[28:31], a[16:23], v7
    ds_read_b128 v[60:63], v1 offset:20480
    s_waitcnt lgkmcnt(5)
    v_smfmac_f32_16x16x64_bf16 v[20:23], v[28:31], v[40:47], v7
    ds_read_b128 v[40:43], v1 offset:24576
    ds_read_b128 v[44:47], v1 offset:28672
    v_smfmac_f32_16x16x64_bf16 v[16:19], v[28:31], a[24:31], v7
    s_waitcnt vmcnt(4)
    s_barrier
    v_smfmac_f32_16x16x64_bf16 v[8:11], v[28:31], a[160:167], v7
    v_smfmac_f32_16x16x64_bf16 v[36:39], v[28:31], a[168:175], v7
    s_waitcnt lgkmcnt(5)
    v_smfmac_f32_16x16x64_bf16 v[24:27], v[28:31], v[48:55], v7
    ds_read_b128 v[28:31], v2 offset:7168
    ds_read_b128 v[48:51], v2 offset:11264
    s_waitcnt lgkmcnt(6)
    v_smfmac_f32_16x16x64_bf16 v[12:15], v[32:35], a[32:39], v7
    ds_read_b128 v[52:55], v2 offset:15360
    s_waitcnt lgkmcnt(5)
    v_smfmac_f32_16x16x64_bf16 v[20:23], v[32:35], v[56:63], v7
    ds_read_b128 v[56:59], v2 offset:12288
    ds_read_b128 v[60:63], v2 offset:16384
    v_smfmac_f32_16x16x64_bf16 v[16:19], v[32:35], a[40:47], v7
    v_smfmac_f32_16x16x64_bf16 v[8:11], v[32:35], a[176:183], v7
    s_waitcnt lgkmcnt(5)
    v_smfmac_f32_16x16x64_bf16 v[24:27], v[32:35], v[40:47], v7
    ds_read_b128 v[40:43], v2 offset:5120
    ds_read_b128 v[44:47], v2 offset:4096
    s_waitcnt lgkmcnt(6)
    v_smfmac_f32_16x16x64_bf16 v[12:15], v[28:31], a[112:119], v7
    v_smfmac_f32_16x16x64_bf16 v[16:19], v[28:31], a[120:127], v7
    v_smfmac_f32_16x16x64_bf16 v[20:23], v[28:31], v[240:247], v7
    v_smfmac_f32_16x16x64_bf16 v[24:27], v[28:31], v[248:255], v7
    v_mov_b32 v1, s47
    v_smfmac_f32_16x16x64_bf16 v[8:11], v[28:31], v[64:71], v7
    s_cmp_eq_u32 s24, 63
    s_cbranch_scc1 L_rlast_s2
    s_nop 0
    v_add_f32 v12, v12, v13
    v_add_f32 v14, v14, v15
    v_add_f32 v16, v16, v17
    v_add_f32 v18, v18, v19
    v_cvt_pk_bf16_f32 v13, v12, v16
    v_cvt_pk_bf16_f32 v15, v14, v18
    ds_write2_b32 v5, v13, v15 offset0:0 offset1:72
    v_add_f32 v20, v20, v21
    v_add_f32 v22, v22, v23
    v_add_f32 v24, v24, v25
    v_add_f32 v26, v26, v27
    v_cvt_pk_bf16_f32 v21, v20, v24
    v_cvt_pk_bf16_f32 v23, v22, v26
    ds_write_b32 v5, v21 offset:2304
    ds_write_b32 v5, v23 offset:2592
    ds_read_b128 v[24:27], v4 offset:128
    v_smfmac_f32_16x16x64_bf16 v[36:39], v[28:31], v[72:79], v7
    ds_read_b128 v[28:31], v4 offset:2432
    v_smfmac_f32_16x16x64_bf16 v[36:39], v[32:35], a[184:191], v7
    ds_read_b128 v[32:35], v2 offset:3072
    s_waitcnt lgkmcnt(7)
    v_smfmac_f32_16x16x64_bf16 v[36:39], v[40:43], a[232:239], v7
    s_waitcnt lgkmcnt(6)
    v_smfmac_f32_16x16x64_bf16 v[36:39], v[44:47], a[216:223], v7
    s_waitcnt lgkmcnt(3)
    s_barrier
    ds_read_b128 v[40:43], v4 offset:192
    ds_read_b128 v[44:47], v4 offset:2496
    s_waitcnt lgkmcnt(4)
    v_mfma_f32_16x16x32_bf16 v[12:15], v[48:51], v[24:27], 0
    ds_read_b128 v[48:51], v4 offset:0
    v_mfma_f32_16x16x32_bf16 v[16:19], v[52:55], v[24:27], 0
    ds_read_b128 v[52:55], v2 offset:9216
    s_waitcnt lgkmcnt(5)
    v_mfma_f32_16x16x32_bf16 v[20:23], v[28:31], v[24:27], 0
    ds_read_b128 v[28:31], v2 offset:13312
    ds_read_b128 v[24:27], v4 offset:2304
    s_waitcnt lgkmcnt(5)
    v_mfma_f32_16x16x32_bf16 v[12:15], v[56:59], v[40:43], v[12:15]
    ds_read_b128 v[56:59], v4 offset:64
    v_mfma_f32_16x16x32_bf16 v[16:19], v[60:63], v[40:43], v[16:19]
    ds_read_b128 v[60:63], v2 offset:10240
    s_waitcnt lgkmcnt(6)
    v_mfma_f32_16x16x32_bf16 v[20:23], v[44:47], v[40:43], v[20:23]
    ds_read_b128 v[44:47], v2 offset:14336
    ds_read_b128 v[40:43], v4 offset:2368
    s_waitcnt lgkmcnt(6)
    v_mfma_f32_16x16x32_bf16 v[12:15], v[52:55], v[48:51], v[12:15]
    s_waitcnt vmcnt(2)
    ds_read_b128 v[52:55], v0 offset:17408
    s_waitcnt lgkmcnt(6)
    v_mfma_f32_16x16x32_bf16 v[16:19], v[28:31], v[48:51], v[16:19]
    ds_read_b128 v[28:31], v0 offset:21504
    s_waitcnt lgkmcnt(6)
    v_mfma_f32_16x16x32_bf16 v[20:23], v[24:27], v[48:51], v[20:23]
    s_waitcnt lgkmcnt(4)
    v_mfma_f32_16x16x32_bf16 v[12:15], v[60:63], v[56:59], v[12:15]
    s_waitcnt lgkmcnt(3)
    v_mfma_f32_16x16x32_bf16 v[16:19], v[44:47], v[56:59], v[16:19]
    s_waitcnt lgkmcnt(2)
    v_mfma_f32_16x16x32_bf16 v[20:23], v[40:43], v[56:59], v[20:23]
    v_smfmac_f32_16x16x64_bf16 v[36:39], v[32:35], a[200:207], v7
    v_mov_b32 v49, 0
    v_mov_b32 v50, 0
    v_add_f32 v8, v8, v9
    v_add_f32 v10, v10, v11
    s_nop 0
    v_mov_b32_dpp v12, v16 quad_perm:[0,1,2,3] row_mask:0xf bank_mask:0xc
    v_mov_b32_dpp v13, v17 quad_perm:[0,1,2,3] row_mask:0xf bank_mask:0xc
    v_mov_b32_dpp v14, v18 quad_perm:[0,1,2,3] row_mask:0xf bank_mask:0xc
    v_mov_b32_dpp v15, v19 quad_perm:[0,1,2,3] row_mask:0xf bank_mask:0xc
    v_mov_b32_dpp v22, v23 quad_perm:[0,1,2,3] row_mask:0xf bank_mask:0xc
    v_mov_b32_dpp v20, v21 quad_perm:[0,1,2,3] row_mask:0x3 bank_mask:0xc
    v_max3_f32 v16, v12, v13, v14
    v_add_f32 v36, v36, v37
    v_mov_b32_dpp v20, v22 quad_perm:[0,1,2,3] row_mask:0xc bank_mask:0xf
    v_max3_f32 v16, v16, v15, v20
    v_pk_mul_f32 v[12:13], v[12:13], s[46:47] op_sel_hi:[1,0]
    v_pk_mul_f32 v[14:15], v[14:15], s[46:47] op_sel_hi:[1,0]
    v_max_f32_dpp v16, v16, v16 row_ror:8 row_mask:0xf bank_mask:0xf
    v_mov_b32 v17, v16
    v_mul_f32 v20, s46, v20
    v_add_f32 v38, v38, v39
    v_permlane16_swap_b32 v16, v17
    v_max_f32 v16, v16, v17
    v_mov_b32 v17, v16
    v_cvt_pk_bf16_f32 v22, v8, v10
    v_cvt_pk_bf16_f32 v23, v36, v38
    v_permlane32_swap_b32 v16, v17
    v_max_f32 v16, v16, v17
    v_mul_f32 v16, s46, v16
    v_sub_f32 v12, v12, v16
    v_sub_f32 v13, v13, v16
    v_sub_f32 v14, v14, v16
    v_sub_f32 v15, v15, v16
    v_sub_f32 v20, v20, v16
    v_exp_f32 v12, v12
    v_exp_f32 v13, v13
    v_exp_f32 v14, v14
    v_exp_f32 v15, v15
    v_cvt_pk_bf16_f32 v24, v12, v13
    v_cvt_pk_bf16_f32 v25, v14, v15
    v_exp_f32 v20, v20
    v_mov_b32_dpp v26, v24 row_ror:8 row_mask:0xf bank_mask:0xf
    v_mov_b32_dpp v27, v25 row_ror:8 row_mask:0xf bank_mask:0xf
    v_mov_b32_dpp v21, v20 row_ror:8 row_mask:0xf bank_mask:0xf
    v_add_f32 v18, v12, v13
    s_waitcnt lgkmcnt(0)
    v_mfma_f32_16x16x32_bf16 v[60:63], v[52:55], v[24:27], 0
    v_cvt_pk_bf16_f32 v48, v20, v21
    v_add_f32 v17, v14, v15
    v_mfma_f32_16x16x32_bf16 v[44:47], v[28:31], v[24:27], 0
    v_add_f32 v18, v18, v20
    v_add_f32 v18, v18, v17
    v_cvt_pk_bf16_f32 v51, v20, v21
    v_mfma_f32_16x16x16_bf16 v[60:63], v[22:23], v[48:49], v[60:63]
    v_add_f32_dpp v18, v18, v18 row_ror:8 row_mask:0xf bank_mask:0xf
    v_mov_b32 v17, v18
    v_mfma_f32_16x16x16_bf16 v[44:47], v[22:23], v[50:51], v[44:47]
    v_lshrrev_b32 v9, 2, v2
    v_permlane16_swap_b32 v18, v17
    v_add_f32 v18, v18, v17
    v_mov_b32 v17, v18
    v_and_b32 v8, 0x300, v2
    v_bfe_u32 v10, v2, 1, 7
    v_permlane32_swap_b32 v18, v17
    v_add_f32 v18, v18, v17
    v_rcp_f32 v18, v18
    v_lshl_or_b32 v8, v8, 4, v10
    v_pk_mul_f32 v[60:61], v[60:61], v[18:19] op_sel_hi:[1,0]
    v_pk_mul_f32 v[62:63], v[62:63], v[18:19] op_sel_hi:[1,0]
    v_pk_mul_f32 v[44:45], v[44:45], v[18:19] op_sel_hi:[1,0]
    v_pk_mul_f32 v[46:47], v[46:47], v[18:19] op_sel_hi:[1,0]
    v_cvt_pk_bf16_f32 v12, v60, v61
    v_cvt_pk_bf16_f32 v13, v62, v63
    v_cvt_pk_bf16_f32 v14, v44, v45
    v_cvt_pk_bf16_f32 v15, v46, v47
    ds_write_b128 v6, v[12:15]
    v_mov_b64 v[10:11], 0
    s_nop 1
    v_mfma_f32_32x32x8_bf16 v[28:43], v[10:11], v[10:11], 0
    v_mfma_f32_32x32x8_bf16 v[44:59], v[10:11], v[10:11], 0
    s_waitcnt lgkmcnt(0)
    s_barrier
    ds_read_b128 v[12:15], v3 offset:30208
    ds_read_b128 v[16:19], v3 offset:31232
    v_mov_b64 v[60:61], 0
    ds_write2_b32 v5, v22, v23 offset0:0 offset1:72
    v_mov_b64 v[62:63], 0
    s_waitcnt lgkmcnt(2)
    s_nop 0
    v_smfmac_f32_16x16x64_bf16 v[28:31], v[12:15], v[224:231], v7
    s_waitcnt lgkmcnt(1)
    v_smfmac_f32_16x16x64_bf16 v[28:31], v[16:19], v[232:239], v7
    s_nop 1
    v_smfmac_f32_16x16x64_bf16 v[32:35], v[12:15], v[96:103], v7
    s_nop 1
    v_smfmac_f32_16x16x64_bf16 v[32:35], v[16:19], v[104:111], v7
    s_nop 1
    v_smfmac_f32_16x16x64_bf16 v[36:39], v[12:15], v[112:119], v7
    v_add_f32 v28, v28, v29
    v_add_f32 v29, v30, v31
    v_smfmac_f32_16x16x64_bf16 v[36:39], v[16:19], v[120:127], v7
    v_cvt_pk_bf16_f32 v30, v28, v29
    v_bfi_b32 v30, 1, v1, v30
    global_store_dword v9, v30, s[42:43] sc1
    v_smfmac_f32_16x16x64_bf16 v[40:43], v[12:15], v[128:135], v7
    v_add_f32 v32, v32, v33
    v_add_f32 v33, v34, v35
    v_smfmac_f32_16x16x64_bf16 v[40:43], v[16:19], v[136:143], v7
    s_nop 1
    v_smfmac_f32_16x16x64_bf16 v[44:47], v[12:15], v[144:151], v7
    v_add_f32 v36, v36, v37
    v_add_f32 v37, v38, v39
    v_smfmac_f32_16x16x64_bf16 v[44:47], v[16:19], v[152:159], v7
    v_cvt_pk_bf16_f32 v38, v32, v36
    v_cvt_pk_bf16_f32 v39, v33, v37
    v_bfi_b32 v38, 1, v1, v38
    v_smfmac_f32_16x16x64_bf16 v[48:51], v[12:15], v[160:167], v7
    global_store_dwordx2 v8, v[38:39], s[26:27] sc1
    v_add_f32 v40, v40, v41
    v_add_f32 v41, v42, v43
    v_smfmac_f32_16x16x64_bf16 v[48:51], v[16:19], v[168:175], v7
    v_add_f32 v44, v44, v45
    v_add_f32 v45, v46, v47
    v_smfmac_f32_16x16x64_bf16 v[52:55], v[12:15], v[176:183], v7
    v_cvt_pk_bf16_f32 v46, v40, v44
    v_cvt_pk_bf16_f32 v47, v41, v45
    v_bfi_b32 v46, 1, v1, v46
    v_smfmac_f32_16x16x64_bf16 v[52:55], v[16:19], v[184:191], v7
    global_store_dwordx2 v8, v[46:47], s[90:91] sc1
    v_add_f32 v48, v48, v49
    v_smfmac_f32_16x16x64_bf16 v[56:59], v[12:15], v[192:199], v7
    v_add_f32 v49, v50, v51
    v_smfmac_f32_16x16x64_bf16 v[56:59], v[16:19], v[200:207], v7
    s_nop 1
    v_smfmac_f32_16x16x64_bf16 v[60:63], v[12:15], v[208:215], v7
    v_add_f32 v52, v52, v53
    v_add_f32 v53, v54, v55
    v_smfmac_f32_16x16x64_bf16 v[60:63], v[16:19], v[216:223], v7
    v_cvt_pk_bf16_f32 v54, v48, v52
    v_cvt_pk_bf16_f32 v55, v49, v53
    v_bfi_b32 v54, 1, v1, v54
    global_store_dwordx2 v8, v[54:55], s[92:93] sc1
    v_add_f32 v56, v56, v57
    v_add_f32 v57, v58, v59
    s_nop 1
    v_add_f32 v60, v60, v61
    v_add_f32 v61, v62, v63
    v_cvt_pk_bf16_f32 v62, v56, v60
    v_cvt_pk_bf16_f32 v63, v57, v61
    v_bfi_b32 v62, 1, v1, v62
    global_store_dwordx2 v8, v[62:63], s[94:95] sc1
    v_mov_b32 v9, 0x0
    v_bfe_u32 v10, v2, 4, 1
    v_lshl_add_u32 v9, v10, 4, v9
    v_bfe_u32 v10, v2, 5, 5
    v_lshl_add_u32 v9, v10, 8, v9
    global_load_dwordx4 v[24:27], v9, s[28:29] sc1
    s_lshl_b32 s13, s24, 17
    s_add_u32 s38, s50, s13
    s_addc_u32 s39, s51, 0
    s_add_u32 s25, s24, 2
    s_min_u32 s25, s25, 63
    s_lshl_b32 s13, s25, 19
    s_add_u32 s58, s88, s13
    s_addc_u32 s59, s89, 0
    s_add_u32 s86, s86, 524288
    s_addc_u32 s87, s87, 0
    s_add_u32 s32, s32, 524288
    s_addc_u32 s33, s33, 0
    s_add_u32 s14, s30, s34
    s_addc_u32 s15, s31, 0
    s_add_u32 s60, s30, s35
    s_addc_u32 s61, s31, 0
    s_add_u32 s20, s14, 4096
    s_addc_u32 s21, s15, 0
    s_and_b32 s12, s24, 1
    s_xor_b32 s13, s12, 1
    s_xor_b32 s47, s13, s40
    s_add_u32 s24, s24, 1
    s_mov_b32 s35, s34
    s_add_u32 s34, s34, 9216
    s_cmp_eq_u32 s34, 27648
    s_cselect_b32 s34, 0, s34
    s_mov_b32 s55, 0
    v_add_u32 v1, 0x10000, v0
    ds_read_b128 v[40:43], v1 offset:32768
    ds_read_b128 v[44:47], v1 offset:36864
    v_add_u32 v1, 0x10000, v0
    ds_read_b128 v[48:51], v1 offset:40960
    ds_read_b128 v[52:55], v1 offset:45056
    v_add_u32 v1, 0x10000, v0
    ds_read_b128 v[56:59], v1 offset:49152
    ds_read_b128 v[60:63], v1 offset:53248
    v_bfe_u32 v20, v2, 6, 1
    v_bfe_u32 v22, v2, 4, 2
    v_bfe_u32 v23, v2, 8, 1
    v_xor_b32 v23, s12, v23
    v_lshlrev_b32 v20, 4, v20
    v_mov_b32 v21, 0x3f80
    v_lshlrev_b32 v21, v20, v21
    v_cmp_eq_u32 vcc, 0, v22
    v_mov_b32 v8, 0x0
    v_bfe_u32 v10, v2, 4, 1
    v_cndmask_b32 v12, 0, v21, vcc
    v_cmp_eq_u32 vcc, 1, v22
    v_lshlrev_b32 v10, 3, v10
    v_xor_b32 v8, v8, v10
    v_cndmask_b32 v13, 0, v21, vcc
    v_cmp_eq_u32 vcc, 2, v22
    v_bfe_u32 v10, v2, 8, 1
    v_lshlrev_b32 v10, 5, v10
    v_cndmask_b32 v14, 0, v21, vcc
    v_cmp_eq_u32 vcc, 3, v22
    v_xor_b32 v8, v8, v10
    v_xor_b32 v8, s41, v8
    v_cndmask_b32 v15, 0, v21, vcc
    v_mov_b64 v[10:11], -1
L_rp1_s2:
    s_waitcnt vmcnt(0)
    v_mfma_f32_16x16x32_bf16 v[16:19], v[12:15], v[24:27], 0
    v_bitop3_b32 v20, v24, v25, v23 bitop3:0x7e
    v_bitop3_b32 v21, v26, v27, v23 bitop3:0x7e
    v_bitop3_b32 v20, v20, v21, 1 bitop3:0xa8
    v_cmp_ne_u32 vcc, 0, v20
    s_nop 3
    v_add_f32_dpp v16, v16, v16 row_ror:8 row_mask:0xf bank_mask:0xf
    v_add_f32_dpp v17, v17, v17 row_ror:8 row_mask:0xf bank_mask:0xf
    v_add_f32_dpp v18, v18, v18 row_ror:8 row_mask:0xf bank_mask:0xf
    v_add_f32_dpp v19, v19, v19 row_ror:8 row_mask:0xf bank_mask:0xf
    v_add_f32_dpp v16, v16, v16 row_ror:4 row_mask:0xf bank_mask:0xf
    v_add_f32_dpp v17, v17, v17 row_ror:4 row_mask:0xf bank_mask:0xf
    v_add_f32_dpp v18, v18, v18 row_ror:4 row_mask:0xf bank_mask:0xf
    v_add_f32_dpp v19, v19, v19 row_ror:4 row_mask:0xf bank_mask:0xf
    v_add_f32_dpp v16, v16, v16 quad_perm:[2,3,0,1] row_mask:0xf bank_mask:0xf
    v_add_f32_dpp v17, v17, v17 quad_perm:[2,3,0,1] row_mask:0xf bank_mask:0xf
    v_add_f32_dpp v18, v18, v18 quad_perm:[2,3,0,1] row_mask:0xf bank_mask:0xf
    v_add_f32_dpp v19, v19, v19 quad_perm:[2,3,0,1] row_mask:0xf bank_mask:0xf
    v_cvt_pk_bf16_f32 v20, v16, v17
    v_cvt_pk_bf16_f32 v21, v18, v19
    s_mov_b64 exec, s[44:45]
    s_cbranch_vccnz L_rp1_s2_rt
    global_store_dwordx2 v8, v[20:21], s[14:15] sc1
    global_store_dwordx2 v8, v[10:11], s[60:61] sc1
    s_mov_b64 exec, -1
    s_barrier
    s_mov_b32 s55, 0
    ds_read_b32 v36, v5 offset:2304
    ds_read_b32 v37, v5 offset:2592
    ds_read2_b32 v[38:39], v5 offset0:0 offset1:72
    v_mov_b64 v[12:13], 0
    v_mov_b64 v[14:15], 0
    v_mov_b64 v[16:17], 0
    v_mov_b64 v[18:19], 0
    v_mov_b64 v[20:21], 0
    v_mov_b64 v[22:23], 0
    v_mov_b64 v[24:25], 0
    v_mov_b64 v[26:27], 0
    global_load_dwordx4 v[28:31], v2, s[20:21] offset:-1024 sc1
    global_load_dwordx4 v[32:35], v2, s[20:21] offset:0 sc1
    v_mov_b64 v[8:9], 0
    v_mov_b64 v[10:11], 0
    s_mov_b32 m0, s62
    s_branch L_rp2_s2
L_rf2_s2:
    s_mov_b64 exec, vcc
    global_load_dwordx4 v[28:31], v2, s[20:21] offset:-1024 sc1
    global_load_dwordx4 v[32:35], v2, s[20:21] offset:0 sc1
    s_mov_b64 exec, -1
    v_mov_b64 v[12:13], 0
    v_mov_b64 v[14:15], 0
    v_mov_b64 v[16:17], 0
    v_mov_b64 v[18:19], 0
    s_add_u32 s55, s55, 1
    s_cmp_gt_u32 s55, 100000
    s_cbranch_scc0 L_rp2_s2
    s_branch L_rx_s2
L_rp1_s2_rt:
    s_mov_b64 exec, vcc
    global_load_dwordx4 v[24:27], v9, s[28:29] sc1
    s_mov_b64 exec, -1
    s_cmp_le_u32 s55, 2
    s_cbranch_scc1 L_bo_57
    s_sleep 4
L_bo_57:
    s_add_u32 s55, s55, 1
    s_cmp_gt_u32 s55, 100000
    s_cbranch_scc0 L_rp1_s2
    s_branch L_rx_s2
L_rp2ok_s2:
    s_branch L_rp2_s2
L_rlast_s2:
    s_lshl_b32 s13, s24, 17
    s_add_u32 s38, s50, s13
    s_addc_u32 s39, s51, 0
    s_waitcnt lgkmcnt(0)
    ds_read_b128 v[12:15], v2 offset:3072
    v_smfmac_f32_16x16x64_bf16 v[36:39], v[28:31], v[72:79], v7
    v_smfmac_f32_16x16x64_bf16 v[36:39], v[32:35], a[184:191], v7
    v_smfmac_f32_16x16x64_bf16 v[36:39], v[40:43], a[232:239], v7
    v_smfmac_f32_16x16x64_bf16 v[36:39], v[44:47], a[216:223], v7
    s_waitcnt lgkmcnt(0)
    v_smfmac_f32_16x16x64_bf16 v[36:39], v[12:15], a[200:207], v7
    v_add_f32 v20, v20, v21
    v_add_f32 v22, v22, v23
    v_add_f32 v24, v24, v25
    v_add_f32 v26, v26, v27
    v_cvt_pk_bf16_f32 v16, v20, v24
    v_cvt_pk_bf16_f32 v17, v22, v26
    s_nop 1
    v_add_f32 v36, v36, v37
    v_add_f32 v38, v38, v39
    v_add_f32 v8, v8, v9
    v_add_f32 v10, v10, v11
    v_cvt_pk_bf16_f32 v18, v8, v10
    v_cvt_pk_bf16_f32 v19, v36, v38
    global_store_dwordx4 v0, v[16:19], s[38:39] sc1
L_rx_s2:
    s_endpgm
L_rent_s3:
    v_add_u32 v1, 0x20000, v0
    ds_read_b128 v[40:43], v1 offset:0
    ds_read_b128 v[44:47], v1 offset:4096
    v_add_u32 v1, 0x20000, v0
    ds_read_b128 v[48:51], v1 offset:8192
    ds_read_b128 v[52:55], v1 offset:12288
    v_add_u32 v1, 0x20000, v0
    ds_read_b128 v[56:59], v1 offset:16384
    ds_read_b128 v[60:63], v1 offset:20480
    ds_read_b128 v[28:31], v2 offset:5120
    ds_read_b128 v[32:35], v2 offset:6144
    v_mov_b64 v[8:9], 0
    v_mov_b64 v[10:11], 0
    v_mov_b64 v[12:13], 0
    v_mov_b64 v[14:15], 0
    v_mov_b64 v[16:17], 0
    v_mov_b64 v[18:19], 0
    v_mov_b64 v[20:21], 0
    v_mov_b64 v[22:23], 0
    v_mov_b64 v[24:25], 0
    v_mov_b64 v[26:27], 0
    s_mov_b32 m0, s62
    s_mov_b32 s55, 0
    s_mov_b32 s47, s40
    s_mov_b64 s[20:21], s[30:31]
    s_waitcnt lgkmcnt(0)
    v_smfmac_f32_16x16x64_bf16 v[12:15], v[28:31], a[80:87], v7
    v_smfmac_f32_16x16x64_bf16 v[16:19], v[28:31], a[88:95], v7
    s_branch L_rgo_s3
.p2align 6
L_rp2_s3:
    s_waitcnt vmcnt(1)
    v_smfmac_f32_16x16x64_bf16 v[12:15], v[28:31], a[80:87], v7
    v_max_u32 v1, v28, v30
    s_waitcnt vmcnt(0)
    v_max3_u32 v1, v1, v32, v34
    v_cmp_eq_u32 vcc, -1, v1
    v_smfmac_f32_16x16x64_bf16 v[16:19], v[28:31], a[88:95], v7
    ds_write_b128 v2, v[28:31] offset:5120
    s_cbranch_vccnz L_rf2_s3
L_rgo_s3:
    v_smfmac_f32_16x16x64_bf16 v[8:11], v[28:31], a[224:231], v7
    ds_write_b128 v2, v[32:35] offset:6144
    s_waitcnt lgkmcnt(2)
    v_smfmac_f32_16x16x64_bf16 v[20:23], v[28:31], v[40:47], v7
    v_add_u32 v1, 0x20000, v0
    ds_read_b128 v[40:43], v1 offset:24576
    v_smfmac_f32_16x16x64_bf16 v[24:27], v[28:31], v[48:55], v7
    ds_read_b128 v[44:47], v1 offset:28672
    ds_read_b128 v[48:51], v0 offset:32768
    v_smfmac_f32_16x16x64_bf16 v[12:15], v[32:35], a[96:103], v7
    s_waitcnt lgkmcnt(3)
    s_barrier
    ds_read_b128 v[28:31], v2 offset:8192
    v_smfmac_f32_16x16x64_bf16 v[20:23], v[32:35], v[56:63], v7
    global_load_lds_dwordx4 v2, s[32:33]
    ds_read_b128 v[52:55], v0 offset:36864
    v_smfmac_f32_16x16x64_bf16 v[16:19], v[32:35], a[104:111], v7
    global_load_lds_dwordx4 v2, s[32:33] offset:1024
    s_mov_b32 m0, s63
    ds_read_b128 v[56:59], v0 offset:40960
    v_smfmac_f32_16x16x64_bf16 v[8:11], v[32:35], a[240:247], v7
    global_load_lds_dwordx4 v2, s[86:87]
    s_add_u32 m0, s63, 3072
    ds_read_b128 v[60:63], v0 offset:45056
    s_waitcnt lgkmcnt(5)
    v_smfmac_f32_16x16x64_bf16 v[24:27], v[32:35], v[40:47], v7
    global_load_lds_dwordx4 v2, s[86:87] offset:1024
    s_mov_b32 m0, 32256
    ds_read_b128 v[32:35], v2 offset:0
    s_waitcnt lgkmcnt(4)
    v_smfmac_f32_16x16x64_bf16 v[12:15], v[28:31], a[128:135], v7
    ds_read_b128 v[40:43], v0 offset:49152
    ds_read_b128 v[44:47], v0 offset:53248
    s_waitcnt lgkmcnt(5)
    v_smfmac_f32_16x16x64_bf16 v[20:23], v[28:31], v[48:55], v7
    global_store_dwordx4 v0, v[36:39], s[38:39] sc1
    ds_read_b128 v[48:51], v0 offset:57344
    v_smfmac_f32_16x16x64_bf16 v[16:19], v[28:31], a[136:143], v7
    ds_read_b128 v[52:55], v0 offset:61440
    v_smfmac_f32_16x16x64_bf16 v[8:11], v[28:31], v[80:87], v7
    v_lshlrev_b32 v36, 2, v0
    global_load_lds_dword v36, s[58:59]
    s_mov_b32 m0, 25856
    v_mov_b64 v[36:37], 0
    v_mov_b64 v[38:39], 0
    s_waitcnt lgkmcnt(5)
    v_smfmac_f32_16x16x64_bf16 v[24:27], v[28:31], v[56:63], v7
    ds_read_b128 v[28:31], v2 offset:1024
    v_add_u32 v1, 0x10000, v0
    s_waitcnt lgkmcnt(5)
    v_smfmac_f32_16x16x64_bf16 v[12:15], v[32:35], a[0:7], v7
    ds_read_b128 v[56:59], v1 offset:0
    ds_read_b128 v[60:63], v1 offset:4096
    s_waitcnt lgkmcnt(5)
    v_smfmac_f32_16x16x64_bf16 v[20:23], v[32:35], v[40:47], v7
    ds_read_b128 v[40:43], v1 offset:8192
    ds_read_b128 v[44:47], v1 offset:12288
    v_smfmac_f32_16x16x64_bf16 v[16:19], v[32:35], a[8:15], v7
    s_mov_b64 exec, 1
    global_load_lds_dwordx4 v2, s[18:19] sc1
    s_mov_b64 exec, -1
    v_smfmac_f32_16x16x64_bf16 v[8:11], v[32:35], a[144:151], v7
    v_smfmac_f32_16x16x64_bf16 v[36:39], v[32:35], a[152:159], v7
    s_waitcnt lgkmcnt(5)
    v_smfmac_f32_16x16x64_bf16 v[24:27], v[32:35], v[48:55], v7
    ds_read_b128 v[32:35], v2 offset:2048
    ds_read_b128 v[48:51], v1 offset:16384
    s_waitcnt lgkmcnt(6)
    v_smfmac_f32_16x16x64_bf16 v[12:15], v[28:31], a[16:23], v7
    ds_read_b128 v[52:55], v1 offset:20480
    s_waitcnt lgkmcnt(5)
    v_smfmac_f32_16x16x64_bf16 v[20:23], v[28:31], v[56:63], v7
    ds_read_b128 v[56:59], v1 offset:24576
    ds_read_b128 v[60:63], v1 offset:28672
    v_smfmac_f32_16x16x64_bf16 v[16:19], v[28:31], a[24:31], v7
    v_smfmac_f32_16x16x64_bf16 v[8:11], v[28:31], a[160:167], v7
    v_smfmac_f32_16x16x64_bf16 v[36:39], v[28:31], a[168:175], v7
    s_waitcnt lgkmcnt(5)
    v_smfmac_f32_16x16x64_bf16 v[24:27], v[28:31], v[40:47], v7
    ds_read_b128 v[28:31], v2 offset:3072
    ds_read_b128 v[40:43], v1 offset:32768
    s_waitcnt lgkmcnt(6)
    v_smfmac_f32_16x16x64_bf16 v[12:15], v[32:35], a[32:39], v7
    ds_read_b128 v[44:47], v1 offset:36864
    s_waitcnt lgkmcnt(5)
    v_smfmac_f32_16x16x64_bf16 v[20:23], v[32:35], v[48:55], v7
    ds_read_b128 v[48:51], v1 offset:40960
    ds_read_b128 v[52:55], v1 offset:45056
    v_smfmac_f32_16x16x64_bf16 v[16:19], v[32:35], a[40:47], v7
    v_smfmac_f32_16x16x64_bf16 v[8:11], v[32:35], a[176:183], v7
    v_smfmac_f32_16x16x64_bf16 v[36:39], v[32:35], a[184:191], v7
    s_waitcnt lgkmcnt(5)
    v_smfmac_f32_16x16x64_bf16 v[24:27], v[32:35], v[56:63], v7
    ds_read_b128 v[32:35], v2 offset:4096
    ds_read_b128 v[56:59], v1 offset:49152
    s_waitcnt lgkmcnt(6)
    v_smfmac_f32_16x16x64_bf16 v[12:15], v[28:31], a[48:55], v7
    ds_read_b128 v[60:63], v1 offset:53248
    s_waitcnt lgkmcnt(5)
    v_smfmac_f32_16x16x64_bf16 v[20:23], v[28:31], v[40:47], v7
    ds_read_b128 v[40:43], v1 offset:57344
    ds_read_b128 v[44:47], v1 offset:61440
    v_smfmac_f32_16x16x64_bf16 v[16:19], v[28:31], a[56:63], v7
    s_waitcnt vmcnt(5)
    s_barrier
    v_smfmac_f32_16x16x64_bf16 v[8:11], v[28:31], a[192:199], v7
    v_smfmac_f32_16x16x64_bf16 v[36:39], v[28:31], a[200:207], v7
    s_waitcnt lgkmcnt(5)
    v_smfmac_f32_16x16x64_bf16 v[24:27], v[28:31], v[48:55], v7
    ds_read_b128 v[28:31], v2 offset:7168
    ds_read_b128 v[48:51], v2 offset:12288
    s_waitcnt lgkmcnt(6)
    v_smfmac_f32_16x16x64_bf16 v[12:15], v[32:35], a[64:71], v7
    ds_read_b128 v[52:55], v2 offset:16384
    s_waitcnt lgkmcnt(5)
    v_smfmac_f32_16x16x64_bf16 v[20:23], v[32:35], v[56:63], v7
    ds_read_b128 v[56:59], v2 offset:9216
    ds_read_b128 v[60:63], v2 offset:13312
    v_smfmac_f32_16x16x64_bf16 v[16:19], v[32:35], a[72:79], v7
    v_smfmac_f32_16x16x64_bf16 v[8:11], v[32:35], a[208:215], v7
    s_waitcnt lgkmcnt(5)
    v_smfmac_f32_16x16x64_bf16 v[24:27], v[32:35], v[40:47], v7
    ds_read_b128 v[40:43], v2 offset:8192
    ds_read_b128 v[44:47], v2 offset:6144
    s_waitcnt lgkmcnt(6)
    v_smfmac_f32_16x16x64_bf16 v[12:15], v[28:31], a[112:119], v7
    v_smfmac_f32_16x16x64_bf16 v[16:19], v[28:31], a[120:127], v7
    v_smfmac_f32_16x16x64_bf16 v[20:23], v[28:31], v[240:247], v7
    v_smfmac_f32_16x16x64_bf16 v[24:27], v[28:31], v[248:255], v7
    v_mov_b32 v1, s47
    v_smfmac_f32_16x16x64_bf16 v[8:11], v[28:31], v[64:71], v7
    s_cmp_eq_u32 s24, 63
    s_cbranch_scc1 L_rlast_s3
    s_nop 0
    v_add_f32 v12, v12, v13
    v_add_f32 v14, v14, v15
    v_add_f32 v16, v16, v17
    v_add_f32 v18, v18, v19
    v_cvt_pk_bf16_f32 v13, v12, v16
    v_cvt_pk_bf16_f32 v15, v14, v18
    ds_write2_b32 v5, v13, v15 offset0:0 offset1:72
    v_add_f32 v20, v20, v21
    v_add_f32 v22, v22, v23
    v_add_f32 v24, v24, v25
    v_add_f32 v26, v26, v27
    v_cvt_pk_bf16_f32 v21, v20, v24
    v_cvt_pk_bf16_f32 v23, v22, v26
    ds_write_b32 v5, v21 offset:2304
    ds_write_b32 v5, v23 offset:2592
    ds_read_b128 v[24:27], v4 offset:192
    v_smfmac_f32_16x16x64_bf16 v[36:39], v[28:31], v[72:79], v7
    ds_read_b128 v[28:31], v4 offset:2496
    v_smfmac_f32_16x16x64_bf16 v[36:39], v[32:35], a[216:223], v7
    ds_read_b128 v[32:35], v2 offset:5120
    s_waitcnt lgkmcnt(7)
    v_smfmac_f32_16x16x64_bf16 v[36:39], v[40:43], v[88:95], v7
    s_waitcnt lgkmcnt(6)
    v_smfmac_f32_16x16x64_bf16 v[36:39], v[44:47], a[248:255], v7
    s_waitcnt lgkmcnt(3)
    s_barrier
    ds_read_b128 v[40:43], v4 offset:0
    ds_read_b128 v[44:47], v4 offset:2304
    s_waitcnt lgkmcnt(4)
    v_mfma_f32_16x16x32_bf16 v[12:15], v[48:51], v[24:27], 0
    ds_read_b128 v[48:51], v4 offset:64
    v_mfma_f32_16x16x32_bf16 v[16:19], v[52:55], v[24:27], 0
    ds_read_b128 v[52:55], v2 offset:10240
    s_waitcnt lgkmcnt(5)
    v_mfma_f32_16x16x32_bf16 v[20:23], v[28:31], v[24:27], 0
    ds_read_b128 v[28:31], v2 offset:14336
    ds_read_b128 v[24:27], v4 offset:2368
    s_waitcnt lgkmcnt(5)
    v_mfma_f32_16x16x32_bf16 v[12:15], v[56:59], v[40:43], v[12:15]
    ds_read_b128 v[56:59], v4 offset:128
    v_mfma_f32_16x16x32_bf16 v[16:19], v[60:63], v[40:43], v[16:19]
    ds_read_b128 v[60:63], v2 offset:11264
    s_waitcnt lgkmcnt(6)
    v_mfma_f32_16x16x32_bf16 v[20:23], v[44:47], v[40:43], v[20:23]
    ds_read_b128 v[44:47], v2 offset:15360
    ds_read_b128 v[40:43], v4 offset:2432
    s_waitcnt lgkmcnt(6)
    v_mfma_f32_16x16x32_bf16 v[12:15], v[52:55], v[48:51], v[12:15]
    s_waitcnt vmcnt(3)
    ds_read_b128 v[52:55], v0 offset:17408
    s_waitcnt lgkmcnt(6)
    v_mfma_f32_16x16x32_bf16 v[16:19], v[28:31], v[48:51], v[16:19]
    ds_read_b128 v[28:31], v0 offset:21504
    s_waitcnt lgkmcnt(6)
    v_mfma_f32_16x16x32_bf16 v[20:23], v[24:27], v[48:51], v[20:23]
    s_waitcnt lgkmcnt(4)
    v_mfma_f32_16x16x32_bf16 v[12:15], v[60:63], v[56:59], v[12:15]
    s_waitcnt lgkmcnt(3)
    v_mfma_f32_16x16x32_bf16 v[16:19], v[44:47], v[56:59], v[16:19]
    s_waitcnt lgkmcnt(2)
    v_mfma_f32_16x16x32_bf16 v[20:23], v[40:43], v[56:59], v[20:23]
    v_smfmac_f32_16x16x64_bf16 v[36:39], v[32:35], a[232:239], v7
    v_mov_b32 v49, 0
    v_mov_b32 v50, 0
    v_add_f32 v8, v8, v9
    v_add_f32 v10, v10, v11
    s_nop 0
    v_mov_b32_dpp v12, v16 quad_perm:[0,1,2,3] row_mask:0xf bank_mask:0xc
    v_mov_b32_dpp v13, v17 quad_perm:[0,1,2,3] row_mask:0xf bank_mask:0xc
    v_mov_b32_dpp v14, v18 quad_perm:[0,1,2,3] row_mask:0xf bank_mask:0xc
    v_mov_b32_dpp v15, v19 quad_perm:[0,1,2,3] row_mask:0xf bank_mask:0xc
    v_mov_b32_dpp v22, v23 quad_perm:[0,1,2,3] row_mask:0xf bank_mask:0xc
    v_mov_b32_dpp v20, v21 quad_perm:[0,1,2,3] row_mask:0x3 bank_mask:0xc
    v_max3_f32 v16, v12, v13, v14
    v_add_f32 v36, v36, v37
    v_mov_b32_dpp v20, v22 quad_perm:[0,1,2,3] row_mask:0xc bank_mask:0xf
    v_max3_f32 v16, v16, v15, v20
    v_pk_mul_f32 v[12:13], v[12:13], s[46:47] op_sel_hi:[1,0]
    v_pk_mul_f32 v[14:15], v[14:15], s[46:47] op_sel_hi:[1,0]
    v_max_f32_dpp v16, v16, v16 row_ror:8 row_mask:0xf bank_mask:0xf
    v_mov_b32 v17, v16
    v_mul_f32 v20, s46, v20
    v_add_f32 v38, v38, v39
    v_permlane16_swap_b32 v16, v17
    v_max_f32 v16, v16, v17
    v_mov_b32 v17, v16
    v_cvt_pk_bf16_f32 v22, v8, v10
    v_cvt_pk_bf16_f32 v23, v36, v38
    v_permlane32_swap_b32 v16, v17
    v_max_f32 v16, v16, v17
    v_mul_f32 v16, s46, v16
    v_sub_f32 v12, v12, v16
    v_sub_f32 v13, v13, v16
    v_sub_f32 v14, v14, v16
    v_sub_f32 v15, v15, v16
    v_sub_f32 v20, v20, v16
    v_exp_f32 v12, v12
    v_exp_f32 v13, v13
    v_exp_f32 v14, v14
    v_exp_f32 v15, v15
    v_cvt_pk_bf16_f32 v24, v12, v13
    v_cvt_pk_bf16_f32 v25, v14, v15
    v_exp_f32 v20, v20
    v_mov_b32_dpp v26, v24 row_ror:8 row_mask:0xf bank_mask:0xf
    v_mov_b32_dpp v27, v25 row_ror:8 row_mask:0xf bank_mask:0xf
    v_mov_b32_dpp v21, v20 row_ror:8 row_mask:0xf bank_mask:0xf
    v_add_f32 v18, v12, v13
    s_waitcnt lgkmcnt(0)
    v_mfma_f32_16x16x32_bf16 v[60:63], v[52:55], v[24:27], 0
    v_cvt_pk_bf16_f32 v48, v20, v21
    v_add_f32 v17, v14, v15
    v_mfma_f32_16x16x32_bf16 v[44:47], v[28:31], v[24:27], 0
    v_add_f32 v18, v18, v20
    v_add_f32 v18, v18, v17
    v_cvt_pk_bf16_f32 v51, v20, v21
    v_mfma_f32_16x16x16_bf16 v[60:63], v[22:23], v[48:49], v[60:63]
    v_add_f32_dpp v18, v18, v18 row_ror:8 row_mask:0xf bank_mask:0xf
    v_mov_b32 v17, v18
    v_mfma_f32_16x16x16_bf16 v[44:47], v[22:23], v[50:51], v[44:47]
    v_lshrrev_b32 v9, 2, v2
    v_permlane16_swap_b32 v18, v17
    v_add_f32 v18, v18, v17
    v_mov_b32 v17, v18
    v_and_b32 v8, 0x300, v2
    v_bfe_u32 v10, v2, 1, 7
    v_permlane32_swap_b32 v18, v17
    v_add_f32 v18, v18, v17
    v_rcp_f32 v18, v18
    v_lshl_or_b32 v8, v8, 4, v10
    v_pk_mul_f32 v[60:61], v[60:61], v[18:19] op_sel_hi:[1,0]
    v_pk_mul_f32 v[62:63], v[62:63], v[18:19] op_sel_hi:[1,0]
    v_pk_mul_f32 v[44:45], v[44:45], v[18:19] op_sel_hi:[1,0]
    v_pk_mul_f32 v[46:47], v[46:47], v[18:19] op_sel_hi:[1,0]
    v_cvt_pk_bf16_f32 v12, v60, v61
    v_cvt_pk_bf16_f32 v13, v62, v63
    v_cvt_pk_bf16_f32 v14, v44, v45
    v_cvt_pk_bf16_f32 v15, v46, v47
    ds_write_b128 v6, v[12:15]
    v_mov_b64 v[10:11], 0
    s_nop 1
    v_mfma_f32_32x32x8_bf16 v[28:43], v[10:11], v[10:11], 0
    v_mfma_f32_32x32x8_bf16 v[44:59], v[10:11], v[10:11], 0
    s_waitcnt lgkmcnt(0)
    s_barrier
    ds_read_b128 v[12:15], v3 offset:30208
    ds_read_b128 v[16:19], v3 offset:31232
    v_mov_b64 v[60:61], 0
    ds_write2_b32 v5, v22, v23 offset0:0 offset1:72
    v_mov_b64 v[62:63], 0
    s_waitcnt lgkmcnt(2)
    s_nop 0
    v_smfmac_f32_16x16x64_bf16 v[28:31], v[12:15], v[224:231], v7
    s_waitcnt lgkmcnt(1)
    v_smfmac_f32_16x16x64_bf16 v[28:31], v[16:19], v[232:239], v7
    s_nop 1
    v_smfmac_f32_16x16x64_bf16 v[32:35], v[12:15], v[96:103], v7
    s_nop 1
    v_smfmac_f32_16x16x64_bf16 v[32:35], v[16:19], v[104:111], v7
    s_nop 1
    v_smfmac_f32_16x16x64_bf16 v[36:39], v[12:15], v[112:119], v7
    v_add_f32 v28, v28, v29
    v_add_f32 v29, v30, v31
    v_smfmac_f32_16x16x64_bf16 v[36:39], v[16:19], v[120:127], v7
    v_cvt_pk_bf16_f32 v30, v28, v29
    v_bfi_b32 v30, 1, v1, v30
    global_store_dword v9, v30, s[42:43] sc1
    v_smfmac_f32_16x16x64_bf16 v[40:43], v[12:15], v[128:135], v7
    v_add_f32 v32, v32, v33
    v_add_f32 v33, v34, v35
    v_smfmac_f32_16x16x64_bf16 v[40:43], v[16:19], v[136:143], v7
    s_nop 1
    v_smfmac_f32_16x16x64_bf16 v[44:47], v[12:15], v[144:151], v7
    v_add_f32 v36, v36, v37
    v_add_f32 v37, v38, v39
    v_smfmac_f32_16x16x64_bf16 v[44:47], v[16:19], v[152:159], v7
    v_cvt_pk_bf16_f32 v38, v32, v36
    v_cvt_pk_bf16_f32 v39, v33, v37
    v_bfi_b32 v38, 1, v1, v38
    v_smfmac_f32_16x16x64_bf16 v[48:51], v[12:15], v[160:167], v7
    global_store_dwordx2 v8, v[38:39], s[26:27] sc1
    v_add_f32 v40, v40, v41
    v_add_f32 v41, v42, v43
    v_smfmac_f32_16x16x64_bf16 v[48:51], v[16:19], v[168:175], v7
    v_add_f32 v44, v44, v45
    v_add_f32 v45, v46, v47
    v_smfmac_f32_16x16x64_bf16 v[52:55], v[12:15], v[176:183], v7
    v_cvt_pk_bf16_f32 v46, v40, v44
    v_cvt_pk_bf16_f32 v47, v41, v45
    v_bfi_b32 v46, 1, v1, v46
    v_smfmac_f32_16x16x64_bf16 v[52:55], v[16:19], v[184:191], v7
    global_store_dwordx2 v8, v[46:47], s[90:91] sc1
    v_add_f32 v48, v48, v49
    v_smfmac_f32_16x16x64_bf16 v[56:59], v[12:15], v[192:199], v7
    v_add_f32 v49, v50, v51
    v_smfmac_f32_16x16x64_bf16 v[56:59], v[16:19], v[200:207], v7
    s_nop 1
    v_smfmac_f32_16x16x64_bf16 v[60:63], v[12:15], v[208:215], v7
    v_add_f32 v52, v52, v53
    v_add_f32 v53, v54, v55
    v_smfmac_f32_16x16x64_bf16 v[60:63], v[16:19], v[216:223], v7
    v_cvt_pk_bf16_f32 v54, v48, v52
    v_cvt_pk_bf16_f32 v55, v49, v53
    v_bfi_b32 v54, 1, v1, v54
    global_store_dwordx2 v8, v[54:55], s[92:93] sc1
    v_add_f32 v56, v56, v57
    v_add_f32 v57, v58, v59
    s_nop 1
    v_add_f32 v60, v60, v61
    v_add_f32 v61, v62, v63
    v_cvt_pk_bf16_f32 v62, v56, v60
    v_cvt_pk_bf16_f32 v63, v57, v61
    v_bfi_b32 v62, 1, v1, v62
    global_store_dwordx2 v8, v[62:63], s[94:95] sc1
    s_lshl_b32 s13, s24, 17
    s_add_u32 s38, s50, s13
    s_addc_u32 s39, s51, 0
    s_add_u32 s25, s24, 2
    s_min_u32 s25, s25, 63
    s_lshl_b32 s13, s25, 19
    s_add_u32 s58, s88, s13
    s_addc_u32 s59, s89, 0
    s_add_u32 s86, s86, 524288
    s_addc_u32 s87, s87, 0
    s_add_u32 s32, s32, 524288
    s_addc_u32 s33, s33, 0
    s_add_u32 s14, s30, s34
    s_addc_u32 s15, s31, 0
    s_add_u32 s60, s30, s35
    s_addc_u32 s61, s31, 0
    s_add_u32 s20, s14, 4096
    s_addc_u32 s21, s15, 0
    s_and_b32 s12, s24, 1
    s_xor_b32 s13, s12, 1
    s_xor_b32 s47, s13, s40
    s_add_u32 s24, s24, 1
    s_mov_b32 s35, s34
    s_add_u32 s34, s34, 9216
    s_cmp_eq_u32 s34, 27648
    s_cselect_b32 s34, 0, s34
    s_mov_b32 s55, 0
    v_add_u32 v1, 0x20000, v0
    ds_read_b128 v[40:43], v1 offset:0
    ds_read_b128 v[44:47], v1 offset:4096
    v_add_u32 v1, 0x20000, v0
    ds_read_b128 v[48:51], v1 offset:8192
    ds_read_b128 v[52:55], v1 offset:12288
    v_add_u32 v1, 0x20000, v0
    ds_read_b128 v[56:59], v1 offset:16384
    ds_read_b128 v[60:63], v1 offset:20480
    v_mov_b32 v28, 25856
    s_waitcnt vmcnt(5)
    ds_read_b128 v[28:31], v28
    s_waitcnt lgkmcnt(0)
    v_min3_u32 v28, v28, v29, v30
    v_min_u32 v28, v28, v31
    s_nop 0
    v_readfirstlane_b32 s12, v28
    s_max_u32 s54, s54, s12
    s_cmp_lt_u32 s25, s54
    s_cbranch_scc1 L_kvok_58
    s_mov_b32 s55, 0
    v_bfe_u32 v28, v2, 2, 4
L_kvp_59:
    global_load_dword v29, v28, s[18:19] sc1
    s_add_u32 s55, s55, 1
    s_cmp_gt_u32 s55, 100000
    s_cbranch_scc1 L_rx_s3
    s_waitcnt vmcnt(0)
    v_min_u32_dpp v29, v29, v29 quad_perm:[1,0,3,2] row_mask:0xf bank_mask:0xf
    s_nop 1
    v_min_u32_dpp v29, v29, v29 quad_perm:[2,3,0,1] row_mask:0xf bank_mask:0xf
    s_nop 0
    v_readfirstlane_b32 s54, v29
    s_cmp_lt_u32 s25, s54
    s_cbranch_scc1 L_kvok_58
    s_sleep 4
    s_branch L_kvp_59
L_kvok_58:
    s_barrier
    s_mov_b32 s55, 0
    ds_read_b32 v36, v5 offset:2304
    ds_read_b32 v37, v5 offset:2592
    ds_read2_b32 v[38:39], v5 offset0:0 offset1:72
    v_mov_b64 v[12:13], 0
    v_mov_b64 v[14:15], 0
    v_mov_b64 v[16:17], 0
    v_mov_b64 v[18:19], 0
    v_mov_b64 v[20:21], 0
    v_mov_b64 v[22:23], 0
    v_mov_b64 v[24:25], 0
    v_mov_b64 v[26:27], 0
    global_load_dwordx4 v[28:31], v2, s[20:21] offset:1024 sc1
    global_load_dwordx4 v[32:35], v2, s[20:21] offset:2048 sc1
    v_mov_b64 v[8:9], 0
    v_mov_b64 v[10:11], 0
    s_mov_b32 m0, s62
    s_branch L_rp2_s3
L_rf2_s3:
    s_mov_b64 exec, vcc
    global_load_dwordx4 v[28:31], v2, s[20:21] offset:1024 sc1
    global_load_dwordx4 v[32:35], v2, s[20:21] offset:2048 sc1
    s_mov_b64 exec, -1
    v_mov_b64 v[12:13], 0
    v_mov_b64 v[14:15], 0
    v_mov_b64 v[16:17], 0
    v_mov_b64 v[18:19], 0
    s_add_u32 s55, s55, 1
    s_cmp_gt_u32 s55, 100000
    s_cbranch_scc0 L_rp2_s3
    s_branch L_rx_s3
L_rp2ok_s3:
    s_branch L_rp2_s3
L_rlast_s3:
    s_lshl_b32 s13, s24, 17
    s_add_u32 s38, s50, s13
    s_addc_u32 s39, s51, 0
    s_waitcnt lgkmcnt(0)
    ds_read_b128 v[12:15], v2 offset:5120
    v_smfmac_f32_16x16x64_bf16 v[36:39], v[28:31], v[72:79], v7
    v_smfmac_f32_16x16x64_bf16 v[36:39], v[32:35], a[216:223], v7
    v_smfmac_f32_16x16x64_bf16 v[36:39], v[40:43], v[88:95], v7
    v_smfmac_f32_16x16x64_bf16 v[36:39], v[44:47], a[248:255], v7
    s_waitcnt lgkmcnt(0)
    v_smfmac_f32_16x16x64_bf16 v[36:39], v[12:15], a[232:239], v7
    v_add_f32 v20, v20, v21
    v_add_f32 v22, v22, v23
    v_add_f32 v24, v24, v25
    v_add_f32 v26, v26, v27
    v_cvt_pk_bf16_f32 v16, v20, v24
    v_cvt_pk_bf16_f32 v17, v22, v26
    s_nop 1
    v_add_f32 v36, v36, v37
    v_add_f32 v38, v38, v39
    v_add_f32 v8, v8, v9
    v_add_f32 v10, v10, v11
    v_cvt_pk_bf16_f32 v18, v8, v10
    v_cvt_pk_bf16_f32 v19, v36, v38
    global_store_dwordx4 v0, v[16:19], s[38:39] sc1
L_rx_s3:
    s_endpgm
L_role_kv:
    s_load_dwordx4 s[16:19], s[0:1], 24
    v_mov_b32 v12, 0x0
    v_bfe_u32 v1, v0, 4, 2
    v_lshl_add_u32 v12, v1, 13, v12
    v_bfe_u32 v1, v0, 6, 2
    v_lshl_add_u32 v12, v1, 17, v12
    v_mov_b32 v2, 0x0
    v_bfe_u32 v1, v0, 0, 4
    v_lshlrev_b32 v1, 4, v1
    v_xor_b32 v2, v2, v1
    v_bfe_u32 v1, v0, 4, 2
    v_lshlrev_b32 v1, 5, v1
    v_xor_b32 v2, v2, v1
    v_add_u32 v12, v12, v2
    v_mov_b32 v13, 0x8000
    v_bfe_u32 v1, v0, 4, 2
    v_lshl_add_u32 v13, v1, 13, v13
    v_bfe_u32 v1, v0, 6, 2
    v_lshl_add_u32 v13, v1, 17, v13
    v_mov_b32 v2, 0x0
    v_bfe_u32 v1, v0, 0, 4
    v_lshlrev_b32 v1, 4, v1
    v_xor_b32 v2, v2, v1
    v_bfe_u32 v1, v0, 4, 2
    v_lshlrev_b32 v1, 5, v1
    v_xor_b32 v2, v2, v1
    v_add_u32 v13, v13, v2
    v_mov_b32 v14, 0x10000
    v_bfe_u32 v1, v0, 4, 2
    v_lshl_add_u32 v14, v1, 13, v14
    v_bfe_u32 v1, v0, 6, 2
    v_lshl_add_u32 v14, v1, 17, v14
    v_mov_b32 v2, 0x80
    v_bfe_u32 v1, v0, 0, 4
    v_lshlrev_b32 v1, 4, v1
    v_xor_b32 v2, v2, v1
    v_bfe_u32 v1, v0, 4, 2
    v_lshlrev_b32 v1, 5, v1
    v_xor_b32 v2, v2, v1
    v_add_u32 v14, v14, v2
    v_mov_b32 v15, 0x18000
    v_bfe_u32 v1, v0, 4, 2
    v_lshl_add_u32 v15, v1, 13, v15
    v_bfe_u32 v1, v0, 6, 2
    v_lshl_add_u32 v15, v1, 17, v15
    v_mov_b32 v2, 0x80
    v_bfe_u32 v1, v0, 0, 4
    v_lshlrev_b32 v1, 4, v1
    v_xor_b32 v2, v2, v1
    v_bfe_u32 v1, v0, 4, 2
    v_lshlrev_b32 v1, 5, v1
    v_xor_b32 v2, v2, v1
    v_add_u32 v15, v15, v2
    v_mov_b32 v16, 0x0
    v_bfe_u32 v1, v0, 0, 2
    v_lshlrev_b32 v1, 3, v1
    v_xor_b32 v16, v16, v1
    v_bfe_i32 v1, v0, 2, 1
    v_and_b32 v1, 0x120, v1
    v_xor_b32 v16, v16, v1
    v_bfe_i32 v1, v0, 3, 1
    v_and_b32 v1, 0x240, v1
    v_xor_b32 v16, v16, v1
    v_bfe_i32 v1, v0, 4, 1
    v_and_b32 v1, 0x880, v1
    v_xor_b32 v16, v16, v1
    v_bfe_u32 v1, v0, 5, 1
    v_lshlrev_b32 v1, 12, v1
    v_xor_b32 v16, v16, v1
    v_bfe_u32 v1, v0, 6, 2
    v_lshlrev_b32 v1, 6, v1
    v_xor_b32 v16, v16, v1
    v_mov_b32 v17, 0x20
    v_bfe_u32 v1, v0, 0, 2
    v_lshlrev_b32 v1, 3, v1
    v_xor_b32 v17, v17, v1
    v_bfe_i32 v1, v0, 2, 1
    v_and_b32 v1, 0x120, v1
    v_xor_b32 v17, v17, v1
    v_bfe_i32 v1, v0, 3, 1
    v_and_b32 v1, 0x240, v1
    v_xor_b32 v17, v17, v1
    v_bfe_i32 v1, v0, 4, 1
    v_and_b32 v1, 0x880, v1
    v_xor_b32 v17, v17, v1
    v_bfe_u32 v1, v0, 5, 1
    v_lshlrev_b32 v1, 12, v1
    v_xor_b32 v17, v17, v1
    v_bfe_u32 v1, v0, 6, 2
    v_lshlrev_b32 v1, 6, v1
    v_xor_b32 v17, v17, v1
    s_lshl_b32 s12, s9, 8
    s_waitcnt lgkmcnt(0)
    s_add_u32 s16, s16, s12
    s_addc_u32 s17, s17, 0
    s_add_u32 s18, s18, s12
    s_addc_u32 s19, s19, 0
    s_lshl_b32 s26, s10, 12
    s_add_u32 s12, s16, 0
    s_addc_u32 s13, s17, 0
    s_add_u32 m0, s26, 0
    s_nop 0
    global_load_lds_dwordx4 v12, s[12:13]
    s_add_u32 m0, s26, 1024
    s_nop 0
    global_load_lds_dwordx4 v13, s[12:13]
    s_add_u32 m0, s26, 2048
    s_nop 0
    global_load_lds_dwordx4 v14, s[12:13]
    s_add_u32 m0, s26, 3072
    s_nop 0
    global_load_lds_dwordx4 v15, s[12:13]
    s_add_u32 s12, s18, 0
    s_addc_u32 s13, s19, 0
    s_add_u32 m0, s26, 16384
    s_nop 0
    global_load_lds_dwordx4 v12, s[12:13]
    s_add_u32 m0, s26, 17408
    s_nop 0
    global_load_lds_dwordx4 v13, s[12:13]
    s_add_u32 m0, s26, 18432
    s_nop 0
    global_load_lds_dwordx4 v14, s[12:13]
    s_add_u32 m0, s26, 19456
    s_nop 0
    global_load_lds_dwordx4 v15, s[12:13]
    s_add_u32 s12, s16, 524288
    s_addc_u32 s13, s17, 0
    s_add_u32 m0, s26, 32768
    s_nop 0
    global_load_lds_dwordx4 v12, s[12:13]
    s_add_u32 m0, s26, 33792
    s_nop 0
    global_load_lds_dwordx4 v13, s[12:13]
    s_add_u32 m0, s26, 34816
    s_nop 0
    global_load_lds_dwordx4 v14, s[12:13]
    s_add_u32 m0, s26, 35840
    s_nop 0
    global_load_lds_dwordx4 v15, s[12:13]
    s_add_u32 s12, s18, 524288
    s_addc_u32 s13, s19, 0
    s_add_u32 m0, s26, 49152
    s_nop 0
    global_load_lds_dwordx4 v12, s[12:13]
    s_add_u32 m0, s26, 50176
    s_nop 0
    global_load_lds_dwordx4 v13, s[12:13]
    s_add_u32 m0, s26, 51200
    s_nop 0
    global_load_lds_dwordx4 v14, s[12:13]
    s_add_u32 m0, s26, 52224
    s_nop 0
    global_load_lds_dwordx4 v15, s[12:13]
    s_add_u32 s12, s16, 1048576
    s_addc_u32 s13, s17, 0
    s_add_u32 m0, s26, 65536
    s_nop 0
    global_load_lds_dwordx4 v12, s[12:13]
    s_add_u32 m0, s26, 66560
    s_nop 0
    global_load_lds_dwordx4 v13, s[12:13]
    s_add_u32 m0, s26, 67584
    s_nop 0
    global_load_lds_dwordx4 v14, s[12:13]
    s_add_u32 m0, s26, 68608
    s_nop 0
    global_load_lds_dwordx4 v15, s[12:13]
    s_add_u32 s12, s18, 1048576
    s_addc_u32 s13, s19, 0
    s_add_u32 m0, s26, 81920
    s_nop 0
    global_load_lds_dwordx4 v12, s[12:13]
    s_add_u32 m0, s26, 82944
    s_nop 0
    global_load_lds_dwordx4 v13, s[12:13]
    s_add_u32 m0, s26, 83968
    s_nop 0
    global_load_lds_dwordx4 v14, s[12:13]
    s_add_u32 m0, s26, 84992
    s_nop 0
    global_load_lds_dwordx4 v15, s[12:13]
    s_add_u32 s12, s16, 1572864
    s_addc_u32 s13, s17, 0
    s_add_u32 m0, s26, 98304
    s_nop 0
    global_load_lds_dwordx4 v12, s[12:13]
    s_add_u32 m0, s26, 99328
    s_nop 0
    global_load_lds_dwordx4 v13, s[12:13]
    s_add_u32 m0, s26, 100352
    s_nop 0
    global_load_lds_dwordx4 v14, s[12:13]
    s_add_u32 m0, s26, 101376
    s_nop 0
    global_load_lds_dwordx4 v15, s[12:13]
    s_waitcnt vmcnt(24)
    s_barrier
    s_add_u32 s12, s18, 1572864
    s_addc_u32 s13, s19, 0
    s_add_u32 m0, s26, 114688
    s_nop 0
    global_load_lds_dwordx4 v12, s[12:13]
    s_add_u32 m0, s26, 115712
    s_nop 0
    global_load_lds_dwordx4 v13, s[12:13]
    s_add_u32 m0, s26, 116736
    s_nop 0
    global_load_lds_dwordx4 v14, s[12:13]
    s_add_u32 m0, s26, 117760
    s_nop 0
    global_load_lds_dwordx4 v15, s[12:13]
    v_add_u32 v28, 0, v16
    v_add_u32 v29, 0, v17
    ds_read_b64_tr_b16 a[0:1], v28 offset:0
    ds_read_b64_tr_b16 a[2:3], v28 offset:1024
    ds_read_b64_tr_b16 a[4:5], v29 offset:0
    ds_read_b64_tr_b16 a[6:7], v29 offset:1024
    ds_read_b64_tr_b16 a[16:17], v28 offset:8192
    ds_read_b64_tr_b16 a[18:19], v28 offset:9216
    ds_read_b64_tr_b16 a[20:21], v29 offset:8192
    ds_read_b64_tr_b16 a[22:23], v29 offset:9216
    s_waitcnt lgkmcnt(0)
    s_waitcnt vmcnt(24)
    s_barrier
    s_add_u32 s12, s16, 2097152
    s_addc_u32 s13, s17, 0
    s_add_u32 m0, s26, 0
    s_nop 0
    global_load_lds_dwordx4 v12, s[12:13]
    s_add_u32 m0, s26, 1024
    s_nop 0
    global_load_lds_dwordx4 v13, s[12:13]
    s_add_u32 m0, s26, 2048
    s_nop 0
    global_load_lds_dwordx4 v14, s[12:13]
    s_add_u32 m0, s26, 3072
    s_nop 0
    global_load_lds_dwordx4 v15, s[12:13]
    v_add_u32 v28, 16384, v16
    v_add_u32 v29, 16384, v17
    ds_read_b64_tr_b16 a[8:9], v28 offset:0
    ds_read_b64_tr_b16 a[10:11], v28 offset:1024
    ds_read_b64_tr_b16 a[12:13], v29 offset:0
    ds_read_b64_tr_b16 a[14:15], v29 offset:1024
    ds_read_b64_tr_b16 a[24:25], v28 offset:8192
    ds_read_b64_tr_b16 a[26:27], v28 offset:9216
    ds_read_b64_tr_b16 a[28:29], v29 offset:8192
    ds_read_b64_tr_b16 a[30:31], v29 offset:9216
    s_waitcnt lgkmcnt(0)
    s_waitcnt vmcnt(24)
    s_barrier
    s_add_u32 s12, s18, 2097152
    s_addc_u32 s13, s19, 0
    s_add_u32 m0, s26, 16384
    s_nop 0
    global_load_lds_dwordx4 v12, s[12:13]
    s_add_u32 m0, s26, 17408
    s_nop 0
    global_load_lds_dwordx4 v13, s[12:13]
    s_add_u32 m0, s26, 18432
    s_nop 0
    global_load_lds_dwordx4 v14, s[12:13]
    s_add_u32 m0, s26, 19456
    s_nop 0
    global_load_lds_dwordx4 v15, s[12:13]
    v_add_u32 v28, 32768, v16
    v_add_u32 v29, 32768, v17
    ds_read_b64_tr_b16 a[32:33], v28 offset:0
    ds_read_b64_tr_b16 a[34:35], v28 offset:1024
    ds_read_b64_tr_b16 a[36:37], v29 offset:0
    ds_read_b64_tr_b16 a[38:39], v29 offset:1024
    ds_read_b64_tr_b16 a[48:49], v28 offset:8192
    ds_read_b64_tr_b16 a[50:51], v28 offset:9216
    ds_read_b64_tr_b16 a[52:53], v29 offset:8192
    ds_read_b64_tr_b16 a[54:55], v29 offset:9216
    s_waitcnt lgkmcnt(0)
    s_waitcnt vmcnt(24)
    s_barrier
    s_add_u32 s12, s16, 2621440
    s_addc_u32 s13, s17, 0
    s_add_u32 m0, s26, 32768
    s_nop 0
    global_load_lds_dwordx4 v12, s[12:13]
    s_add_u32 m0, s26, 33792
    s_nop 0
    global_load_lds_dwordx4 v13, s[12:13]
    s_add_u32 m0, s26, 34816
    s_nop 0
    global_load_lds_dwordx4 v14, s[12:13]
    s_add_u32 m0, s26, 35840
    s_nop 0
    global_load_lds_dwordx4 v15, s[12:13]
    v_add_u32 v28, 49152, v16
    v_add_u32 v29, 49152, v17
    ds_read_b64_tr_b16 a[40:41], v28 offset:0
    ds_read_b64_tr_b16 a[42:43], v28 offset:1024
    ds_read_b64_tr_b16 a[44:45], v29 offset:0
    ds_read_b64_tr_b16 a[46:47], v29 offset:1024
    ds_read_b64_tr_b16 a[56:57], v28 offset:8192
    ds_read_b64_tr_b16 a[58:59], v28 offset:9216
    ds_read_b64_tr_b16 a[60:61], v29 offset:8192
    ds_read_b64_tr_b16 a[62:63], v29 offset:9216
    s_waitcnt lgkmcnt(0)
    s_waitcnt vmcnt(24)
    s_barrier
    s_add_u32 s12, s18, 2621440
    s_addc_u32 s13, s19, 0
    s_add_u32 m0, s26, 49152
    s_nop 0
    global_load_lds_dwordx4 v12, s[12:13]
    s_add_u32 m0, s26, 50176
    s_nop 0
    global_load_lds_dwordx4 v13, s[12:13]
    s_add_u32 m0, s26, 51200
    s_nop 0
    global_load_lds_dwordx4 v14, s[12:13]
    s_add_u32 m0, s26, 52224
    s_nop 0
    global_load_lds_dwordx4 v15, s[12:13]
    v_add_u32 v28, 65536, v16
    v_add_u32 v29, 65536, v17
    ds_read_b64_tr_b16 a[64:65], v28 offset:0
    ds_read_b64_tr_b16 a[66:67], v28 offset:1024
    ds_read_b64_tr_b16 a[68:69], v29 offset:0
    ds_read_b64_tr_b16 a[70:71], v29 offset:1024
    ds_read_b64_tr_b16 a[80:81], v28 offset:8192
    ds_read_b64_tr_b16 a[82:83], v28 offset:9216
    ds_read_b64_tr_b16 a[84:85], v29 offset:8192
    ds_read_b64_tr_b16 a[86:87], v29 offset:9216
    s_waitcnt lgkmcnt(0)
    s_waitcnt vmcnt(24)
    s_barrier
    s_add_u32 s12, s16, 3145728
    s_addc_u32 s13, s17, 0
    s_add_u32 m0, s26, 65536
    s_nop 0
    global_load_lds_dwordx4 v12, s[12:13]
    s_add_u32 m0, s26, 66560
    s_nop 0
    global_load_lds_dwordx4 v13, s[12:13]
    s_add_u32 m0, s26, 67584
    s_nop 0
    global_load_lds_dwordx4 v14, s[12:13]
    s_add_u32 m0, s26, 68608
    s_nop 0
    global_load_lds_dwordx4 v15, s[12:13]
    v_add_u32 v28, 81920, v16
    v_add_u32 v29, 81920, v17
    ds_read_b64_tr_b16 a[72:73], v28 offset:0
    ds_read_b64_tr_b16 a[74:75], v28 offset:1024
    ds_read_b64_tr_b16 a[76:77], v29 offset:0
    ds_read_b64_tr_b16 a[78:79], v29 offset:1024
    ds_read_b64_tr_b16 a[88:89], v28 offset:8192
    ds_read_b64_tr_b16 a[90:91], v28 offset:9216
    ds_read_b64_tr_b16 a[92:93], v29 offset:8192
    ds_read_b64_tr_b16 a[94:95], v29 offset:9216
    s_waitcnt lgkmcnt(0)
    s_waitcnt vmcnt(24)
    s_barrier
    s_add_u32 s12, s18, 3145728
    s_addc_u32 s13, s19, 0
    s_add_u32 m0, s26, 81920
    s_nop 0
    global_load_lds_dwordx4 v12, s[12:13]
    s_add_u32 m0, s26, 82944
    s_nop 0
    global_load_lds_dwordx4 v13, s[12:13]
    s_add_u32 m0, s26, 83968
    s_nop 0
    global_load_lds_dwordx4 v14, s[12:13]
    s_add_u32 m0, s26, 84992
    s_nop 0
    global_load_lds_dwordx4 v15, s[12:13]
    v_add_u32 v28, 98304, v16
    v_add_u32 v29, 98304, v17
    ds_read_b64_tr_b16 a[96:97], v28 offset:0
    ds_read_b64_tr_b16 a[98:99], v28 offset:1024
    ds_read_b64_tr_b16 a[100:101], v29 offset:0
    ds_read_b64_tr_b16 a[102:103], v29 offset:1024
    ds_read_b64_tr_b16 a[112:113], v28 offset:8192
    ds_read_b64_tr_b16 a[114:115], v28 offset:9216
    ds_read_b64_tr_b16 a[116:117], v29 offset:8192
    ds_read_b64_tr_b16 a[118:119], v29 offset:9216
    s_waitcnt lgkmcnt(0)
    s_waitcnt vmcnt(24)
    s_barrier
    s_add_u32 s12, s16, 3670016
    s_addc_u32 s13, s17, 0
    s_add_u32 m0, s26, 98304
    s_nop 0
    global_load_lds_dwordx4 v12, s[12:13]
    s_add_u32 m0, s26, 99328
    s_nop 0
    global_load_lds_dwordx4 v13, s[12:13]
    s_add_u32 m0, s26, 100352
    s_nop 0
    global_load_lds_dwordx4 v14, s[12:13]
    s_add_u32 m0, s26, 101376
    s_nop 0
    global_load_lds_dwordx4 v15, s[12:13]
    v_add_u32 v28, 114688, v16
    v_add_u32 v29, 114688, v17
    ds_read_b64_tr_b16 a[104:105], v28 offset:0
    ds_read_b64_tr_b16 a[106:107], v28 offset:1024
    ds_read_b64_tr_b16 a[108:109], v29 offset:0
    ds_read_b64_tr_b16 a[110:111], v29 offset:1024
    ds_read_b64_tr_b16 a[120:121], v28 offset:8192
    ds_read_b64_tr_b16 a[122:123], v28 offset:9216
    ds_read_b64_tr_b16 a[124:125], v29 offset:8192
    ds_read_b64_tr_b16 a[126:127], v29 offset:9216
    s_waitcnt lgkmcnt(0)
    s_waitcnt vmcnt(24)
    s_barrier
    s_add_u32 s12, s18, 3670016
    s_addc_u32 s13, s19, 0
    s_add_u32 m0, s26, 114688
    s_nop 0
    global_load_lds_dwordx4 v12, s[12:13]
    s_add_u32 m0, s26, 115712
    s_nop 0
    global_load_lds_dwordx4 v13, s[12:13]
    s_add_u32 m0, s26, 116736
    s_nop 0
    global_load_lds_dwordx4 v14, s[12:13]
    s_add_u32 m0, s26, 117760
    s_nop 0
    global_load_lds_dwordx4 v15, s[12:13]
    v_add_u32 v28, 0, v16
    v_add_u32 v29, 0, v17
    ds_read_b64_tr_b16 a[128:129], v28 offset:0
    ds_read_b64_tr_b16 a[130:131], v28 offset:1024
    ds_read_b64_tr_b16 a[132:133], v29 offset:0
    ds_read_b64_tr_b16 a[134:135], v29 offset:1024
    ds_read_b64_tr_b16 a[144:145], v28 offset:8192
    ds_read_b64_tr_b16 a[146:147], v28 offset:9216
    ds_read_b64_tr_b16 a[148:149], v29 offset:8192
    ds_read_b64_tr_b16 a[150:151], v29 offset:9216
    s_waitcnt lgkmcnt(0)
    s_waitcnt vmcnt(24)
    s_barrier
    s_add_u32 s12, s16, 4194304
    s_addc_u32 s13, s17, 0
    s_add_u32 m0, s26, 0
    s_nop 0
    global_load_lds_dwordx4 v12, s[12:13]
    s_add_u32 m0, s26, 1024
    s_nop 0
    global_load_lds_dwordx4 v13, s[12:13]
    s_add_u32 m0, s26, 2048
    s_nop 0
    global_load_lds_dwordx4 v14, s[12:13]
    s_add_u32 m0, s26, 3072
    s_nop 0
    global_load_lds_dwordx4 v15, s[12:13]
    v_add_u32 v28, 16384, v16
    v_add_u32 v29, 16384, v17
    ds_read_b64_tr_b16 a[136:137], v28 offset:0
    ds_read_b64_tr_b16 a[138:139], v28 offset:1024
    ds_read_b64_tr_b16 a[140:141], v29 offset:0
    ds_read_b64_tr_b16 a[142:143], v29 offset:1024
    ds_read_b64_tr_b16 a[152:153], v28 offset:8192
    ds_read_b64_tr_b16 a[154:155], v28 offset:9216
    ds_read_b64_tr_b16 a[156:157], v29 offset:8192
    ds_read_b64_tr_b16 a[158:159], v29 offset:9216
    s_waitcnt lgkmcnt(0)
    s_waitcnt vmcnt(24)
    s_barrier
    s_add_u32 s12, s18, 4194304
    s_addc_u32 s13, s19, 0
    s_add_u32 m0, s26, 16384
    s_nop 0
    global_load_lds_dwordx4 v12, s[12:13]
    s_add_u32 m0, s26, 17408
    s_nop 0
    global_load_lds_dwordx4 v13, s[12:13]
    s_add_u32 m0, s26, 18432
    s_nop 0
    global_load_lds_dwordx4 v14, s[12:13]
    s_add_u32 m0, s26, 19456
    s_nop 0
    global_load_lds_dwordx4 v15, s[12:13]
    v_add_u32 v28, 32768, v16
    v_add_u32 v29, 32768, v17
    ds_read_b64_tr_b16 a[160:161], v28 offset:0
    ds_read_b64_tr_b16 a[162:163], v28 offset:1024
    ds_read_b64_tr_b16 a[164:165], v29 offset:0
    ds_read_b64_tr_b16 a[166:167], v29 offset:1024
    ds_read_b64_tr_b16 a[176:177], v28 offset:8192
    ds_read_b64_tr_b16 a[178:179], v28 offset:9216
    ds_read_b64_tr_b16 a[180:181], v29 offset:8192
    ds_read_b64_tr_b16 a[182:183], v29 offset:9216
    s_waitcnt lgkmcnt(0)
    s_waitcnt vmcnt(24)
    s_barrier
    v_add_u32 v28, 49152, v16
    v_add_u32 v29, 49152, v17
    ds_read_b64_tr_b16 a[168:169], v28 offset:0
    ds_read_b64_tr_b16 a[170:171], v28 offset:1024
    ds_read_b64_tr_b16 a[172:173], v29 offset:0
    ds_read_b64_tr_b16 a[174:175], v29 offset:1024
    ds_read_b64_tr_b16 a[184:185], v28 offset:8192
    ds_read_b64_tr_b16 a[186:187], v28 offset:9216
    ds_read_b64_tr_b16 a[188:189], v29 offset:8192
    ds_read_b64_tr_b16 a[190:191], v29 offset:9216
    s_waitcnt lgkmcnt(0)
    s_waitcnt vmcnt(20)
    s_barrier
    v_add_u32 v28, 65536, v16
    v_add_u32 v29, 65536, v17
    ds_read_b64_tr_b16 a[192:193], v28 offset:0
    ds_read_b64_tr_b16 a[194:195], v28 offset:1024
    ds_read_b64_tr_b16 a[196:197], v29 offset:0
    ds_read_b64_tr_b16 a[198:199], v29 offset:1024
    ds_read_b64_tr_b16 a[208:209], v28 offset:8192
    ds_read_b64_tr_b16 a[210:211], v28 offset:9216
    ds_read_b64_tr_b16 a[212:213], v29 offset:8192
    ds_read_b64_tr_b16 a[214:215], v29 offset:9216
    s_waitcnt lgkmcnt(0)
    s_waitcnt vmcnt(16)
    s_barrier
    v_add_u32 v28, 81920, v16
    v_add_u32 v29, 81920, v17
    ds_read_b64_tr_b16 a[200:201], v28 offset:0
    ds_read_b64_tr_b16 a[202:203], v28 offset:1024
    ds_read_b64_tr_b16 a[204:205], v29 offset:0
    ds_read_b64_tr_b16 a[206:207], v29 offset:1024
    ds_read_b64_tr_b16 a[216:217], v28 offset:8192
    ds_read_b64_tr_b16 a[218:219], v28 offset:9216
    ds_read_b64_tr_b16 a[220:221], v29 offset:8192
    ds_read_b64_tr_b16 a[222:223], v29 offset:9216
    s_waitcnt lgkmcnt(0)
    s_waitcnt vmcnt(12)
    s_barrier
    v_add_u32 v28, 98304, v16
    v_add_u32 v29, 98304, v17
    ds_read_b64_tr_b16 a[224:225], v28 offset:0
    ds_read_b64_tr_b16 a[226:227], v28 offset:1024
    ds_read_b64_tr_b16 a[228:229], v29 offset:0
    ds_read_b64_tr_b16 a[230:231], v29 offset:1024
    ds_read_b64_tr_b16 a[240:241], v28 offset:8192
    ds_read_b64_tr_b16 a[242:243], v28 offset:9216
    ds_read_b64_tr_b16 a[244:245], v29 offset:8192
    ds_read_b64_tr_b16 a[246:247], v29 offset:9216
    s_waitcnt lgkmcnt(0)
    s_waitcnt vmcnt(8)
    s_barrier
    v_add_u32 v28, 114688, v16
    v_add_u32 v29, 114688, v17
    ds_read_b64_tr_b16 a[232:233], v28 offset:0
    ds_read_b64_tr_b16 a[234:235], v28 offset:1024
    ds_read_b64_tr_b16 a[236:237], v29 offset:0
    ds_read_b64_tr_b16 a[238:239], v29 offset:1024
    ds_read_b64_tr_b16 a[248:249], v28 offset:8192
    ds_read_b64_tr_b16 a[250:251], v28 offset:9216
    ds_read_b64_tr_b16 a[252:253], v29 offset:8192
    ds_read_b64_tr_b16 a[254:255], v29 offset:9216
    s_waitcnt lgkmcnt(0)
    s_waitcnt vmcnt(4)
    s_barrier
    v_add_u32 v28, 0, v16
    v_add_u32 v29, 0, v17
    ds_read_b64_tr_b16 v[224:225], v28 offset:0
    ds_read_b64_tr_b16 v[226:227], v28 offset:1024
    ds_read_b64_tr_b16 v[228:229], v29 offset:0
    ds_read_b64_tr_b16 v[230:231], v29 offset:1024
    ds_read_b64_tr_b16 v[240:241], v28 offset:8192
    ds_read_b64_tr_b16 v[242:243], v28 offset:9216
    ds_read_b64_tr_b16 v[244:245], v29 offset:8192
    ds_read_b64_tr_b16 v[246:247], v29 offset:9216
    s_waitcnt lgkmcnt(0)
    s_waitcnt vmcnt(0)
    s_barrier
    v_add_u32 v28, 16384, v16
    v_add_u32 v29, 16384, v17
    ds_read_b64_tr_b16 v[232:233], v28 offset:0
    ds_read_b64_tr_b16 v[234:235], v28 offset:1024
    ds_read_b64_tr_b16 v[236:237], v29 offset:0
    ds_read_b64_tr_b16 v[238:239], v29 offset:1024
    ds_read_b64_tr_b16 v[248:249], v28 offset:8192
    ds_read_b64_tr_b16 v[250:251], v28 offset:9216
    ds_read_b64_tr_b16 v[252:253], v29 offset:8192
    ds_read_b64_tr_b16 v[254:255], v29 offset:9216
    s_waitcnt lgkmcnt(0)
    s_barrier
    v_mov_b32 v12, 0x0
    v_bfe_u32 v13, v0, 0, 2
    v_lshl_add_u32 v12, v13, 2, v12
    v_bfe_u32 v13, v0, 2, 1
    v_lshl_add_u32 v12, v13, 7, v12
    s_mov_b32 s12, 0
L_mc_61:
    global_load_dword v13, v12, s[6:7] sc1
    s_add_u32 s12, s12, 1
    s_cmp_gt_u32 s12, 100000
    s_cbranch_scc1 L_exit
    s_waitcnt vmcnt(0)
    v_and_b32 v14, 0xff, v13
    v_cmp_ne_u32 vcc, 32, v14
    s_cbranch_vccz L_mc_done_60
    v_cmp_lt_u32 vcc, 32, v14
    s_cbranch_vccnz L_exit
    s_sleep 24
    s_branch L_mc_61
L_mc_done_60:
    v_readlane_b32 s12, v13, s8
    s_mul_i32 s13, s3, s3
    s_lshl_b32 s13, s13, 10
    s_add_u32 s13, s13, s3
    s_lshl_b32 s13, s13, 8
    s_add_u32 s13, s13, 1
    s_lshl_b32 s13, s13, 5
    s_cmp_eq_u32 s12, s13
    s_cselect_b32 s11, 1, 0
    v_lshlrev_b32 v1, 4, v0
    v_mov_b32 v2, 0x0
    v_bfe_u32 v12, v0, 0, 6
    v_lshl_add_u32 v2, v12, 4, v2
    s_sub_u32 s24, s8, 1
    s_mul_i32 s12, s24, 36864
    s_add_u32 s12, s12, 1048576
    s_add_u32 s20, s4, s12
    s_addc_u32 s21, s5, 0
    s_lshl_b32 s12, s24, 5
    s_add_u32 s12, s12, s9
    s_lshl_b32 s13, s12, 12
    s_add_u32 s13, s13, 50331648
    s_add_u32 s34, s4, s13
    s_addc_u32 s35, s5, 0
    v_mov_b32 v80, -1
    v_mov_b32 v81, -1
    v_mov_b32 v82, -1
    v_mov_b32 v83, -1
    s_lshl_b32 s12, s12, 14
    s_add_u32 s12, s12, 16779264
    s_add_u32 s22, s4, s12
    s_addc_u32 s23, s5, 0
    s_lshl_b32 s13, s10, 11
    s_add_u32 s12, s12, s13
    s_add_u32 s12, s12, 6144
    s_add_u32 s30, s4, s12
    s_addc_u32 s31, s5, 0
    s_lshl_b32 s12, s8, 5
    s_add_u32 s12, s12, s9
    s_lshl_b32 s12, s12, 5
    s_add_u32 s12, s12, s10
    s_lshl_b32 s12, s12, 2
    s_add_u32 s12, s12, 65536
    s_add_u32 s32, s4, s12
    s_addc_u32 s33, s5, 0
    s_lshl_b32 s26, s10, 10
    s_mov_b32 s27, 0
    s_mov_b32 s28, 0
    s_mov_b32 s29, 0
    s_cmp_lg_u32 s10, 0
    s_cbranch_scc1 L_hw_62
    v_mbcnt_lo_u32_b32 v12, -1, 0
    v_mbcnt_hi_u32_b32 v12, -1, v12
    v_min_u32 v12, 47, v12
    v_lshlrev_b32 v12, 3, v12
    v_add_u32 v12, 118784, v12
    s_mov_b32 s12, 0
L_hwl_63:
    global_load_dwordx2 v[14:15], v12, s[4:5] sc1
    s_add_u32 s12, s12, 1
    s_cmp_gt_u32 s12, 100000
    s_cbranch_scc1 L_exit
    s_waitcnt vmcnt(0)
    v_and_b32 v14, v14, v15
    v_cmp_eq_u32 vcc, 0, v14
    s_cbranch_vccz L_hw_62
    s_sleep 6
    s_branch L_hwl_63
L_hw_62:
    s_barrier
    s_mov_b64 s[12:13], s[20:21]
    s_add_u32 m0, s26, 0
    s_nop 0
    global_load_lds_dwordx4 v1, s[12:13]
    s_add_u32 s12, s12, 4096
    s_addc_u32 s13, s13, 0
    s_add_u32 m0, s26, 4096
    s_nop 0
    global_load_lds_dwordx4 v1, s[12:13]
    s_add_u32 s12, s12, 4096
    s_addc_u32 s13, s13, 0
    s_add_u32 m0, s26, 8192
    s_nop 0
    global_load_lds_dwordx4 v1, s[12:13]
    s_add_u32 s12, s12, 4096
    s_addc_u32 s13, s13, 0
    s_add_u32 m0, s26, 12288
    s_nop 0
    global_load_lds_dwordx4 v1, s[12:13]
    s_add_u32 s12, s12, 4096
    s_addc_u32 s13, s13, 0
    s_add_u32 m0, s26, 16384
    s_nop 0
    global_load_lds_dwordx4 v1, s[12:13]
    s_add_u32 s12, s12, 4096
    s_addc_u32 s13, s13, 0
    s_add_u32 m0, s26, 20480
    s_nop 0
    global_load_lds_dwordx4 v1, s[12:13]
    s_add_u32 s12, s12, 4096
    s_addc_u32 s13, s13, 0
    s_add_u32 m0, s26, 24576
    s_nop 0
    global_load_lds_dwordx4 v1, s[12:13]
    s_add_u32 s12, s12, 4096
    s_addc_u32 s13, s13, 0
    s_add_u32 m0, s26, 28672
    s_nop 0
    global_load_lds_dwordx4 v1, s[12:13]
    s_add_u32 s12, s12, 4096
    s_addc_u32 s13, s13, 0
    s_add_u32 m0, s26, 32768
    s_nop 0
    global_load_lds_dwordx4 v1, s[12:13]
    s_add_u32 s20, s20, 36864
    s_addc_u32 s21, s21, 0
    s_add_u32 s26, s26, 36864
    s_cmp_ge_u32 s26, 110592
    s_cselect_b32 s12, 110592, 0
    s_sub_u32 s26, s26, s12
    s_mov_b64 s[12:13], s[20:21]
    s_add_u32 m0, s26, 0
    s_nop 0
    global_load_lds_dwordx4 v1, s[12:13]
    s_add_u32 s12, s12, 4096
    s_addc_u32 s13, s13, 0
    s_add_u32 m0, s26, 4096
    s_nop 0
    global_load_lds_dwordx4 v1, s[12:13]
    s_add_u32 s12, s12, 4096
    s_addc_u32 s13, s13, 0
    s_add_u32 m0, s26, 8192
    s_nop 0
    global_load_lds_dwordx4 v1, s[12:13]
    s_add_u32 s12, s12, 4096
    s_addc_u32 s13, s13, 0
    s_add_u32 m0, s26, 12288
    s_nop 0
    global_load_lds_dwordx4 v1, s[12:13]
    s_add_u32 s12, s12, 4096
    s_addc_u32 s13, s13, 0
    s_add_u32 m0, s26, 16384
    s_nop 0
    global_load_lds_dwordx4 v1, s[12:13]
    s_add_u32 s12, s12, 4096
    s_addc_u32 s13, s13, 0
    s_add_u32 m0, s26, 20480
    s_nop 0
    global_load_lds_dwordx4 v1, s[12:13]
    s_add_u32 s12, s12, 4096
    s_addc_u32 s13, s13, 0
    s_add_u32 m0, s26, 24576
    s_nop 0
    global_load_lds_dwordx4 v1, s[12:13]
    s_add_u32 s12, s12, 4096
    s_addc_u32 s13, s13, 0
    s_add_u32 m0, s26, 28672
    s_nop 0
    global_load_lds_dwordx4 v1, s[12:13]
    s_add_u32 s12, s12, 4096
    s_addc_u32 s13, s13, 0
    s_add_u32 m0, s26, 32768
    s_nop 0
    global_load_lds_dwordx4 v1, s[12:13]
    s_add_u32 s20, s20, 36864
    s_addc_u32 s21, s21, 0
    s_add_u32 s26, s26, 36864
    s_cmp_ge_u32 s26, 110592
    s_cselect_b32 s12, 110592, 0
    s_sub_u32 s26, s26, s12
    s_waitcnt vmcnt(9)
    s_branch L_kv_first
L_kv_top:
    s_waitcnt vmcnt(15)
L_kv_first:
    s_barrier
    v_add_u32 v3, s27, v2
    v_mov_b32 v4, s28
    ds_read_b128 v[40:43], v3 offset:0
    ds_read_b128 v[44:47], v3 offset:18432
    ds_read_b128 v[48:51], v3 offset:1024
    ds_read_b128 v[52:55], v3 offset:19456
    ds_read_b128 v[56:59], v3 offset:2048
    s_mov_b64 s[12:13], s[20:21]
    ds_read_b128 v[60:63], v3 offset:20480
    s_waitcnt lgkmcnt(5)
    v_mfma_f32_16x16x32_bf16 v[8:11], a[0:3], v[40:43], 0
    s_add_u32 m0, s26, 0
    v_mfma_f32_16x16x32_bf16 v[16:19], a[4:7], v[40:43], 0
    global_load_lds_dwordx4 v1, s[12:13]
    v_mfma_f32_16x16x32_bf16 v[24:27], v[40:43], a[8:11], 0
    s_add_u32 s12, s12, 4096
    s_addc_u32 s13, s13, 0
    v_mfma_f32_16x16x32_bf16 v[32:35], v[40:43], a[12:15], 0
    ds_read_b128 v[40:43], v3 offset:3072
    s_waitcnt lgkmcnt(5)
    v_mfma_f32_16x16x32_bf16 v[12:15], a[0:3], v[44:47], 0
    s_add_u32 m0, s26, 4096
    v_mfma_f32_16x16x32_bf16 v[20:23], a[4:7], v[44:47], 0
    global_load_lds_dwordx4 v1, s[12:13]
    v_mfma_f32_16x16x32_bf16 v[28:31], v[44:47], a[8:11], 0
    s_add_u32 s12, s12, 4096
    s_addc_u32 s13, s13, 0
    v_mfma_f32_16x16x32_bf16 v[36:39], v[44:47], a[12:15], 0
    ds_read_b128 v[44:47], v3 offset:21504
    s_waitcnt lgkmcnt(5)
    v_mfma_f32_16x16x32_bf16 v[8:11], a[16:19], v[48:51], v[8:11]
    s_add_u32 m0, s26, 8192
    v_mfma_f32_16x16x32_bf16 v[16:19], a[20:23], v[48:51], v[16:19]
    global_load_lds_dwordx4 v1, s[12:13]
    v_mfma_f32_16x16x32_bf16 v[24:27], v[48:51], a[24:27], v[24:27]
    s_add_u32 s12, s12, 4096
    s_addc_u32 s13, s13, 0
    v_mfma_f32_16x16x32_bf16 v[32:35], v[48:51], a[28:31], v[32:35]
    ds_read_b128 v[48:51], v3 offset:4096
    s_waitcnt lgkmcnt(5)
    v_mfma_f32_16x16x32_bf16 v[12:15], a[16:19], v[52:55], v[12:15]
    s_add_u32 m0, s26, 12288
    v_mfma_f32_16x16x32_bf16 v[20:23], a[20:23], v[52:55], v[20:23]
    global_load_lds_dwordx4 v1, s[12:13]
    v_mfma_f32_16x16x32_bf16 v[28:31], v[52:55], a[24:27], v[28:31]
    s_add_u32 s12, s12, 4096
    s_addc_u32 s13, s13, 0
    v_mfma_f32_16x16x32_bf16 v[36:39], v[52:55], a[28:31], v[36:39]
    ds_read_b128 v[52:55], v3 offset:22528
    s_waitcnt lgkmcnt(5)
    v_mfma_f32_16x16x32_bf16 v[8:11], a[32:35], v[56:59], v[8:11]
    s_add_u32 m0, s26, 16384
    v_mfma_f32_16x16x32_bf16 v[16:19], a[36:39], v[56:59], v[16:19]
    global_load_lds_dwordx4 v1, s[12:13]
    v_mfma_f32_16x16x32_bf16 v[24:27], v[56:59], a[40:43], v[24:27]
    s_add_u32 s12, s12, 4096
    s_addc_u32 s13, s13, 0
    v_mfma_f32_16x16x32_bf16 v[32:35], v[56:59], a[44:47], v[32:35]
    ds_read_b128 v[56:59], v3 offset:5120
    s_waitcnt lgkmcnt(5)
    v_mfma_f32_16x16x32_bf16 v[12:15], a[32:35], v[60:63], v[12:15]
    s_add_u32 m0, s26, 20480
    v_mfma_f32_16x16x32_bf16 v[20:23], a[36:39], v[60:63], v[20:23]
    global_load_lds_dwordx4 v1, s[12:13]
    v_mfma_f32_16x16x32_bf16 v[28:31], v[60:63], a[40:43], v[28:31]
    s_add_u32 s12, s12, 4096
    s_addc_u32 s13, s13, 0
    v_mfma_f32_16x16x32_bf16 v[36:39], v[60:63], a[44:47], v[36:39]
    ds_read_b128 v[60:63], v3 offset:23552
    s_waitcnt lgkmcnt(5)
    v_mfma_f32_16x16x32_bf16 v[8:11], a[48:51], v[40:43], v[8:11]
    s_add_u32 m0, s26, 24576
    v_mfma_f32_16x16x32_bf16 v[16:19], a[52:55], v[40:43], v[16:19]
    global_load_lds_dwordx4 v1, s[12:13]
    v_mfma_f32_16x16x32_bf16 v[24:27], v[40:43], a[56:59], v[24:27]
    s_add_u32 s12, s12, 4096
    s_addc_u32 s13, s13, 0
    v_mfma_f32_16x16x32_bf16 v[32:35], v[40:43], a[60:63], v[32:35]
    ds_read_b128 v[40:43], v3 offset:6144
    s_waitcnt lgkmcnt(5)
    v_mfma_f32_16x16x32_bf16 v[12:15], a[48:51], v[44:47], v[12:15]
    s_add_u32 m0, s26, 28672
    v_mfma_f32_16x16x32_bf16 v[20:23], a[52:55], v[44:47], v[20:23]
    global_load_lds_dwordx4 v1, s[12:13]
    v_mfma_f32_16x16x32_bf16 v[28:31], v[44:47], a[56:59], v[28:31]
    s_add_u32 s12, s12, 4096
    s_addc_u32 s13, s13, 0
    v_mfma_f32_16x16x32_bf16 v[36:39], v[44:47], a[60:63], v[36:39]
    ds_read_b128 v[44:47], v3 offset:24576
    s_waitcnt lgkmcnt(5)
    v_mfma_f32_16x16x32_bf16 v[8:11], a[64:67], v[48:51], v[8:11]
    s_add_u32 m0, s26, 32768
    v_mfma_f32_16x16x32_bf16 v[16:19], a[68:71], v[48:51], v[16:19]
    global_load_lds_dwordx4 v1, s[12:13]
    v_mfma_f32_16x16x32_bf16 v[24:27], v[48:51], a[72:75], v[24:27]
    v_mfma_f32_16x16x32_bf16 v[32:35], v[48:51], a[76:79], v[32:35]
    ds_read_b128 v[48:51], v3 offset:7168
    s_waitcnt lgkmcnt(5)
    v_mfma_f32_16x16x32_bf16 v[12:15], a[64:67], v[52:55], v[12:15]
    v_mfma_f32_16x16x32_bf16 v[20:23], a[68:71], v[52:55], v[20:23]
    v_mfma_f32_16x16x32_bf16 v[28:31], v[52:55], a[72:75], v[28:31]
    v_mfma_f32_16x16x32_bf16 v[36:39], v[52:55], a[76:79], v[36:39]
    ds_read_b128 v[52:55], v3 offset:25600
    s_waitcnt lgkmcnt(5)
    v_mfma_f32_16x16x32_bf16 v[8:11], a[80:83], v[56:59], v[8:11]
    s_add_u32 s20, s20, 36864
    s_addc_u32 s21, s21, 0
    s_add_u32 s26, s26, 36864
    s_cmp_ge_u32 s26, 110592
    s_cselect_b32 s12, 110592, 0
    s_sub_u32 s26, s26, s12
    v_mfma_f32_16x16x32_bf16 v[16:19], a[84:87], v[56:59], v[16:19]
    v_mfma_f32_16x16x32_bf16 v[24:27], v[56:59], a[88:91], v[24:27]
    v_mfma_f32_16x16x32_bf16 v[32:35], v[56:59], a[92:95], v[32:35]
    ds_read_b128 v[56:59], v3 offset:8192
    s_waitcnt lgkmcnt(5)
    v_mfma_f32_16x16x32_bf16 v[12:15], a[80:83], v[60:63], v[12:15]
    v_mfma_f32_16x16x32_bf16 v[20:23], a[84:87], v[60:63], v[20:23]
    v_mfma_f32_16x16x32_bf16 v[28:31], v[60:63], a[88:91], v[28:31]
    v_mfma_f32_16x16x32_bf16 v[36:39], v[60:63], a[92:95], v[36:39]
    ds_read_b128 v[60:63], v3 offset:26624
    s_waitcnt lgkmcnt(5)
    v_mfma_f32_16x16x32_bf16 v[8:11], a[96:99], v[40:43], v[8:11]
    v_mfma_f32_16x16x32_bf16 v[16:19], a[100:103], v[40:43], v[16:19]
    v_mfma_f32_16x16x32_bf16 v[24:27], v[40:43], a[104:107], v[24:27]
    v_mfma_f32_16x16x32_bf16 v[32:35], v[40:43], a[108:111], v[32:35]
    ds_read_b128 v[40:43], v3 offset:9216
    s_waitcnt lgkmcnt(5)
    v_mfma_f32_16x16x32_bf16 v[12:15], a[96:99], v[44:47], v[12:15]
    v_mfma_f32_16x16x32_bf16 v[20:23], a[100:103], v[44:47], v[20:23]
    v_mfma_f32_16x16x32_bf16 v[28:31], v[44:47], a[104:107], v[28:31]
    v_mfma_f32_16x16x32_bf16 v[36:39], v[44:47], a[108:111], v[36:39]
    ds_read_b128 v[44:47], v3 offset:27648
    s_waitcnt lgkmcnt(5)
    v_mfma_f32_16x16x32_bf16 v[8:11], a[112:115], v[48:51], v[8:11]
    v_mfma_f32_16x16x32_bf16 v[16:19], a[116:119], v[48:51], v[16:19]
    v_mfma_f32_16x16x32_bf16 v[24:27], v[48:51], a[120:123], v[24:27]
    v_mfma_f32_16x16x32_bf16 v[32:35], v[48:51], a[124:127], v[32:35]
    ds_read_b128 v[48:51], v3 offset:10240
    s_waitcnt lgkmcnt(5)
    v_mfma_f32_16x16x32_bf16 v[12:15], a[112:115], v[52:55], v[12:15]
    v_mfma_f32_16x16x32_bf16 v[20:23], a[116:119], v[52:55], v[20:23]
    v_mfma_f32_16x16x32_bf16 v[28:31], v[52:55], a[120:123], v[28:31]
    v_mfma_f32_16x16x32_bf16 v[36:39], v[52:55], a[124:127], v[36:39]
    ds_read_b128 v[52:55], v3 offset:28672
    s_waitcnt lgkmcnt(5)
    v_mfma_f32_16x16x32_bf16 v[8:11], a[128:131], v[56:59], v[8:11]
    v_mfma_f32_16x16x32_bf16 v[16:19], a[132:135], v[56:59], v[16:19]
    v_mfma_f32_16x16x32_bf16 v[24:27], v[56:59], a[136:139], v[24:27]
    v_mfma_f32_16x16x32_bf16 v[32:35], v[56:59], a[140:143], v[32:35]
    ds_read_b128 v[56:59], v3 offset:11264
    s_waitcnt lgkmcnt(5)
    v_mfma_f32_16x16x32_bf16 v[12:15], a[128:131], v[60:63], v[12:15]
    v_mfma_f32_16x16x32_bf16 v[20:23], a[132:135], v[60:63], v[20:23]
    v_mfma_f32_16x16x32_bf16 v[28:31], v[60:63], a[136:139], v[28:31]
    v_mfma_f32_16x16x32_bf16 v[36:39], v[60:63], a[140:143], v[36:39]
    ds_read_b128 v[60:63], v3 offset:29696
    s_waitcnt lgkmcnt(5)
    v_mfma_f32_16x16x32_bf16 v[8:11], a[144:147], v[40:43], v[8:11]
    v_mfma_f32_16x16x32_bf16 v[16:19], a[148:151], v[40:43], v[16:19]
    v_mfma_f32_16x16x32_bf16 v[24:27], v[40:43], a[152:155], v[24:27]
    v_mfma_f32_16x16x32_bf16 v[32:35], v[40:43], a[156:159], v[32:35]
    ds_read_b128 v[40:43], v3 offset:12288
    s_waitcnt lgkmcnt(5)
    v_mfma_f32_16x16x32_bf16 v[12:15], a[144:147], v[44:47], v[12:15]
    v_mfma_f32_16x16x32_bf16 v[20:23], a[148:151], v[44:47], v[20:23]
    v_mfma_f32_16x16x32_bf16 v[28:31], v[44:47], a[152:155], v[28:31]
    v_mfma_f32_16x16x32_bf16 v[36:39], v[44:47], a[156:159], v[36:39]
    ds_read_b128 v[44:47], v3 offset:30720
    s_waitcnt lgkmcnt(5)
    v_mfma_f32_16x16x32_bf16 v[8:11], a[160:163], v[48:51], v[8:11]
    s_waitcnt vmcnt(9)
    s_mov_b64 exec, 1
    global_store_dword v2, v4, s[32:33] sc1
    s_mov_b64 exec, -1
    v_mfma_f32_16x16x32_bf16 v[16:19], a[164:167], v[48:51], v[16:19]
    v_mfma_f32_16x16x32_bf16 v[24:27], v[48:51], a[168:171], v[24:27]
    v_mfma_f32_16x16x32_bf16 v[32:35], v[48:51], a[172:175], v[32:35]
    ds_read_b128 v[48:51], v3 offset:13312
    s_waitcnt lgkmcnt(5)
    v_mfma_f32_16x16x32_bf16 v[12:15], a[160:163], v[52:55], v[12:15]
    v_mfma_f32_16x16x32_bf16 v[20:23], a[164:167], v[52:55], v[20:23]
    v_mfma_f32_16x16x32_bf16 v[28:31], v[52:55], a[168:171], v[28:31]
    v_mfma_f32_16x16x32_bf16 v[36:39], v[52:55], a[172:175], v[36:39]
    ds_read_b128 v[52:55], v3 offset:31744
    s_waitcnt lgkmcnt(5)
    v_mfma_f32_16x16x32_bf16 v[8:11], a[176:179], v[56:59], v[8:11]
    v_mfma_f32_16x16x32_bf16 v[16:19], a[180:183], v[56:59], v[16:19]
    v_mfma_f32_16x16x32_bf16 v[24:27], v[56:59], a[184:187], v[24:27]
    v_mfma_f32_16x16x32_bf16 v[32:35], v[56:59], a[188:191], v[32:35]
    ds_read_b128 v[56:59], v3 offset:14336
    s_waitcnt lgkmcnt(5)
    v_mfma_f32_16x16x32_bf16 v[12:15], a[176:179], v[60:63], v[12:15]
    v_mfma_f32_16x16x32_bf16 v[20:23], a[180:183], v[60:63], v[20:23]
    v_mfma_f32_16x16x32_bf16 v[28:31], v[60:63], a[184:187], v[28:31]
    v_mfma_f32_16x16x32_bf16 v[36:39], v[60:63], a[188:191], v[36:39]
    ds_read_b128 v[60:63], v3 offset:32768
    s_waitcnt lgkmcnt(5)
    v_mfma_f32_16x16x32_bf16 v[8:11], a[192:195], v[40:43], v[8:11]
    global_store_dwordx4 v1, v[80:83], s[34:35] sc1
    v_mfma_f32_16x16x32_bf16 v[16:19], a[196:199], v[40:43], v[16:19]
    v_mfma_f32_16x16x32_bf16 v[24:27], v[40:43], a[200:203], v[24:27]
    v_mfma_f32_16x16x32_bf16 v[32:35], v[40:43], a[204:207], v[32:35]
    ds_read_b128 v[40:43], v3 offset:15360
    s_waitcnt lgkmcnt(5)
    v_mfma_f32_16x16x32_bf16 v[12:15], a[192:195], v[44:47], v[12:15]
    v_mfma_f32_16x16x32_bf16 v[20:23], a[196:199], v[44:47], v[20:23]
    v_mfma_f32_16x16x32_bf16 v[28:31], v[44:47], a[200:203], v[28:31]
    v_mfma_f32_16x16x32_bf16 v[36:39], v[44:47], a[204:207], v[36:39]
    ds_read_b128 v[44:47], v3 offset:33792
    s_waitcnt lgkmcnt(5)
    v_mfma_f32_16x16x32_bf16 v[8:11], a[208:211], v[48:51], v[8:11]
    v_mfma_f32_16x16x32_bf16 v[16:19], a[212:215], v[48:51], v[16:19]
    v_mfma_f32_16x16x32_bf16 v[24:27], v[48:51], a[216:219], v[24:27]
    v_mfma_f32_16x16x32_bf16 v[32:35], v[48:51], a[220:223], v[32:35]
    ds_read_b128 v[48:51], v3 offset:16384
    s_waitcnt lgkmcnt(5)
    v_mfma_f32_16x16x32_bf16 v[12:15], a[208:211], v[52:55], v[12:15]
    v_mfma_f32_16x16x32_bf16 v[20:23], a[212:215], v[52:55], v[20:23]
    v_mfma_f32_16x16x32_bf16 v[28:31], v[52:55], a[216:219], v[28:31]
    v_mfma_f32_16x16x32_bf16 v[36:39], v[52:55], a[220:223], v[36:39]
    ds_read_b128 v[52:55], v3 offset:34816
    s_waitcnt lgkmcnt(5)
    v_mfma_f32_16x16x32_bf16 v[8:11], a[224:227], v[56:59], v[8:11]
    v_mfma_f32_16x16x32_bf16 v[16:19], a[228:231], v[56:59], v[16:19]
    v_mfma_f32_16x16x32_bf16 v[24:27], v[56:59], a[232:235], v[24:27]
    v_mfma_f32_16x16x32_bf16 v[32:35], v[56:59], a[236:239], v[32:35]
    ds_read_b128 v[56:59], v3 offset:17408
    s_waitcnt lgkmcnt(5)
    v_mfma_f32_16x16x32_bf16 v[12:15], a[224:227], v[60:63], v[12:15]
    v_mfma_f32_16x16x32_bf16 v[20:23], a[228:231], v[60:63], v[20:23]
    v_mfma_f32_16x16x32_bf16 v[28:31], v[60:63], a[232:235], v[28:31]
    v_mfma_f32_16x16x32_bf16 v[36:39], v[60:63], a[236:239], v[36:39]
    ds_read_b128 v[60:63], v3 offset:35840
    s_waitcnt lgkmcnt(5)
    v_mfma_f32_16x16x32_bf16 v[8:11], a[240:243], v[40:43], v[8:11]
    v_mfma_f32_16x16x32_bf16 v[16:19], a[244:247], v[40:43], v[16:19]
    v_mfma_f32_16x16x32_bf16 v[24:27], v[40:43], a[248:251], v[24:27]
    v_mfma_f32_16x16x32_bf16 v[32:35], v[40:43], a[252:255], v[32:35]
    s_waitcnt lgkmcnt(4)
    v_mfma_f32_16x16x32_bf16 v[12:15], a[240:243], v[44:47], v[12:15]
    v_mfma_f32_16x16x32_bf16 v[20:23], a[244:247], v[44:47], v[20:23]
    v_mfma_f32_16x16x32_bf16 v[28:31], v[44:47], a[248:251], v[28:31]
    v_mfma_f32_16x16x32_bf16 v[36:39], v[44:47], a[252:255], v[36:39]
    s_waitcnt lgkmcnt(3)
    v_mfma_f32_16x16x32_bf16 v[8:11], v[224:227], v[48:51], v[8:11]
    v_mfma_f32_16x16x32_bf16 v[16:19], v[228:231], v[48:51], v[16:19]
    v_mfma_f32_16x16x32_bf16 v[24:27], v[48:51], v[232:235], v[24:27]
    v_mfma_f32_16x16x32_bf16 v[32:35], v[48:51], v[236:239], v[32:35]
    s_waitcnt lgkmcnt(2)
    v_mfma_f32_16x16x32_bf16 v[12:15], v[224:227], v[52:55], v[12:15]
    v_mfma_f32_16x16x32_bf16 v[20:23], v[228:231], v[52:55], v[20:23]
    v_mfma_f32_16x16x32_bf16 v[28:31], v[52:55], v[232:235], v[28:31]
    v_mfma_f32_16x16x32_bf16 v[36:39], v[52:55], v[236:239], v[36:39]
    s_waitcnt lgkmcnt(1)
    v_mfma_f32_16x16x32_bf16 v[8:11], v[240:243], v[56:59], v[8:11]
    v_mfma_f32_16x16x32_bf16 v[16:19], v[244:247], v[56:59], v[16:19]
    v_mfma_f32_16x16x32_bf16 v[24:27], v[56:59], v[248:251], v[24:27]
    v_mfma_f32_16x16x32_bf16 v[32:35], v[56:59], v[252:255], v[32:35]
    s_waitcnt lgkmcnt(0)
    v_mfma_f32_16x16x32_bf16 v[12:15], v[240:243], v[60:63], v[12:15]
    v_mfma_f32_16x16x32_bf16 v[20:23], v[244:247], v[60:63], v[20:23]
    v_mfma_f32_16x16x32_bf16 v[28:31], v[60:63], v[248:251], v[28:31]
    v_mfma_f32_16x16x32_bf16 v[36:39], v[60:63], v[252:255], v[36:39]
    s_nop 0
    v_cvt_pk_bf16_f32 v64, v8, v16
    v_cvt_pk_bf16_f32 v65, v9, v17
    v_cvt_pk_bf16_f32 v66, v10, v18
    v_cvt_pk_bf16_f32 v67, v11, v19
    global_store_dwordx4 v1, v[64:67], s[22:23] offset:-2048 sc1
    v_cvt_pk_bf16_f32 v68, v12, v20
    v_cvt_pk_bf16_f32 v69, v13, v21
    v_cvt_pk_bf16_f32 v70, v14, v22
    v_cvt_pk_bf16_f32 v71, v15, v23
    global_store_dwordx4 v1, v[68:71], s[22:23] offset:2048 sc1
    v_cvt_pk_bf16_f32 v72, v24, v25
    v_cvt_pk_bf16_f32 v73, v26, v27
    v_cvt_pk_bf16_f32 v74, v28, v29
    v_cvt_pk_bf16_f32 v75, v30, v31
    global_store_dwordx4 v2, v[72:75], s[30:31] offset:0 sc1
    v_cvt_pk_bf16_f32 v76, v32, v33
    v_cvt_pk_bf16_f32 v77, v34, v35
    v_cvt_pk_bf16_f32 v78, v36, v37
    v_cvt_pk_bf16_f32 v79, v38, v39
    global_store_dwordx4 v2, v[76:79], s[30:31] offset:1024 sc1
    s_add_u32 s22, s22, 524288
    s_addc_u32 s23, s23, 0
    s_add_u32 s30, s30, 524288
    s_addc_u32 s31, s31, 0
    s_add_u32 s34, s34, 131072
    s_addc_u32 s35, s35, 0
    s_add_u32 s27, s27, 36864
    s_cmp_ge_u32 s27, 110592
    s_cselect_b32 s27, 0, s27
    s_add_u32 s28, s28, 1
    s_add_u32 s24, s24, 1
    s_cmp_lt_u32 s24, 64
    s_cbranch_scc1 L_kv_top
    s_waitcnt vmcnt(0)
    v_mov_b32 v4, s28
    s_mov_b64 exec, 1
    global_store_dword v2, v4, s[32:33] sc1
    s_branch L_exit
L_role_a:
    s_mul_i32 s14, s9, 3
    s_add_u32 s14, s14, s8
    s_sub_u32 s14, s14, 2
    s_cmp_ge_u32 s14, 54
    s_cbranch_scc1 L_nomod
    s_load_dwordx4 s[16:19], s[0:1], 88
    v_mov_b32 v2, 0x0
    v_bfe_u32 v1, v0, 0, 3
    v_lshl_add_u32 v2, v1, 4, v2
    v_bfe_u32 v1, v0, 3, 5
    v_mul_u32_u24 v1, 0x1b00, v1
    v_add_u32 v2, v2, v1
    v_mov_b32 v3, 0x0
    v_bfe_u32 v1, v0, 3, 5
    v_lshl_add_u32 v3, v1, 1, v3
    s_lshl_b32 s12, s14, 7
    s_waitcnt lgkmcnt(0)
    s_add_u32 s18, s18, s12
    s_addc_u32 s19, s19, 0
    global_load_ushort v8, v3, s[16:17] offset:0
    global_load_ushort v9, v3, s[16:17] offset:64
    global_load_ushort v10, v3, s[16:17] offset:128
    global_load_ushort v11, v3, s[16:17] offset:192
    global_load_ushort v12, v3, s[16:17] offset:256
    global_load_ushort v13, v3, s[16:17] offset:320
    global_load_ushort v14, v3, s[16:17] offset:384
    global_load_ushort v15, v3, s[16:17] offset:448
    global_load_ushort v16, v3, s[16:17] offset:512
    global_load_ushort v17, v3, s[16:17] offset:576
    global_load_ushort v18, v3, s[16:17] offset:640
    global_load_ushort v19, v3, s[16:17] offset:704
    global_load_ushort v20, v3, s[16:17] offset:768
    global_load_ushort v21, v3, s[16:17] offset:832
    global_load_ushort v22, v3, s[16:17] offset:896
    global_load_ushort v23, v3, s[16:17] offset:960
    global_load_ushort v24, v3, s[16:17] offset:1024
    global_load_ushort v25, v3, s[16:17] offset:1088
    global_load_dwordx4 v[40:43], v2, s[18:19]
    s_add_u32 s18, s18, 221184
    s_addc_u32 s19, s19, 0
    global_load_dwordx4 v[44:47], v2, s[18:19]
    s_add_u32 s18, s18, 221184
    s_addc_u32 s19, s19, 0
    global_load_dwordx4 v[48:51], v2, s[18:19]
    s_add_u32 s18, s18, 221184
    s_addc_u32 s19, s19, 0
    global_load_dwordx4 v[52:55], v2, s[18:19]
    s_add_u32 s18, s18, 221184
    s_addc_u32 s19, s19, 0
    global_load_dwordx4 v[56:59], v2, s[18:19]
    s_add_u32 s18, s18, 221184
    s_addc_u32 s19, s19, 0
    global_load_dwordx4 v[60:63], v2, s[18:19]
    s_add_u32 s18, s18, 221184
    s_addc_u32 s19, s19, 0
    global_load_dwordx4 v[64:67], v2, s[18:19]
    s_add_u32 s18, s18, 221184
    s_addc_u32 s19, s19, 0
    global_load_dwordx4 v[68:71], v2, s[18:19]
    s_add_u32 s18, s18, 221184
    s_addc_u32 s19, s19, 0
    global_load_dwordx4 v[72:75], v2, s[18:19]
    s_add_u32 s18, s18, 221184
    s_addc_u32 s19, s19, 0
    global_load_dwordx4 v[76:79], v2, s[18:19]
    s_add_u32 s18, s18, 221184
    s_addc_u32 s19, s19, 0
    global_load_dwordx4 v[80:83], v2, s[18:19]
    s_add_u32 s18, s18, 221184
    s_addc_u32 s19, s19, 0
    global_load_dwordx4 v[84:87], v2, s[18:19]
    s_add_u32 s18, s18, 221184
    s_addc_u32 s19, s19, 0
    global_load_dwordx4 v[88:91], v2, s[18:19]
    s_add_u32 s18, s18, 221184
    s_addc_u32 s19, s19, 0
    global_load_dwordx4 v[92:95], v2, s[18:19]
    s_add_u32 s18, s18, 221184
    s_addc_u32 s19, s19, 0
    global_load_dwordx4 v[96:99], v2, s[18:19]
    s_add_u32 s18, s18, 221184
    s_addc_u32 s19, s19, 0
    global_load_dwordx4 v[100:103], v2, s[18:19]
    s_add_u32 s18, s18, 221184
    s_addc_u32 s19, s19, 0
    global_load_dwordx4 v[104:107], v2, s[18:19]
    s_add_u32 s18, s18, 221184
    s_addc_u32 s19, s19, 0
    global_load_dwordx4 v[108:111], v2, s[18:19]
    s_mov_b32 s12, 0xbfb8aa3b
    s_waitcnt vmcnt(18)
    v_lshlrev_b32 v8, 16, v8
    v_mul_f32 v4, s12, v8
    v_exp_f32 v4, v4
    s_nop 0
    v_add_f32 v4, 1.0, v4
    v_rcp_f32 v4, v4
    s_nop 0
    v_mul_f32 v8, v8, v4
    v_cvt_pk_bf16_f32 v8, v8, v8
    v_lshlrev_b32 v8, 16, v8
    v_lshlrev_b32 v9, 16, v9
    v_mul_f32 v4, s12, v9
    v_exp_f32 v4, v4
    s_nop 0
    v_add_f32 v4, 1.0, v4
    v_rcp_f32 v4, v4
    s_nop 0
    v_mul_f32 v9, v9, v4
    v_cvt_pk_bf16_f32 v9, v9, v9
    v_lshlrev_b32 v9, 16, v9
    v_lshlrev_b32 v10, 16, v10
    v_mul_f32 v4, s12, v10
    v_exp_f32 v4, v4
    s_nop 0
    v_add_f32 v4, 1.0, v4
    v_rcp_f32 v4, v4
    s_nop 0
    v_mul_f32 v10, v10, v4
    v_cvt_pk_bf16_f32 v10, v10, v10
    v_lshlrev_b32 v10, 16, v10
    v_lshlrev_b32 v11, 16, v11
    v_mul_f32 v4, s12, v11
    v_exp_f32 v4, v4
    s_nop 0
    v_add_f32 v4, 1.0, v4
    v_rcp_f32 v4, v4
    s_nop 0
    v_mul_f32 v11, v11, v4
    v_cvt_pk_bf16_f32 v11, v11, v11
    v_lshlrev_b32 v11, 16, v11
    v_lshlrev_b32 v12, 16, v12
    v_mul_f32 v4, s12, v12
    v_exp_f32 v4, v4
    s_nop 0
    v_add_f32 v4, 1.0, v4
    v_rcp_f32 v4, v4
    s_nop 0
    v_mul_f32 v12, v12, v4
    v_cvt_pk_bf16_f32 v12, v12, v12
    v_lshlrev_b32 v12, 16, v12
    v_lshlrev_b32 v13, 16, v13
    v_mul_f32 v4, s12, v13
    v_exp_f32 v4, v4
    s_nop 0
    v_add_f32 v4, 1.0, v4
    v_rcp_f32 v4, v4
    s_nop 0
    v_mul_f32 v13, v13, v4
    v_cvt_pk_bf16_f32 v13, v13, v13
    v_lshlrev_b32 v13, 16, v13
    v_lshlrev_b32 v14, 16, v14
    v_mul_f32 v4, s12, v14
    v_exp_f32 v4, v4
    s_nop 0
    v_add_f32 v4, 1.0, v4
    v_rcp_f32 v4, v4
    s_nop 0
    v_mul_f32 v14, v14, v4
    v_cvt_pk_bf16_f32 v14, v14, v14
    v_lshlrev_b32 v14, 16, v14
    v_lshlrev_b32 v15, 16, v15
    v_mul_f32 v4, s12, v15
    v_exp_f32 v4, v4
    s_nop 0
    v_add_f32 v4, 1.0, v4
    v_rcp_f32 v4, v4
    s_nop 0
    v_mul_f32 v15, v15, v4
    v_cvt_pk_bf16_f32 v15, v15, v15
    v_lshlrev_b32 v15, 16, v15
    v_lshlrev_b32 v16, 16, v16
    v_mul_f32 v4, s12, v16
    v_exp_f32 v4, v4
    s_nop 0
    v_add_f32 v4, 1.0, v4
    v_rcp_f32 v4, v4
    s_nop 0
    v_mul_f32 v16, v16, v4
    v_cvt_pk_bf16_f32 v16, v16, v16
    v_lshlrev_b32 v16, 16, v16
    v_lshlrev_b32 v17, 16, v17
    v_mul_f32 v4, s12, v17
    v_exp_f32 v4, v4
    s_nop 0
    v_add_f32 v4, 1.0, v4
    v_rcp_f32 v4, v4
    s_nop 0
    v_mul_f32 v17, v17, v4
    v_cvt_pk_bf16_f32 v17, v17, v17
    v_lshlrev_b32 v17, 16, v17
    v_lshlrev_b32 v18, 16, v18
    v_mul_f32 v4, s12, v18
    v_exp_f32 v4, v4
    s_nop 0
    v_add_f32 v4, 1.0, v4
    v_rcp_f32 v4, v4
    s_nop 0
    v_mul_f32 v18, v18, v4
    v_cvt_pk_bf16_f32 v18, v18, v18
    v_lshlrev_b32 v18, 16, v18
    v_lshlrev_b32 v19, 16, v19
    v_mul_f32 v4, s12, v19
    v_exp_f32 v4, v4
    s_nop 0
    v_add_f32 v4, 1.0, v4
    v_rcp_f32 v4, v4
    s_nop 0
    v_mul_f32 v19, v19, v4
    v_cvt_pk_bf16_f32 v19, v19, v19
    v_lshlrev_b32 v19, 16, v19
    v_lshlrev_b32 v20, 16, v20
    v_mul_f32 v4, s12, v20
    v_exp_f32 v4, v4
    s_nop 0
    v_add_f32 v4, 1.0, v4
    v_rcp_f32 v4, v4
    s_nop 0
    v_mul_f32 v20, v20, v4
    v_cvt_pk_bf16_f32 v20, v20, v20
    v_lshlrev_b32 v20, 16, v20
    v_lshlrev_b32 v21, 16, v21
    v_mul_f32 v4, s12, v21
    v_exp_f32 v4, v4
    s_nop 0
    v_add_f32 v4, 1.0, v4
    v_rcp_f32 v4, v4
    s_nop 0
    v_mul_f32 v21, v21, v4
    v_cvt_pk_bf16_f32 v21, v21, v21
    v_lshlrev_b32 v21, 16, v21
    v_lshlrev_b32 v22, 16, v22
    v_mul_f32 v4, s12, v22
    v_exp_f32 v4, v4
    s_nop 0
    v_add_f32 v4, 1.0, v4
    v_rcp_f32 v4, v4
    s_nop 0
    v_mul_f32 v22, v22, v4
    v_cvt_pk_bf16_f32 v22, v22, v22
    v_lshlrev_b32 v22, 16, v22
    v_lshlrev_b32 v23, 16, v23
    v_mul_f32 v4, s12, v23
    v_exp_f32 v4, v4
    s_nop 0
    v_add_f32 v4, 1.0, v4
    v_rcp_f32 v4, v4
    s_nop 0
    v_mul_f32 v23, v23, v4
    v_cvt_pk_bf16_f32 v23, v23, v23
    v_lshlrev_b32 v23, 16, v23
    v_lshlrev_b32 v24, 16, v24
    v_mul_f32 v4, s12, v24
    v_exp_f32 v4, v4
    s_nop 0
    v_add_f32 v4, 1.0, v4
    v_rcp_f32 v4, v4
    s_nop 0
    v_mul_f32 v24, v24, v4
    v_cvt_pk_bf16_f32 v24, v24, v24
    v_lshlrev_b32 v24, 16, v24
    v_lshlrev_b32 v25, 16, v25
    v_mul_f32 v4, s12, v25
    v_exp_f32 v4, v4
    s_nop 0
    v_add_f32 v4, 1.0, v4
    v_rcp_f32 v4, v4
    s_nop 0
    v_mul_f32 v25, v25, v4
    v_cvt_pk_bf16_f32 v25, v25, v25
    v_lshlrev_b32 v25, 16, v25
    v_mov_b32 v28, 0
    v_mov_b32 v29, 0
    v_mov_b32 v30, 0
    v_mov_b32 v31, 0
    v_mov_b32 v32, 0
    v_mov_b32 v33, 0
    v_mov_b32 v34, 0
    v_mov_b32 v35, 0
    s_waitcnt vmcnt(17)
    v_lshlrev_b32 v4, 16, v40
    v_and_b32 v5, 0xffff0000, v40
    v_fmac_f32 v28, v4, v8
    v_fmac_f32 v29, v5, v8
    v_lshlrev_b32 v4, 16, v41
    v_and_b32 v5, 0xffff0000, v41
    v_fmac_f32 v30, v4, v8
    v_fmac_f32 v31, v5, v8
    v_lshlrev_b32 v4, 16, v42
    v_and_b32 v5, 0xffff0000, v42
    v_fmac_f32 v32, v4, v8
    v_fmac_f32 v33, v5, v8
    v_lshlrev_b32 v4, 16, v43
    v_and_b32 v5, 0xffff0000, v43
    v_fmac_f32 v34, v4, v8
    v_fmac_f32 v35, v5, v8
    s_waitcnt vmcnt(16)
    v_lshlrev_b32 v4, 16, v44
    v_and_b32 v5, 0xffff0000, v44
    v_fmac_f32 v28, v4, v9
    v_fmac_f32 v29, v5, v9
    v_lshlrev_b32 v4, 16, v45
    v_and_b32 v5, 0xffff0000, v45
    v_fmac_f32 v30, v4, v9
    v_fmac_f32 v31, v5, v9
    v_lshlrev_b32 v4, 16, v46
    v_and_b32 v5, 0xffff0000, v46
    v_fmac_f32 v32, v4, v9
    v_fmac_f32 v33, v5, v9
    v_lshlrev_b32 v4, 16, v47
    v_and_b32 v5, 0xffff0000, v47
    v_fmac_f32 v34, v4, v9
    v_fmac_f32 v35, v5, v9
    s_waitcnt vmcnt(15)
    v_lshlrev_b32 v4, 16, v48
    v_and_b32 v5, 0xffff0000, v48
    v_fmac_f32 v28, v4, v10
    v_fmac_f32 v29, v5, v10
    v_lshlrev_b32 v4, 16, v49
    v_and_b32 v5, 0xffff0000, v49
    v_fmac_f32 v30, v4, v10
    v_fmac_f32 v31, v5, v10
    v_lshlrev_b32 v4, 16, v50
    v_and_b32 v5, 0xffff0000, v50
    v_fmac_f32 v32, v4, v10
    v_fmac_f32 v33, v5, v10
    v_lshlrev_b32 v4, 16, v51
    v_and_b32 v5, 0xffff0000, v51
    v_fmac_f32 v34, v4, v10
    v_fmac_f32 v35, v5, v10
    s_waitcnt vmcnt(14)
    v_lshlrev_b32 v4, 16, v52
    v_and_b32 v5, 0xffff0000, v52
    v_fmac_f32 v28, v4, v11
    v_fmac_f32 v29, v5, v11
    v_lshlrev_b32 v4, 16, v53
    v_and_b32 v5, 0xffff0000, v53
    v_fmac_f32 v30, v4, v11
    v_fmac_f32 v31, v5, v11
    v_lshlrev_b32 v4, 16, v54
    v_and_b32 v5, 0xffff0000, v54
    v_fmac_f32 v32, v4, v11
    v_fmac_f32 v33, v5, v11
    v_lshlrev_b32 v4, 16, v55
    v_and_b32 v5, 0xffff0000, v55
    v_fmac_f32 v34, v4, v11
    v_fmac_f32 v35, v5, v11
    s_waitcnt vmcnt(13)
    v_lshlrev_b32 v4, 16, v56
    v_and_b32 v5, 0xffff0000, v56
    v_fmac_f32 v28, v4, v12
    v_fmac_f32 v29, v5, v12
    v_lshlrev_b32 v4, 16, v57
    v_and_b32 v5, 0xffff0000, v57
    v_fmac_f32 v30, v4, v12
    v_fmac_f32 v31, v5, v12
    v_lshlrev_b32 v4, 16, v58
    v_and_b32 v5, 0xffff0000, v58
    v_fmac_f32 v32, v4, v12
    v_fmac_f32 v33, v5, v12
    v_lshlrev_b32 v4, 16, v59
    v_and_b32 v5, 0xffff0000, v59
    v_fmac_f32 v34, v4, v12
    v_fmac_f32 v35, v5, v12
    s_waitcnt vmcnt(12)
    v_lshlrev_b32 v4, 16, v60
    v_and_b32 v5, 0xffff0000, v60
    v_fmac_f32 v28, v4, v13
    v_fmac_f32 v29, v5, v13
    v_lshlrev_b32 v4, 16, v61
    v_and_b32 v5, 0xffff0000, v61
    v_fmac_f32 v30, v4, v13
    v_fmac_f32 v31, v5, v13
    v_lshlrev_b32 v4, 16, v62
    v_and_b32 v5, 0xffff0000, v62
    v_fmac_f32 v32, v4, v13
    v_fmac_f32 v33, v5, v13
    v_lshlrev_b32 v4, 16, v63
    v_and_b32 v5, 0xffff0000, v63
    v_fmac_f32 v34, v4, v13
    v_fmac_f32 v35, v5, v13
    s_waitcnt vmcnt(11)
    v_lshlrev_b32 v4, 16, v64
    v_and_b32 v5, 0xffff0000, v64
    v_fmac_f32 v28, v4, v14
    v_fmac_f32 v29, v5, v14
    v_lshlrev_b32 v4, 16, v65
    v_and_b32 v5, 0xffff0000, v65
    v_fmac_f32 v30, v4, v14
    v_fmac_f32 v31, v5, v14
    v_lshlrev_b32 v4, 16, v66
    v_and_b32 v5, 0xffff0000, v66
    v_fmac_f32 v32, v4, v14
    v_fmac_f32 v33, v5, v14
    v_lshlrev_b32 v4, 16, v67
    v_and_b32 v5, 0xffff0000, v67
    v_fmac_f32 v34, v4, v14
    v_fmac_f32 v35, v5, v14
    s_waitcnt vmcnt(10)
    v_lshlrev_b32 v4, 16, v68
    v_and_b32 v5, 0xffff0000, v68
    v_fmac_f32 v28, v4, v15
    v_fmac_f32 v29, v5, v15
    v_lshlrev_b32 v4, 16, v69
    v_and_b32 v5, 0xffff0000, v69
    v_fmac_f32 v30, v4, v15
    v_fmac_f32 v31, v5, v15
    v_lshlrev_b32 v4, 16, v70
    v_and_b32 v5, 0xffff0000, v70
    v_fmac_f32 v32, v4, v15
    v_fmac_f32 v33, v5, v15
    v_lshlrev_b32 v4, 16, v71
    v_and_b32 v5, 0xffff0000, v71
    v_fmac_f32 v34, v4, v15
    v_fmac_f32 v35, v5, v15
    s_waitcnt vmcnt(9)
    v_lshlrev_b32 v4, 16, v72
    v_and_b32 v5, 0xffff0000, v72
    v_fmac_f32 v28, v4, v16
    v_fmac_f32 v29, v5, v16
    v_lshlrev_b32 v4, 16, v73
    v_and_b32 v5, 0xffff0000, v73
    v_fmac_f32 v30, v4, v16
    v_fmac_f32 v31, v5, v16
    v_lshlrev_b32 v4, 16, v74
    v_and_b32 v5, 0xffff0000, v74
    v_fmac_f32 v32, v4, v16
    v_fmac_f32 v33, v5, v16
    v_lshlrev_b32 v4, 16, v75
    v_and_b32 v5, 0xffff0000, v75
    v_fmac_f32 v34, v4, v16
    v_fmac_f32 v35, v5, v16
    s_waitcnt vmcnt(8)
    v_lshlrev_b32 v4, 16, v76
    v_and_b32 v5, 0xffff0000, v76
    v_fmac_f32 v28, v4, v17
    v_fmac_f32 v29, v5, v17
    v_lshlrev_b32 v4, 16, v77
    v_and_b32 v5, 0xffff0000, v77
    v_fmac_f32 v30, v4, v17
    v_fmac_f32 v31, v5, v17
    v_lshlrev_b32 v4, 16, v78
    v_and_b32 v5, 0xffff0000, v78
    v_fmac_f32 v32, v4, v17
    v_fmac_f32 v33, v5, v17
    v_lshlrev_b32 v4, 16, v79
    v_and_b32 v5, 0xffff0000, v79
    v_fmac_f32 v34, v4, v17
    v_fmac_f32 v35, v5, v17
    s_waitcnt vmcnt(7)
    v_lshlrev_b32 v4, 16, v80
    v_and_b32 v5, 0xffff0000, v80
    v_fmac_f32 v28, v4, v18
    v_fmac_f32 v29, v5, v18
    v_lshlrev_b32 v4, 16, v81
    v_and_b32 v5, 0xffff0000, v81
    v_fmac_f32 v30, v4, v18
    v_fmac_f32 v31, v5, v18
    v_lshlrev_b32 v4, 16, v82
    v_and_b32 v5, 0xffff0000, v82
    v_fmac_f32 v32, v4, v18
    v_fmac_f32 v33, v5, v18
    v_lshlrev_b32 v4, 16, v83
    v_and_b32 v5, 0xffff0000, v83
    v_fmac_f32 v34, v4, v18
    v_fmac_f32 v35, v5, v18
    s_waitcnt vmcnt(6)
    v_lshlrev_b32 v4, 16, v84
    v_and_b32 v5, 0xffff0000, v84
    v_fmac_f32 v28, v4, v19
    v_fmac_f32 v29, v5, v19
    v_lshlrev_b32 v4, 16, v85
    v_and_b32 v5, 0xffff0000, v85
    v_fmac_f32 v30, v4, v19
    v_fmac_f32 v31, v5, v19
    v_lshlrev_b32 v4, 16, v86
    v_and_b32 v5, 0xffff0000, v86
    v_fmac_f32 v32, v4, v19
    v_fmac_f32 v33, v5, v19
    v_lshlrev_b32 v4, 16, v87
    v_and_b32 v5, 0xffff0000, v87
    v_fmac_f32 v34, v4, v19
    v_fmac_f32 v35, v5, v19
    s_waitcnt vmcnt(5)
    v_lshlrev_b32 v4, 16, v88
    v_and_b32 v5, 0xffff0000, v88
    v_fmac_f32 v28, v4, v20
    v_fmac_f32 v29, v5, v20
    v_lshlrev_b32 v4, 16, v89
    v_and_b32 v5, 0xffff0000, v89
    v_fmac_f32 v30, v4, v20
    v_fmac_f32 v31, v5, v20
    v_lshlrev_b32 v4, 16, v90
    v_and_b32 v5, 0xffff0000, v90
    v_fmac_f32 v32, v4, v20
    v_fmac_f32 v33, v5, v20
    v_lshlrev_b32 v4, 16, v91
    v_and_b32 v5, 0xffff0000, v91
    v_fmac_f32 v34, v4, v20
    v_fmac_f32 v35, v5, v20
    s_waitcnt vmcnt(4)
    v_lshlrev_b32 v4, 16, v92
    v_and_b32 v5, 0xffff0000, v92
    v_fmac_f32 v28, v4, v21
    v_fmac_f32 v29, v5, v21
    v_lshlrev_b32 v4, 16, v93
    v_and_b32 v5, 0xffff0000, v93
    v_fmac_f32 v30, v4, v21
    v_fmac_f32 v31, v5, v21
    v_lshlrev_b32 v4, 16, v94
    v_and_b32 v5, 0xffff0000, v94
    v_fmac_f32 v32, v4, v21
    v_fmac_f32 v33, v5, v21
    v_lshlrev_b32 v4, 16, v95
    v_and_b32 v5, 0xffff0000, v95
    v_fmac_f32 v34, v4, v21
    v_fmac_f32 v35, v5, v21
    s_waitcnt vmcnt(3)
    v_lshlrev_b32 v4, 16, v96
    v_and_b32 v5, 0xffff0000, v96
    v_fmac_f32 v28, v4, v22
    v_fmac_f32 v29, v5, v22
    v_lshlrev_b32 v4, 16, v97
    v_and_b32 v5, 0xffff0000, v97
    v_fmac_f32 v30, v4, v22
    v_fmac_f32 v31, v5, v22
    v_lshlrev_b32 v4, 16, v98
    v_and_b32 v5, 0xffff0000, v98
    v_fmac_f32 v32, v4, v22
    v_fmac_f32 v33, v5, v22
    v_lshlrev_b32 v4, 16, v99
    v_and_b32 v5, 0xffff0000, v99
    v_fmac_f32 v34, v4, v22
    v_fmac_f32 v35, v5, v22
    s_waitcnt vmcnt(2)
    v_lshlrev_b32 v4, 16, v100
    v_and_b32 v5, 0xffff0000, v100
    v_fmac_f32 v28, v4, v23
    v_fmac_f32 v29, v5, v23
    v_lshlrev_b32 v4, 16, v101
    v_and_b32 v5, 0xffff0000, v101
    v_fmac_f32 v30, v4, v23
    v_fmac_f32 v31, v5, v23
    v_lshlrev_b32 v4, 16, v102
    v_and_b32 v5, 0xffff0000, v102
    v_fmac_f32 v32, v4, v23
    v_fmac_f32 v33, v5, v23
    v_lshlrev_b32 v4, 16, v103
    v_and_b32 v5, 0xffff0000, v103
    v_fmac_f32 v34, v4, v23
    v_fmac_f32 v35, v5, v23
    s_waitcnt vmcnt(1)
    v_lshlrev_b32 v4, 16, v104
    v_and_b32 v5, 0xffff0000, v104
    v_fmac_f32 v28, v4, v24
    v_fmac_f32 v29, v5, v24
    v_lshlrev_b32 v4, 16, v105
    v_and_b32 v5, 0xffff0000, v105
    v_fmac_f32 v30, v4, v24
    v_fmac_f32 v31, v5, v24
    v_lshlrev_b32 v4, 16, v106
    v_and_b32 v5, 0xffff0000, v106
    v_fmac_f32 v32, v4, v24
    v_fmac_f32 v33, v5, v24
    v_lshlrev_b32 v4, 16, v107
    v_and_b32 v5, 0xffff0000, v107
    v_fmac_f32 v34, v4, v24
    v_fmac_f32 v35, v5, v24
    s_waitcnt vmcnt(0)
    v_lshlrev_b32 v4, 16, v108
    v_and_b32 v5, 0xffff0000, v108
    v_fmac_f32 v28, v4, v25
    v_fmac_f32 v29, v5, v25
    v_lshlrev_b32 v4, 16, v109
    v_and_b32 v5, 0xffff0000, v109
    v_fmac_f32 v30, v4, v25
    v_fmac_f32 v31, v5, v25
    v_lshlrev_b32 v4, 16, v110
    v_and_b32 v5, 0xffff0000, v110
    v_fmac_f32 v32, v4, v25
    v_fmac_f32 v33, v5, v25
    v_lshlrev_b32 v4, 16, v111
    v_and_b32 v5, 0xffff0000, v111
    v_fmac_f32 v34, v4, v25
    v_fmac_f32 v35, v5, v25
    v_lshlrev_b32 v4, 5, v0
    ds_write_b128 v4, v[28:31]
    ds_write_b128 v4, v[32:35] offset:16
    s_waitcnt lgkmcnt(0)
    s_barrier
    s_cmp_lg_u32 s10, 0
    s_cbranch_scc1 L_md_64
    v_lshlrev_b32 v4, 2, v0
    ds_read_b32 v8, v4 offset:0
    ds_read_b32 v9, v4 offset:256
    ds_read_b32 v10, v4 offset:512
    ds_read_b32 v11, v4 offset:768
    ds_read_b32 v12, v4 offset:1024
    ds_read_b32 v13, v4 offset:1280
    ds_read_b32 v14, v4 offset:1536
    ds_read_b32 v15, v4 offset:1792
    ds_read_b32 v16, v4 offset:2048
    ds_read_b32 v17, v4 offset:2304
    ds_read_b32 v18, v4 offset:2560
    ds_read_b32 v19, v4 offset:2816
    ds_read_b32 v20, v4 offset:3072
    ds_read_b32 v21, v4 offset:3328
    ds_read_b32 v22, v4 offset:3584
    ds_read_b32 v23, v4 offset:3840
    ds_read_b32 v24, v4 offset:4096
    ds_read_b32 v25, v4 offset:4352
    ds_read_b32 v26, v4 offset:4608
    ds_read_b32 v27, v4 offset:4864
    ds_read_b32 v28, v4 offset:5120
    ds_read_b32 v29, v4 offset:5376
    ds_read_b32 v30, v4 offset:5632
    ds_read_b32 v31, v4 offset:5888
    ds_read_b32 v32, v4 offset:6144
    ds_read_b32 v33, v4 offset:6400
    ds_read_b32 v34, v4 offset:6656
    ds_read_b32 v35, v4 offset:6912
    ds_read_b32 v36, v4 offset:7168
    ds_read_b32 v37, v4 offset:7424
    ds_read_b32 v38, v4 offset:7680
    ds_read_b32 v39, v4 offset:7936
    s_waitcnt lgkmcnt(0)
    v_add_f32 v8, v8, v24
    v_add_f32 v9, v9, v25
    v_add_f32 v10, v10, v26
    v_add_f32 v11, v11, v27
    v_add_f32 v12, v12, v28
    v_add_f32 v13, v13, v29
    v_add_f32 v14, v14, v30
    v_add_f32 v15, v15, v31
    v_add_f32 v16, v16, v32
    v_add_f32 v17, v17, v33
    v_add_f32 v18, v18, v34
    v_add_f32 v19, v19, v35
    v_add_f32 v20, v20, v36
    v_add_f32 v21, v21, v37
    v_add_f32 v22, v22, v38
    v_add_f32 v23, v23, v39
    v_add_f32 v8, v8, v16
    v_add_f32 v9, v9, v17
    v_add_f32 v10, v10, v18
    v_add_f32 v11, v11, v19
    v_add_f32 v12, v12, v20
    v_add_f32 v13, v13, v21
    v_add_f32 v14, v14, v22
    v_add_f32 v15, v15, v23
    v_add_f32 v8, v8, v12
    v_add_f32 v9, v9, v13
    v_add_f32 v10, v10, v14
    v_add_f32 v11, v11, v15
    v_add_f32 v8, v8, v10
    v_add_f32 v9, v9, v11
    v_add_f32 v8, v8, v9
    v_cvt_pk_bf16_f32 v8, v8, v8
    v_lshlrev_b32 v8, 16, v8
    v_add_f32 v9, 1.0, v8
    s_sub_u32 s12, s14, 9
    s_sub_u32 s13, s14, 36
    s_min_u32 s12, s12, s13
    s_cmp_lt_u32 s12, 9
    s_cselect_b64 vcc, -1, 0
    v_cndmask_b32 v8, v8, v9, vcc
    v_cvt_pk_bf16_f32 v8, v8, v8
    s_lshl_b32 s12, s14, 7
    v_lshl_add_u32 v4, v0, 1, s12
    global_store_short v4, v8, s[4:5] offset:0 sc1
    s_waitcnt vmcnt(0)
L_md_64:
    s_cmp_lt_u32 s14, 18
    s_cbranch_scc1 L_md2_65
    s_cmp_lg_u32 s10, 0
    s_cbranch_scc1 L_arr_67
    v_mov_b32 v4, 32
    v_mov_b32 v5, 1
    s_mov_b64 exec, 1
    global_atomic_add v4, v5, s[6:7] sc1
    s_mov_b64 exec, -1
L_arr_67:
    s_branch L_md3_66
L_md2_65:
    s_cmp_lg_u32 s10, 0
    s_cbranch_scc1 L_arr_68
    v_mov_b32 v4, 160
    v_mov_b32 v5, 1
    s_mov_b64 exec, 1
    global_atomic_add v4, v5, s[6:7] sc1
    s_mov_b64 exec, -1
L_arr_68:
L_md3_66:
    s_barrier
L_nomod:
    s_load_dwordx2 s[16:17], s[0:1], 16
    s_load_dwordx2 s[18:19], s[0:1], 40
    s_load_dwordx2 s[34:35], s[0:1], 0
    v_mov_b32 v12, 0x0
    v_bfe_u32 v1, v0, 4, 2
    v_lshl_add_u32 v12, v1, 13, v12
    v_bfe_u32 v1, v0, 6, 2
    v_lshl_add_u32 v12, v1, 17, v12
    v_mov_b32 v2, 0x0
    v_bfe_u32 v1, v0, 0, 4
    v_lshlrev_b32 v1, 4, v1
    v_xor_b32 v2, v2, v1
    v_bfe_u32 v1, v0, 4, 2
    v_lshlrev_b32 v1, 5, v1
    v_xor_b32 v2, v2, v1
    v_add_u32 v12, v12, v2
    v_mov_b32 v13, 0x8000
    v_bfe_u32 v1, v0, 4, 2
    v_lshl_add_u32 v13, v1, 13, v13
    v_bfe_u32 v1, v0, 6, 2
    v_lshl_add_u32 v13, v1, 17, v13
    v_mov_b32 v2, 0x0
    v_bfe_u32 v1, v0, 0, 4
    v_lshlrev_b32 v1, 4, v1
    v_xor_b32 v2, v2, v1
    v_bfe_u32 v1, v0, 4, 2
    v_lshlrev_b32 v1, 5, v1
    v_xor_b32 v2, v2, v1
    v_add_u32 v13, v13, v2
    v_mov_b32 v14, 0x10000
    v_bfe_u32 v1, v0, 4, 2
    v_lshl_add_u32 v14, v1, 13, v14
    v_bfe_u32 v1, v0, 6, 2
    v_lshl_add_u32 v14, v1, 17, v14
    v_mov_b32 v2, 0x80
    v_bfe_u32 v1, v0, 0, 4
    v_lshlrev_b32 v1, 4, v1
    v_xor_b32 v2, v2, v1
    v_bfe_u32 v1, v0, 4, 2
    v_lshlrev_b32 v1, 5, v1
    v_xor_b32 v2, v2, v1
    v_add_u32 v14, v14, v2
    v_mov_b32 v15, 0x18000
    v_bfe_u32 v1, v0, 4, 2
    v_lshl_add_u32 v15, v1, 13, v15
    v_bfe_u32 v1, v0, 6, 2
    v_lshl_add_u32 v15, v1, 17, v15
    v_mov_b32 v2, 0x80
    v_bfe_u32 v1, v0, 0, 4
    v_lshlrev_b32 v1, 4, v1
    v_xor_b32 v2, v2, v1
    v_bfe_u32 v1, v0, 4, 2
    v_lshlrev_b32 v1, 5, v1
    v_xor_b32 v2, v2, v1
    v_add_u32 v15, v15, v2
    v_mov_b32 v16, 0x0
    v_bfe_u32 v1, v0, 0, 2
    v_lshlrev_b32 v1, 3, v1
    v_xor_b32 v16, v16, v1
    v_bfe_i32 v1, v0, 2, 1
    v_and_b32 v1, 0x120, v1
    v_xor_b32 v16, v16, v1
    v_bfe_i32 v1, v0, 3, 1
    v_and_b32 v1, 0x240, v1
    v_xor_b32 v16, v16, v1
    v_bfe_i32 v1, v0, 4, 1
    v_and_b32 v1, 0x880, v1
    v_xor_b32 v16, v16, v1
    v_bfe_u32 v1, v0, 5, 1
    v_lshlrev_b32 v1, 12, v1
    v_xor_b32 v16, v16, v1
    v_bfe_u32 v1, v0, 6, 2
    v_lshlrev_b32 v1, 6, v1
    v_xor_b32 v16, v16, v1
    v_mov_b32 v17, 0x20
    v_bfe_u32 v1, v0, 0, 2
    v_lshlrev_b32 v1, 3, v1
    v_xor_b32 v17, v17, v1
    v_bfe_i32 v1, v0, 2, 1
    v_and_b32 v1, 0x120, v1
    v_xor_b32 v17, v17, v1
    v_bfe_i32 v1, v0, 3, 1
    v_and_b32 v1, 0x240, v1
    v_xor_b32 v17, v17, v1
    v_bfe_i32 v1, v0, 4, 1
    v_and_b32 v1, 0x880, v1
    v_xor_b32 v17, v17, v1
    v_bfe_u32 v1, v0, 5, 1
    v_lshlrev_b32 v1, 12, v1
    v_xor_b32 v17, v17, v1
    v_bfe_u32 v1, v0, 6, 2
    v_lshlrev_b32 v1, 6, v1
    v_xor_b32 v17, v17, v1
    v_mov_b32 v20, 0x0
    v_bfe_u32 v1, v0, 3, 3
    v_mul_u32_u24 v1, 0x480, v1
    v_add_u32 v20, v20, v1
    v_bfe_u32 v1, v0, 6, 2
    v_mul_u32_u24 v1, 0x9000, v1
    v_add_u32 v20, v20, v1
    v_mov_b32 v2, 0x0
    v_bfe_u32 v1, v0, 0, 3
    v_lshlrev_b32 v1, 4, v1
    v_xor_b32 v2, v2, v1
    v_bfe_u32 v1, v0, 4, 2
    v_lshlrev_b32 v1, 5, v1
    v_xor_b32 v2, v2, v1
    v_add_u32 v20, v20, v2
    v_mov_b32 v21, 0x2400
    v_bfe_u32 v1, v0, 3, 3
    v_mul_u32_u24 v1, 0x480, v1
    v_add_u32 v21, v21, v1
    v_bfe_u32 v1, v0, 6, 2
    v_mul_u32_u24 v1, 0x9000, v1
    v_add_u32 v21, v21, v1
    v_mov_b32 v2, 0x0
    v_bfe_u32 v1, v0, 0, 3
    v_lshlrev_b32 v1, 4, v1
    v_xor_b32 v2, v2, v1
    v_bfe_u32 v1, v0, 4, 2
    v_lshlrev_b32 v1, 5, v1
    v_xor_b32 v2, v2, v1
    v_add_u32 v21, v21, v2
    v_mov_b32 v22, 0x4800
    v_bfe_u32 v1, v0, 3, 3
    v_mul_u32_u24 v1, 0x480, v1
    v_add_u32 v22, v22, v1
    v_bfe_u32 v1, v0, 6, 2
    v_mul_u32_u24 v1, 0x9000, v1
    v_add_u32 v22, v22, v1
    v_mov_b32 v2, 0x0
    v_bfe_u32 v1, v0, 0, 3
    v_lshlrev_b32 v1, 4, v1
    v_xor_b32 v2, v2, v1
    v_bfe_u32 v1, v0, 4, 2
    v_lshlrev_b32 v1, 5, v1
    v_xor_b32 v2, v2, v1
    v_add_u32 v22, v22, v2
    v_mov_b32 v23, 0x6c00
    v_bfe_u32 v1, v0, 3, 3
    v_mul_u32_u24 v1, 0x480, v1
    v_add_u32 v23, v23, v1
    v_bfe_u32 v1, v0, 6, 2
    v_mul_u32_u24 v1, 0x9000, v1
    v_add_u32 v23, v23, v1
    v_mov_b32 v2, 0x0
    v_bfe_u32 v1, v0, 0, 3
    v_lshlrev_b32 v1, 4, v1
    v_xor_b32 v2, v2, v1
    v_bfe_u32 v1, v0, 4, 2
    v_lshlrev_b32 v1, 5, v1
    v_xor_b32 v2, v2, v1
    v_add_u32 v23, v23, v2
    v_mov_b32 v18, 0x0
    v_bfe_u32 v1, v0, 0, 2
    v_lshlrev_b32 v1, 3, v1
    v_xor_b32 v18, v18, v1
    v_bfe_u32 v1, v0, 2, 1
    v_lshlrev_b32 v1, 7, v1
    v_xor_b32 v18, v18, v1
    v_bfe_i32 v1, v0, 3, 1
    v_and_b32 v1, 0x120, v1
    v_xor_b32 v18, v18, v1
    v_bfe_i32 v1, v0, 4, 1
    v_and_b32 v1, 0x240, v1
    v_xor_b32 v18, v18, v1
    v_bfe_u32 v1, v0, 5, 1
    v_lshlrev_b32 v1, 10, v1
    v_xor_b32 v18, v18, v1
    v_bfe_u32 v1, v0, 6, 2
    v_lshlrev_b32 v1, 5, v1
    v_xor_b32 v18, v18, v1
    s_lshl_b32 s12, s9, 8
    s_waitcnt lgkmcnt(0)
    s_add_u32 s16, s16, s12
    s_addc_u32 s17, s17, 0
    s_mul_i32 s12, s9, 147456
    s_add_u32 s18, s18, s12
    s_addc_u32 s19, s19, 0
    s_lshl_b32 s26, s10, 12
    s_add_u32 s12, s16, 0
    s_addc_u32 s13, s17, 0
    s_add_u32 m0, s26, 0
    s_nop 0
    global_load_lds_dwordx4 v12, s[12:13]
    s_add_u32 m0, s26, 1024
    s_nop 0
    global_load_lds_dwordx4 v13, s[12:13]
    s_add_u32 m0, s26, 2048
    s_nop 0
    global_load_lds_dwordx4 v14, s[12:13]
    s_add_u32 m0, s26, 3072
    s_nop 0
    global_load_lds_dwordx4 v15, s[12:13]
    s_add_u32 s12, s16, 524288
    s_addc_u32 s13, s17, 0
    s_add_u32 m0, s26, 16384
    s_nop 0
    global_load_lds_dwordx4 v12, s[12:13]
    s_add_u32 m0, s26, 17408
    s_nop 0
    global_load_lds_dwordx4 v13, s[12:13]
    s_add_u32 m0, s26, 18432
    s_nop 0
    global_load_lds_dwordx4 v14, s[12:13]
    s_add_u32 m0, s26, 19456
    s_nop 0
    global_load_lds_dwordx4 v15, s[12:13]
    s_add_u32 s12, s16, 1048576
    s_addc_u32 s13, s17, 0
    s_add_u32 m0, s26, 32768
    s_nop 0
    global_load_lds_dwordx4 v12, s[12:13]
    s_add_u32 m0, s26, 33792
    s_nop 0
    global_load_lds_dwordx4 v13, s[12:13]
    s_add_u32 m0, s26, 34816
    s_nop 0
    global_load_lds_dwordx4 v14, s[12:13]
    s_add_u32 m0, s26, 35840
    s_nop 0
    global_load_lds_dwordx4 v15, s[12:13]
    s_add_u32 s12, s16, 1572864
    s_addc_u32 s13, s17, 0
    s_add_u32 m0, s26, 49152
    s_nop 0
    global_load_lds_dwordx4 v12, s[12:13]
    s_add_u32 m0, s26, 50176
    s_nop 0
    global_load_lds_dwordx4 v13, s[12:13]
    s_add_u32 m0, s26, 51200
    s_nop 0
    global_load_lds_dwordx4 v14, s[12:13]
    s_add_u32 m0, s26, 52224
    s_nop 0
    global_load_lds_dwordx4 v15, s[12:13]
    s_add_u32 s12, s16, 2097152
    s_addc_u32 s13, s17, 0
    s_add_u32 m0, s26, 65536
    s_nop 0
    global_load_lds_dwordx4 v12, s[12:13]
    s_add_u32 m0, s26, 66560
    s_nop 0
    global_load_lds_dwordx4 v13, s[12:13]
    s_add_u32 m0, s26, 67584
    s_nop 0
    global_load_lds_dwordx4 v14, s[12:13]
    s_add_u32 m0, s26, 68608
    s_nop 0
    global_load_lds_dwordx4 v15, s[12:13]
    s_add_u32 s12, s16, 2621440
    s_addc_u32 s13, s17, 0
    s_add_u32 m0, s26, 81920
    s_nop 0
    global_load_lds_dwordx4 v12, s[12:13]
    s_add_u32 m0, s26, 82944
    s_nop 0
    global_load_lds_dwordx4 v13, s[12:13]
    s_add_u32 m0, s26, 83968
    s_nop 0
    global_load_lds_dwordx4 v14, s[12:13]
    s_add_u32 m0, s26, 84992
    s_nop 0
    global_load_lds_dwordx4 v15, s[12:13]
    s_add_u32 s12, s16, 3145728
    s_addc_u32 s13, s17, 0
    s_add_u32 m0, s26, 98304
    s_nop 0
    global_load_lds_dwordx4 v12, s[12:13]
    s_add_u32 m0, s26, 99328
    s_nop 0
    global_load_lds_dwordx4 v13, s[12:13]
    s_add_u32 m0, s26, 100352
    s_nop 0
    global_load_lds_dwordx4 v14, s[12:13]
    s_add_u32 m0, s26, 101376
    s_nop 0
    global_load_lds_dwordx4 v15, s[12:13]
    s_waitcnt vmcnt(24)
    s_barrier
    s_add_u32 s12, s16, 3670016
    s_addc_u32 s13, s17, 0
    s_add_u32 m0, s26, 114688
    s_nop 0
    global_load_lds_dwordx4 v12, s[12:13]
    s_add_u32 m0, s26, 115712
    s_nop 0
    global_load_lds_dwordx4 v13, s[12:13]
    s_add_u32 m0, s26, 116736
    s_nop 0
    global_load_lds_dwordx4 v14, s[12:13]
    s_add_u32 m0, s26, 117760
    s_nop 0
    global_load_lds_dwordx4 v15, s[12:13]
    v_add_u32 v28, 0, v16
    v_add_u32 v29, 0, v17
    ds_read_b64_tr_b16 a[0:1], v28 offset:0
    ds_read_b64_tr_b16 a[2:3], v28 offset:1024
    ds_read_b64_tr_b16 a[4:5], v29 offset:0
    ds_read_b64_tr_b16 a[6:7], v29 offset:1024
    ds_read_b64_tr_b16 a[8:9], v28 offset:8192
    ds_read_b64_tr_b16 a[10:11], v28 offset:9216
    ds_read_b64_tr_b16 a[12:13], v29 offset:8192
    ds_read_b64_tr_b16 a[14:15], v29 offset:9216
    s_waitcnt lgkmcnt(0)
    s_waitcnt vmcnt(24)
    s_barrier
    s_add_u32 s12, s16, 4194304
    s_addc_u32 s13, s17, 0
    s_add_u32 m0, s26, 0
    s_nop 0
    global_load_lds_dwordx4 v12, s[12:13]
    s_add_u32 m0, s26, 1024
    s_nop 0
    global_load_lds_dwordx4 v13, s[12:13]
    s_add_u32 m0, s26, 2048
    s_nop 0
    global_load_lds_dwordx4 v14, s[12:13]
    s_add_u32 m0, s26, 3072
    s_nop 0
    global_load_lds_dwordx4 v15, s[12:13]
    v_add_u32 v28, 16384, v16
    v_add_u32 v29, 16384, v17
    ds_read_b64_tr_b16 a[16:17], v28 offset:0
    ds_read_b64_tr_b16 a[18:19], v28 offset:1024
    ds_read_b64_tr_b16 a[20:21], v29 offset:0
    ds_read_b64_tr_b16 a[22:23], v29 offset:1024
    ds_read_b64_tr_b16 a[24:25], v28 offset:8192
    ds_read_b64_tr_b16 a[26:27], v28 offset:9216
    ds_read_b64_tr_b16 a[28:29], v29 offset:8192
    ds_read_b64_tr_b16 a[30:31], v29 offset:9216
    s_waitcnt lgkmcnt(0)
    s_waitcnt vmcnt(24)
    s_barrier
    s_add_u32 s12, s18, 0
    s_addc_u32 s13, s19, 0
    s_add_u32 m0, s26, 16384
    s_nop 0
    global_load_lds_dwordx4 v20, s[12:13]
    s_add_u32 m0, s26, 17408
    s_nop 0
    global_load_lds_dwordx4 v21, s[12:13]
    s_add_u32 m0, s26, 18432
    s_nop 0
    global_load_lds_dwordx4 v22, s[12:13]
    s_add_u32 m0, s26, 19456
    s_nop 0
    global_load_lds_dwordx4 v23, s[12:13]
    v_add_u32 v28, 32768, v16
    v_add_u32 v29, 32768, v17
    ds_read_b64_tr_b16 a[32:33], v28 offset:0
    ds_read_b64_tr_b16 a[34:35], v28 offset:1024
    ds_read_b64_tr_b16 a[36:37], v29 offset:0
    ds_read_b64_tr_b16 a[38:39], v29 offset:1024
    ds_read_b64_tr_b16 a[40:41], v28 offset:8192
    ds_read_b64_tr_b16 a[42:43], v28 offset:9216
    ds_read_b64_tr_b16 a[44:45], v29 offset:8192
    ds_read_b64_tr_b16 a[46:47], v29 offset:9216
    s_waitcnt lgkmcnt(0)
    s_waitcnt vmcnt(24)
    s_barrier
    s_add_u32 s12, s18, 128
    s_addc_u32 s13, s19, 0
    s_add_u32 m0, s26, 32768
    s_nop 0
    global_load_lds_dwordx4 v20, s[12:13]
    s_add_u32 m0, s26, 33792
    s_nop 0
    global_load_lds_dwordx4 v21, s[12:13]
    s_add_u32 m0, s26, 34816
    s_nop 0
    global_load_lds_dwordx4 v22, s[12:13]
    s_add_u32 m0, s26, 35840
    s_nop 0
    global_load_lds_dwordx4 v23, s[12:13]
    v_add_u32 v28, 49152, v16
    v_add_u32 v29, 49152, v17
    ds_read_b64_tr_b16 a[48:49], v28 offset:0
    ds_read_b64_tr_b16 a[50:51], v28 offset:1024
    ds_read_b64_tr_b16 a[52:53], v29 offset:0
    ds_read_b64_tr_b16 a[54:55], v29 offset:1024
    ds_read_b64_tr_b16 a[56:57], v28 offset:8192
    ds_read_b64_tr_b16 a[58:59], v28 offset:9216
    ds_read_b64_tr_b16 a[60:61], v29 offset:8192
    ds_read_b64_tr_b16 a[62:63], v29 offset:9216
    s_waitcnt lgkmcnt(0)
    s_waitcnt vmcnt(24)
    s_barrier
    s_add_u32 s12, s18, 256
    s_addc_u32 s13, s19, 0
    s_add_u32 m0, s26, 49152
    s_nop 0
    global_load_lds_dwordx4 v20, s[12:13]
    s_add_u32 m0, s26, 50176
    s_nop 0
    global_load_lds_dwordx4 v21, s[12:13]
    s_add_u32 m0, s26, 51200
    s_nop 0
    global_load_lds_dwordx4 v22, s[12:13]
    s_add_u32 m0, s26, 52224
    s_nop 0
    global_load_lds_dwordx4 v23, s[12:13]
    v_add_u32 v28, 65536, v16
    v_add_u32 v29, 65536, v17
    ds_read_b64_tr_b16 a[64:65], v28 offset:0
    ds_read_b64_tr_b16 a[66:67], v28 offset:1024
    ds_read_b64_tr_b16 a[68:69], v29 offset:0
    ds_read_b64_tr_b16 a[70:71], v29 offset:1024
    ds_read_b64_tr_b16 a[72:73], v28 offset:8192
    ds_read_b64_tr_b16 a[74:75], v28 offset:9216
    ds_read_b64_tr_b16 a[76:77], v29 offset:8192
    ds_read_b64_tr_b16 a[78:79], v29 offset:9216
    s_waitcnt lgkmcnt(0)
    s_waitcnt vmcnt(24)
    s_barrier
    s_add_u32 s12, s18, 384
    s_addc_u32 s13, s19, 0
    s_add_u32 m0, s26, 65536
    s_nop 0
    global_load_lds_dwordx4 v20, s[12:13]
    s_add_u32 m0, s26, 66560
    s_nop 0
    global_load_lds_dwordx4 v21, s[12:13]
    s_add_u32 m0, s26, 67584
    s_nop 0
    global_load_lds_dwordx4 v22, s[12:13]
    s_add_u32 m0, s26, 68608
    s_nop 0
    global_load_lds_dwordx4 v23, s[12:13]
    v_add_u32 v28, 81920, v16
    v_add_u32 v29, 81920, v17
    ds_read_b64_tr_b16 a[80:81], v28 offset:0
    ds_read_b64_tr_b16 a[82:83], v28 offset:1024
    ds_read_b64_tr_b16 a[84:85], v29 offset:0
    ds_read_b64_tr_b16 a[86:87], v29 offset:1024
    ds_read_b64_tr_b16 a[88:89], v28 offset:8192
    ds_read_b64_tr_b16 a[90:91], v28 offset:9216
    ds_read_b64_tr_b16 a[92:93], v29 offset:8192
    ds_read_b64_tr_b16 a[94:95], v29 offset:9216
    s_waitcnt lgkmcnt(0)
    s_waitcnt vmcnt(24)
    s_barrier
    s_add_u32 s12, s18, 512
    s_addc_u32 s13, s19, 0
    s_add_u32 m0, s26, 81920
    s_nop 0
    global_load_lds_dwordx4 v20, s[12:13]
    s_add_u32 m0, s26, 82944
    s_nop 0
    global_load_lds_dwordx4 v21, s[12:13]
    s_add_u32 m0, s26, 83968
    s_nop 0
    global_load_lds_dwordx4 v22, s[12:13]
    s_add_u32 m0, s26, 84992
    s_nop 0
    global_load_lds_dwordx4 v23, s[12:13]
    v_add_u32 v28, 98304, v16
    v_add_u32 v29, 98304, v17
    ds_read_b64_tr_b16 a[96:97], v28 offset:0
    ds_read_b64_tr_b16 a[98:99], v28 offset:1024
    ds_read_b64_tr_b16 a[100:101], v29 offset:0
    ds_read_b64_tr_b16 a[102:103], v29 offset:1024
    ds_read_b64_tr_b16 a[104:105], v28 offset:8192
    ds_read_b64_tr_b16 a[106:107], v28 offset:9216
    ds_read_b64_tr_b16 a[108:109], v29 offset:8192
    ds_read_b64_tr_b16 a[110:111], v29 offset:9216
    s_waitcnt lgkmcnt(0)
    s_waitcnt vmcnt(24)
    s_barrier
    s_add_u32 s12, s18, 640
    s_addc_u32 s13, s19, 0
    s_add_u32 m0, s26, 98304
    s_nop 0
    global_load_lds_dwordx4 v20, s[12:13]
    s_add_u32 m0, s26, 99328
    s_nop 0
    global_load_lds_dwordx4 v21, s[12:13]
    s_add_u32 m0, s26, 100352
    s_nop 0
    global_load_lds_dwordx4 v22, s[12:13]
    s_add_u32 m0, s26, 101376
    s_nop 0
    global_load_lds_dwordx4 v23, s[12:13]
    v_add_u32 v28, 114688, v16
    v_add_u32 v29, 114688, v17
    ds_read_b64_tr_b16 a[112:113], v28 offset:0
    ds_read_b64_tr_b16 a[114:115], v28 offset:1024
    ds_read_b64_tr_b16 a[116:117], v29 offset:0
    ds_read_b64_tr_b16 a[118:119], v29 offset:1024
    ds_read_b64_tr_b16 a[120:121], v28 offset:8192
    ds_read_b64_tr_b16 a[122:123], v28 offset:9216
    ds_read_b64_tr_b16 a[124:125], v29 offset:8192
    ds_read_b64_tr_b16 a[126:127], v29 offset:9216
    s_waitcnt lgkmcnt(0)
    s_waitcnt vmcnt(24)
    s_barrier
    s_add_u32 s12, s18, 768
    s_addc_u32 s13, s19, 0
    s_add_u32 m0, s26, 114688
    s_nop 0
    global_load_lds_dwordx4 v20, s[12:13]
    s_add_u32 m0, s26, 115712
    s_nop 0
    global_load_lds_dwordx4 v21, s[12:13]
    s_add_u32 m0, s26, 116736
    s_nop 0
    global_load_lds_dwordx4 v22, s[12:13]
    s_add_u32 m0, s26, 117760
    s_nop 0
    global_load_lds_dwordx4 v23, s[12:13]
    v_add_u32 v28, 0, v16
    v_add_u32 v29, 0, v17
    ds_read_b64_tr_b16 a[128:129], v28 offset:0
    ds_read_b64_tr_b16 a[130:131], v28 offset:1024
    ds_read_b64_tr_b16 a[132:133], v29 offset:0
    ds_read_b64_tr_b16 a[134:135], v29 offset:1024
    ds_read_b64_tr_b16 a[136:137], v28 offset:8192
    ds_read_b64_tr_b16 a[138:139], v28 offset:9216
    ds_read_b64_tr_b16 a[140:141], v29 offset:8192
    ds_read_b64_tr_b16 a[142:143], v29 offset:9216
    s_waitcnt lgkmcnt(0)
    s_waitcnt vmcnt(24)
    s_barrier
    s_add_u32 s12, s18, 896
    s_addc_u32 s13, s19, 0
    s_add_u32 m0, s26, 0
    s_nop 0
    global_load_lds_dwordx4 v20, s[12:13]
    s_add_u32 m0, s26, 1024
    s_nop 0
    global_load_lds_dwordx4 v21, s[12:13]
    s_add_u32 m0, s26, 2048
    s_nop 0
    global_load_lds_dwordx4 v22, s[12:13]
    s_add_u32 m0, s26, 3072
    s_nop 0
    global_load_lds_dwordx4 v23, s[12:13]
    v_add_u32 v28, 16384, v18
    ds_read_b64_tr_b16 a[144:145], v28 offset:0
    ds_read_b64_tr_b16 a[146:147], v28 offset:2048
    ds_read_b64_tr_b16 a[148:149], v28 offset:4096
    ds_read_b64_tr_b16 a[150:151], v28 offset:6144
    ds_read_b64_tr_b16 a[152:153], v28 offset:8192
    ds_read_b64_tr_b16 a[154:155], v28 offset:10240
    ds_read_b64_tr_b16 a[156:157], v28 offset:12288
    ds_read_b64_tr_b16 a[158:159], v28 offset:14336
    s_waitcnt lgkmcnt(0)
    s_waitcnt vmcnt(24)
    s_barrier
    s_add_u32 s12, s18, 1024
    s_addc_u32 s13, s19, 0
    s_add_u32 m0, s26, 16384
    s_nop 0
    global_load_lds_dwordx4 v20, s[12:13]
    s_add_u32 m0, s26, 17408
    s_nop 0
    global_load_lds_dwordx4 v21, s[12:13]
    s_add_u32 m0, s26, 18432
    s_nop 0
    global_load_lds_dwordx4 v22, s[12:13]
    s_add_u32 m0, s26, 19456
    s_nop 0
    global_load_lds_dwordx4 v23, s[12:13]
    v_add_u32 v28, 32768, v18
    ds_read_b64_tr_b16 a[160:161], v28 offset:0
    ds_read_b64_tr_b16 a[162:163], v28 offset:2048
    ds_read_b64_tr_b16 a[164:165], v28 offset:4096
    ds_read_b64_tr_b16 a[166:167], v28 offset:6144
    ds_read_b64_tr_b16 a[168:169], v28 offset:8192
    ds_read_b64_tr_b16 a[170:171], v28 offset:10240
    ds_read_b64_tr_b16 a[172:173], v28 offset:12288
    ds_read_b64_tr_b16 a[174:175], v28 offset:14336
    s_waitcnt lgkmcnt(0)
    s_waitcnt vmcnt(24)
    s_barrier
    v_add_u32 v28, 49152, v18
    ds_read_b64_tr_b16 a[176:177], v28 offset:0
    ds_read_b64_tr_b16 a[178:179], v28 offset:2048
    ds_read_b64_tr_b16 a[180:181], v28 offset:4096
    ds_read_b64_tr_b16 a[182:183], v28 offset:6144
    ds_read_b64_tr_b16 a[184:185], v28 offset:8192
    ds_read_b64_tr_b16 a[186:187], v28 offset:10240
    ds_read_b64_tr_b16 a[188:189], v28 offset:12288
    ds_read_b64_tr_b16 a[190:191], v28 offset:14336
    s_waitcnt lgkmcnt(0)
    s_waitcnt vmcnt(20)
    s_barrier
    v_add_u32 v28, 65536, v18
    ds_read_b64_tr_b16 a[192:193], v28 offset:0
    ds_read_b64_tr_b16 a[194:195], v28 offset:2048
    ds_read_b64_tr_b16 a[196:197], v28 offset:4096
    ds_read_b64_tr_b16 a[198:199], v28 offset:6144
    ds_read_b64_tr_b16 a[200:201], v28 offset:8192
    ds_read_b64_tr_b16 a[202:203], v28 offset:10240
    ds_read_b64_tr_b16 a[204:205], v28 offset:12288
    ds_read_b64_tr_b16 a[206:207], v28 offset:14336
    s_waitcnt lgkmcnt(0)
    s_waitcnt vmcnt(16)
    s_barrier
    v_add_u32 v28, 81920, v18
    ds_read_b64_tr_b16 a[208:209], v28 offset:0
    ds_read_b64_tr_b16 a[210:211], v28 offset:2048
    ds_read_b64_tr_b16 a[212:213], v28 offset:4096
    ds_read_b64_tr_b16 a[214:215], v28 offset:6144
    ds_read_b64_tr_b16 a[216:217], v28 offset:8192
    ds_read_b64_tr_b16 a[218:219], v28 offset:10240
    ds_read_b64_tr_b16 a[220:221], v28 offset:12288
    ds_read_b64_tr_b16 a[222:223], v28 offset:14336
    s_waitcnt lgkmcnt(0)
    s_waitcnt vmcnt(12)
    s_barrier
    v_add_u32 v28, 98304, v18
    ds_read_b64_tr_b16 a[224:225], v28 offset:0
    ds_read_b64_tr_b16 a[226:227], v28 offset:2048
    ds_read_b64_tr_b16 a[228:229], v28 offset:4096
    ds_read_b64_tr_b16 a[230:231], v28 offset:6144
    ds_read_b64_tr_b16 a[232:233], v28 offset:8192
    ds_read_b64_tr_b16 a[234:235], v28 offset:10240
    ds_read_b64_tr_b16 a[236:237], v28 offset:12288
    ds_read_b64_tr_b16 a[238:239], v28 offset:14336
    s_waitcnt lgkmcnt(0)
    s_waitcnt vmcnt(8)
    s_barrier
    v_add_u32 v28, 114688, v18
    ds_read_b64_tr_b16 a[240:241], v28 offset:0
    ds_read_b64_tr_b16 a[242:243], v28 offset:2048
    ds_read_b64_tr_b16 a[244:245], v28 offset:4096
    ds_read_b64_tr_b16 a[246:247], v28 offset:6144
    ds_read_b64_tr_b16 a[248:249], v28 offset:8192
    ds_read_b64_tr_b16 a[250:251], v28 offset:10240
    ds_read_b64_tr_b16 a[252:253], v28 offset:12288
    ds_read_b64_tr_b16 a[254:255], v28 offset:14336
    s_waitcnt lgkmcnt(0)
    s_waitcnt vmcnt(4)
    s_barrier
    v_add_u32 v28, 0, v18
    ds_read_b64_tr_b16 v[224:225], v28 offset:0
    ds_read_b64_tr_b16 v[226:227], v28 offset:2048
    ds_read_b64_tr_b16 v[228:229], v28 offset:4096
    ds_read_b64_tr_b16 v[230:231], v28 offset:6144
    ds_read_b64_tr_b16 v[232:233], v28 offset:8192
    ds_read_b64_tr_b16 v[234:235], v28 offset:10240
    ds_read_b64_tr_b16 v[236:237], v28 offset:12288
    ds_read_b64_tr_b16 v[238:239], v28 offset:14336
    s_waitcnt lgkmcnt(0)
    s_waitcnt vmcnt(0)
    s_barrier
    v_add_u32 v28, 16384, v18
    ds_read_b64_tr_b16 v[240:241], v28 offset:0
    ds_read_b64_tr_b16 v[242:243], v28 offset:2048
    ds_read_b64_tr_b16 v[244:245], v28 offset:4096
    ds_read_b64_tr_b16 v[246:247], v28 offset:6144
    ds_read_b64_tr_b16 v[248:249], v28 offset:8192
    ds_read_b64_tr_b16 v[250:251], v28 offset:10240
    ds_read_b64_tr_b16 v[252:253], v28 offset:12288
    ds_read_b64_tr_b16 v[254:255], v28 offset:14336
    s_waitcnt lgkmcnt(0)
    s_barrier
    v_mov_b32 v12, 0x0
    v_bfe_u32 v13, v0, 0, 2
    v_lshl_add_u32 v12, v13, 2, v12
    v_bfe_u32 v13, v0, 2, 1
    v_lshl_add_u32 v12, v13, 7, v12
    s_mov_b32 s12, 0
L_mc_70:
    global_load_dword v13, v12, s[6:7] sc1
    s_add_u32 s12, s12, 1
    s_cmp_gt_u32 s12, 100000
    s_cbranch_scc1 L_exit
    s_waitcnt vmcnt(0)
    v_and_b32 v14, 0xff, v13
    v_cmp_ne_u32 vcc, 32, v14
    s_cbranch_vccz L_mc_done_69
    v_cmp_lt_u32 vcc, 32, v14
    s_cbranch_vccnz L_exit
    s_sleep 24
    s_branch L_mc_70
L_mc_done_69:
    v_readlane_b32 s12, v13, s8
    s_mul_i32 s13, s3, s3
    s_lshl_b32 s13, s13, 10
    s_add_u32 s13, s13, s3
    s_lshl_b32 s13, s13, 8
    s_add_u32 s13, s13, 1
    s_lshl_b32 s13, s13, 5
    s_cmp_eq_u32 s12, s13
    s_cselect_b32 s11, 1, 0
    v_mov_b32 v1, 0x0
    v_bfe_u32 v12, v0, 0, 6
    v_lshl_add_u32 v1, v12, 4, v1
    v_mov_b32 v2, 0x0
    v_bfe_u32 v12, v0, 0, 4
    v_lshl_add_u32 v2, v12, 3, v2
    v_bfe_u32 v12, v0, 4, 2
    v_mul_u32_u24 v12, 0x24000, v12
    v_add_u32 v2, v2, v12
    v_bfe_u32 v12, v0, 6, 2
    v_lshl_add_u32 v2, v12, 8, v2
    v_mov_b32 v3, 0x400
    v_bfe_u32 v12, v0, 0, 4
    v_mul_u32_u24 v12, 0x9000, v12
    v_add_u32 v3, v3, v12
    v_bfe_u32 v12, v0, 4, 4
    v_lshl_add_u32 v3, v12, 3, v3
    v_mov_b32 v4, 0x0
    v_bfe_u32 v12, v0, 0, 4
    v_lshl_add_u32 v4, v12, 4, v4
    v_bfe_u32 v12, v0, 4, 2
    v_mul_u32_u24 v12, 0x480, v12
    v_add_u32 v4, v4, v12
    v_bfe_u32 v12, v0, 6, 2
    v_lshl_add_u32 v4, v12, 8, v4
    v_mov_b32 v6, 0x400
    v_bfe_u32 v12, v0, 0, 3
    v_lshl_add_u32 v6, v12, 4, v6
    v_bfe_u32 v12, v0, 3, 5
    v_mul_u32_u24 v12, 0x480, v12
    v_add_u32 v6, v6, v12
    v_mov_b32 v5, 0x16000
    v_bfe_u32 v12, v0, 0, 3
    v_lshl_add_u32 v5, v12, 3, v5
    v_bfe_u32 v12, v0, 3, 1
    v_lshl_add_u32 v5, v12, 10, v5
    v_bfe_u32 v12, v0, 4, 1
    v_lshl_add_u32 v5, v12, 2, v5
    v_bfe_u32 v12, v0, 6, 2
    v_lshl_add_u32 v5, v12, 6, v5
    v_mov_b32 v7, 0x0
    v_bfe_u32 v12, v0, 0, 6
    v_lshl_add_u32 v7, v12, 2, v7
    s_mul_i32 s12, s8, 1179648
    s_add_u32 s12, s12, 67108864
    s_mul_i32 s13, s9, 1152
    s_add_u32 s13, s13, s12
    s_add_u32 s40, s4, s13
    s_addc_u32 s41, s5, 0
    s_mul_i32 s13, s9, 36864
    s_add_u32 s13, s13, s12
    s_add_u32 s42, s4, s13
    s_addc_u32 s43, s5, 0
    s_lshl_b32 s12, s8, 7
    s_add_u32 s12, s12, 114688
    s_add_u32 s44, s4, s12
    s_addc_u32 s45, s5, 0
    s_mov_b32 s47, 0
    v_mov_b32 v81, 0x12000
    v_bfe_u32 v12, v0, 0, 6
    v_lshl_add_u32 v81, v12, 4, v81
    v_bfe_u32 v12, v0, 7, 1
    v_lshl_add_u32 v81, v12, 12, v81
    v_mov_b32 v82, 0x14000
    v_bfe_u32 v12, v0, 0, 6
    v_lshl_add_u32 v82, v12, 4, v82
    v_bfe_u32 v12, v0, 6, 2
    v_lshl_add_u32 v82, v12, 11, v82
    v_mov_b32 v87, 0x17000
    v_bfe_u32 v12, v0, 0, 4
    v_lshl_add_u32 v87, v12, 2, v87
    v_bfe_u32 v12, v0, 4, 2
    v_mul_u32_u24 v12, 0x240, v12
    v_add_u32 v87, v87, v12
    v_bfe_u32 v12, v0, 6, 2
    v_lshl_add_u32 v87, v12, 6, v87
    v_mov_b32 v83, 0x17000
    v_bfe_u32 v12, v0, 0, 1
    v_mul_u32_u24 v12, 0x120, v12
    v_add_u32 v83, v83, v12
    v_bfe_u32 v12, v0, 2, 2
    v_mul_u32_u24 v12, 0x240, v12
    v_add_u32 v83, v83, v12
    v_bfe_u32 v12, v0, 4, 2
    v_lshl_add_u32 v83, v12, 4, v83
    v_mov_b32 v109, 0x18000
    v_bfe_u32 v12, v0, 0, 8
    v_lshl_add_u32 v109, v12, 3, v109
    v_mov_b32 v84, 0x18000
    v_bfe_u32 v12, v0, 0, 6
    v_lshl_add_u32 v84, v12, 3, v84
    v_bfe_u32 v12, v0, 6, 1
    v_lshl_add_u32 v84, v12, 10, v84
    v_mov_b32 v85, 0xce6e6b28
    s_bfe_u32 s12, s9, 0x30001
    s_lshl_b32 s12, s12, 4
    v_xor_b32 v86, s12, v7
    v_mov_b32 v12, 0x0
    v_bfe_u32 v13, v0, 0, 4
    v_lshl_add_u32 v12, v13, 0, v12
    v_bfe_i32 v13, v0, 4, 1
    v_and_b32 v13, 0xfffffffc, v13
    v_add_u32 v12, v12, v13
    v_bfe_i32 v13, v0, 5, 1
    v_and_b32 v13, 0xfffffff8, v13
    v_add_u32 v12, v12, v13
    v_bfe_u32 v13, v0, 7, 1
    v_lshl_add_u32 v12, v13, 4, v12
    v_cmp_le_i32 s[64:65], 0, v12
    v_cmp_le_i32 s[66:67], 1, v12
    v_cmp_le_i32 s[68:69], 2, v12
    v_cmp_le_i32 s[70:71], 3, v12
    v_cmp_le_i32 s[72:73], 16, v12
    v_cmp_le_i32 s[74:75], 17, v12
    v_cmp_le_i32 s[76:77], 18, v12
    v_cmp_le_i32 s[78:79], 19, v12
    v_lshlrev_b32 v0, 4, v0
    s_sub_u32 s24, s8, 2
    s_mul_i32 s12, s24, 36864
    s_add_u32 s13, s12, 1048576
    s_add_u32 s20, s4, s13
    s_addc_u32 s21, s5, 0
    s_mul_i32 s13, s9, 1152
    s_add_u32 s12, s12, s13
    s_add_u32 s34, s34, s12
    s_addc_u32 s35, s35, 0
    s_add_u32 s13, s12, 7340032
    s_add_u32 s36, s4, s13
    s_addc_u32 s37, s5, 0
    s_add_u32 s13, s12, 4194304
    s_add_u32 s38, s4, s13
    s_addc_u32 s39, s5, 0
    s_lshl_b32 s12, s24, 5
    s_add_u32 s12, s12, s9
    s_lshl_b32 s13, s12, 14
    s_add_u32 s13, s13, 16781312
    s_add_u32 s22, s4, s13
    s_addc_u32 s23, s5, 0
    s_lshl_b32 s13, s12, 12
    s_add_u32 s13, s13, 50331648
    s_add_u32 s30, s4, s13
    s_addc_u32 s31, s5, 0
    s_lshl_b32 s13, s12, 2
    s_add_u32 s13, s13, 106496
    s_add_u32 s52, s4, s13
    s_addc_u32 s53, s5, 0
    s_lshl_b32 s12, s9, 7
    s_add_u32 s13, s12, 69632
    s_add_u32 s54, s4, s13
    s_addc_u32 s55, s5, 0
    s_add_u32 s13, s12, 98304
    s_add_u32 s56, s4, s13
    s_addc_u32 s57, s5, 0
    s_mov_b32 s58, 0
    s_mov_b32 s59, 0
    s_lshl_b32 s26, s10, 10
    s_mov_b32 s27, 0
    s_mov_b32 s60, 0x3db504f3
    s_mov_b32 s61, 0x3fb8aa3b
    s_cmp_lg_u32 s10, 0
    s_cbranch_scc1 L_hw_71
    v_mbcnt_lo_u32_b32 v12, -1, 0
    v_mbcnt_hi_u32_b32 v12, -1, v12
    v_min_u32 v12, 47, v12
    v_lshlrev_b32 v12, 3, v12
    v_add_u32 v12, 118784, v12
    s_mov_b32 s12, 0
L_hwl_72:
    global_load_dwordx2 v[14:15], v12, s[4:5] sc1
    s_add_u32 s12, s12, 1
    s_cmp_gt_u32 s12, 100000
    s_cbranch_scc1 L_exit
    s_waitcnt vmcnt(0)
    v_and_b32 v14, v14, v15
    v_cmp_eq_u32 vcc, 0, v14
    s_cbranch_vccz L_hw_71
    s_sleep 6
    s_branch L_hwl_72
L_hw_71:
    s_barrier
    s_cmp_lg_u32 s10, 0
    s_cbranch_scc1 L_cwd_74
    v_mov_b32 v12, 32
    s_mov_b32 s12, 0
L_cw_73:
    global_load_dword v13, v12, s[6:7] sc1
    s_add_u32 s12, s12, 1
    s_cmp_gt_u32 s12, 100000
    s_cbranch_scc1 L_exit
    s_waitcnt vmcnt(0)
    v_cmp_gt_u32 vcc, 36, v13
    s_cbranch_vccz L_cwd_74
    s_sleep 12
    s_branch L_cw_73
L_cwd_74:
    s_barrier
    s_add_u32 s12, s4, 2304
    s_addc_u32 s13, s5, 0
    global_load_dword v88, v7, s[12:13] offset:0 sc1
    global_load_dword v89, v7, s[12:13] offset:256 sc1
    global_load_dword v90, v7, s[12:13] offset:512 sc1
    global_load_dword v91, v7, s[12:13] offset:768 sc1
    global_load_dword v92, v7, s[12:13] offset:1024 sc1
    s_add_u32 s12, s4, 4608
    s_addc_u32 s13, s5, 0
    global_load_dword v93, v7, s[12:13] offset:0 sc1
    global_load_dword v94, v7, s[12:13] offset:256 sc1
    global_load_dword v95, v7, s[12:13] offset:512 sc1
    global_load_dword v96, v7, s[12:13] offset:768 sc1
    global_load_dword v97, v7, s[12:13] offset:1024 sc1
    s_add_u32 s12, s4, 3456
    s_addc_u32 s13, s5, 0
    global_load_dword v98, v7, s[12:13] offset:0 sc1
    global_load_dword v99, v7, s[12:13] offset:256 sc1
    global_load_dword v100, v7, s[12:13] offset:512 sc1
    global_load_dword v101, v7, s[12:13] offset:768 sc1
    global_load_dword v102, v7, s[12:13] offset:1024 sc1
    s_mov_b64 s[12:13], s[20:21]
    s_add_u32 m0, s26, 0
    s_nop 0
    global_load_lds_dwordx4 v0, s[12:13]
    s_add_u32 s12, s12, 4096
    s_addc_u32 s13, s13, 0
    s_add_u32 m0, s26, 4096
    s_nop 0
    global_load_lds_dwordx4 v0, s[12:13]
    s_add_u32 s12, s12, 4096
    s_addc_u32 s13, s13, 0
    s_add_u32 m0, s26, 8192
    s_nop 0
    global_load_lds_dwordx4 v0, s[12:13]
    s_add_u32 s12, s12, 4096
    s_addc_u32 s13, s13, 0
    s_add_u32 m0, s26, 12288
    s_nop 0
    global_load_lds_dwordx4 v0, s[12:13]
    s_add_u32 s12, s12, 4096
    s_addc_u32 s13, s13, 0
    s_add_u32 m0, s26, 16384
    s_nop 0
    global_load_lds_dwordx4 v0, s[12:13]
    s_add_u32 s12, s12, 4096
    s_addc_u32 s13, s13, 0
    s_add_u32 m0, s26, 20480
    s_nop 0
    global_load_lds_dwordx4 v0, s[12:13]
    s_add_u32 s12, s12, 4096
    s_addc_u32 s13, s13, 0
    s_add_u32 m0, s26, 24576
    s_nop 0
    global_load_lds_dwordx4 v0, s[12:13]
    s_add_u32 s12, s12, 4096
    s_addc_u32 s13, s13, 0
    s_add_u32 m0, s26, 28672
    s_nop 0
    global_load_lds_dwordx4 v0, s[12:13]
    s_add_u32 s12, s12, 4096
    s_addc_u32 s13, s13, 0
    s_add_u32 m0, s26, 32768
    s_nop 0
    global_load_lds_dwordx4 v0, s[12:13]
    s_add_u32 s20, s20, 110592
    s_addc_u32 s21, s21, 0
    s_xor_b32 s26, s26, 36864
    s_waitcnt vmcnt(0)
    s_cmp_eq_u32 s11, 0
    s_cbranch_scc1 L_a_top_s
L_a_top_f:
    s_add_u32 s25, s24, 1
    s_cmp_ge_u32 s58, s25
    s_cbranch_scc1 L_cw_75
    v_and_b32 v8, 12, v7
    s_mov_b32 s12, 0
L_fw_76:
    global_load_dword v9, v8, s[54:55] sc1
    s_add_u32 s12, s12, 1
    s_cmp_gt_u32 s12, 100000
    s_cbranch_scc1 L_exit
    s_waitcnt vmcnt(0)
    v_cmp_gt_u32 vcc, s25, v9
    s_cbranch_vccz L_fwd_77
    s_sleep 16
    s_branch L_fw_76
L_fwd_77:
    v_min_u32_dpp v9, v9, v9 quad_perm:[1,0,3,2] row_mask:0xf bank_mask:0xf
    s_nop 1
    v_min_u32_dpp v9, v9, v9 quad_perm:[2,3,0,1] row_mask:0xf bank_mask:0xf
    s_nop 0
    v_readfirstlane_b32 s58, v9
L_cw_75:
    global_load_dwordx4 v[112:115], v1, s[22:23] offset:-4096
    global_load_dwordx4 v[116:119], v1, s[22:23] offset:-3072
    global_load_dwordx4 v[120:123], v1, s[22:23] offset:-2048
    global_load_dwordx4 v[124:127], v1, s[22:23] offset:-1024
    global_load_dwordx4 v[128:131], v1, s[22:23] offset:0
    global_load_dwordx4 v[132:135], v1, s[22:23] offset:1024
    global_load_dwordx4 v[136:139], v1, s[22:23] offset:2048
    global_load_dwordx4 v[140:143], v1, s[22:23] offset:3072
    s_and_b32 s12, s10, 1
    s_lshl_b32 s12, s12, 12
    s_add_u32 s12, s12, 4096
    s_add_u32 s12, s22, s12
    s_addc_u32 s13, s23, 0
    global_load_dwordx4 v[144:147], v1, s[12:13] offset:0
    global_load_dwordx4 v[148:151], v1, s[12:13] offset:1024
    global_load_dwordx4 v[152:155], v1, s[12:13] offset:2048
    global_load_dwordx4 v[156:159], v1, s[12:13] offset:3072
    s_mov_b32 exec_hi, 0
    global_load_dword v108, v7, s[34:35] offset:1024
    s_mov_b64 exec, -1
    global_load_dword v104, v7, s[34:35] offset:0
    global_load_dword v105, v7, s[34:35] offset:256
    global_load_dword v106, v7, s[34:35] offset:512
    global_load_dword v107, v7, s[34:35] offset:768
    v_add_u32 v80, s27, v1
    s_barrier
    ds_read_b128 v[24:27], v80 offset:0
    ds_read_b128 v[28:31], v80 offset:18432
    ds_read_b128 v[32:35], v80 offset:1024
    ds_read_b128 v[36:39], v80 offset:19456
    ds_read_b128 v[40:43], v80 offset:2048
    s_mov_b64 s[12:13], s[20:21]
    s_add_u32 m0, s26, 0
    s_nop 0
    global_load_lds_dwordx4 v0, s[12:13]
    s_add_u32 s12, s12, 4096
    s_addc_u32 s13, s13, 0
    s_add_u32 m0, s26, 4096
    s_nop 0
    global_load_lds_dwordx4 v0, s[12:13]
    s_add_u32 s12, s12, 4096
    s_addc_u32 s13, s13, 0
    s_add_u32 m0, s26, 8192
    s_nop 0
    global_load_lds_dwordx4 v0, s[12:13]
    s_add_u32 s12, s12, 4096
    s_addc_u32 s13, s13, 0
    s_add_u32 m0, s26, 12288
    s_nop 0
    global_load_lds_dwordx4 v0, s[12:13]
    s_add_u32 s12, s12, 4096
    s_addc_u32 s13, s13, 0
    s_add_u32 m0, s26, 16384
    s_nop 0
    global_load_lds_dwordx4 v0, s[12:13]
    s_add_u32 s12, s12, 4096
    s_addc_u32 s13, s13, 0
    s_add_u32 m0, s26, 20480
    s_nop 0
    global_load_lds_dwordx4 v0, s[12:13]
    s_add_u32 s12, s12, 4096
    s_addc_u32 s13, s13, 0
    s_add_u32 m0, s26, 24576
    s_nop 0
    global_load_lds_dwordx4 v0, s[12:13]
    s_add_u32 s12, s12, 4096
    s_addc_u32 s13, s13, 0
    s_add_u32 m0, s26, 28672
    s_nop 0
    global_load_lds_dwordx4 v0, s[12:13]
    s_add_u32 s12, s12, 4096
    s_addc_u32 s13, s13, 0
    s_add_u32 m0, s26, 32768
    s_nop 0
    global_load_lds_dwordx4 v0, s[12:13]
    s_add_u32 s20, s20, 110592
    s_addc_u32 s21, s21, 0
    s_xor_b32 s26, s26, 36864
    s_xor_b32 s27, s27, 36864
    ds_read_b128 v[44:47], v80 offset:20480
    s_waitcnt lgkmcnt(5)
    v_mfma_f32_16x16x32_bf16 v[8:11], a[0:3], v[24:27], 0
    v_mfma_f32_16x16x32_bf16 v[16:19], a[4:7], v[24:27], 0
    ds_read_b128 v[24:27], v80 offset:3072
    s_waitcnt lgkmcnt(5)
    v_mfma_f32_16x16x32_bf16 v[12:15], a[0:3], v[28:31], 0
    v_mfma_f32_16x16x32_bf16 v[20:23], a[4:7], v[28:31], 0
    ds_read_b128 v[28:31], v80 offset:21504
    s_waitcnt lgkmcnt(5)
    v_mfma_f32_16x16x32_bf16 v[8:11], a[8:11], v[32:35], v[8:11]
    v_mfma_f32_16x16x32_bf16 v[16:19], a[12:15], v[32:35], v[16:19]
    ds_read_b128 v[32:35], v80 offset:4096
    s_waitcnt lgkmcnt(5)
    v_mfma_f32_16x16x32_bf16 v[12:15], a[8:11], v[36:39], v[12:15]
    v_mfma_f32_16x16x32_bf16 v[20:23], a[12:15], v[36:39], v[20:23]
    ds_read_b128 v[36:39], v80 offset:22528
    s_waitcnt lgkmcnt(5)
    v_mfma_f32_16x16x32_bf16 v[8:11], a[16:19], v[40:43], v[8:11]
    v_mfma_f32_16x16x32_bf16 v[16:19], a[20:23], v[40:43], v[16:19]
    ds_read_b128 v[40:43], v80 offset:5120
    s_waitcnt lgkmcnt(5)
    v_mfma_f32_16x16x32_bf16 v[12:15], a[16:19], v[44:47], v[12:15]
    v_mfma_f32_16x16x32_bf16 v[20:23], a[20:23], v[44:47], v[20:23]
    ds_read_b128 v[44:47], v80 offset:23552
    s_waitcnt lgkmcnt(5)
    v_mfma_f32_16x16x32_bf16 v[8:11], a[24:27], v[24:27], v[8:11]
    v_mfma_f32_16x16x32_bf16 v[16:19], a[28:31], v[24:27], v[16:19]
    ds_read_b128 v[24:27], v80 offset:6144
    s_waitcnt lgkmcnt(5)
    v_mfma_f32_16x16x32_bf16 v[12:15], a[24:27], v[28:31], v[12:15]
    v_mfma_f32_16x16x32_bf16 v[20:23], a[28:31], v[28:31], v[20:23]
    ds_read_b128 v[28:31], v80 offset:24576
    s_waitcnt lgkmcnt(5)
    v_mfma_f32_16x16x32_bf16 v[8:11], a[32:35], v[32:35], v[8:11]
    v_mfma_f32_16x16x32_bf16 v[16:19], a[36:39], v[32:35], v[16:19]
    ds_read_b128 v[32:35], v80 offset:7168
    s_waitcnt lgkmcnt(5)
    v_mfma_f32_16x16x32_bf16 v[12:15], a[32:35], v[36:39], v[12:15]
    v_mfma_f32_16x16x32_bf16 v[20:23], a[36:39], v[36:39], v[20:23]
    ds_read_b128 v[36:39], v80 offset:25600
    s_waitcnt lgkmcnt(5)
    v_mfma_f32_16x16x32_bf16 v[8:11], a[40:43], v[40:43], v[8:11]
    v_mfma_f32_16x16x32_bf16 v[16:19], a[44:47], v[40:43], v[16:19]
    ds_read_b128 v[40:43], v80 offset:8192
    s_waitcnt lgkmcnt(5)
    v_mfma_f32_16x16x32_bf16 v[12:15], a[40:43], v[44:47], v[12:15]
    v_mfma_f32_16x16x32_bf16 v[20:23], a[44:47], v[44:47], v[20:23]
    ds_read_b128 v[44:47], v80 offset:26624
    s_waitcnt lgkmcnt(5)
    v_mfma_f32_16x16x32_bf16 v[8:11], a[48:51], v[24:27], v[8:11]
    v_mfma_f32_16x16x32_bf16 v[16:19], a[52:55], v[24:27], v[16:19]
    ds_read_b128 v[24:27], v80 offset:9216
    s_waitcnt lgkmcnt(5)
    v_mfma_f32_16x16x32_bf16 v[12:15], a[48:51], v[28:31], v[12:15]
    v_mfma_f32_16x16x32_bf16 v[20:23], a[52:55], v[28:31], v[20:23]
    ds_read_b128 v[28:31], v80 offset:27648
    s_waitcnt lgkmcnt(5)
    v_mfma_f32_16x16x32_bf16 v[8:11], a[56:59], v[32:35], v[8:11]
    v_mfma_f32_16x16x32_bf16 v[16:19], a[60:63], v[32:35], v[16:19]
    ds_read_b128 v[32:35], v80 offset:10240
    s_waitcnt lgkmcnt(5)
    v_mfma_f32_16x16x32_bf16 v[12:15], a[56:59], v[36:39], v[12:15]
    v_mfma_f32_16x16x32_bf16 v[20:23], a[60:63], v[36:39], v[20:23]
    ds_read_b128 v[36:39], v80 offset:28672
    s_waitcnt lgkmcnt(5)
    v_mfma_f32_16x16x32_bf16 v[8:11], a[64:67], v[40:43], v[8:11]
    v_mfma_f32_16x16x32_bf16 v[16:19], a[68:71], v[40:43], v[16:19]
    ds_read_b128 v[40:43], v80 offset:11264
    s_waitcnt lgkmcnt(5)
    v_mfma_f32_16x16x32_bf16 v[12:15], a[64:67], v[44:47], v[12:15]
    v_mfma_f32_16x16x32_bf16 v[20:23], a[68:71], v[44:47], v[20:23]
    ds_read_b128 v[44:47], v80 offset:29696
    s_waitcnt lgkmcnt(5)
    v_mfma_f32_16x16x32_bf16 v[8:11], a[72:75], v[24:27], v[8:11]
    v_mfma_f32_16x16x32_bf16 v[16:19], a[76:79], v[24:27], v[16:19]
    ds_read_b128 v[24:27], v80 offset:12288
    s_waitcnt lgkmcnt(5)
    v_mfma_f32_16x16x32_bf16 v[12:15], a[72:75], v[28:31], v[12:15]
    v_mfma_f32_16x16x32_bf16 v[20:23], a[76:79], v[28:31], v[20:23]
    ds_read_b128 v[28:31], v80 offset:30720
    s_waitcnt lgkmcnt(5)
    v_mfma_f32_16x16x32_bf16 v[8:11], a[80:83], v[32:35], v[8:11]
    v_mfma_f32_16x16x32_bf16 v[16:19], a[84:87], v[32:35], v[16:19]
    ds_read_b128 v[32:35], v80 offset:13312
    s_waitcnt lgkmcnt(5)
    v_mfma_f32_16x16x32_bf16 v[12:15], a[80:83], v[36:39], v[12:15]
    v_mfma_f32_16x16x32_bf16 v[20:23], a[84:87], v[36:39], v[20:23]
    ds_read_b128 v[36:39], v80 offset:31744
    s_waitcnt lgkmcnt(5)
    v_mfma_f32_16x16x32_bf16 v[8:11], a[88:91], v[40:43], v[8:11]
    v_mfma_f32_16x16x32_bf16 v[16:19], a[92:95], v[40:43], v[16:19]
    ds_read_b128 v[40:43], v80 offset:14336
    s_waitcnt lgkmcnt(5)
    v_mfma_f32_16x16x32_bf16 v[12:15], a[88:91], v[44:47], v[12:15]
    v_mfma_f32_16x16x32_bf16 v[20:23], a[92:95], v[44:47], v[20:23]
    ds_read_b128 v[44:47], v80 offset:32768
    s_waitcnt lgkmcnt(5)
    v_mfma_f32_16x16x32_bf16 v[8:11], a[96:99], v[24:27], v[8:11]
    v_mfma_f32_16x16x32_bf16 v[16:19], a[100:103], v[24:27], v[16:19]
    ds_read_b128 v[24:27], v80 offset:15360
    s_waitcnt lgkmcnt(5)
    v_mfma_f32_16x16x32_bf16 v[12:15], a[96:99], v[28:31], v[12:15]
    v_mfma_f32_16x16x32_bf16 v[20:23], a[100:103], v[28:31], v[20:23]
    ds_read_b128 v[28:31], v80 offset:33792
    s_waitcnt lgkmcnt(5)
    v_mfma_f32_16x16x32_bf16 v[8:11], a[104:107], v[32:35], v[8:11]
    v_mfma_f32_16x16x32_bf16 v[16:19], a[108:111], v[32:35], v[16:19]
    ds_read_b128 v[32:35], v80 offset:16384
    s_waitcnt lgkmcnt(5)
    v_mfma_f32_16x16x32_bf16 v[12:15], a[104:107], v[36:39], v[12:15]
    v_mfma_f32_16x16x32_bf16 v[20:23], a[108:111], v[36:39], v[20:23]
    ds_read_b128 v[36:39], v80 offset:34816
    s_waitcnt lgkmcnt(5)
    v_mfma_f32_16x16x32_bf16 v[8:11], a[112:115], v[40:43], v[8:11]
    v_mfma_f32_16x16x32_bf16 v[16:19], a[116:119], v[40:43], v[16:19]
    ds_read_b128 v[40:43], v80 offset:17408
    s_waitcnt lgkmcnt(5)
    v_mfma_f32_16x16x32_bf16 v[12:15], a[112:115], v[44:47], v[12:15]
    v_mfma_f32_16x16x32_bf16 v[20:23], a[116:119], v[44:47], v[20:23]
    ds_read_b128 v[44:47], v80 offset:35840
    s_waitcnt lgkmcnt(5)
    v_mfma_f32_16x16x32_bf16 v[8:11], a[120:123], v[24:27], v[8:11]
    v_mfma_f32_16x16x32_bf16 v[16:19], a[124:127], v[24:27], v[16:19]
    s_waitcnt lgkmcnt(4)
    v_mfma_f32_16x16x32_bf16 v[12:15], a[120:123], v[28:31], v[12:15]
    v_mfma_f32_16x16x32_bf16 v[20:23], a[124:127], v[28:31], v[20:23]
    s_waitcnt lgkmcnt(3)
    v_mfma_f32_16x16x32_bf16 v[8:11], a[128:131], v[32:35], v[8:11]
    v_mfma_f32_16x16x32_bf16 v[16:19], a[132:135], v[32:35], v[16:19]
    s_waitcnt lgkmcnt(2)
    v_mfma_f32_16x16x32_bf16 v[12:15], a[128:131], v[36:39], v[12:15]
    v_mfma_f32_16x16x32_bf16 v[20:23], a[132:135], v[36:39], v[20:23]
    s_waitcnt lgkmcnt(1)
    v_mfma_f32_16x16x32_bf16 v[8:11], a[136:139], v[40:43], v[8:11]
    v_mfma_f32_16x16x32_bf16 v[16:19], a[140:143], v[40:43], v[16:19]
    s_waitcnt lgkmcnt(0)
    v_mfma_f32_16x16x32_bf16 v[12:15], a[136:139], v[44:47], v[12:15]
    v_mfma_f32_16x16x32_bf16 v[20:23], a[140:143], v[44:47], v[20:23]
    s_nop 4
    v_cvt_pk_bf16_f32 v48, v8, v16
    v_cvt_pk_bf16_f32 v49, v9, v17
    v_cvt_pk_bf16_f32 v50, v10, v18
    v_cvt_pk_bf16_f32 v51, v11, v19
    v_add_u32 v56, 73728, v0
    ds_write_b128 v56, v[48:51]
    v_cvt_pk_bf16_f32 v52, v12, v20
    v_cvt_pk_bf16_f32 v53, v13, v21
    v_cvt_pk_bf16_f32 v54, v14, v22
    v_cvt_pk_bf16_f32 v55, v15, v23
    v_add_u32 v56, 77824, v0
    ds_write_b128 v56, v[52:55]
    s_waitcnt lgkmcnt(0)
    s_barrier
    ds_read_b128 v[24:27], v81 offset:0
    ds_read_b128 v[28:31], v81 offset:1024
    ds_read_b128 v[32:35], v81 offset:2048
    ds_read_b128 v[36:39], v81 offset:3072
    s_waitcnt vmcnt(9) lgkmcnt(0)
    v_mfma_f32_16x16x32_bf16 v[8:11], v[112:115], v[24:27], 0
    v_mfma_f32_16x16x32_bf16 v[12:15], v[128:131], v[24:27], 0
    v_mfma_f32_16x16x32_bf16 v[8:11], v[116:119], v[28:31], v[8:11]
    v_mfma_f32_16x16x32_bf16 v[12:15], v[132:135], v[28:31], v[12:15]
    v_mfma_f32_16x16x32_bf16 v[8:11], v[120:123], v[32:35], v[8:11]
    v_mfma_f32_16x16x32_bf16 v[12:15], v[136:139], v[32:35], v[12:15]
    v_mfma_f32_16x16x32_bf16 v[8:11], v[124:127], v[36:39], v[8:11]
    v_mfma_f32_16x16x32_bf16 v[12:15], v[140:143], v[36:39], v[12:15]
    v_and_b32 v40, 0x7c, v7
    v_add_u32 v40, 1024, v40
    s_mov_b32 s12, 0
L_fw_78:
    global_load_dword v41, v40, s[44:45] sc1
    s_add_u32 s12, s12, 1
    s_cmp_gt_u32 s12, 100000
    s_cbranch_scc1 L_exit
    s_waitcnt vmcnt(0)
    v_cmp_gt_u32 vcc, s47, v41
    s_cbranch_vccz L_fwd_79
    s_branch L_fw_78
L_fwd_79:
    v_cvt_pk_bf16_f32 v9, v8, v9
    v_lshlrev_b32 v8, 16, v9
    v_and_b32 v9, 0xffff0000, v9
    v_pk_mul_f32 v[8:9], v[8:9], s[60:61] op_sel_hi:[1,0]
    v_cvt_pk_bf16_f32 v9, v8, v9
    v_lshlrev_b32 v8, 16, v9
    v_and_b32 v9, 0xffff0000, v9
    v_cvt_pk_bf16_f32 v11, v10, v11
    v_lshlrev_b32 v10, 16, v11
    v_and_b32 v11, 0xffff0000, v11
    v_pk_mul_f32 v[10:11], v[10:11], s[60:61] op_sel_hi:[1,0]
    v_cvt_pk_bf16_f32 v11, v10, v11
    v_lshlrev_b32 v10, 16, v11
    v_and_b32 v11, 0xffff0000, v11
    v_cvt_pk_bf16_f32 v13, v12, v13
    v_lshlrev_b32 v12, 16, v13
    v_and_b32 v13, 0xffff0000, v13
    v_pk_mul_f32 v[12:13], v[12:13], s[60:61] op_sel_hi:[1,0]
    v_cvt_pk_bf16_f32 v13, v12, v13
    v_lshlrev_b32 v12, 16, v13
    v_and_b32 v13, 0xffff0000, v13
    v_cvt_pk_bf16_f32 v15, v14, v15
    v_lshlrev_b32 v14, 16, v15
    v_and_b32 v15, 0xffff0000, v15
    v_pk_mul_f32 v[14:15], v[14:15], s[60:61] op_sel_hi:[1,0]
    v_cvt_pk_bf16_f32 v15, v14, v15
    v_lshlrev_b32 v14, 16, v15
    v_and_b32 v15, 0xffff0000, v15
    v_cndmask_b32 v8, v85, v8, s[64:65]
    v_cndmask_b32 v9, v85, v9, s[66:67]
    v_cndmask_b32 v10, v85, v10, s[68:69]
    v_cndmask_b32 v11, v85, v11, s[70:71]
    v_cndmask_b32 v12, v85, v12, s[72:73]
    v_cndmask_b32 v13, v85, v13, s[74:75]
    v_cndmask_b32 v14, v85, v14, s[76:77]
    v_cndmask_b32 v15, v85, v15, s[78:79]
    v_max3_f32 v20, v8, v9, v10
    v_max3_f32 v20, v20, v11, v12
    v_max3_f32 v20, v20, v13, v14
    v_max_f32 v20, v20, v15
    s_mov_b32 s12, 0
L_km_80:
    global_load_dwordx4 v[40:43], v0, s[30:31] sc1
    s_add_u32 s12, s12, 1
    s_cmp_gt_u32 s12, 100000
    s_cbranch_scc1 L_exit
    s_waitcnt vmcnt(0)
    ds_write2_b32 v87, v40, v41 offset0:0 offset1:72
    ds_write_b64 v109, v[42:43]
    v_max3_u32 v44, v40, v41, v42
    v_max_u32 v44, v44, v43
    v_cmp_eq_u32 vcc, -1, v44
    s_cbranch_vccz L_kmok_81
    s_sleep 1
    s_branch L_km_80
L_kmok_81:
    s_waitcnt lgkmcnt(0)
    s_barrier
    ds_read_b128 v[160:163], v83 offset:0
    ds_read_b128 v[164:167], v83 offset:64
    ds_read_b128 v[168:171], v83 offset:128
    ds_read_b128 v[172:175], v83 offset:192
    ds_read_b64 v[176:177], v84 offset:0
    ds_read_b64 v[178:179], v84 offset:512
    s_waitcnt lgkmcnt(5)
    v_mfma_f32_16x16x32_bf16 v[16:19], v[160:163], v[24:27], 0
    s_waitcnt lgkmcnt(4)
    v_mfma_f32_16x16x32_bf16 v[16:19], v[164:167], v[28:31], v[16:19]
    s_waitcnt lgkmcnt(3)
    v_mfma_f32_16x16x32_bf16 v[16:19], v[168:171], v[32:35], v[16:19]
    s_waitcnt lgkmcnt(2)
    v_mfma_f32_16x16x32_bf16 v[16:19], v[172:175], v[36:39], v[16:19]
    s_nop 7
    v_cvt_pk_bf16_f32 v17, v16, v17
    v_lshlrev_b32 v16, 16, v17
    v_and_b32 v17, 0xffff0000, v17
    v_pk_mul_f32 v[16:17], v[16:17], s[60:61] op_sel_hi:[1,0]
    v_cvt_pk_bf16_f32 v17, v16, v17
    v_lshlrev_b32 v16, 16, v17
    v_and_b32 v17, 0xffff0000, v17
    v_max3_f32 v20, v20, v16, v17
    v_mov_b32 v21, v20
    s_nop 1
    v_permlane16_swap_b32 v20, v21
    v_max_f32 v20, v20, v21
    v_mov_b32 v21, v20
    s_nop 1
    v_permlane32_swap_b32 v20, v21
    v_max_f32 v20, v20, v21
    v_pk_add_f32 v[8:9], v[8:9], v[20:21] op_sel_hi:[1,0] neg_lo:[0,1] neg_hi:[0,1]
    v_pk_add_f32 v[10:11], v[10:11], v[20:21] op_sel_hi:[1,0] neg_lo:[0,1] neg_hi:[0,1]
    v_pk_add_f32 v[12:13], v[12:13], v[20:21] op_sel_hi:[1,0] neg_lo:[0,1] neg_hi:[0,1]
    v_pk_add_f32 v[14:15], v[14:15], v[20:21] op_sel_hi:[1,0] neg_lo:[0,1] neg_hi:[0,1]
    v_pk_add_f32 v[16:17], v[16:17], v[20:21] op_sel_hi:[1,0] neg_lo:[0,1] neg_hi:[0,1]
    v_pk_mul_f32 v[8:9], v[8:9], s[60:61] op_sel:[0,1]
    v_pk_mul_f32 v[10:11], v[10:11], s[60:61] op_sel:[0,1]
    v_pk_mul_f32 v[12:13], v[12:13], s[60:61] op_sel:[0,1]
    v_pk_mul_f32 v[14:15], v[14:15], s[60:61] op_sel:[0,1]
    v_pk_mul_f32 v[16:17], v[16:17], s[60:61] op_sel:[0,1]
    v_exp_f32 v8, v8
    v_exp_f32 v9, v9
    v_exp_f32 v10, v10
    v_exp_f32 v11, v11
    v_exp_f32 v12, v12
    v_exp_f32 v13, v13
    v_exp_f32 v14, v14
    v_exp_f32 v15, v15
    v_exp_f32 v16, v16
    v_exp_f32 v17, v17
    v_pk_add_f32 v[22:23], v[8:9], v[10:11]
    v_pk_add_f32 v[22:23], v[22:23], v[12:13]
    v_pk_add_f32 v[22:23], v[22:23], v[14:15]
    v_pk_add_f32 v[22:23], v[22:23], v[16:17]
    v_add_f32 v22, v22, v23
    v_mov_b32 v21, v22
    s_nop 1
    v_permlane16_swap_b32 v22, v21
    v_add_f32 v22, v22, v21
    v_mov_b32 v21, v22
    s_nop 1
    v_permlane32_swap_b32 v22, v21
    v_add_f32 v22, v22, v21
    v_rcp_f32 v22, v22
    s_nop 0
    v_pk_mul_f32 v[8:9], v[8:9], v[22:23] op_sel_hi:[1,0]
    v_pk_mul_f32 v[10:11], v[10:11], v[22:23] op_sel_hi:[1,0]
    v_pk_mul_f32 v[12:13], v[12:13], v[22:23] op_sel_hi:[1,0]
    v_pk_mul_f32 v[14:15], v[14:15], v[22:23] op_sel_hi:[1,0]
    v_pk_mul_f32 v[16:17], v[16:17], v[22:23] op_sel_hi:[1,0]
    v_cvt_pk_bf16_f32 v40, v8, v9
    v_cvt_pk_bf16_f32 v41, v10, v11
    v_cvt_pk_bf16_f32 v42, v12, v13
    v_cvt_pk_bf16_f32 v43, v14, v15
    v_cvt_pk_bf16_f32 v44, v16, v17
    v_mov_b32 v45, 0
    v_mov_b32 v46, 0
    v_mov_b32 v47, v44
    v_mfma_f32_16x16x32_bf16 v[24:27], v[144:147], v[40:43], 0
    v_mfma_f32_16x16x32_bf16 v[28:31], v[148:151], v[40:43], 0
    v_mfma_f32_16x16x32_bf16 v[32:35], v[152:155], v[40:43], 0
    v_mfma_f32_16x16x32_bf16 v[36:39], v[156:159], v[40:43], 0
    s_waitcnt lgkmcnt(0)
    s_nop 1
    v_mfma_f32_16x16x16_bf16 v[24:27], v[176:177], v[44:45], v[24:27]
    v_mfma_f32_16x16x16_bf16 v[28:31], v[176:177], v[46:47], v[28:31]
    v_mfma_f32_16x16x16_bf16 v[32:35], v[178:179], v[44:45], v[32:35]
    v_mfma_f32_16x16x16_bf16 v[36:39], v[178:179], v[46:47], v[36:39]
    s_nop 4
    v_cvt_pk_bf16_f32 v48, v24, v25
    v_cvt_pk_bf16_f32 v49, v26, v27
    v_cvt_pk_bf16_f32 v50, v28, v29
    v_cvt_pk_bf16_f32 v51, v30, v31
    v_cvt_pk_bf16_f32 v52, v32, v33
    v_cvt_pk_bf16_f32 v53, v34, v35
    v_cvt_pk_bf16_f32 v54, v36, v37
    v_cvt_pk_bf16_f32 v55, v38, v39
    ds_write_b128 v82, v[48:51]
    ds_write_b128 v82, v[52:55] offset:1024
    s_waitcnt lgkmcnt(0)
    s_barrier
    v_add_u32 v1, 81920, v1
    s_add_u32 s47, s47, 1
    s_xor_b32 s46, s47, s9
    s_and_b32 s46, s46, 1
    v_mov_b32 v24, s46
    ds_read_b128 v[8:11], v1 offset:0
    ds_read_b128 v[12:15], v1 offset:1024
    ds_read_b128 v[16:19], v1 offset:2048
    ds_read_b128 v[20:23], v1 offset:3072
    s_waitcnt lgkmcnt(3)
    v_mfma_f32_16x16x32_bf16 v[28:31], v[240:243], v[8:11], 0
    v_mfma_f32_16x16x32_bf16 v[32:35], v[8:11], a[144:147], 0
    v_mfma_f32_16x16x32_bf16 v[36:39], v[8:11], a[160:163], 0
    s_waitcnt lgkmcnt(2)
    v_mfma_f32_16x16x32_bf16 v[28:31], v[244:247], v[12:15], v[28:31]
    v_mfma_f32_16x16x32_bf16 v[32:35], v[12:15], a[148:151], v[32:35]
    v_mfma_f32_16x16x32_bf16 v[36:39], v[12:15], a[164:167], v[36:39]
    s_waitcnt lgkmcnt(1)
    v_mfma_f32_16x16x32_bf16 v[28:31], v[248:251], v[16:19], v[28:31]
    v_mfma_f32_16x16x32_bf16 v[32:35], v[16:19], a[152:155], v[32:35]
    v_mfma_f32_16x16x32_bf16 v[36:39], v[16:19], a[168:171], v[36:39]
    s_waitcnt lgkmcnt(0)
    v_mfma_f32_16x16x32_bf16 v[28:31], v[252:255], v[20:23], v[28:31]
    v_mfma_f32_16x16x32_bf16 v[32:35], v[20:23], a[156:159], v[32:35]
    v_mfma_f32_16x16x32_bf16 v[36:39], v[20:23], a[172:175], v[36:39]
    v_mfma_f32_16x16x32_bf16 v[40:43], v[8:11], a[176:179], 0
    v_mfma_f32_16x16x32_bf16 v[44:47], v[8:11], a[192:195], 0
    v_mfma_f32_16x16x32_bf16 v[40:43], v[12:15], a[180:183], v[40:43]
    v_mfma_f32_16x16x32_bf16 v[44:47], v[12:15], a[196:199], v[44:47]
    s_nop 1
    v_cvt_pk_bf16_f32 v28, v28, v29
    v_cvt_pk_bf16_f32 v29, v30, v31
    v_mfma_f32_16x16x32_bf16 v[40:43], v[16:19], a[184:187], v[40:43]
    v_bfi_b32 v28, 1, v24, v28
    s_add_u32 s12, s40, 0
    s_addc_u32 s13, s41, 0
    global_store_dwordx2 v3, v[28:29], s[12:13]
    v_mfma_f32_16x16x32_bf16 v[44:47], v[16:19], a[200:203], v[44:47]
    v_cvt_pk_bf16_f32 v52, v32, v36
    v_cvt_pk_bf16_f32 v56, v33, v37
    v_mfma_f32_16x16x32_bf16 v[40:43], v[20:23], a[188:191], v[40:43]
    v_cvt_pk_bf16_f32 v60, v34, v38
    v_cvt_pk_bf16_f32 v64, v35, v39
    v_mfma_f32_16x16x32_bf16 v[44:47], v[20:23], a[204:207], v[44:47]
    v_bfi_b32 v52, 1, v24, v52
    v_bfi_b32 v56, 1, v24, v56
    v_mfma_f32_16x16x32_bf16 v[48:51], v[8:11], a[208:211], 0
    v_bfi_b32 v60, 1, v24, v60
    v_bfi_b32 v64, 1, v24, v64
    v_mfma_f32_16x16x32_bf16 v[28:31], v[8:11], a[224:227], 0
    v_mfma_f32_16x16x32_bf16 v[48:51], v[12:15], a[212:215], v[48:51]
    v_mfma_f32_16x16x32_bf16 v[28:31], v[12:15], a[228:231], v[28:31]
    v_cvt_pk_bf16_f32 v53, v40, v44
    v_cvt_pk_bf16_f32 v57, v41, v45
    v_mfma_f32_16x16x32_bf16 v[48:51], v[16:19], a[216:219], v[48:51]
    v_cvt_pk_bf16_f32 v61, v42, v46
    v_cvt_pk_bf16_f32 v65, v43, v47
    v_mfma_f32_16x16x32_bf16 v[28:31], v[16:19], a[232:235], v[28:31]
    s_add_u32 s12, s40, 0
    s_addc_u32 s13, s41, 0
    global_store_dwordx2 v2, v[52:53], s[12:13] offset:0
    v_mfma_f32_16x16x32_bf16 v[48:51], v[20:23], a[220:223], v[48:51]
    s_add_u32 s12, s40, 36864
    s_addc_u32 s13, s41, 0
    global_store_dwordx2 v2, v[56:57], s[12:13] offset:0
    v_mfma_f32_16x16x32_bf16 v[28:31], v[20:23], a[236:239], v[28:31]
    s_add_u32 s12, s40, 73728
    s_addc_u32 s13, s41, 0
    global_store_dwordx2 v2, v[60:61], s[12:13] offset:0
    v_mfma_f32_16x16x32_bf16 v[32:35], v[8:11], a[240:243], 0
    s_add_u32 s12, s40, 110592
    s_addc_u32 s13, s41, 0
    global_store_dwordx2 v2, v[64:65], s[12:13] offset:0
    v_mfma_f32_16x16x32_bf16 v[36:39], v[8:11], v[224:227], 0
    v_mfma_f32_16x16x32_bf16 v[32:35], v[12:15], a[244:247], v[32:35]
    v_mfma_f32_16x16x32_bf16 v[36:39], v[12:15], v[228:231], v[36:39]
    v_cvt_pk_bf16_f32 v54, v48, v28
    v_cvt_pk_bf16_f32 v58, v49, v29
    v_mfma_f32_16x16x32_bf16 v[32:35], v[16:19], a[248:251], v[32:35]
    v_cvt_pk_bf16_f32 v62, v50, v30
    v_cvt_pk_bf16_f32 v66, v51, v31
    v_mfma_f32_16x16x32_bf16 v[36:39], v[16:19], v[232:235], v[36:39]
    v_bfi_b32 v54, 1, v24, v54
    v_bfi_b32 v58, 1, v24, v58
    v_mfma_f32_16x16x32_bf16 v[32:35], v[20:23], a[252:255], v[32:35]
    v_bfi_b32 v62, 1, v24, v62
    v_bfi_b32 v66, 1, v24, v66
    v_mfma_f32_16x16x32_bf16 v[36:39], v[20:23], v[236:239], v[36:39]
    ds_read_b128 v[8:11], v1 offset:4096
    ds_read_b128 v[12:15], v1 offset:5120
    ds_read_b128 v[16:19], v1 offset:6144
    ds_read_b128 v[20:23], v1 offset:7168
    s_waitcnt lgkmcnt(3)
    v_mfma_f32_16x16x32_bf16 v[40:43], v[240:243], v[8:11], 0
    v_mfma_f32_16x16x32_bf16 v[44:47], v[8:11], a[144:147], 0
    v_mfma_f32_16x16x32_bf16 v[48:51], v[8:11], a[160:163], 0
    s_waitcnt lgkmcnt(2)
    v_mfma_f32_16x16x32_bf16 v[40:43], v[244:247], v[12:15], v[40:43]
    v_cvt_pk_bf16_f32 v55, v32, v36
    v_cvt_pk_bf16_f32 v59, v33, v37
    v_mfma_f32_16x16x32_bf16 v[44:47], v[12:15], a[148:151], v[44:47]
    v_cvt_pk_bf16_f32 v63, v34, v38
    v_cvt_pk_bf16_f32 v67, v35, v39
    v_mfma_f32_16x16x32_bf16 v[48:51], v[12:15], a[164:167], v[48:51]
    s_add_u32 s12, s40, 0
    s_addc_u32 s13, s41, 0
    global_store_dwordx2 v2, v[54:55], s[12:13] offset:128
    s_waitcnt lgkmcnt(1)
    v_mfma_f32_16x16x32_bf16 v[40:43], v[248:251], v[16:19], v[40:43]
    s_add_u32 s12, s40, 36864
    s_addc_u32 s13, s41, 0
    global_store_dwordx2 v2, v[58:59], s[12:13] offset:128
    v_mfma_f32_16x16x32_bf16 v[44:47], v[16:19], a[152:155], v[44:47]
    s_add_u32 s12, s40, 73728
    s_addc_u32 s13, s41, 0
    global_store_dwordx2 v2, v[62:63], s[12:13] offset:128
    v_mfma_f32_16x16x32_bf16 v[48:51], v[16:19], a[168:171], v[48:51]
    s_add_u32 s12, s40, 110592
    s_addc_u32 s13, s41, 0
    global_store_dwordx2 v2, v[66:67], s[12:13] offset:128
    s_waitcnt lgkmcnt(0)
    v_mfma_f32_16x16x32_bf16 v[40:43], v[252:255], v[20:23], v[40:43]
    v_mfma_f32_16x16x32_bf16 v[44:47], v[20:23], a[156:159], v[44:47]
    v_mfma_f32_16x16x32_bf16 v[48:51], v[20:23], a[172:175], v[48:51]
    v_mfma_f32_16x16x32_bf16 v[28:31], v[8:11], a[176:179], 0
    v_mfma_f32_16x16x32_bf16 v[32:35], v[8:11], a[192:195], 0
    v_mfma_f32_16x16x32_bf16 v[28:31], v[12:15], a[180:183], v[28:31]
    v_mfma_f32_16x16x32_bf16 v[32:35], v[12:15], a[196:199], v[32:35]
    s_nop 1
    v_cvt_pk_bf16_f32 v40, v40, v41
    v_cvt_pk_bf16_f32 v41, v42, v43
    v_mfma_f32_16x16x32_bf16 v[28:31], v[16:19], a[184:187], v[28:31]
    v_bfi_b32 v40, 1, v24, v40
    s_add_u32 s12, s40, 589824
    s_addc_u32 s13, s41, 0
    global_store_dwordx2 v3, v[40:41], s[12:13]
    v_mfma_f32_16x16x32_bf16 v[32:35], v[16:19], a[200:203], v[32:35]
    v_cvt_pk_bf16_f32 v52, v44, v48
    v_cvt_pk_bf16_f32 v56, v45, v49
    v_mfma_f32_16x16x32_bf16 v[28:31], v[20:23], a[188:191], v[28:31]
    v_cvt_pk_bf16_f32 v60, v46, v50
    v_cvt_pk_bf16_f32 v64, v47, v51
    v_mfma_f32_16x16x32_bf16 v[32:35], v[20:23], a[204:207], v[32:35]
    v_bfi_b32 v52, 1, v24, v52
    v_bfi_b32 v56, 1, v24, v56
    v_mfma_f32_16x16x32_bf16 v[36:39], v[8:11], a[208:211], 0
    v_bfi_b32 v60, 1, v24, v60
    v_bfi_b32 v64, 1, v24, v64
    v_mfma_f32_16x16x32_bf16 v[40:43], v[8:11], a[224:227], 0
    v_mfma_f32_16x16x32_bf16 v[36:39], v[12:15], a[212:215], v[36:39]
    v_mfma_f32_16x16x32_bf16 v[40:43], v[12:15], a[228:231], v[40:43]
    v_cvt_pk_bf16_f32 v53, v28, v32
    v_cvt_pk_bf16_f32 v57, v29, v33
    v_mfma_f32_16x16x32_bf16 v[36:39], v[16:19], a[216:219], v[36:39]
    v_cvt_pk_bf16_f32 v61, v30, v34
    v_cvt_pk_bf16_f32 v65, v31, v35
    v_mfma_f32_16x16x32_bf16 v[40:43], v[16:19], a[232:235], v[40:43]
    s_add_u32 s12, s40, 589824
    s_addc_u32 s13, s41, 0
    global_store_dwordx2 v2, v[52:53], s[12:13] offset:0
    v_mfma_f32_16x16x32_bf16 v[36:39], v[20:23], a[220:223], v[36:39]
    s_add_u32 s12, s40, 626688
    s_addc_u32 s13, s41, 0
    global_store_dwordx2 v2, v[56:57], s[12:13] offset:0
    v_mfma_f32_16x16x32_bf16 v[40:43], v[20:23], a[236:239], v[40:43]
    s_add_u32 s12, s40, 663552
    s_addc_u32 s13, s41, 0
    global_store_dwordx2 v2, v[60:61], s[12:13] offset:0
    v_mfma_f32_16x16x32_bf16 v[44:47], v[8:11], a[240:243], 0
    s_add_u32 s12, s40, 700416
    s_addc_u32 s13, s41, 0
    global_store_dwordx2 v2, v[64:65], s[12:13] offset:0
    v_mfma_f32_16x16x32_bf16 v[48:51], v[8:11], v[224:227], 0
    v_mfma_f32_16x16x32_bf16 v[44:47], v[12:15], a[244:247], v[44:47]
    v_mfma_f32_16x16x32_bf16 v[48:51], v[12:15], v[228:231], v[48:51]
    v_cvt_pk_bf16_f32 v54, v36, v40
    v_cvt_pk_bf16_f32 v58, v37, v41
    v_mfma_f32_16x16x32_bf16 v[44:47], v[16:19], a[248:251], v[44:47]
    v_cvt_pk_bf16_f32 v62, v38, v42
    v_cvt_pk_bf16_f32 v66, v39, v43
    v_mfma_f32_16x16x32_bf16 v[48:51], v[16:19], v[232:235], v[48:51]
    v_bfi_b32 v54, 1, v24, v54
    v_bfi_b32 v58, 1, v24, v58
    v_mfma_f32_16x16x32_bf16 v[44:47], v[20:23], a[252:255], v[44:47]
    v_bfi_b32 v62, 1, v24, v62
    v_bfi_b32 v66, 1, v24, v66
    v_mfma_f32_16x16x32_bf16 v[48:51], v[20:23], v[236:239], v[48:51]
    s_nop 7
    v_cvt_pk_bf16_f32 v55, v44, v48
    v_cvt_pk_bf16_f32 v59, v45, v49
    v_cvt_pk_bf16_f32 v63, v46, v50
    v_cvt_pk_bf16_f32 v67, v47, v51
    s_add_u32 s12, s40, 589824
    s_addc_u32 s13, s41, 0
    global_store_dwordx2 v2, v[54:55], s[12:13] offset:128
    s_add_u32 s12, s40, 626688
    s_addc_u32 s13, s41, 0
    global_store_dwordx2 v2, v[58:59], s[12:13] offset:128
    s_add_u32 s12, s40, 663552
    s_addc_u32 s13, s41, 0
    global_store_dwordx2 v2, v[62:63], s[12:13] offset:128
    s_add_u32 s12, s40, 700416
    s_addc_u32 s13, s41, 0
    global_store_dwordx2 v2, v[66:67], s[12:13] offset:128
    v_bfe_u32 v10, v7, 2, 1
    v_lshlrev_b32 v10, 4, v10
    v_mov_b32 v11, 0x3f80
    v_lshlrev_b32 v11, v10, v11
    v_bfe_u32 v10, v7, 3, 2
    v_cmp_eq_u32 vcc, 0, v10
    s_nop 1
    v_cndmask_b32 v12, 0, v11, vcc
    v_cmp_eq_u32 vcc, 1, v10
    s_nop 1
    v_cndmask_b32 v13, 0, v11, vcc
    v_cmp_eq_u32 vcc, 2, v10
    s_nop 1
    v_cndmask_b32 v14, 0, v11, vcc
    v_cmp_eq_u32 vcc, 3, v10
    s_nop 1
    v_cndmask_b32 v15, 0, v11, vcc
    v_mov_b32 v26, 0x16800
    v_bfe_u32 v10, v0, 4, 3
    v_lshl_add_u32 v26, v10, 5, v26
    v_bfe_u32 v10, v0, 8, 1
    v_lshl_add_u32 v26, v10, 4, v26
    v_bfe_u32 v10, v0, 10, 2
    v_lshl_add_u32 v26, v10, 8, v26
    s_and_b32 s12, s47, 1
    s_sub_u32 s12, 0, s12
    v_bfe_i32 v10, v7, 6, 1
    v_bfe_i32 v11, v7, 5, 1
    v_xor_b32 v10, s12, v10
    v_xor_b32 v11, s12, v11
    s_waitcnt vmcnt(0)
    s_cmp_lg_u32 s47, 1
    s_cbranch_scc1 L_nf_82
    s_barrier
    s_cmp_lg_u32 s10, 0
    s_cbranch_scc1 L_pf_83
    s_lshl_b32 s12, s9, 2
    v_mov_b32 v8, s12
    v_mov_b32 v9, s47
    s_mov_b64 exec, 1
    global_store_dword v8, v9, s[44:45] offset:0
    s_mov_b64 exec, -1
L_pf_83:
    v_and_b32 v8, 0x7c, v7
    s_mov_b32 s12, 0
L_fw_84:
    global_load_dword v9, v8, s[44:45] sc1
    s_add_u32 s12, s12, 1
    s_cmp_gt_u32 s12, 100000
    s_cbranch_scc1 L_exit
    s_waitcnt vmcnt(0)
    v_cmp_gt_u32 vcc, s47, v9
    s_cbranch_vccz L_fwd_85
    s_sleep 8
    s_branch L_fw_84
L_fwd_85:
L_nf_82:
    s_mov_b32 s14, 0
L_xr_86:
    s_mov_b64 s[12:13], s[42:43]
    global_load_dwordx4 v[60:63], v6, s[12:13] sc1
    global_load_dwordx4 v[28:31], v4, s[12:13] sc1
    s_add_u32 s12, s12, 4608
    s_addc_u32 s13, s13, 0
    global_load_dwordx4 v[32:35], v4, s[12:13] sc1
    s_add_u32 s12, s12, 4608
    s_addc_u32 s13, s13, 0
    global_load_dwordx4 v[36:39], v4, s[12:13] sc1
    s_add_u32 s12, s12, 4608
    s_addc_u32 s13, s13, 0
    global_load_dwordx4 v[40:43], v4, s[12:13] sc1
    s_add_u32 s12, s12, 4608
    s_addc_u32 s13, s13, 0
    global_load_dwordx4 v[44:47], v4, s[12:13] sc1
    s_add_u32 s12, s12, 4608
    s_addc_u32 s13, s13, 0
    global_load_dwordx4 v[48:51], v4, s[12:13] sc1
    s_add_u32 s12, s12, 4608
    s_addc_u32 s13, s13, 0
    global_load_dwordx4 v[52:55], v4, s[12:13] sc1
    s_add_u32 s12, s12, 4608
    s_addc_u32 s13, s13, 0
    global_load_dwordx4 v[56:59], v4, s[12:13] sc1
    s_mov_b64 exec, -1
    s_add_u32 s14, s14, 1
    s_cmp_gt_u32 s14, 100000
    s_cbranch_scc1 L_exit
    s_waitcnt vmcnt(8)
    v_mfma_f32_16x16x32_bf16 v[20:23], v[12:15], v[60:63], 0
    v_bitop3_b32 v8, v60, v62, v11 bitop3:0x7e
    v_and_b32 v8, 1, v8
    s_waitcnt vmcnt(7)
    v_mfma_f32_16x16x32_bf16 v[16:19], v[12:15], v[28:31], 0
    v_bitop3_b32 v9, v28, v30, v10 bitop3:0x7e
    v_and_or_b32 v8, v9, 1, v8
    s_waitcnt vmcnt(6)
    v_mfma_f32_16x16x32_bf16 v[16:19], v[12:15], v[32:35], v[16:19]
    v_bitop3_b32 v9, v32, v34, v10 bitop3:0x7e
    v_and_or_b32 v8, v9, 1, v8
    s_waitcnt vmcnt(5)
    v_mfma_f32_16x16x32_bf16 v[16:19], v[12:15], v[36:39], v[16:19]
    v_bitop3_b32 v9, v36, v38, v10 bitop3:0x7e
    v_and_or_b32 v8, v9, 1, v8
    s_waitcnt vmcnt(4)
    v_mfma_f32_16x16x32_bf16 v[16:19], v[12:15], v[40:43], v[16:19]
    v_bitop3_b32 v9, v40, v42, v10 bitop3:0x7e
    v_and_or_b32 v8, v9, 1, v8
    s_waitcnt vmcnt(3)
    v_mfma_f32_16x16x32_bf16 v[16:19], v[12:15], v[44:47], v[16:19]
    v_bitop3_b32 v9, v44, v46, v10 bitop3:0x7e
    v_and_or_b32 v8, v9, 1, v8
    v_add_f32_dpp v20, v20, v20 row_ror:8 row_mask:0xf bank_mask:0xf
    v_add_f32_dpp v21, v21, v21 row_ror:8 row_mask:0xf bank_mask:0xf
    v_add_f32_dpp v22, v22, v22 row_ror:8 row_mask:0xf bank_mask:0xf
    v_add_f32_dpp v23, v23, v23 row_ror:8 row_mask:0xf bank_mask:0xf
    ds_write_b128 v26, v[20:23]
    s_waitcnt vmcnt(2)
    v_mfma_f32_16x16x32_bf16 v[16:19], v[12:15], v[48:51], v[16:19]
    v_bitop3_b32 v9, v48, v50, v10 bitop3:0x7e
    v_and_or_b32 v8, v9, 1, v8
    s_waitcnt vmcnt(1)
    v_mfma_f32_16x16x32_bf16 v[16:19], v[12:15], v[52:55], v[16:19]
    v_bitop3_b32 v9, v52, v54, v10 bitop3:0x7e
    v_and_or_b32 v8, v9, 1, v8
    s_waitcnt vmcnt(0)
    v_mfma_f32_16x16x32_bf16 v[16:19], v[12:15], v[56:59], v[16:19]
    v_bitop3_b32 v9, v56, v58, v10 bitop3:0x7e
    v_and_or_b32 v8, v9, 1, v8
    v_cmp_ne_u32 vcc, 0, v8
    s_mov_b64 exec, vcc
    s_cbranch_vccnz L_xr_86
    s_mov_b64 exec, -1
    s_nop 1
    ds_write_b32 v5, v16 offset:0
    ds_write_b32 v5, v17 offset:256
    ds_write_b32 v5, v18 offset:512
    ds_write_b32 v5, v19 offset:768
    s_waitcnt lgkmcnt(0)
    s_barrier
    s_cmp_lg_u32 s10, 1
    s_cbranch_scc1 L_pf_87
    s_lshl_b32 s12, s9, 2
    v_mov_b32 v8, s12
    v_mov_b32 v9, s47
    s_mov_b64 exec, 1
    global_store_dword v8, v9, s[44:45] offset:1024
    s_mov_b64 exec, -1
L_pf_87:
    v_subrev_u32 v1, 81920, v1
    s_cmp_lg_u32 s10, 0
    s_cbranch_scc1 L_a_next_f
    v_add_u32 v7, 45056, v7
    v_lshlrev_b32 v48, 1, v7
    ds_read_b64 v[16:17], v48 offset:2048
    ds_read_b64 v[18:19], v48 offset:2304
    ds_read_b64 v[20:21], v48 offset:2560
    ds_read_b64 v[22:23], v48 offset:2816
    ds_read_b64 v[8:9], v48 offset:0
    ds_read_b64 v[10:11], v48 offset:512
    ds_read_b64 v[12:13], v48 offset:1024
    ds_read_b64 v[14:15], v48 offset:1536
    s_waitcnt lgkmcnt(4)
    v_pk_add_f32 v[16:17], v[16:17], v[18:19]
    v_pk_add_f32 v[20:21], v[20:21], v[22:23]
    v_pk_add_f32 v[16:17], v[16:17], v[20:21]
    s_waitcnt lgkmcnt(0)
    v_cvt_pk_bf16_f32 v9, v8, v9
    v_lshlrev_b32 v8, 16, v9
    v_and_b32 v9, 0xffff0000, v9
    v_cvt_pk_bf16_f32 v11, v10, v11
    v_lshlrev_b32 v10, 16, v11
    v_and_b32 v11, 0xffff0000, v11
    v_cvt_pk_bf16_f32 v13, v12, v13
    v_lshlrev_b32 v12, 16, v13
    v_and_b32 v13, 0xffff0000, v13
    v_cvt_pk_bf16_f32 v15, v14, v15
    v_lshlrev_b32 v14, 16, v15
    v_and_b32 v15, 0xffff0000, v15
    v_cvt_pk_bf16_f32 v17, v16, v17
    v_lshlrev_b32 v16, 16, v17
    v_and_b32 v17, 0xffff0000, v17
    v_subrev_u32 v7, 45056, v7
    v_mov_b64 v[20:21], 0
    v_lshlrev_b32 v18, 16, v88
    v_and_b32 v19, 0xffff0000, v88
    v_pk_mul_f32 v[8:9], v[8:9], v[18:19]
    v_cvt_pk_bf16_f32 v9, v8, v9
    v_lshlrev_b32 v8, 16, v9
    v_and_b32 v9, 0xffff0000, v9
    v_lshlrev_b32 v18, 16, v104
    v_and_b32 v19, 0xffff0000, v104
    v_pk_add_f32 v[8:9], v[8:9], v[18:19]
    v_cvt_pk_bf16_f32 v24, v8, v9
    v_lshlrev_b32 v8, 16, v24
    v_and_b32 v9, 0xffff0000, v24
    global_store_dword v7, v24, s[36:37] offset:0 sc1
    v_pk_add_f32 v[20:21], v[20:21], v[8:9]
    v_lshlrev_b32 v18, 16, v89
    v_and_b32 v19, 0xffff0000, v89
    v_pk_mul_f32 v[10:11], v[10:11], v[18:19]
    v_cvt_pk_bf16_f32 v11, v10, v11
    v_lshlrev_b32 v10, 16, v11
    v_and_b32 v11, 0xffff0000, v11
    v_lshlrev_b32 v18, 16, v105
    v_and_b32 v19, 0xffff0000, v105
    v_pk_add_f32 v[10:11], v[10:11], v[18:19]
    v_cvt_pk_bf16_f32 v25, v10, v11
    v_lshlrev_b32 v10, 16, v25
    v_and_b32 v11, 0xffff0000, v25
    global_store_dword v7, v25, s[36:37] offset:256 sc1
    v_pk_add_f32 v[20:21], v[20:21], v[10:11]
    v_lshlrev_b32 v18, 16, v90
    v_and_b32 v19, 0xffff0000, v90
    v_pk_mul_f32 v[12:13], v[12:13], v[18:19]
    v_cvt_pk_bf16_f32 v13, v12, v13
    v_lshlrev_b32 v12, 16, v13
    v_and_b32 v13, 0xffff0000, v13
    v_lshlrev_b32 v18, 16, v106
    v_and_b32 v19, 0xffff0000, v106
    v_pk_add_f32 v[12:13], v[12:13], v[18:19]
    v_cvt_pk_bf16_f32 v26, v12, v13
    v_lshlrev_b32 v12, 16, v26
    v_and_b32 v13, 0xffff0000, v26
    global_store_dword v7, v26, s[36:37] offset:512 sc1
    v_pk_add_f32 v[20:21], v[20:21], v[12:13]
    v_lshlrev_b32 v18, 16, v91
    v_and_b32 v19, 0xffff0000, v91
    v_pk_mul_f32 v[14:15], v[14:15], v[18:19]
    v_cvt_pk_bf16_f32 v15, v14, v15
    v_lshlrev_b32 v14, 16, v15
    v_and_b32 v15, 0xffff0000, v15
    v_lshlrev_b32 v18, 16, v107
    v_and_b32 v19, 0xffff0000, v107
    v_pk_add_f32 v[14:15], v[14:15], v[18:19]
    v_cvt_pk_bf16_f32 v27, v14, v15
    v_lshlrev_b32 v14, 16, v27
    v_and_b32 v15, 0xffff0000, v27
    global_store_dword v7, v27, s[36:37] offset:768 sc1
    v_pk_add_f32 v[20:21], v[20:21], v[14:15]
    s_mov_b32 exec_hi, 0
    v_lshlrev_b32 v18, 16, v92
    v_and_b32 v19, 0xffff0000, v92
    v_pk_mul_f32 v[16:17], v[16:17], v[18:19]
    v_cvt_pk_bf16_f32 v17, v16, v17
    v_lshlrev_b32 v16, 16, v17
    v_and_b32 v17, 0xffff0000, v17
    v_lshlrev_b32 v18, 16, v108
    v_and_b32 v19, 0xffff0000, v108
    v_pk_add_f32 v[16:17], v[16:17], v[18:19]
    v_cvt_pk_bf16_f32 v28, v16, v17
    v_lshlrev_b32 v16, 16, v28
    v_and_b32 v17, 0xffff0000, v28
    global_store_dword v7, v28, s[36:37] offset:1024 sc1
    v_pk_add_f32 v[20:21], v[20:21], v[16:17]
    s_mov_b64 exec, -1
    v_add_f32 v20, v20, v21
    s_nop 1
    v_add_f32_dpp v20, v20, v20 quad_perm:[1,0,3,2] row_mask:0xf bank_mask:0xf
    s_nop 1
    v_add_f32_dpp v20, v20, v20 quad_perm:[2,3,0,1] row_mask:0xf bank_mask:0xf
    s_nop 1
    v_add_f32_dpp v20, v20, v20 row_ror:4 row_mask:0xf bank_mask:0xf
    s_nop 1
    v_add_f32_dpp v20, v20, v20 row_ror:8 row_mask:0xf bank_mask:0xf
    v_mov_b32 v21, v20
    s_nop 1
    v_permlane16_swap_b32 v20, v21
    v_add_f32 v20, v20, v21
    v_mov_b32 v21, v20
    s_nop 1
    v_permlane32_swap_b32 v20, v21
    v_add_f32 v20, v20, v21
    v_mul_f32 v20, 0x3ae38e39, v20
    v_mov_b64 v[22:23], 0
    v_pk_add_f32 v[18:19], v[8:9], v[20:21] op_sel_hi:[1,0] neg_lo:[0,1] neg_hi:[0,1]
    v_pk_fma_f32 v[22:23], v[18:19], v[18:19], v[22:23]
    v_pk_add_f32 v[18:19], v[10:11], v[20:21] op_sel_hi:[1,0] neg_lo:[0,1] neg_hi:[0,1]
    v_pk_fma_f32 v[22:23], v[18:19], v[18:19], v[22:23]
    v_pk_add_f32 v[18:19], v[12:13], v[20:21] op_sel_hi:[1,0] neg_lo:[0,1] neg_hi:[0,1]
    v_pk_fma_f32 v[22:23], v[18:19], v[18:19], v[22:23]
    v_pk_add_f32 v[18:19], v[14:15], v[20:21] op_sel_hi:[1,0] neg_lo:[0,1] neg_hi:[0,1]
    v_pk_fma_f32 v[22:23], v[18:19], v[18:19], v[22:23]
    s_mov_b32 exec_hi, 0
    v_pk_add_f32 v[18:19], v[16:17], v[20:21] op_sel_hi:[1,0] neg_lo:[0,1] neg_hi:[0,1]
    v_pk_fma_f32 v[22:23], v[18:19], v[18:19], v[22:23]
    s_mov_b64 exec, -1
    v_add_f32 v22, v22, v23
    s_nop 1
    v_add_f32_dpp v22, v22, v22 quad_perm:[1,0,3,2] row_mask:0xf bank_mask:0xf
    s_nop 1
    v_add_f32_dpp v22, v22, v22 quad_perm:[2,3,0,1] row_mask:0xf bank_mask:0xf
    s_nop 1
    v_add_f32_dpp v22, v22, v22 row_ror:4 row_mask:0xf bank_mask:0xf
    s_nop 1
    v_add_f32_dpp v22, v22, v22 row_ror:8 row_mask:0xf bank_mask:0xf
    v_mov_b32 v23, v22
    s_nop 1
    v_permlane16_swap_b32 v22, v23
    v_add_f32 v22, v22, v23
    v_mov_b32 v23, v22
    s_nop 1
    v_permlane32_swap_b32 v22, v23
    v_add_f32 v22, v22, v23
    v_mul_f32 v22, 0x3ae38e39, v22
    v_cvt_pk_bf16_f32 v22, v22, v22
    v_lshlrev_b32 v22, 16, v22
    v_cvt_pk_bf16_f32 v20, v20, v20
    v_lshlrev_b32 v20, 16, v20
    v_add_f32 v22, 0x3727c5ac, v22
    v_cvt_pk_bf16_f32 v22, v22, v22
    v_lshlrev_b32 v22, 16, v22
    v_sqrt_f32 v22, v22
    s_nop 0
    v_cvt_pk_bf16_f32 v22, v22, v22
    v_lshlrev_b32 v22, 16, v22
    v_rcp_f32 v22, v22
    v_pk_add_f32 v[8:9], v[8:9], v[20:21] op_sel_hi:[1,0] neg_lo:[0,1] neg_hi:[0,1]
    v_cvt_pk_bf16_f32 v9, v8, v9
    v_lshlrev_b32 v8, 16, v9
    v_and_b32 v9, 0xffff0000, v9
    v_pk_mul_f32 v[8:9], v[8:9], v[22:23] op_sel_hi:[1,0]
    v_cvt_pk_bf16_f32 v9, v8, v9
    v_lshlrev_b32 v8, 16, v9
    v_and_b32 v9, 0xffff0000, v9
    v_lshlrev_b32 v18, 16, v93
    v_and_b32 v19, 0xffff0000, v93
    v_pk_mul_f32 v[8:9], v[8:9], v[18:19]
    v_cvt_pk_bf16_f32 v9, v8, v9
    v_lshlrev_b32 v8, 16, v9
    v_and_b32 v9, 0xffff0000, v9
    v_lshlrev_b32 v18, 16, v98
    v_and_b32 v19, 0xffff0000, v98
    v_pk_add_f32 v[8:9], v[8:9], v[18:19]
    v_cvt_pk_bf16_f32 v30, v8, v9
    global_store_dword v86, v30, s[38:39] offset:0 sc1
    v_pk_add_f32 v[10:11], v[10:11], v[20:21] op_sel_hi:[1,0] neg_lo:[0,1] neg_hi:[0,1]
    v_cvt_pk_bf16_f32 v11, v10, v11
    v_lshlrev_b32 v10, 16, v11
    v_and_b32 v11, 0xffff0000, v11
    v_pk_mul_f32 v[10:11], v[10:11], v[22:23] op_sel_hi:[1,0]
    v_cvt_pk_bf16_f32 v11, v10, v11
    v_lshlrev_b32 v10, 16, v11
    v_and_b32 v11, 0xffff0000, v11
    v_lshlrev_b32 v18, 16, v94
    v_and_b32 v19, 0xffff0000, v94
    v_pk_mul_f32 v[10:11], v[10:11], v[18:19]
    v_cvt_pk_bf16_f32 v11, v10, v11
    v_lshlrev_b32 v10, 16, v11
    v_and_b32 v11, 0xffff0000, v11
    v_lshlrev_b32 v18, 16, v99
    v_and_b32 v19, 0xffff0000, v99
    v_pk_add_f32 v[10:11], v[10:11], v[18:19]
    v_cvt_pk_bf16_f32 v31, v10, v11
    global_store_dword v86, v31, s[38:39] offset:256 sc1
    v_pk_add_f32 v[12:13], v[12:13], v[20:21] op_sel_hi:[1,0] neg_lo:[0,1] neg_hi:[0,1]
    v_cvt_pk_bf16_f32 v13, v12, v13
    v_lshlrev_b32 v12, 16, v13
    v_and_b32 v13, 0xffff0000, v13
    v_pk_mul_f32 v[12:13], v[12:13], v[22:23] op_sel_hi:[1,0]
    v_cvt_pk_bf16_f32 v13, v12, v13
    v_lshlrev_b32 v12, 16, v13
    v_and_b32 v13, 0xffff0000, v13
    v_lshlrev_b32 v18, 16, v95
    v_and_b32 v19, 0xffff0000, v95
    v_pk_mul_f32 v[12:13], v[12:13], v[18:19]
    v_cvt_pk_bf16_f32 v13, v12, v13
    v_lshlrev_b32 v12, 16, v13
    v_and_b32 v13, 0xffff0000, v13
    v_lshlrev_b32 v18, 16, v100
    v_and_b32 v19, 0xffff0000, v100
    v_pk_add_f32 v[12:13], v[12:13], v[18:19]
    v_cvt_pk_bf16_f32 v32, v12, v13
    global_store_dword v86, v32, s[38:39] offset:512 sc1
    v_pk_add_f32 v[14:15], v[14:15], v[20:21] op_sel_hi:[1,0] neg_lo:[0,1] neg_hi:[0,1]
    v_cvt_pk_bf16_f32 v15, v14, v15
    v_lshlrev_b32 v14, 16, v15
    v_and_b32 v15, 0xffff0000, v15
    v_pk_mul_f32 v[14:15], v[14:15], v[22:23] op_sel_hi:[1,0]
    v_cvt_pk_bf16_f32 v15, v14, v15
    v_lshlrev_b32 v14, 16, v15
    v_and_b32 v15, 0xffff0000, v15
    v_lshlrev_b32 v18, 16, v96
    v_and_b32 v19, 0xffff0000, v96
    v_pk_mul_f32 v[14:15], v[14:15], v[18:19]
    v_cvt_pk_bf16_f32 v15, v14, v15
    v_lshlrev_b32 v14, 16, v15
    v_and_b32 v15, 0xffff0000, v15
    v_lshlrev_b32 v18, 16, v101
    v_and_b32 v19, 0xffff0000, v101
    v_pk_add_f32 v[14:15], v[14:15], v[18:19]
    v_cvt_pk_bf16_f32 v33, v14, v15
    global_store_dword v86, v33, s[38:39] offset:768 sc1
    s_mov_b32 exec_hi, 0
    v_pk_add_f32 v[16:17], v[16:17], v[20:21] op_sel_hi:[1,0] neg_lo:[0,1] neg_hi:[0,1]
    v_cvt_pk_bf16_f32 v17, v16, v17
    v_lshlrev_b32 v16, 16, v17
    v_and_b32 v17, 0xffff0000, v17
    v_pk_mul_f32 v[16:17], v[16:17], v[22:23] op_sel_hi:[1,0]
    v_cvt_pk_bf16_f32 v17, v16, v17
    v_lshlrev_b32 v16, 16, v17
    v_and_b32 v17, 0xffff0000, v17
    v_lshlrev_b32 v18, 16, v97
    v_and_b32 v19, 0xffff0000, v97
    v_pk_mul_f32 v[16:17], v[16:17], v[18:19]
    v_cvt_pk_bf16_f32 v17, v16, v17
    v_lshlrev_b32 v16, 16, v17
    v_and_b32 v17, 0xffff0000, v17
    v_lshlrev_b32 v18, 16, v102
    v_and_b32 v19, 0xffff0000, v102
    v_pk_add_f32 v[16:17], v[16:17], v[18:19]
    v_cvt_pk_bf16_f32 v34, v16, v17
    global_store_dword v86, v34, s[38:39] offset:1024 sc1
    s_mov_b64 exec, 1
    v_mov_b32 v18, 1
    s_waitcnt vmcnt(0)
    global_store_dword v7, v18, s[52:53] sc1
    s_mov_b64 exec, -1
L_a_next_f:
    s_add_u32 s34, s34, 110592
    s_addc_u32 s35, s35, 0
    s_add_u32 s36, s36, 110592
    s_addc_u32 s37, s37, 0
    s_add_u32 s38, s38, 110592
    s_addc_u32 s39, s39, 0
    s_add_u32 s22, s22, 1572864
    s_addc_u32 s23, s23, 0
    s_add_u32 s30, s30, 393216
    s_addc_u32 s31, s31, 0
    s_add_u32 s52, s52, 384
    s_addc_u32 s53, s53, 0
    s_add_u32 s24, s24, 3
    s_cmp_lt_u32 s24, 64
    s_cbranch_scc1 L_a_top_f
    s_branch L_exit
L_a_top_s:
    s_add_u32 s25, s24, 1
    s_cmp_ge_u32 s58, s25
    s_cbranch_scc1 L_cw_88
    v_and_b32 v8, 12, v7
    s_mov_b32 s12, 0
L_fw_89:
    global_load_dword v9, v8, s[54:55] sc1
    s_add_u32 s12, s12, 1
    s_cmp_gt_u32 s12, 100000
    s_cbranch_scc1 L_exit
    s_waitcnt vmcnt(0)
    v_cmp_gt_u32 vcc, s25, v9
    s_cbranch_vccz L_fwd_90
    s_sleep 16
    s_branch L_fw_89
L_fwd_90:
    v_min_u32_dpp v9, v9, v9 quad_perm:[1,0,3,2] row_mask:0xf bank_mask:0xf
    s_nop 1
    v_min_u32_dpp v9, v9, v9 quad_perm:[2,3,0,1] row_mask:0xf bank_mask:0xf
    s_nop 0
    v_readfirstlane_b32 s58, v9
L_cw_88:
    global_load_dwordx4 v[112:115], v1, s[22:23] offset:-4096
    global_load_dwordx4 v[116:119], v1, s[22:23] offset:-3072
    global_load_dwordx4 v[120:123], v1, s[22:23] offset:-2048
    global_load_dwordx4 v[124:127], v1, s[22:23] offset:-1024
    global_load_dwordx4 v[128:131], v1, s[22:23] offset:0
    global_load_dwordx4 v[132:135], v1, s[22:23] offset:1024
    global_load_dwordx4 v[136:139], v1, s[22:23] offset:2048
    global_load_dwordx4 v[140:143], v1, s[22:23] offset:3072
    s_and_b32 s12, s10, 1
    s_lshl_b32 s12, s12, 12
    s_add_u32 s12, s12, 4096
    s_add_u32 s12, s22, s12
    s_addc_u32 s13, s23, 0
    global_load_dwordx4 v[144:147], v1, s[12:13] offset:0
    global_load_dwordx4 v[148:151], v1, s[12:13] offset:1024
    global_load_dwordx4 v[152:155], v1, s[12:13] offset:2048
    global_load_dwordx4 v[156:159], v1, s[12:13] offset:3072
    s_mov_b32 exec_hi, 0
    global_load_dword v108, v7, s[34:35] offset:1024
    s_mov_b64 exec, -1
    global_load_dword v104, v7, s[34:35] offset:0
    global_load_dword v105, v7, s[34:35] offset:256
    global_load_dword v106, v7, s[34:35] offset:512
    global_load_dword v107, v7, s[34:35] offset:768
    v_add_u32 v80, s27, v1
    s_barrier
    ds_read_b128 v[24:27], v80 offset:0
    ds_read_b128 v[28:31], v80 offset:18432
    ds_read_b128 v[32:35], v80 offset:1024
    ds_read_b128 v[36:39], v80 offset:19456
    ds_read_b128 v[40:43], v80 offset:2048
    s_mov_b64 s[12:13], s[20:21]
    s_add_u32 m0, s26, 0
    s_nop 0
    global_load_lds_dwordx4 v0, s[12:13]
    s_add_u32 s12, s12, 4096
    s_addc_u32 s13, s13, 0
    s_add_u32 m0, s26, 4096
    s_nop 0
    global_load_lds_dwordx4 v0, s[12:13]
    s_add_u32 s12, s12, 4096
    s_addc_u32 s13, s13, 0
    s_add_u32 m0, s26, 8192
    s_nop 0
    global_load_lds_dwordx4 v0, s[12:13]
    s_add_u32 s12, s12, 4096
    s_addc_u32 s13, s13, 0
    s_add_u32 m0, s26, 12288
    s_nop 0
    global_load_lds_dwordx4 v0, s[12:13]
    s_add_u32 s12, s12, 4096
    s_addc_u32 s13, s13, 0
    s_add_u32 m0, s26, 16384
    s_nop 0
    global_load_lds_dwordx4 v0, s[12:13]
    s_add_u32 s12, s12, 4096
    s_addc_u32 s13, s13, 0
    s_add_u32 m0, s26, 20480
    s_nop 0
    global_load_lds_dwordx4 v0, s[12:13]
    s_add_u32 s12, s12, 4096
    s_addc_u32 s13, s13, 0
    s_add_u32 m0, s26, 24576
    s_nop 0
    global_load_lds_dwordx4 v0, s[12:13]
    s_add_u32 s12, s12, 4096
    s_addc_u32 s13, s13, 0
    s_add_u32 m0, s26, 28672
    s_nop 0
    global_load_lds_dwordx4 v0, s[12:13]
    s_add_u32 s12, s12, 4096
    s_addc_u32 s13, s13, 0
    s_add_u32 m0, s26, 32768
    s_nop 0
    global_load_lds_dwordx4 v0, s[12:13]
    s_add_u32 s20, s20, 110592
    s_addc_u32 s21, s21, 0
    s_xor_b32 s26, s26, 36864
    s_xor_b32 s27, s27, 36864
    ds_read_b128 v[44:47], v80 offset:20480
    s_waitcnt lgkmcnt(5)
    v_mfma_f32_16x16x32_bf16 v[8:11], a[0:3], v[24:27], 0
    v_mfma_f32_16x16x32_bf16 v[16:19], a[4:7], v[24:27], 0
    ds_read_b128 v[24:27], v80 offset:3072
    s_waitcnt lgkmcnt(5)
    v_mfma_f32_16x16x32_bf16 v[12:15], a[0:3], v[28:31], 0
    v_mfma_f32_16x16x32_bf16 v[20:23], a[4:7], v[28:31], 0
    ds_read_b128 v[28:31], v80 offset:21504
    s_waitcnt lgkmcnt(5)
    v_mfma_f32_16x16x32_bf16 v[8:11], a[8:11], v[32:35], v[8:11]
    v_mfma_f32_16x16x32_bf16 v[16:19], a[12:15], v[32:35], v[16:19]
    ds_read_b128 v[32:35], v80 offset:4096
    s_waitcnt lgkmcnt(5)
    v_mfma_f32_16x16x32_bf16 v[12:15], a[8:11], v[36:39], v[12:15]
    v_mfma_f32_16x16x32_bf16 v[20:23], a[12:15], v[36:39], v[20:23]
    ds_read_b128 v[36:39], v80 offset:22528
    s_waitcnt lgkmcnt(5)
    v_mfma_f32_16x16x32_bf16 v[8:11], a[16:19], v[40:43], v[8:11]
    v_mfma_f32_16x16x32_bf16 v[16:19], a[20:23], v[40:43], v[16:19]
    ds_read_b128 v[40:43], v80 offset:5120
    s_waitcnt lgkmcnt(5)
    v_mfma_f32_16x16x32_bf16 v[12:15], a[16:19], v[44:47], v[12:15]
    v_mfma_f32_16x16x32_bf16 v[20:23], a[20:23], v[44:47], v[20:23]
    ds_read_b128 v[44:47], v80 offset:23552
    s_waitcnt lgkmcnt(5)
    v_mfma_f32_16x16x32_bf16 v[8:11], a[24:27], v[24:27], v[8:11]
    v_mfma_f32_16x16x32_bf16 v[16:19], a[28:31], v[24:27], v[16:19]
    ds_read_b128 v[24:27], v80 offset:6144
    s_waitcnt lgkmcnt(5)
    v_mfma_f32_16x16x32_bf16 v[12:15], a[24:27], v[28:31], v[12:15]
    v_mfma_f32_16x16x32_bf16 v[20:23], a[28:31], v[28:31], v[20:23]
    ds_read_b128 v[28:31], v80 offset:24576
    s_waitcnt lgkmcnt(5)
    v_mfma_f32_16x16x32_bf16 v[8:11], a[32:35], v[32:35], v[8:11]
    v_mfma_f32_16x16x32_bf16 v[16:19], a[36:39], v[32:35], v[16:19]
    ds_read_b128 v[32:35], v80 offset:7168
    s_waitcnt lgkmcnt(5)
    v_mfma_f32_16x16x32_bf16 v[12:15], a[32:35], v[36:39], v[12:15]
    v_mfma_f32_16x16x32_bf16 v[20:23], a[36:39], v[36:39], v[20:23]
    ds_read_b128 v[36:39], v80 offset:25600
    s_waitcnt lgkmcnt(5)
    v_mfma_f32_16x16x32_bf16 v[8:11], a[40:43], v[40:43], v[8:11]
    v_mfma_f32_16x16x32_bf16 v[16:19], a[44:47], v[40:43], v[16:19]
    ds_read_b128 v[40:43], v80 offset:8192
    s_waitcnt lgkmcnt(5)
    v_mfma_f32_16x16x32_bf16 v[12:15], a[40:43], v[44:47], v[12:15]
    v_mfma_f32_16x16x32_bf16 v[20:23], a[44:47], v[44:47], v[20:23]
    ds_read_b128 v[44:47], v80 offset:26624
    s_waitcnt lgkmcnt(5)
    v_mfma_f32_16x16x32_bf16 v[8:11], a[48:51], v[24:27], v[8:11]
    v_mfma_f32_16x16x32_bf16 v[16:19], a[52:55], v[24:27], v[16:19]
    ds_read_b128 v[24:27], v80 offset:9216
    s_waitcnt lgkmcnt(5)
    v_mfma_f32_16x16x32_bf16 v[12:15], a[48:51], v[28:31], v[12:15]
    v_mfma_f32_16x16x32_bf16 v[20:23], a[52:55], v[28:31], v[20:23]
    ds_read_b128 v[28:31], v80 offset:27648
    s_waitcnt lgkmcnt(5)
    v_mfma_f32_16x16x32_bf16 v[8:11], a[56:59], v[32:35], v[8:11]
    v_mfma_f32_16x16x32_bf16 v[16:19], a[60:63], v[32:35], v[16:19]
    ds_read_b128 v[32:35], v80 offset:10240
    s_waitcnt lgkmcnt(5)
    v_mfma_f32_16x16x32_bf16 v[12:15], a[56:59], v[36:39], v[12:15]
    v_mfma_f32_16x16x32_bf16 v[20:23], a[60:63], v[36:39], v[20:23]
    ds_read_b128 v[36:39], v80 offset:28672
    s_waitcnt lgkmcnt(5)
    v_mfma_f32_16x16x32_bf16 v[8:11], a[64:67], v[40:43], v[8:11]
    v_mfma_f32_16x16x32_bf16 v[16:19], a[68:71], v[40:43], v[16:19]
    ds_read_b128 v[40:43], v80 offset:11264
    s_waitcnt lgkmcnt(5)
    v_mfma_f32_16x16x32_bf16 v[12:15], a[64:67], v[44:47], v[12:15]
    v_mfma_f32_16x16x32_bf16 v[20:23], a[68:71], v[44:47], v[20:23]
    ds_read_b128 v[44:47], v80 offset:29696
    s_waitcnt lgkmcnt(5)
    v_mfma_f32_16x16x32_bf16 v[8:11], a[72:75], v[24:27], v[8:11]
    v_mfma_f32_16x16x32_bf16 v[16:19], a[76:79], v[24:27], v[16:19]
    ds_read_b128 v[24:27], v80 offset:12288
    s_waitcnt lgkmcnt(5)
    v_mfma_f32_16x16x32_bf16 v[12:15], a[72:75], v[28:31], v[12:15]
    v_mfma_f32_16x16x32_bf16 v[20:23], a[76:79], v[28:31], v[20:23]
    ds_read_b128 v[28:31], v80 offset:30720
    s_waitcnt lgkmcnt(5)
    v_mfma_f32_16x16x32_bf16 v[8:11], a[80:83], v[32:35], v[8:11]
    v_mfma_f32_16x16x32_bf16 v[16:19], a[84:87], v[32:35], v[16:19]
    ds_read_b128 v[32:35], v80 offset:13312
    s_waitcnt lgkmcnt(5)
    v_mfma_f32_16x16x32_bf16 v[12:15], a[80:83], v[36:39], v[12:15]
    v_mfma_f32_16x16x32_bf16 v[20:23], a[84:87], v[36:39], v[20:23]
    ds_read_b128 v[36:39], v80 offset:31744
    s_waitcnt lgkmcnt(5)
    v_mfma_f32_16x16x32_bf16 v[8:11], a[88:91], v[40:43], v[8:11]
    v_mfma_f32_16x16x32_bf16 v[16:19], a[92:95], v[40:43], v[16:19]
    ds_read_b128 v[40:43], v80 offset:14336
    s_waitcnt lgkmcnt(5)
    v_mfma_f32_16x16x32_bf16 v[12:15], a[88:91], v[44:47], v[12:15]
    v_mfma_f32_16x16x32_bf16 v[20:23], a[92:95], v[44:47], v[20:23]
    ds_read_b128 v[44:47], v80 offset:32768
    s_waitcnt lgkmcnt(5)
    v_mfma_f32_16x16x32_bf16 v[8:11], a[96:99], v[24:27], v[8:11]
    v_mfma_f32_16x16x32_bf16 v[16:19], a[100:103], v[24:27], v[16:19]
    ds_read_b128 v[24:27], v80 offset:15360
    s_waitcnt lgkmcnt(5)
    v_mfma_f32_16x16x32_bf16 v[12:15], a[96:99], v[28:31], v[12:15]
    v_mfma_f32_16x16x32_bf16 v[20:23], a[100:103], v[28:31], v[20:23]
    ds_read_b128 v[28:31], v80 offset:33792
    s_waitcnt lgkmcnt(5)
    v_mfma_f32_16x16x32_bf16 v[8:11], a[104:107], v[32:35], v[8:11]
    v_mfma_f32_16x16x32_bf16 v[16:19], a[108:111], v[32:35], v[16:19]
    ds_read_b128 v[32:35], v80 offset:16384
    s_waitcnt lgkmcnt(5)
    v_mfma_f32_16x16x32_bf16 v[12:15], a[104:107], v[36:39], v[12:15]
    v_mfma_f32_16x16x32_bf16 v[20:23], a[108:111], v[36:39], v[20:23]
    ds_read_b128 v[36:39], v80 offset:34816
    s_waitcnt lgkmcnt(5)
    v_mfma_f32_16x16x32_bf16 v[8:11], a[112:115], v[40:43], v[8:11]
    v_mfma_f32_16x16x32_bf16 v[16:19], a[116:119], v[40:43], v[16:19]
    ds_read_b128 v[40:43], v80 offset:17408
    s_waitcnt lgkmcnt(5)
    v_mfma_f32_16x16x32_bf16 v[12:15], a[112:115], v[44:47], v[12:15]
    v_mfma_f32_16x16x32_bf16 v[20:23], a[116:119], v[44:47], v[20:23]
    ds_read_b128 v[44:47], v80 offset:35840
    s_waitcnt lgkmcnt(5)
    v_mfma_f32_16x16x32_bf16 v[8:11], a[120:123], v[24:27], v[8:11]
    v_mfma_f32_16x16x32_bf16 v[16:19], a[124:127], v[24:27], v[16:19]
    s_waitcnt lgkmcnt(4)
    v_mfma_f32_16x16x32_bf16 v[12:15], a[120:123], v[28:31], v[12:15]
    v_mfma_f32_16x16x32_bf16 v[20:23], a[124:127], v[28:31], v[20:23]
    s_waitcnt lgkmcnt(3)
    v_mfma_f32_16x16x32_bf16 v[8:11], a[128:131], v[32:35], v[8:11]
    v_mfma_f32_16x16x32_bf16 v[16:19], a[132:135], v[32:35], v[16:19]
    s_waitcnt lgkmcnt(2)
    v_mfma_f32_16x16x32_bf16 v[12:15], a[128:131], v[36:39], v[12:15]
    v_mfma_f32_16x16x32_bf16 v[20:23], a[132:135], v[36:39], v[20:23]
    s_waitcnt lgkmcnt(1)
    v_mfma_f32_16x16x32_bf16 v[8:11], a[136:139], v[40:43], v[8:11]
    v_mfma_f32_16x16x32_bf16 v[16:19], a[140:143], v[40:43], v[16:19]
    s_waitcnt lgkmcnt(0)
    v_mfma_f32_16x16x32_bf16 v[12:15], a[136:139], v[44:47], v[12:15]
    v_mfma_f32_16x16x32_bf16 v[20:23], a[140:143], v[44:47], v[20:23]
    s_nop 4
    v_cvt_pk_bf16_f32 v48, v8, v16
    v_cvt_pk_bf16_f32 v49, v9, v17
    v_cvt_pk_bf16_f32 v50, v10, v18
    v_cvt_pk_bf16_f32 v51, v11, v19
    v_add_u32 v56, 73728, v0
    ds_write_b128 v56, v[48:51]
    v_cvt_pk_bf16_f32 v52, v12, v20
    v_cvt_pk_bf16_f32 v53, v13, v21
    v_cvt_pk_bf16_f32 v54, v14, v22
    v_cvt_pk_bf16_f32 v55, v15, v23
    v_add_u32 v56, 77824, v0
    ds_write_b128 v56, v[52:55]
    s_waitcnt lgkmcnt(0)
    s_barrier
    ds_read_b128 v[24:27], v81 offset:0
    ds_read_b128 v[28:31], v81 offset:1024
    ds_read_b128 v[32:35], v81 offset:2048
    ds_read_b128 v[36:39], v81 offset:3072
    s_waitcnt vmcnt(9) lgkmcnt(0)
    v_mfma_f32_16x16x32_bf16 v[8:11], v[112:115], v[24:27], 0
    v_mfma_f32_16x16x32_bf16 v[12:15], v[128:131], v[24:27], 0
    v_mfma_f32_16x16x32_bf16 v[8:11], v[116:119], v[28:31], v[8:11]
    v_mfma_f32_16x16x32_bf16 v[12:15], v[132:135], v[28:31], v[12:15]
    v_mfma_f32_16x16x32_bf16 v[8:11], v[120:123], v[32:35], v[8:11]
    v_mfma_f32_16x16x32_bf16 v[12:15], v[136:139], v[32:35], v[12:15]
    v_mfma_f32_16x16x32_bf16 v[8:11], v[124:127], v[36:39], v[8:11]
    v_mfma_f32_16x16x32_bf16 v[12:15], v[140:143], v[36:39], v[12:15]
    v_and_b32 v40, 0x7c, v7
    v_add_u32 v40, 1024, v40
    s_mov_b32 s12, 0
L_fw_91:
    global_load_dword v41, v40, s[44:45] sc1
    s_add_u32 s12, s12, 1
    s_cmp_gt_u32 s12, 100000
    s_cbranch_scc1 L_exit
    s_waitcnt vmcnt(0)
    v_cmp_gt_u32 vcc, s47, v41
    s_cbranch_vccz L_fwd_92
    s_branch L_fw_91
L_fwd_92:
    v_cvt_pk_bf16_f32 v9, v8, v9
    v_lshlrev_b32 v8, 16, v9
    v_and_b32 v9, 0xffff0000, v9
    v_pk_mul_f32 v[8:9], v[8:9], s[60:61] op_sel_hi:[1,0]
    v_cvt_pk_bf16_f32 v9, v8, v9
    v_lshlrev_b32 v8, 16, v9
    v_and_b32 v9, 0xffff0000, v9
    v_cvt_pk_bf16_f32 v11, v10, v11
    v_lshlrev_b32 v10, 16, v11
    v_and_b32 v11, 0xffff0000, v11
    v_pk_mul_f32 v[10:11], v[10:11], s[60:61] op_sel_hi:[1,0]
    v_cvt_pk_bf16_f32 v11, v10, v11
    v_lshlrev_b32 v10, 16, v11
    v_and_b32 v11, 0xffff0000, v11
    v_cvt_pk_bf16_f32 v13, v12, v13
    v_lshlrev_b32 v12, 16, v13
    v_and_b32 v13, 0xffff0000, v13
    v_pk_mul_f32 v[12:13], v[12:13], s[60:61] op_sel_hi:[1,0]
    v_cvt_pk_bf16_f32 v13, v12, v13
    v_lshlrev_b32 v12, 16, v13
    v_and_b32 v13, 0xffff0000, v13
    v_cvt_pk_bf16_f32 v15, v14, v15
    v_lshlrev_b32 v14, 16, v15
    v_and_b32 v15, 0xffff0000, v15
    v_pk_mul_f32 v[14:15], v[14:15], s[60:61] op_sel_hi:[1,0]
    v_cvt_pk_bf16_f32 v15, v14, v15
    v_lshlrev_b32 v14, 16, v15
    v_and_b32 v15, 0xffff0000, v15
    v_cndmask_b32 v8, v85, v8, s[64:65]
    v_cndmask_b32 v9, v85, v9, s[66:67]
    v_cndmask_b32 v10, v85, v10, s[68:69]
    v_cndmask_b32 v11, v85, v11, s[70:71]
    v_cndmask_b32 v12, v85, v12, s[72:73]
    v_cndmask_b32 v13, v85, v13, s[74:75]
    v_cndmask_b32 v14, v85, v14, s[76:77]
    v_cndmask_b32 v15, v85, v15, s[78:79]
    v_max3_f32 v20, v8, v9, v10
    v_max3_f32 v20, v20, v11, v12
    v_max3_f32 v20, v20, v13, v14
    v_max_f32 v20, v20, v15
    s_mov_b32 s12, 0
L_km_93:
    global_load_dwordx4 v[40:43], v0, s[30:31] sc1
    s_add_u32 s12, s12, 1
    s_cmp_gt_u32 s12, 100000
    s_cbranch_scc1 L_exit
    s_waitcnt vmcnt(0)
    ds_write2_b32 v87, v40, v41 offset0:0 offset1:72
    ds_write_b64 v109, v[42:43]
    v_max3_u32 v44, v40, v41, v42
    v_max_u32 v44, v44, v43
    v_cmp_eq_u32 vcc, -1, v44
    s_cbranch_vccz L_kmok_94
    s_sleep 1
    s_branch L_km_93
L_kmok_94:
    s_waitcnt lgkmcnt(0)
    s_barrier
    ds_read_b128 v[160:163], v83 offset:0
    ds_read_b128 v[164:167], v83 offset:64
    ds_read_b128 v[168:171], v83 offset:128
    ds_read_b128 v[172:175], v83 offset:192
    ds_read_b64 v[176:177], v84 offset:0
    ds_read_b64 v[178:179], v84 offset:512
    s_waitcnt lgkmcnt(5)
    v_mfma_f32_16x16x32_bf16 v[16:19], v[160:163], v[24:27], 0
    s_waitcnt lgkmcnt(4)
    v_mfma_f32_16x16x32_bf16 v[16:19], v[164:167], v[28:31], v[16:19]
    s_waitcnt lgkmcnt(3)
    v_mfma_f32_16x16x32_bf16 v[16:19], v[168:171], v[32:35], v[16:19]
    s_waitcnt lgkmcnt(2)
    v_mfma_f32_16x16x32_bf16 v[16:19], v[172:175], v[36:39], v[16:19]
    s_nop 7
    v_cvt_pk_bf16_f32 v17, v16, v17
    v_lshlrev_b32 v16, 16, v17
    v_and_b32 v17, 0xffff0000, v17
    v_pk_mul_f32 v[16:17], v[16:17], s[60:61] op_sel_hi:[1,0]
    v_cvt_pk_bf16_f32 v17, v16, v17
    v_lshlrev_b32 v16, 16, v17
    v_and_b32 v17, 0xffff0000, v17
    v_max3_f32 v20, v20, v16, v17
    v_mov_b32 v21, v20
    s_nop 1
    v_permlane16_swap_b32 v20, v21
    v_max_f32 v20, v20, v21
    v_mov_b32 v21, v20
    s_nop 1
    v_permlane32_swap_b32 v20, v21
    v_max_f32 v20, v20, v21
    v_pk_add_f32 v[8:9], v[8:9], v[20:21] op_sel_hi:[1,0] neg_lo:[0,1] neg_hi:[0,1]
    v_pk_add_f32 v[10:11], v[10:11], v[20:21] op_sel_hi:[1,0] neg_lo:[0,1] neg_hi:[0,1]
    v_pk_add_f32 v[12:13], v[12:13], v[20:21] op_sel_hi:[1,0] neg_lo:[0,1] neg_hi:[0,1]
    v_pk_add_f32 v[14:15], v[14:15], v[20:21] op_sel_hi:[1,0] neg_lo:[0,1] neg_hi:[0,1]
    v_pk_add_f32 v[16:17], v[16:17], v[20:21] op_sel_hi:[1,0] neg_lo:[0,1] neg_hi:[0,1]
    v_pk_mul_f32 v[8:9], v[8:9], s[60:61] op_sel:[0,1]
    v_pk_mul_f32 v[10:11], v[10:11], s[60:61] op_sel:[0,1]
    v_pk_mul_f32 v[12:13], v[12:13], s[60:61] op_sel:[0,1]
    v_pk_mul_f32 v[14:15], v[14:15], s[60:61] op_sel:[0,1]
    v_pk_mul_f32 v[16:17], v[16:17], s[60:61] op_sel:[0,1]
    v_exp_f32 v8, v8
    v_exp_f32 v9, v9
    v_exp_f32 v10, v10
    v_exp_f32 v11, v11
    v_exp_f32 v12, v12
    v_exp_f32 v13, v13
    v_exp_f32 v14, v14
    v_exp_f32 v15, v15
    v_exp_f32 v16, v16
    v_exp_f32 v17, v17
    v_pk_add_f32 v[22:23], v[8:9], v[10:11]
    v_pk_add_f32 v[22:23], v[22:23], v[12:13]
    v_pk_add_f32 v[22:23], v[22:23], v[14:15]
    v_pk_add_f32 v[22:23], v[22:23], v[16:17]
    v_add_f32 v22, v22, v23
    v_mov_b32 v21, v22
    s_nop 1
    v_permlane16_swap_b32 v22, v21
    v_add_f32 v22, v22, v21
    v_mov_b32 v21, v22
    s_nop 1
    v_permlane32_swap_b32 v22, v21
    v_add_f32 v22, v22, v21
    v_rcp_f32 v22, v22
    s_nop 0
    v_pk_mul_f32 v[8:9], v[8:9], v[22:23] op_sel_hi:[1,0]
    v_pk_mul_f32 v[10:11], v[10:11], v[22:23] op_sel_hi:[1,0]
    v_pk_mul_f32 v[12:13], v[12:13], v[22:23] op_sel_hi:[1,0]
    v_pk_mul_f32 v[14:15], v[14:15], v[22:23] op_sel_hi:[1,0]
    v_pk_mul_f32 v[16:17], v[16:17], v[22:23] op_sel_hi:[1,0]
    v_cvt_pk_bf16_f32 v40, v8, v9
    v_cvt_pk_bf16_f32 v41, v10, v11
    v_cvt_pk_bf16_f32 v42, v12, v13
    v_cvt_pk_bf16_f32 v43, v14, v15
    v_cvt_pk_bf16_f32 v44, v16, v17
    v_mov_b32 v45, 0
    v_mov_b32 v46, 0
    v_mov_b32 v47, v44
    v_mfma_f32_16x16x32_bf16 v[24:27], v[144:147], v[40:43], 0
    v_mfma_f32_16x16x32_bf16 v[28:31], v[148:151], v[40:43], 0
    v_mfma_f32_16x16x32_bf16 v[32:35], v[152:155], v[40:43], 0
    v_mfma_f32_16x16x32_bf16 v[36:39], v[156:159], v[40:43], 0
    s_waitcnt lgkmcnt(0)
    s_nop 1
    v_mfma_f32_16x16x16_bf16 v[24:27], v[176:177], v[44:45], v[24:27]
    v_mfma_f32_16x16x16_bf16 v[28:31], v[176:177], v[46:47], v[28:31]
    v_mfma_f32_16x16x16_bf16 v[32:35], v[178:179], v[44:45], v[32:35]
    v_mfma_f32_16x16x16_bf16 v[36:39], v[178:179], v[46:47], v[36:39]
    s_nop 4
    v_cvt_pk_bf16_f32 v48, v24, v25
    v_cvt_pk_bf16_f32 v49, v26, v27
    v_cvt_pk_bf16_f32 v50, v28, v29
    v_cvt_pk_bf16_f32 v51, v30, v31
    v_cvt_pk_bf16_f32 v52, v32, v33
    v_cvt_pk_bf16_f32 v53, v34, v35
    v_cvt_pk_bf16_f32 v54, v36, v37
    v_cvt_pk_bf16_f32 v55, v38, v39
    ds_write_b128 v82, v[48:51]
    ds_write_b128 v82, v[52:55] offset:1024
    s_waitcnt lgkmcnt(0)
    s_barrier
    v_add_u32 v1, 81920, v1
    s_add_u32 s47, s47, 1
    s_xor_b32 s46, s47, s9
    s_and_b32 s46, s46, 1
    v_mov_b32 v24, s46
    ds_read_b128 v[8:11], v1 offset:0
    ds_read_b128 v[12:15], v1 offset:1024
    ds_read_b128 v[16:19], v1 offset:2048
    ds_read_b128 v[20:23], v1 offset:3072
    s_waitcnt lgkmcnt(3)
    v_mfma_f32_16x16x32_bf16 v[28:31], v[240:243], v[8:11], 0
    v_mfma_f32_16x16x32_bf16 v[32:35], v[8:11], a[144:147], 0
    v_mfma_f32_16x16x32_bf16 v[36:39], v[8:11], a[160:163], 0
    s_waitcnt lgkmcnt(2)
    v_mfma_f32_16x16x32_bf16 v[28:31], v[244:247], v[12:15], v[28:31]
    v_mfma_f32_16x16x32_bf16 v[32:35], v[12:15], a[148:151], v[32:35]
    v_mfma_f32_16x16x32_bf16 v[36:39], v[12:15], a[164:167], v[36:39]
    s_waitcnt lgkmcnt(1)
    v_mfma_f32_16x16x32_bf16 v[28:31], v[248:251], v[16:19], v[28:31]
    v_mfma_f32_16x16x32_bf16 v[32:35], v[16:19], a[152:155], v[32:35]
    v_mfma_f32_16x16x32_bf16 v[36:39], v[16:19], a[168:171], v[36:39]
    s_waitcnt lgkmcnt(0)
    v_mfma_f32_16x16x32_bf16 v[28:31], v[252:255], v[20:23], v[28:31]
    v_mfma_f32_16x16x32_bf16 v[32:35], v[20:23], a[156:159], v[32:35]
    v_mfma_f32_16x16x32_bf16 v[36:39], v[20:23], a[172:175], v[36:39]
    v_mfma_f32_16x16x32_bf16 v[40:43], v[8:11], a[176:179], 0
    v_mfma_f32_16x16x32_bf16 v[44:47], v[8:11], a[192:195], 0
    v_mfma_f32_16x16x32_bf16 v[40:43], v[12:15], a[180:183], v[40:43]
    v_mfma_f32_16x16x32_bf16 v[44:47], v[12:15], a[196:199], v[44:47]
    s_nop 1
    v_cvt_pk_bf16_f32 v28, v28, v29
    v_cvt_pk_bf16_f32 v29, v30, v31
    v_mfma_f32_16x16x32_bf16 v[40:43], v[16:19], a[184:187], v[40:43]
    v_bfi_b32 v28, 1, v24, v28
    s_add_u32 s12, s40, 0
    s_addc_u32 s13, s41, 0
    global_store_dwordx2 v3, v[28:29], s[12:13] sc1
    v_mfma_f32_16x16x32_bf16 v[44:47], v[16:19], a[200:203], v[44:47]
    v_cvt_pk_bf16_f32 v52, v32, v36
    v_cvt_pk_bf16_f32 v56, v33, v37
    v_mfma_f32_16x16x32_bf16 v[40:43], v[20:23], a[188:191], v[40:43]
    v_cvt_pk_bf16_f32 v60, v34, v38
    v_cvt_pk_bf16_f32 v64, v35, v39
    v_mfma_f32_16x16x32_bf16 v[44:47], v[20:23], a[204:207], v[44:47]
    v_bfi_b32 v52, 1, v24, v52
    v_bfi_b32 v56, 1, v24, v56
    v_mfma_f32_16x16x32_bf16 v[48:51], v[8:11], a[208:211], 0
    v_bfi_b32 v60, 1, v24, v60
    v_bfi_b32 v64, 1, v24, v64
    v_mfma_f32_16x16x32_bf16 v[28:31], v[8:11], a[224:227], 0
    v_mfma_f32_16x16x32_bf16 v[48:51], v[12:15], a[212:215], v[48:51]
    v_mfma_f32_16x16x32_bf16 v[28:31], v[12:15], a[228:231], v[28:31]
    v_cvt_pk_bf16_f32 v53, v40, v44
    v_cvt_pk_bf16_f32 v57, v41, v45
    v_mfma_f32_16x16x32_bf16 v[48:51], v[16:19], a[216:219], v[48:51]
    v_cvt_pk_bf16_f32 v61, v42, v46
    v_cvt_pk_bf16_f32 v65, v43, v47
    v_mfma_f32_16x16x32_bf16 v[28:31], v[16:19], a[232:235], v[28:31]
    s_add_u32 s12, s40, 0
    s_addc_u32 s13, s41, 0
    global_store_dwordx2 v2, v[52:53], s[12:13] offset:0 sc1
    v_mfma_f32_16x16x32_bf16 v[48:51], v[20:23], a[220:223], v[48:51]
    s_add_u32 s12, s40, 36864
    s_addc_u32 s13, s41, 0
    global_store_dwordx2 v2, v[56:57], s[12:13] offset:0 sc1
    v_mfma_f32_16x16x32_bf16 v[28:31], v[20:23], a[236:239], v[28:31]
    s_add_u32 s12, s40, 73728
    s_addc_u32 s13, s41, 0
    global_store_dwordx2 v2, v[60:61], s[12:13] offset:0 sc1
    v_mfma_f32_16x16x32_bf16 v[32:35], v[8:11], a[240:243], 0
    s_add_u32 s12, s40, 110592
    s_addc_u32 s13, s41, 0
    global_store_dwordx2 v2, v[64:65], s[12:13] offset:0 sc1
    v_mfma_f32_16x16x32_bf16 v[36:39], v[8:11], v[224:227], 0
    v_mfma_f32_16x16x32_bf16 v[32:35], v[12:15], a[244:247], v[32:35]
    v_mfma_f32_16x16x32_bf16 v[36:39], v[12:15], v[228:231], v[36:39]
    v_cvt_pk_bf16_f32 v54, v48, v28
    v_cvt_pk_bf16_f32 v58, v49, v29
    v_mfma_f32_16x16x32_bf16 v[32:35], v[16:19], a[248:251], v[32:35]
    v_cvt_pk_bf16_f32 v62, v50, v30
    v_cvt_pk_bf16_f32 v66, v51, v31
    v_mfma_f32_16x16x32_bf16 v[36:39], v[16:19], v[232:235], v[36:39]
    v_bfi_b32 v54, 1, v24, v54
    v_bfi_b32 v58, 1, v24, v58
    v_mfma_f32_16x16x32_bf16 v[32:35], v[20:23], a[252:255], v[32:35]
    v_bfi_b32 v62, 1, v24, v62
    v_bfi_b32 v66, 1, v24, v66
    v_mfma_f32_16x16x32_bf16 v[36:39], v[20:23], v[236:239], v[36:39]
    ds_read_b128 v[8:11], v1 offset:4096
    ds_read_b128 v[12:15], v1 offset:5120
    ds_read_b128 v[16:19], v1 offset:6144
    ds_read_b128 v[20:23], v1 offset:7168
    s_waitcnt lgkmcnt(3)
    v_mfma_f32_16x16x32_bf16 v[40:43], v[240:243], v[8:11], 0
    v_mfma_f32_16x16x32_bf16 v[44:47], v[8:11], a[144:147], 0
    v_mfma_f32_16x16x32_bf16 v[48:51], v[8:11], a[160:163], 0
    s_waitcnt lgkmcnt(2)
    v_mfma_f32_16x16x32_bf16 v[40:43], v[244:247], v[12:15], v[40:43]
    v_cvt_pk_bf16_f32 v55, v32, v36
    v_cvt_pk_bf16_f32 v59, v33, v37
    v_mfma_f32_16x16x32_bf16 v[44:47], v[12:15], a[148:151], v[44:47]
    v_cvt_pk_bf16_f32 v63, v34, v38
    v_cvt_pk_bf16_f32 v67, v35, v39
    v_mfma_f32_16x16x32_bf16 v[48:51], v[12:15], a[164:167], v[48:51]
    s_add_u32 s12, s40, 0
    s_addc_u32 s13, s41, 0
    global_store_dwordx2 v2, v[54:55], s[12:13] offset:128 sc1
    s_waitcnt lgkmcnt(1)
    v_mfma_f32_16x16x32_bf16 v[40:43], v[248:251], v[16:19], v[40:43]
    s_add_u32 s12, s40, 36864
    s_addc_u32 s13, s41, 0
    global_store_dwordx2 v2, v[58:59], s[12:13] offset:128 sc1
    v_mfma_f32_16x16x32_bf16 v[44:47], v[16:19], a[152:155], v[44:47]
    s_add_u32 s12, s40, 73728
    s_addc_u32 s13, s41, 0
    global_store_dwordx2 v2, v[62:63], s[12:13] offset:128 sc1
    v_mfma_f32_16x16x32_bf16 v[48:51], v[16:19], a[168:171], v[48:51]
    s_add_u32 s12, s40, 110592
    s_addc_u32 s13, s41, 0
    global_store_dwordx2 v2, v[66:67], s[12:13] offset:128 sc1
    s_waitcnt lgkmcnt(0)
    v_mfma_f32_16x16x32_bf16 v[40:43], v[252:255], v[20:23], v[40:43]
    v_mfma_f32_16x16x32_bf16 v[44:47], v[20:23], a[156:159], v[44:47]
    v_mfma_f32_16x16x32_bf16 v[48:51], v[20:23], a[172:175], v[48:51]
    v_mfma_f32_16x16x32_bf16 v[28:31], v[8:11], a[176:179], 0
    v_mfma_f32_16x16x32_bf16 v[32:35], v[8:11], a[192:195], 0
    v_mfma_f32_16x16x32_bf16 v[28:31], v[12:15], a[180:183], v[28:31]
    v_mfma_f32_16x16x32_bf16 v[32:35], v[12:15], a[196:199], v[32:35]
    s_nop 1
    v_cvt_pk_bf16_f32 v40, v40, v41
    v_cvt_pk_bf16_f32 v41, v42, v43
    v_mfma_f32_16x16x32_bf16 v[28:31], v[16:19], a[184:187], v[28:31]
    v_bfi_b32 v40, 1, v24, v40
    s_add_u32 s12, s40, 589824
    s_addc_u32 s13, s41, 0
    global_store_dwordx2 v3, v[40:41], s[12:13] sc1
    v_mfma_f32_16x16x32_bf16 v[32:35], v[16:19], a[200:203], v[32:35]
    v_cvt_pk_bf16_f32 v52, v44, v48
    v_cvt_pk_bf16_f32 v56, v45, v49
    v_mfma_f32_16x16x32_bf16 v[28:31], v[20:23], a[188:191], v[28:31]
    v_cvt_pk_bf16_f32 v60, v46, v50
    v_cvt_pk_bf16_f32 v64, v47, v51
    v_mfma_f32_16x16x32_bf16 v[32:35], v[20:23], a[204:207], v[32:35]
    v_bfi_b32 v52, 1, v24, v52
    v_bfi_b32 v56, 1, v24, v56
    v_mfma_f32_16x16x32_bf16 v[36:39], v[8:11], a[208:211], 0
    v_bfi_b32 v60, 1, v24, v60
    v_bfi_b32 v64, 1, v24, v64
    v_mfma_f32_16x16x32_bf16 v[40:43], v[8:11], a[224:227], 0
    v_mfma_f32_16x16x32_bf16 v[36:39], v[12:15], a[212:215], v[36:39]
    v_mfma_f32_16x16x32_bf16 v[40:43], v[12:15], a[228:231], v[40:43]
    v_cvt_pk_bf16_f32 v53, v28, v32
    v_cvt_pk_bf16_f32 v57, v29, v33
    v_mfma_f32_16x16x32_bf16 v[36:39], v[16:19], a[216:219], v[36:39]
    v_cvt_pk_bf16_f32 v61, v30, v34
    v_cvt_pk_bf16_f32 v65, v31, v35
    v_mfma_f32_16x16x32_bf16 v[40:43], v[16:19], a[232:235], v[40:43]
    s_add_u32 s12, s40, 589824
    s_addc_u32 s13, s41, 0
    global_store_dwordx2 v2, v[52:53], s[12:13] offset:0 sc1
    v_mfma_f32_16x16x32_bf16 v[36:39], v[20:23], a[220:223], v[36:39]
    s_add_u32 s12, s40, 626688
    s_addc_u32 s13, s41, 0
    global_store_dwordx2 v2, v[56:57], s[12:13] offset:0 sc1
    v_mfma_f32_16x16x32_bf16 v[40:43], v[20:23], a[236:239], v[40:43]
    s_add_u32 s12, s40, 663552
    s_addc_u32 s13, s41, 0
    global_store_dwordx2 v2, v[60:61], s[12:13] offset:0 sc1
    v_mfma_f32_16x16x32_bf16 v[44:47], v[8:11], a[240:243], 0
    s_add_u32 s12, s40, 700416
    s_addc_u32 s13, s41, 0
    global_store_dwordx2 v2, v[64:65], s[12:13] offset:0 sc1
    v_mfma_f32_16x16x32_bf16 v[48:51], v[8:11], v[224:227], 0
    v_mfma_f32_16x16x32_bf16 v[44:47], v[12:15], a[244:247], v[44:47]
    v_mfma_f32_16x16x32_bf16 v[48:51], v[12:15], v[228:231], v[48:51]
    v_cvt_pk_bf16_f32 v54, v36, v40
    v_cvt_pk_bf16_f32 v58, v37, v41
    v_mfma_f32_16x16x32_bf16 v[44:47], v[16:19], a[248:251], v[44:47]
    v_cvt_pk_bf16_f32 v62, v38, v42
    v_cvt_pk_bf16_f32 v66, v39, v43
    v_mfma_f32_16x16x32_bf16 v[48:51], v[16:19], v[232:235], v[48:51]
    v_bfi_b32 v54, 1, v24, v54
    v_bfi_b32 v58, 1, v24, v58
    v_mfma_f32_16x16x32_bf16 v[44:47], v[20:23], a[252:255], v[44:47]
    v_bfi_b32 v62, 1, v24, v62
    v_bfi_b32 v66, 1, v24, v66
    v_mfma_f32_16x16x32_bf16 v[48:51], v[20:23], v[236:239], v[48:51]
    s_nop 7
    v_cvt_pk_bf16_f32 v55, v44, v48
    v_cvt_pk_bf16_f32 v59, v45, v49
    v_cvt_pk_bf16_f32 v63, v46, v50
    v_cvt_pk_bf16_f32 v67, v47, v51
    s_add_u32 s12, s40, 589824
    s_addc_u32 s13, s41, 0
    global_store_dwordx2 v2, v[54:55], s[12:13] offset:128 sc1
    s_add_u32 s12, s40, 626688
    s_addc_u32 s13, s41, 0
    global_store_dwordx2 v2, v[58:59], s[12:13] offset:128 sc1
    s_add_u32 s12, s40, 663552
    s_addc_u32 s13, s41, 0
    global_store_dwordx2 v2, v[62:63], s[12:13] offset:128 sc1
    s_add_u32 s12, s40, 700416
    s_addc_u32 s13, s41, 0
    global_store_dwordx2 v2, v[66:67], s[12:13] offset:128 sc1
    v_bfe_u32 v10, v7, 2, 1
    v_lshlrev_b32 v10, 4, v10
    v_mov_b32 v11, 0x3f80
    v_lshlrev_b32 v11, v10, v11
    v_bfe_u32 v10, v7, 3, 2
    v_cmp_eq_u32 vcc, 0, v10
    s_nop 1
    v_cndmask_b32 v12, 0, v11, vcc
    v_cmp_eq_u32 vcc, 1, v10
    s_nop 1
    v_cndmask_b32 v13, 0, v11, vcc
    v_cmp_eq_u32 vcc, 2, v10
    s_nop 1
    v_cndmask_b32 v14, 0, v11, vcc
    v_cmp_eq_u32 vcc, 3, v10
    s_nop 1
    v_cndmask_b32 v15, 0, v11, vcc
    v_mov_b32 v26, 0x16800
    v_bfe_u32 v10, v0, 4, 3
    v_lshl_add_u32 v26, v10, 5, v26
    v_bfe_u32 v10, v0, 8, 1
    v_lshl_add_u32 v26, v10, 4, v26
    v_bfe_u32 v10, v0, 10, 2
    v_lshl_add_u32 v26, v10, 8, v26
    s_and_b32 s12, s47, 1
    s_sub_u32 s12, 0, s12
    v_bfe_i32 v10, v7, 6, 1
    v_bfe_i32 v11, v7, 5, 1
    v_xor_b32 v10, s12, v10
    v_xor_b32 v11, s12, v11
    s_waitcnt vmcnt(0)
    s_cmp_lg_u32 s47, 1
    s_cbranch_scc1 L_nf_95
    s_barrier
    s_cmp_lg_u32 s10, 0
    s_cbranch_scc1 L_pf_96
    s_lshl_b32 s12, s9, 2
    v_mov_b32 v8, s12
    v_mov_b32 v9, s47
    s_mov_b64 exec, 1
    global_store_dword v8, v9, s[44:45] offset:0 sc1
    s_mov_b64 exec, -1
L_pf_96:
    v_and_b32 v8, 0x7c, v7
    s_mov_b32 s12, 0
L_fw_97:
    global_load_dword v9, v8, s[44:45] sc1
    s_add_u32 s12, s12, 1
    s_cmp_gt_u32 s12, 100000
    s_cbranch_scc1 L_exit
    s_waitcnt vmcnt(0)
    v_cmp_gt_u32 vcc, s47, v9
    s_cbranch_vccz L_fwd_98
    s_sleep 8
    s_branch L_fw_97
L_fwd_98:
L_nf_95:
    s_mov_b32 s14, 0
L_xr_99:
    s_mov_b64 s[12:13], s[42:43]
    global_load_dwordx4 v[60:63], v6, s[12:13] sc1
    global_load_dwordx4 v[28:31], v4, s[12:13] sc1
    s_add_u32 s12, s12, 4608
    s_addc_u32 s13, s13, 0
    global_load_dwordx4 v[32:35], v4, s[12:13] sc1
    s_add_u32 s12, s12, 4608
    s_addc_u32 s13, s13, 0
    global_load_dwordx4 v[36:39], v4, s[12:13] sc1
    s_add_u32 s12, s12, 4608
    s_addc_u32 s13, s13, 0
    global_load_dwordx4 v[40:43], v4, s[12:13] sc1
    s_add_u32 s12, s12, 4608
    s_addc_u32 s13, s13, 0
    global_load_dwordx4 v[44:47], v4, s[12:13] sc1
    s_add_u32 s12, s12, 4608
    s_addc_u32 s13, s13, 0
    global_load_dwordx4 v[48:51], v4, s[12:13] sc1
    s_add_u32 s12, s12, 4608
    s_addc_u32 s13, s13, 0
    global_load_dwordx4 v[52:55], v4, s[12:13] sc1
    s_add_u32 s12, s12, 4608
    s_addc_u32 s13, s13, 0
    global_load_dwordx4 v[56:59], v4, s[12:13] sc1
    s_mov_b64 exec, -1
    s_add_u32 s14, s14, 1
    s_cmp_gt_u32 s14, 100000
    s_cbranch_scc1 L_exit
    s_waitcnt vmcnt(8)
    v_mfma_f32_16x16x32_bf16 v[20:23], v[12:15], v[60:63], 0
    v_bitop3_b32 v8, v60, v62, v11 bitop3:0x7e
    v_and_b32 v8, 1, v8
    s_waitcnt vmcnt(7)
    v_mfma_f32_16x16x32_bf16 v[16:19], v[12:15], v[28:31], 0
    v_bitop3_b32 v9, v28, v30, v10 bitop3:0x7e
    v_and_or_b32 v8, v9, 1, v8
    s_waitcnt vmcnt(6)
    v_mfma_f32_16x16x32_bf16 v[16:19], v[12:15], v[32:35], v[16:19]
    v_bitop3_b32 v9, v32, v34, v10 bitop3:0x7e
    v_and_or_b32 v8, v9, 1, v8
    s_waitcnt vmcnt(5)
    v_mfma_f32_16x16x32_bf16 v[16:19], v[12:15], v[36:39], v[16:19]
    v_bitop3_b32 v9, v36, v38, v10 bitop3:0x7e
    v_and_or_b32 v8, v9, 1, v8
    s_waitcnt vmcnt(4)
    v_mfma_f32_16x16x32_bf16 v[16:19], v[12:15], v[40:43], v[16:19]
    v_bitop3_b32 v9, v40, v42, v10 bitop3:0x7e
    v_and_or_b32 v8, v9, 1, v8
    s_waitcnt vmcnt(3)
    v_mfma_f32_16x16x32_bf16 v[16:19], v[12:15], v[44:47], v[16:19]
    v_bitop3_b32 v9, v44, v46, v10 bitop3:0x7e
    v_and_or_b32 v8, v9, 1, v8
    v_add_f32_dpp v20, v20, v20 row_ror:8 row_mask:0xf bank_mask:0xf
    v_add_f32_dpp v21, v21, v21 row_ror:8 row_mask:0xf bank_mask:0xf
    v_add_f32_dpp v22, v22, v22 row_ror:8 row_mask:0xf bank_mask:0xf
    v_add_f32_dpp v23, v23, v23 row_ror:8 row_mask:0xf bank_mask:0xf
    ds_write_b128 v26, v[20:23]
    s_waitcnt vmcnt(2)
    v_mfma_f32_16x16x32_bf16 v[16:19], v[12:15], v[48:51], v[16:19]
    v_bitop3_b32 v9, v48, v50, v10 bitop3:0x7e
    v_and_or_b32 v8, v9, 1, v8
    s_waitcnt vmcnt(1)
    v_mfma_f32_16x16x32_bf16 v[16:19], v[12:15], v[52:55], v[16:19]
    v_bitop3_b32 v9, v52, v54, v10 bitop3:0x7e
    v_and_or_b32 v8, v9, 1, v8
    s_waitcnt vmcnt(0)
    v_mfma_f32_16x16x32_bf16 v[16:19], v[12:15], v[56:59], v[16:19]
    v_bitop3_b32 v9, v56, v58, v10 bitop3:0x7e
    v_and_or_b32 v8, v9, 1, v8
    v_cmp_ne_u32 vcc, 0, v8
    s_mov_b64 exec, vcc
    s_cbranch_vccnz L_xr_99
    s_mov_b64 exec, -1
    s_nop 1
    ds_write_b32 v5, v16 offset:0
    ds_write_b32 v5, v17 offset:256
    ds_write_b32 v5, v18 offset:512
    ds_write_b32 v5, v19 offset:768
    s_waitcnt lgkmcnt(0)
    s_barrier
    s_cmp_lg_u32 s10, 1
    s_cbranch_scc1 L_pf_100
    s_lshl_b32 s12, s9, 2
    v_mov_b32 v8, s12
    v_mov_b32 v9, s47
    s_mov_b64 exec, 1
    global_store_dword v8, v9, s[44:45] offset:1024 sc1
    s_mov_b64 exec, -1
L_pf_100:
    v_subrev_u32 v1, 81920, v1
    s_cmp_lg_u32 s10, 0
    s_cbranch_scc1 L_a_next_s
    v_add_u32 v7, 45056, v7
    v_lshlrev_b32 v48, 1, v7
    ds_read_b64 v[16:17], v48 offset:2048
    ds_read_b64 v[18:19], v48 offset:2304
    ds_read_b64 v[20:21], v48 offset:2560
    ds_read_b64 v[22:23], v48 offset:2816
    ds_read_b64 v[8:9], v48 offset:0
    ds_read_b64 v[10:11], v48 offset:512
    ds_read_b64 v[12:13], v48 offset:1024
    ds_read_b64 v[14:15], v48 offset:1536
    s_waitcnt lgkmcnt(4)
    v_pk_add_f32 v[16:17], v[16:17], v[18:19]
    v_pk_add_f32 v[20:21], v[20:21], v[22:23]
    v_pk_add_f32 v[16:17], v[16:17], v[20:21]
    s_waitcnt lgkmcnt(0)
    v_cvt_pk_bf16_f32 v9, v8, v9
    v_lshlrev_b32 v8, 16, v9
    v_and_b32 v9, 0xffff0000, v9
    v_cvt_pk_bf16_f32 v11, v10, v11
    v_lshlrev_b32 v10, 16, v11
    v_and_b32 v11, 0xffff0000, v11
    v_cvt_pk_bf16_f32 v13, v12, v13
    v_lshlrev_b32 v12, 16, v13
    v_and_b32 v13, 0xffff0000, v13
    v_cvt_pk_bf16_f32 v15, v14, v15
    v_lshlrev_b32 v14, 16, v15
    v_and_b32 v15, 0xffff0000, v15
    v_cvt_pk_bf16_f32 v17, v16, v17
    v_lshlrev_b32 v16, 16, v17
    v_and_b32 v17, 0xffff0000, v17
    v_subrev_u32 v7, 45056, v7
    v_mov_b64 v[20:21], 0
    v_lshlrev_b32 v18, 16, v88
    v_and_b32 v19, 0xffff0000, v88
    v_pk_mul_f32 v[8:9], v[8:9], v[18:19]
    v_cvt_pk_bf16_f32 v9, v8, v9
    v_lshlrev_b32 v8, 16, v9
    v_and_b32 v9, 0xffff0000, v9
    v_lshlrev_b32 v18, 16, v104
    v_and_b32 v19, 0xffff0000, v104
    v_pk_add_f32 v[8:9], v[8:9], v[18:19]
    v_cvt_pk_bf16_f32 v24, v8, v9
    v_lshlrev_b32 v8, 16, v24
    v_and_b32 v9, 0xffff0000, v24
    global_store_dword v7, v24, s[36:37] offset:0 sc1
    v_pk_add_f32 v[20:21], v[20:21], v[8:9]
    v_lshlrev_b32 v18, 16, v89
    v_and_b32 v19, 0xffff0000, v89
    v_pk_mul_f32 v[10:11], v[10:11], v[18:19]
    v_cvt_pk_bf16_f32 v11, v10, v11
    v_lshlrev_b32 v10, 16, v11
    v_and_b32 v11, 0xffff0000, v11
    v_lshlrev_b32 v18, 16, v105
    v_and_b32 v19, 0xffff0000, v105
    v_pk_add_f32 v[10:11], v[10:11], v[18:19]
    v_cvt_pk_bf16_f32 v25, v10, v11
    v_lshlrev_b32 v10, 16, v25
    v_and_b32 v11, 0xffff0000, v25
    global_store_dword v7, v25, s[36:37] offset:256 sc1
    v_pk_add_f32 v[20:21], v[20:21], v[10:11]
    v_lshlrev_b32 v18, 16, v90
    v_and_b32 v19, 0xffff0000, v90
    v_pk_mul_f32 v[12:13], v[12:13], v[18:19]
    v_cvt_pk_bf16_f32 v13, v12, v13
    v_lshlrev_b32 v12, 16, v13
    v_and_b32 v13, 0xffff0000, v13
    v_lshlrev_b32 v18, 16, v106
    v_and_b32 v19, 0xffff0000, v106
    v_pk_add_f32 v[12:13], v[12:13], v[18:19]
    v_cvt_pk_bf16_f32 v26, v12, v13
    v_lshlrev_b32 v12, 16, v26
    v_and_b32 v13, 0xffff0000, v26
    global_store_dword v7, v26, s[36:37] offset:512 sc1
    v_pk_add_f32 v[20:21], v[20:21], v[12:13]
    v_lshlrev_b32 v18, 16, v91
    v_and_b32 v19, 0xffff0000, v91
    v_pk_mul_f32 v[14:15], v[14:15], v[18:19]
    v_cvt_pk_bf16_f32 v15, v14, v15
    v_lshlrev_b32 v14, 16, v15
    v_and_b32 v15, 0xffff0000, v15
    v_lshlrev_b32 v18, 16, v107
    v_and_b32 v19, 0xffff0000, v107
    v_pk_add_f32 v[14:15], v[14:15], v[18:19]
    v_cvt_pk_bf16_f32 v27, v14, v15
    v_lshlrev_b32 v14, 16, v27
    v_and_b32 v15, 0xffff0000, v27
    global_store_dword v7, v27, s[36:37] offset:768 sc1
    v_pk_add_f32 v[20:21], v[20:21], v[14:15]
    s_mov_b32 exec_hi, 0
    v_lshlrev_b32 v18, 16, v92
    v_and_b32 v19, 0xffff0000, v92
    v_pk_mul_f32 v[16:17], v[16:17], v[18:19]
    v_cvt_pk_bf16_f32 v17, v16, v17
    v_lshlrev_b32 v16, 16, v17
    v_and_b32 v17, 0xffff0000, v17
    v_lshlrev_b32 v18, 16, v108
    v_and_b32 v19, 0xffff0000, v108
    v_pk_add_f32 v[16:17], v[16:17], v[18:19]
    v_cvt_pk_bf16_f32 v28, v16, v17
    v_lshlrev_b32 v16, 16, v28
    v_and_b32 v17, 0xffff0000, v28
    global_store_dword v7, v28, s[36:37] offset:1024 sc1
    v_pk_add_f32 v[20:21], v[20:21], v[16:17]
    s_mov_b64 exec, -1
    v_add_f32 v20, v20, v21
    s_nop 1
    v_add_f32_dpp v20, v20, v20 quad_perm:[1,0,3,2] row_mask:0xf bank_mask:0xf
    s_nop 1
    v_add_f32_dpp v20, v20, v20 quad_perm:[2,3,0,1] row_mask:0xf bank_mask:0xf
    s_nop 1
    v_add_f32_dpp v20, v20, v20 row_ror:4 row_mask:0xf bank_mask:0xf
    s_nop 1
    v_add_f32_dpp v20, v20, v20 row_ror:8 row_mask:0xf bank_mask:0xf
    v_mov_b32 v21, v20
    s_nop 1
    v_permlane16_swap_b32 v20, v21
    v_add_f32 v20, v20, v21
    v_mov_b32 v21, v20
    s_nop 1
    v_permlane32_swap_b32 v20, v21
    v_add_f32 v20, v20, v21
    v_mul_f32 v20, 0x3ae38e39, v20
    v_mov_b64 v[22:23], 0
    v_pk_add_f32 v[18:19], v[8:9], v[20:21] op_sel_hi:[1,0] neg_lo:[0,1] neg_hi:[0,1]
    v_pk_fma_f32 v[22:23], v[18:19], v[18:19], v[22:23]
    v_pk_add_f32 v[18:19], v[10:11], v[20:21] op_sel_hi:[1,0] neg_lo:[0,1] neg_hi:[0,1]
    v_pk_fma_f32 v[22:23], v[18:19], v[18:19], v[22:23]
    v_pk_add_f32 v[18:19], v[12:13], v[20:21] op_sel_hi:[1,0] neg_lo:[0,1] neg_hi:[0,1]
    v_pk_fma_f32 v[22:23], v[18:19], v[18:19], v[22:23]
    v_pk_add_f32 v[18:19], v[14:15], v[20:21] op_sel_hi:[1,0] neg_lo:[0,1] neg_hi:[0,1]
    v_pk_fma_f32 v[22:23], v[18:19], v[18:19], v[22:23]
    s_mov_b32 exec_hi, 0
    v_pk_add_f32 v[18:19], v[16:17], v[20:21] op_sel_hi:[1,0] neg_lo:[0,1] neg_hi:[0,1]
    v_pk_fma_f32 v[22:23], v[18:19], v[18:19], v[22:23]
    s_mov_b64 exec, -1
    v_add_f32 v22, v22, v23
    s_nop 1
    v_add_f32_dpp v22, v22, v22 quad_perm:[1,0,3,2] row_mask:0xf bank_mask:0xf
    s_nop 1
    v_add_f32_dpp v22, v22, v22 quad_perm:[2,3,0,1] row_mask:0xf bank_mask:0xf
    s_nop 1
    v_add_f32_dpp v22, v22, v22 row_ror:4 row_mask:0xf bank_mask:0xf
    s_nop 1
    v_add_f32_dpp v22, v22, v22 row_ror:8 row_mask:0xf bank_mask:0xf
    v_mov_b32 v23, v22
    s_nop 1
    v_permlane16_swap_b32 v22, v23
    v_add_f32 v22, v22, v23
    v_mov_b32 v23, v22
    s_nop 1
    v_permlane32_swap_b32 v22, v23
    v_add_f32 v22, v22, v23
    v_mul_f32 v22, 0x3ae38e39, v22
    v_cvt_pk_bf16_f32 v22, v22, v22
    v_lshlrev_b32 v22, 16, v22
    v_cvt_pk_bf16_f32 v20, v20, v20
    v_lshlrev_b32 v20, 16, v20
    v_add_f32 v22, 0x3727c5ac, v22
    v_cvt_pk_bf16_f32 v22, v22, v22
    v_lshlrev_b32 v22, 16, v22
    v_sqrt_f32 v22, v22
    s_nop 0
    v_cvt_pk_bf16_f32 v22, v22, v22
    v_lshlrev_b32 v22, 16, v22
    v_rcp_f32 v22, v22
    v_pk_add_f32 v[8:9], v[8:9], v[20:21] op_sel_hi:[1,0] neg_lo:[0,1] neg_hi:[0,1]
    v_cvt_pk_bf16_f32 v9, v8, v9
    v_lshlrev_b32 v8, 16, v9
    v_and_b32 v9, 0xffff0000, v9
    v_pk_mul_f32 v[8:9], v[8:9], v[22:23] op_sel_hi:[1,0]
    v_cvt_pk_bf16_f32 v9, v8, v9
    v_lshlrev_b32 v8, 16, v9
    v_and_b32 v9, 0xffff0000, v9
    v_lshlrev_b32 v18, 16, v93
    v_and_b32 v19, 0xffff0000, v93
    v_pk_mul_f32 v[8:9], v[8:9], v[18:19]
    v_cvt_pk_bf16_f32 v9, v8, v9
    v_lshlrev_b32 v8, 16, v9
    v_and_b32 v9, 0xffff0000, v9
    v_lshlrev_b32 v18, 16, v98
    v_and_b32 v19, 0xffff0000, v98
    v_pk_add_f32 v[8:9], v[8:9], v[18:19]
    v_cvt_pk_bf16_f32 v30, v8, v9
    global_store_dword v86, v30, s[38:39] offset:0 sc1
    v_pk_add_f32 v[10:11], v[10:11], v[20:21] op_sel_hi:[1,0] neg_lo:[0,1] neg_hi:[0,1]
    v_cvt_pk_bf16_f32 v11, v10, v11
    v_lshlrev_b32 v10, 16, v11
    v_and_b32 v11, 0xffff0000, v11
    v_pk_mul_f32 v[10:11], v[10:11], v[22:23] op_sel_hi:[1,0]
    v_cvt_pk_bf16_f32 v11, v10, v11
    v_lshlrev_b32 v10, 16, v11
    v_and_b32 v11, 0xffff0000, v11
    v_lshlrev_b32 v18, 16, v94
    v_and_b32 v19, 0xffff0000, v94
    v_pk_mul_f32 v[10:11], v[10:11], v[18:19]
    v_cvt_pk_bf16_f32 v11, v10, v11
    v_lshlrev_b32 v10, 16, v11
    v_and_b32 v11, 0xffff0000, v11
    v_lshlrev_b32 v18, 16, v99
    v_and_b32 v19, 0xffff0000, v99
    v_pk_add_f32 v[10:11], v[10:11], v[18:19]
    v_cvt_pk_bf16_f32 v31, v10, v11
    global_store_dword v86, v31, s[38:39] offset:256 sc1
    v_pk_add_f32 v[12:13], v[12:13], v[20:21] op_sel_hi:[1,0] neg_lo:[0,1] neg_hi:[0,1]
    v_cvt_pk_bf16_f32 v13, v12, v13
    v_lshlrev_b32 v12, 16, v13
    v_and_b32 v13, 0xffff0000, v13
    v_pk_mul_f32 v[12:13], v[12:13], v[22:23] op_sel_hi:[1,0]
    v_cvt_pk_bf16_f32 v13, v12, v13
    v_lshlrev_b32 v12, 16, v13
    v_and_b32 v13, 0xffff0000, v13
    v_lshlrev_b32 v18, 16, v95
    v_and_b32 v19, 0xffff0000, v95
    v_pk_mul_f32 v[12:13], v[12:13], v[18:19]
    v_cvt_pk_bf16_f32 v13, v12, v13
    v_lshlrev_b32 v12, 16, v13
    v_and_b32 v13, 0xffff0000, v13
    v_lshlrev_b32 v18, 16, v100
    v_and_b32 v19, 0xffff0000, v100
    v_pk_add_f32 v[12:13], v[12:13], v[18:19]
    v_cvt_pk_bf16_f32 v32, v12, v13
    global_store_dword v86, v32, s[38:39] offset:512 sc1
    v_pk_add_f32 v[14:15], v[14:15], v[20:21] op_sel_hi:[1,0] neg_lo:[0,1] neg_hi:[0,1]
    v_cvt_pk_bf16_f32 v15, v14, v15
    v_lshlrev_b32 v14, 16, v15
    v_and_b32 v15, 0xffff0000, v15
    v_pk_mul_f32 v[14:15], v[14:15], v[22:23] op_sel_hi:[1,0]
    v_cvt_pk_bf16_f32 v15, v14, v15
    v_lshlrev_b32 v14, 16, v15
    v_and_b32 v15, 0xffff0000, v15
    v_lshlrev_b32 v18, 16, v96
    v_and_b32 v19, 0xffff0000, v96
    v_pk_mul_f32 v[14:15], v[14:15], v[18:19]
    v_cvt_pk_bf16_f32 v15, v14, v15
    v_lshlrev_b32 v14, 16, v15
    v_and_b32 v15, 0xffff0000, v15
    v_lshlrev_b32 v18, 16, v101
    v_and_b32 v19, 0xffff0000, v101
    v_pk_add_f32 v[14:15], v[14:15], v[18:19]
    v_cvt_pk_bf16_f32 v33, v14, v15
    global_store_dword v86, v33, s[38:39] offset:768 sc1
    s_mov_b32 exec_hi, 0
    v_pk_add_f32 v[16:17], v[16:17], v[20:21] op_sel_hi:[1,0] neg_lo:[0,1] neg_hi:[0,1]
    v_cvt_pk_bf16_f32 v17, v16, v17
    v_lshlrev_b32 v16, 16, v17
    v_and_b32 v17, 0xffff0000, v17
    v_pk_mul_f32 v[16:17], v[16:17], v[22:23] op_sel_hi:[1,0]
    v_cvt_pk_bf16_f32 v17, v16, v17
    v_lshlrev_b32 v16, 16, v17
    v_and_b32 v17, 0xffff0000, v17
    v_lshlrev_b32 v18, 16, v97
    v_and_b32 v19, 0xffff0000, v97
    v_pk_mul_f32 v[16:17], v[16:17], v[18:19]
    v_cvt_pk_bf16_f32 v17, v16, v17
    v_lshlrev_b32 v16, 16, v17
    v_and_b32 v17, 0xffff0000, v17
    v_lshlrev_b32 v18, 16, v102
    v_and_b32 v19, 0xffff0000, v102
    v_pk_add_f32 v[16:17], v[16:17], v[18:19]
    v_cvt_pk_bf16_f32 v34, v16, v17
    global_store_dword v86, v34, s[38:39] offset:1024 sc1
    s_mov_b64 exec, 1
    v_mov_b32 v18, 1
    s_waitcnt vmcnt(0)
    global_store_dword v7, v18, s[52:53] sc1
    s_mov_b64 exec, -1
L_a_next_s:
    s_add_u32 s34, s34, 110592
    s_addc_u32 s35, s35, 0
    s_add_u32 s36, s36, 110592
    s_addc_u32 s37, s37, 0
    s_add_u32 s38, s38, 110592
    s_addc_u32 s39, s39, 0
    s_add_u32 s22, s22, 1572864
    s_addc_u32 s23, s23, 0
    s_add_u32 s30, s30, 393216
    s_addc_u32 s31, s31, 0
    s_add_u32 s52, s52, 384
    s_addc_u32 s53, s53, 0
    s_add_u32 s24, s24, 3
    s_cmp_lt_u32 s24, 64
    s_cbranch_scc1 L_a_top_s
    s_branch L_exit
L_code_end:
    s_endpgm
.section .rodata,"a"
.p2align 6
.amdhsa_kernel adaLN_cond__memory_aug_recurrent_mem_tr__swiglu_ffn__prompt_kernel
  .amdhsa_next_free_vgpr 512
  .amdhsa_next_free_sgpr 102
  .amdhsa_accum_offset 256
  .amdhsa_group_segment_fixed_size 0
  .amdhsa_kernarg_size 128
  .amdhsa_user_sgpr_count 2
  .amdhsa_user_sgpr_kernarg_segment_ptr 1
  .amdhsa_system_sgpr_workgroup_id_x 1
  .amdhsa_float_denorm_mode_32 3
.end_amdhsa_kernel
```
